```python
import torch

def _softmax(x, axis=-1):
    return torch.softmax(x, dim=axis)

def _gelu(x):
    return torch.nn.functional.gelu(x, approximate='tanh')

def _silu(x):
    return torch.nn.functional.silu(x)

def _sigmoid(x):
    return torch.sigmoid(x)

def _layernorm(x, axis=-1, eps=1e-05):
    m = x.mean(dim=axis, keepdim=True)
    v = x.var(dim=axis, keepdim=True, unbiased=False)
    return (x - m) / torch.sqrt(v + eps)

def _scatter_add(tgt, idx, src, axis=0):
    return tgt.clone().index_add_(axis, idx, src)

def _segment_sum(src, seg, n):
    out = torch.zeros((n,) + src.shape[1:], dtype=src.dtype)
    return out.index_add_(0, seg, src)

def _pad(x, pw):
    flat = tuple((v for pair in reversed(pw) for v in pair))
    return torch.nn.functional.pad(x, flat)
kernel_name = 'recurrent_scan__memory_aug_recurrent_mem_tr__geglu_ffn__prompt'

def setup_inputs():

    _w = lambda a: (lambda t: t.to(torch.bfloat16) if t.is_floating_point() else t)(torch.as_tensor(a))

    def _A_setup():
        B, S, Dm = (1, 2048, 640)
        H, Dh = (32, 128)
        M, seg = (8, 32)
        seg = min(seg, S)
        S = S // seg * seg
        return {'x': _w((lambda *s: torch.randn(*s, dtype=torch.bfloat16) * 0.05)(B, S, Dm)), 'mem0': _w((lambda *s: torch.randn(*s, dtype=torch.bfloat16) * 0.2)(B, M, Dm)), 'Wq': _w((lambda *s: torch.randn(*s, dtype=torch.bfloat16) * 0.8)(Dm, H, Dh) * Dm ** (-0.5)), 'Wk': _w((lambda *s: torch.randn(*s, dtype=torch.bfloat16) * 0.8)(Dm, H, Dh) * Dm ** (-0.5)), 'Wv': _w((lambda *s: torch.randn(*s, dtype=torch.bfloat16) * 0.2)(Dm, H, Dh) * Dm ** (-0.5)), 'Wo': _w((lambda *s: torch.randn(*s, dtype=torch.bfloat16) * 0.2)(H, Dh, Dm) * (H * Dh) ** (-0.5)), 'seg_len': seg}
    _A_in = _A_setup()

    def _B_setup():
        B, S, D, F = (1, 2048, 640, 1728)
        return {'x': _w((lambda *s: torch.randn(*s, dtype=torch.bfloat16) * 0.05)(B, S, D)), 'w_gate': _w((lambda *s: torch.randn(*s, dtype=torch.bfloat16) * 0.1)(D, F)), 'w_up': _w((lambda *s: torch.randn(*s, dtype=torch.bfloat16) * 0.1)(D, F)), 'w_down': _w((lambda *s: torch.randn(*s, dtype=torch.bfloat16) * 0.1)(F, D))}
    _B_in = _B_setup()
    return {'A_x': _A_in['x'], 'A_mem0': _A_in['mem0'], 'A_Wq': _A_in['Wq'], 'A_Wk': _A_in['Wk'], 'A_Wv': _A_in['Wv'], 'A_Wo': _A_in['Wo'], 'A_seg_len': _A_in['seg_len'], 'B_x': _B_in['x'], 'B_w_gate': _B_in['w_gate'], 'B_w_up': _B_in['w_up'], 'B_w_down': _B_in['w_down']}

def reference(A_x, A_mem0, A_Wq, A_Wk, A_Wv, A_Wo, A_seg_len, B_x, B_w_gate, B_w_up, B_w_down):

    def _A_ref(x, mem0, Wq, Wk, Wv, Wo, seg_len):
        B, S, Dm = x.shape
        H, Dh = (Wq.shape[1], Wq.shape[2])
        M = mem0.shape[1]
        scale = Dh ** (-0.5)
        n_seg = S // seg_len
        L = M + seg_len
        idx = torch.arange(L)
        mask = (idx[:, None] < M) | (idx[:, None] >= idx[None, :])
        mem = mem0
        outs = []
        for s in range(n_seg):
            xs = x[:, s * seg_len:(s + 1) * seg_len, :].clone()
            h = torch.concatenate([mem, xs], axis=1)
            q = torch.einsum('btd,dhe->bhte', h, Wq)
            k = torch.einsum('btd,dhe->bhte', h, Wk)
            v = torch.einsum('btd,dhe->bhte', h, Wv)
            scores = torch.einsum('bhqe,bhke->bhqk', q, k) * scale
            scores = torch.where(mask[None, None], scores, -1000000000.0)
            p = _softmax(scores, axis=-1)
            o = torch.einsum('bhqk,bhke->bhqe', p, v)
            o = torch.einsum('bhte,hed->btd', o, Wo)
            mem = o[:, :M, :].clone()
            outs.append(o[:, M:, :])
        return torch.concatenate(outs, axis=1)

    def _B_ref(x, w_gate, w_up, w_down):
        return _gelu(x @ w_gate) * (x @ w_up) @ w_down
    x = A_x
    xn = _layernorm(x, axis=-1)
    s = _A_ref(xn, A_mem0, A_Wq, A_Wk, A_Wv, A_Wo, A_seg_len)
    g = _silu(_B_ref(xn, B_w_gate, B_w_up, B_w_down))
    return x + s * g
```

```asm
; @launch grid=(256,1,1) block=(256,1,1) lds=163840
.amdgcn_target "amdgcn-amd-amdhsa--gfx950"
.text
.globl recurrent_scan__memory_aug_recurrent_mem_tr__geglu_ffn__prompt_kernel
.p2align 8
.type recurrent_scan__memory_aug_recurrent_mem_tr__geglu_ffn__prompt_kernel,@function
recurrent_scan__memory_aug_recurrent_mem_tr__geglu_ffn__prompt_kernel:
    s_cmp_ge_u32 s2, 256
    s_cbranch_scc1 L_END
    s_load_dwordx16 s[16:31], s[0:1], 0
    s_load_dwordx8 s[32:39], s[0:1], 64
    s_load_dwordx4 s[40:43], s[0:1], 96
    s_getreg_b32 s45, hwreg(HW_REG_XCC_ID)
    s_and_b32 s45, s45, 15
    v_lshrrev_b32 v1, 6, v0
    s_nop 0
    v_readfirstlane_b32 s44, v1
    s_waitcnt lgkmcnt(0)
    s_mov_b32 s4, s42
    s_and_b32 s5, s43, 0xffff
    s_mov_b32 s6, 0x10000000
    s_mov_b32 s7, 0x20000
    s_mov_b32 s48, s40
    s_and_b32 s49, s41, 0xffff
    s_mov_b32 s50, 0x100
    s_mov_b32 s51, 0x20000
    s_cmp_lg_u32 s44, 0
    s_cbranch_scc1 L_WAITROLE
    s_lshl_b32 s62, s2, 7
    v_lshlrev_b32 v1, 4, v0
    v_mov_b32 v4, 0
    v_mov_b32 v5, 0
    v_mov_b32 v6, 0
    v_mov_b32 v7, 0
    s_mov_b64 exec, 1
    v_mov_b32 v2, 1
    v_mov_b32 v8, 1
    s_and_b32 s63, s45, 7
    s_lshl_b32 s63, s63, 5
    v_mov_b32 v3, s63
    buffer_atomic_add v2, v3, s[48:51], 0 offen sc0
    s_mov_b64 exec, 0xff
    buffer_store_dwordx4 v[4:7], v1, s[4:7], s62 offen sc1
    s_mov_b64 exec, 1
    s_cmp_lt_u32 s45, 8
    s_cbranch_scc1 L_XOK
    v_mov_b32 v9, 4
    buffer_atomic_add v8, v9, s[48:51], 0 offen
L_XOK:
    s_and_b32 s45, s45, 7
    s_waitcnt vmcnt(0)
    buffer_atomic_add v8, v3, s[48:51], 0 offen offset:16
    v_readfirstlane_b32 s46, v2
    s_mov_b64 exec, -1
    s_cmp_lt_u32 s46, 32
    s_cbranch_scc1 L_HAVEROLE
    v_and_b32 v1, 7, v0
    v_lshlrev_b32 v1, 5, v1
    v_and_b32 v2, 8, v0
    v_lshl_add_u32 v1, v2, 1, v1
    s_mov_b32 s60, 0
L_tk_1:
    buffer_load_dword v2, v1, s[48:51], 0 offen sc1
    s_waitcnt vmcnt(0)
    v_readlane_b32 s62, v2, 8
    v_readlane_b32 s52, v2, 9
    s_nop 0
    s_add_u32 s62, s62, s52
    v_readlane_b32 s52, v2, 10
    s_nop 0
    s_add_u32 s62, s62, s52
    v_readlane_b32 s52, v2, 11
    s_nop 0
    s_add_u32 s62, s62, s52
    v_readlane_b32 s52, v2, 12
    s_nop 0
    s_add_u32 s62, s62, s52
    v_readlane_b32 s52, v2, 13
    s_nop 0
    s_add_u32 s62, s62, s52
    v_readlane_b32 s52, v2, 14
    s_nop 0
    s_add_u32 s62, s62, s52
    v_readlane_b32 s52, v2, 15
    s_nop 0
    s_add_u32 s62, s62, s52
    s_cmp_ge_u32 s62, 256
    s_cbranch_scc1 L_tkd_2
    s_sleep 2
    s_add_u32 s60, s60, 1
    s_cmp_lt_u32 s60, 0x100000
    s_cbranch_scc1 L_tk_1
    s_movk_i32 s62, 1
    s_branch L_ABORT
L_tkd_2:
    buffer_load_dword v2, v1, s[48:51], 0 offen sc1
    s_waitcnt vmcnt(0)
    v_readlane_b32 s52, v2, 0
    v_readlane_b32 s53, v2, 1
    v_readlane_b32 s54, v2, 2
    v_readlane_b32 s55, v2, 3
    v_readlane_b32 s56, v2, 4
    v_readlane_b32 s57, v2, 5
    v_readlane_b32 s58, v2, 6
    v_readlane_b32 s59, v2, 7
    s_sub_u32 s63, s46, 32
    s_cmp_le_u32 s45, 0
    s_cbranch_scc1 L_ov_3
    s_max_u32 s64, s52, 32
    s_sub_u32 s64, s64, 32
    s_add_u32 s63, s63, s64
L_ov_3:
    s_cmp_le_u32 s45, 1
    s_cbranch_scc1 L_ov_4
    s_max_u32 s64, s53, 32
    s_sub_u32 s64, s64, 32
    s_add_u32 s63, s63, s64
L_ov_4:
    s_cmp_le_u32 s45, 2
    s_cbranch_scc1 L_ov_5
    s_max_u32 s64, s54, 32
    s_sub_u32 s64, s64, 32
    s_add_u32 s63, s63, s64
L_ov_5:
    s_cmp_le_u32 s45, 3
    s_cbranch_scc1 L_ov_6
    s_max_u32 s64, s55, 32
    s_sub_u32 s64, s64, 32
    s_add_u32 s63, s63, s64
L_ov_6:
    s_cmp_le_u32 s45, 4
    s_cbranch_scc1 L_ov_7
    s_max_u32 s64, s56, 32
    s_sub_u32 s64, s64, 32
    s_add_u32 s63, s63, s64
L_ov_7:
    s_cmp_le_u32 s45, 5
    s_cbranch_scc1 L_ov_8
    s_max_u32 s64, s57, 32
    s_sub_u32 s64, s64, 32
    s_add_u32 s63, s63, s64
L_ov_8:
    s_cmp_le_u32 s45, 6
    s_cbranch_scc1 L_ov_9
    s_max_u32 s64, s58, 32
    s_sub_u32 s64, s64, 32
    s_add_u32 s63, s63, s64
L_ov_9:
    s_min_u32 s64, s52, 32
    s_sub_u32 s65, 32, s64
    s_cmp_ge_u32 s63, s65
    s_cbranch_scc1 L_uf_10
    s_movk_i32 s45, 0
    s_add_u32 s46, s64, s63
    s_branch L_HAVEROLE
L_uf_10:
    s_sub_u32 s63, s63, s65
    s_min_u32 s64, s53, 32
    s_sub_u32 s65, 32, s64
    s_cmp_ge_u32 s63, s65
    s_cbranch_scc1 L_uf_11
    s_movk_i32 s45, 1
    s_add_u32 s46, s64, s63
    s_branch L_HAVEROLE
L_uf_11:
    s_sub_u32 s63, s63, s65
    s_min_u32 s64, s54, 32
    s_sub_u32 s65, 32, s64
    s_cmp_ge_u32 s63, s65
    s_cbranch_scc1 L_uf_12
    s_movk_i32 s45, 2
    s_add_u32 s46, s64, s63
    s_branch L_HAVEROLE
L_uf_12:
    s_sub_u32 s63, s63, s65
    s_min_u32 s64, s55, 32
    s_sub_u32 s65, 32, s64
    s_cmp_ge_u32 s63, s65
    s_cbranch_scc1 L_uf_13
    s_movk_i32 s45, 3
    s_add_u32 s46, s64, s63
    s_branch L_HAVEROLE
L_uf_13:
    s_sub_u32 s63, s63, s65
    s_min_u32 s64, s56, 32
    s_sub_u32 s65, 32, s64
    s_cmp_ge_u32 s63, s65
    s_cbranch_scc1 L_uf_14
    s_movk_i32 s45, 4
    s_add_u32 s46, s64, s63
    s_branch L_HAVEROLE
L_uf_14:
    s_sub_u32 s63, s63, s65
    s_min_u32 s64, s57, 32
    s_sub_u32 s65, 32, s64
    s_cmp_ge_u32 s63, s65
    s_cbranch_scc1 L_uf_15
    s_movk_i32 s45, 5
    s_add_u32 s46, s64, s63
    s_branch L_HAVEROLE
L_uf_15:
    s_sub_u32 s63, s63, s65
    s_min_u32 s64, s58, 32
    s_sub_u32 s65, 32, s64
    s_cmp_ge_u32 s63, s65
    s_cbranch_scc1 L_uf_16
    s_movk_i32 s45, 6
    s_add_u32 s46, s64, s63
    s_branch L_HAVEROLE
L_uf_16:
    s_sub_u32 s63, s63, s65
    s_min_u32 s64, s59, 32
    s_sub_u32 s65, 32, s64
    s_cmp_ge_u32 s63, s65
    s_cbranch_scc1 L_uf_17
    s_movk_i32 s45, 7
    s_add_u32 s46, s64, s63
    s_branch L_HAVEROLE
L_uf_17:
    s_sub_u32 s63, s63, s65
    s_movk_i32 s45, 8
L_HAVEROLE:
    s_lshl_b32 s47, s45, 5
    s_add_u32 s47, s47, s46
    v_mov_b32 v1, s47
    v_mov_b32 v2, 0x27ff8
    ds_write_b32 v2, v1
L_WAITROLE:
    s_waitcnt lgkmcnt(0)
    s_barrier
    v_mov_b32 v2, 0x27ff8
    ds_read_b32 v1, v2
    s_waitcnt lgkmcnt(0)
    v_readfirstlane_b32 s47, v1
    s_nop 0
    s_cmp_ge_u32 s47, 256
    s_cbranch_scc1 L_END
    s_lshr_b32 s45, s47, 5
    s_and_b32 s46, s47, 31
    s_cmp_lt_u32 s45, 2
    s_cbranch_scc0 L_NOT_CHAIN
    s_branch L_CHAIN
L_NOT_CHAIN:
    s_cmp_eq_u32 s45, 5
    s_cbranch_scc0 L_NOT_KP
    s_branch L_KP
L_NOT_KP:
    s_cmp_eq_u32 s45, 3
    s_cbranch_scc0 L_NOT_VP
    s_branch L_VP
L_NOT_VP:
    s_cmp_eq_u32 s45, 4
    s_cbranch_scc0 L_NOT_QA
    s_branch L_QA
L_NOT_QA:
    s_cmp_eq_u32 s45, 2
    s_cbranch_scc0 L_NOT_GU
    s_branch L_GU
L_NOT_GU:
    s_sub_u32 s61, s47, 192
    s_mov_b32 s8, s16
    s_and_b32 s9, s17, 0xffff
    s_mov_b32 s10, 0x280000
    s_mov_b32 s11, 0x20000
    v_bfe_u32 v1, v0, 0, 3
    v_mul_u32_u24 v1, 0x500, v1
    v_bfe_u32 v2, v0, 3, 3
    v_lshl_add_u32 v1, v2, 4, v1
    v_bfe_u32 v2, v0, 6, 2
    v_mul_u32_u24 v2, 0x2800, v2
    v_add_u32 v1, v2, v1
    s_mul_i32 s62, s61, 40960
    buffer_load_dwordx4 v[16:19], v1, s[8:11], s62 offen offset:0
    buffer_load_dwordx4 v[20:23], v1, s[8:11], s62 offen offset:128
    buffer_load_dwordx4 v[24:27], v1, s[8:11], s62 offen offset:256
    buffer_load_dwordx4 v[28:31], v1, s[8:11], s62 offen offset:384
    buffer_load_dwordx4 v[32:35], v1, s[8:11], s62 offen offset:512
    buffer_load_dwordx4 v[36:39], v1, s[8:11], s62 offen offset:640
    buffer_load_dwordx4 v[40:43], v1, s[8:11], s62 offen offset:768
    buffer_load_dwordx4 v[44:47], v1, s[8:11], s62 offen offset:896
    buffer_load_dwordx4 v[48:51], v1, s[8:11], s62 offen offset:1024
    buffer_load_dwordx4 v[52:55], v1, s[8:11], s62 offen offset:1152
    v_bfe_u32 v3, v0, 0, 3
    v_lshlrev_b32 v3, 4, v3
    v_bfe_u32 v2, v0, 3, 3
    v_lshl_add_u32 v3, v2, 9, v3
    v_bfe_u32 v2, v0, 6, 2
    v_lshl_add_u32 v3, v2, 7, v3
    v_mov_b32 v4, 0
    v_mov_b32 v5, 0
    s_waitcnt vmcnt(9)
    v_lshlrev_b32 v64, 16, v16
    v_and_b32 v65, 0xffff0000, v16
    v_pk_add_f32 v[4:5], v[4:5], v[64:65]
    v_lshlrev_b32 v66, 16, v17
    v_and_b32 v67, 0xffff0000, v17
    v_pk_add_f32 v[4:5], v[4:5], v[66:67]
    v_lshlrev_b32 v68, 16, v18
    v_and_b32 v69, 0xffff0000, v18
    v_pk_add_f32 v[4:5], v[4:5], v[68:69]
    v_lshlrev_b32 v70, 16, v19
    v_and_b32 v71, 0xffff0000, v19
    v_pk_add_f32 v[4:5], v[4:5], v[70:71]
    s_waitcnt vmcnt(8)
    v_lshlrev_b32 v72, 16, v20
    v_and_b32 v73, 0xffff0000, v20
    v_pk_add_f32 v[4:5], v[4:5], v[72:73]
    v_lshlrev_b32 v74, 16, v21
    v_and_b32 v75, 0xffff0000, v21
    v_pk_add_f32 v[4:5], v[4:5], v[74:75]
    v_lshlrev_b32 v76, 16, v22
    v_and_b32 v77, 0xffff0000, v22
    v_pk_add_f32 v[4:5], v[4:5], v[76:77]
    v_lshlrev_b32 v78, 16, v23
    v_and_b32 v79, 0xffff0000, v23
    v_pk_add_f32 v[4:5], v[4:5], v[78:79]
    s_waitcnt vmcnt(7)
    v_lshlrev_b32 v80, 16, v24
    v_and_b32 v81, 0xffff0000, v24
    v_pk_add_f32 v[4:5], v[4:5], v[80:81]
    v_lshlrev_b32 v82, 16, v25
    v_and_b32 v83, 0xffff0000, v25
    v_pk_add_f32 v[4:5], v[4:5], v[82:83]
    v_lshlrev_b32 v84, 16, v26
    v_and_b32 v85, 0xffff0000, v26
    v_pk_add_f32 v[4:5], v[4:5], v[84:85]
    v_lshlrev_b32 v86, 16, v27
    v_and_b32 v87, 0xffff0000, v27
    v_pk_add_f32 v[4:5], v[4:5], v[86:87]
    s_waitcnt vmcnt(6)
    v_lshlrev_b32 v88, 16, v28
    v_and_b32 v89, 0xffff0000, v28
    v_pk_add_f32 v[4:5], v[4:5], v[88:89]
    v_lshlrev_b32 v90, 16, v29
    v_and_b32 v91, 0xffff0000, v29
    v_pk_add_f32 v[4:5], v[4:5], v[90:91]
    v_lshlrev_b32 v92, 16, v30
    v_and_b32 v93, 0xffff0000, v30
    v_pk_add_f32 v[4:5], v[4:5], v[92:93]
    v_lshlrev_b32 v94, 16, v31
    v_and_b32 v95, 0xffff0000, v31
    v_pk_add_f32 v[4:5], v[4:5], v[94:95]
    s_waitcnt vmcnt(5)
    v_lshlrev_b32 v96, 16, v32
    v_and_b32 v97, 0xffff0000, v32
    v_pk_add_f32 v[4:5], v[4:5], v[96:97]
    v_lshlrev_b32 v98, 16, v33
    v_and_b32 v99, 0xffff0000, v33
    v_pk_add_f32 v[4:5], v[4:5], v[98:99]
    v_lshlrev_b32 v100, 16, v34
    v_and_b32 v101, 0xffff0000, v34
    v_pk_add_f32 v[4:5], v[4:5], v[100:101]
    v_lshlrev_b32 v102, 16, v35
    v_and_b32 v103, 0xffff0000, v35
    v_pk_add_f32 v[4:5], v[4:5], v[102:103]
    s_waitcnt vmcnt(4)
    v_lshlrev_b32 v104, 16, v36
    v_and_b32 v105, 0xffff0000, v36
    v_pk_add_f32 v[4:5], v[4:5], v[104:105]
    v_lshlrev_b32 v106, 16, v37
    v_and_b32 v107, 0xffff0000, v37
    v_pk_add_f32 v[4:5], v[4:5], v[106:107]
    v_lshlrev_b32 v108, 16, v38
    v_and_b32 v109, 0xffff0000, v38
    v_pk_add_f32 v[4:5], v[4:5], v[108:109]
    v_lshlrev_b32 v110, 16, v39
    v_and_b32 v111, 0xffff0000, v39
    v_pk_add_f32 v[4:5], v[4:5], v[110:111]
    s_waitcnt vmcnt(3)
    v_lshlrev_b32 v112, 16, v40
    v_and_b32 v113, 0xffff0000, v40
    v_pk_add_f32 v[4:5], v[4:5], v[112:113]
    v_lshlrev_b32 v114, 16, v41
    v_and_b32 v115, 0xffff0000, v41
    v_pk_add_f32 v[4:5], v[4:5], v[114:115]
    v_lshlrev_b32 v116, 16, v42
    v_and_b32 v117, 0xffff0000, v42
    v_pk_add_f32 v[4:5], v[4:5], v[116:117]
    v_lshlrev_b32 v118, 16, v43
    v_and_b32 v119, 0xffff0000, v43
    v_pk_add_f32 v[4:5], v[4:5], v[118:119]
    s_waitcnt vmcnt(2)
    v_lshlrev_b32 v120, 16, v44
    v_and_b32 v121, 0xffff0000, v44
    v_pk_add_f32 v[4:5], v[4:5], v[120:121]
    v_lshlrev_b32 v122, 16, v45
    v_and_b32 v123, 0xffff0000, v45
    v_pk_add_f32 v[4:5], v[4:5], v[122:123]
    v_lshlrev_b32 v124, 16, v46
    v_and_b32 v125, 0xffff0000, v46
    v_pk_add_f32 v[4:5], v[4:5], v[124:125]
    v_lshlrev_b32 v126, 16, v47
    v_and_b32 v127, 0xffff0000, v47
    v_pk_add_f32 v[4:5], v[4:5], v[126:127]
    s_waitcnt vmcnt(1)
    v_lshlrev_b32 v128, 16, v48
    v_and_b32 v129, 0xffff0000, v48
    v_pk_add_f32 v[4:5], v[4:5], v[128:129]
    v_lshlrev_b32 v130, 16, v49
    v_and_b32 v131, 0xffff0000, v49
    v_pk_add_f32 v[4:5], v[4:5], v[130:131]
    v_lshlrev_b32 v132, 16, v50
    v_and_b32 v133, 0xffff0000, v50
    v_pk_add_f32 v[4:5], v[4:5], v[132:133]
    v_lshlrev_b32 v134, 16, v51
    v_and_b32 v135, 0xffff0000, v51
    v_pk_add_f32 v[4:5], v[4:5], v[134:135]
    s_waitcnt vmcnt(0)
    v_lshlrev_b32 v136, 16, v52
    v_and_b32 v137, 0xffff0000, v52
    v_pk_add_f32 v[4:5], v[4:5], v[136:137]
    v_lshlrev_b32 v138, 16, v53
    v_and_b32 v139, 0xffff0000, v53
    v_pk_add_f32 v[4:5], v[4:5], v[138:139]
    v_lshlrev_b32 v140, 16, v54
    v_and_b32 v141, 0xffff0000, v54
    v_pk_add_f32 v[4:5], v[4:5], v[140:141]
    v_lshlrev_b32 v142, 16, v55
    v_and_b32 v143, 0xffff0000, v55
    v_pk_add_f32 v[4:5], v[4:5], v[142:143]
    v_add_f32 v4, v4, v5
    s_nop 1
    v_add_f32_dpp v4, v4, v4 row_ror:8 row_mask:0xf bank_mask:0xf
    v_mov_b32 v5, v4
    s_nop 1
    v_permlane16_swap_b32 v4, v5
    v_add_f32 v4, v4, v5
    v_mov_b32 v5, v4
    s_nop 1
    v_permlane32_swap_b32 v4, v5
    v_add_f32 v4, v4, v5
    v_mul_f32 v4, 0x3acccccd, v4
    v_mov_b32 v5, v4
    v_mov_b32 v6, 0
    v_mov_b32 v7, 0
    v_pk_add_f32 v[8:9], v[64:65], v[4:5] neg_lo:[0,1] neg_hi:[0,1]
    v_pk_fma_f32 v[6:7], v[8:9], v[8:9], v[6:7]
    v_pk_add_f32 v[8:9], v[66:67], v[4:5] neg_lo:[0,1] neg_hi:[0,1]
    v_pk_fma_f32 v[6:7], v[8:9], v[8:9], v[6:7]
    v_pk_add_f32 v[8:9], v[68:69], v[4:5] neg_lo:[0,1] neg_hi:[0,1]
    v_pk_fma_f32 v[6:7], v[8:9], v[8:9], v[6:7]
    v_pk_add_f32 v[8:9], v[70:71], v[4:5] neg_lo:[0,1] neg_hi:[0,1]
    v_pk_fma_f32 v[6:7], v[8:9], v[8:9], v[6:7]
    v_pk_add_f32 v[8:9], v[72:73], v[4:5] neg_lo:[0,1] neg_hi:[0,1]
    v_pk_fma_f32 v[6:7], v[8:9], v[8:9], v[6:7]
    v_pk_add_f32 v[8:9], v[74:75], v[4:5] neg_lo:[0,1] neg_hi:[0,1]
    v_pk_fma_f32 v[6:7], v[8:9], v[8:9], v[6:7]
    v_pk_add_f32 v[8:9], v[76:77], v[4:5] neg_lo:[0,1] neg_hi:[0,1]
    v_pk_fma_f32 v[6:7], v[8:9], v[8:9], v[6:7]
    v_pk_add_f32 v[8:9], v[78:79], v[4:5] neg_lo:[0,1] neg_hi:[0,1]
    v_pk_fma_f32 v[6:7], v[8:9], v[8:9], v[6:7]
    v_pk_add_f32 v[8:9], v[80:81], v[4:5] neg_lo:[0,1] neg_hi:[0,1]
    v_pk_fma_f32 v[6:7], v[8:9], v[8:9], v[6:7]
    v_pk_add_f32 v[8:9], v[82:83], v[4:5] neg_lo:[0,1] neg_hi:[0,1]
    v_pk_fma_f32 v[6:7], v[8:9], v[8:9], v[6:7]
    v_pk_add_f32 v[8:9], v[84:85], v[4:5] neg_lo:[0,1] neg_hi:[0,1]
    v_pk_fma_f32 v[6:7], v[8:9], v[8:9], v[6:7]
    v_pk_add_f32 v[8:9], v[86:87], v[4:5] neg_lo:[0,1] neg_hi:[0,1]
    v_pk_fma_f32 v[6:7], v[8:9], v[8:9], v[6:7]
    v_pk_add_f32 v[8:9], v[88:89], v[4:5] neg_lo:[0,1] neg_hi:[0,1]
    v_pk_fma_f32 v[6:7], v[8:9], v[8:9], v[6:7]
    v_pk_add_f32 v[8:9], v[90:91], v[4:5] neg_lo:[0,1] neg_hi:[0,1]
    v_pk_fma_f32 v[6:7], v[8:9], v[8:9], v[6:7]
    v_pk_add_f32 v[8:9], v[92:93], v[4:5] neg_lo:[0,1] neg_hi:[0,1]
    v_pk_fma_f32 v[6:7], v[8:9], v[8:9], v[6:7]
    v_pk_add_f32 v[8:9], v[94:95], v[4:5] neg_lo:[0,1] neg_hi:[0,1]
    v_pk_fma_f32 v[6:7], v[8:9], v[8:9], v[6:7]
    v_pk_add_f32 v[8:9], v[96:97], v[4:5] neg_lo:[0,1] neg_hi:[0,1]
    v_pk_fma_f32 v[6:7], v[8:9], v[8:9], v[6:7]
    v_pk_add_f32 v[8:9], v[98:99], v[4:5] neg_lo:[0,1] neg_hi:[0,1]
    v_pk_fma_f32 v[6:7], v[8:9], v[8:9], v[6:7]
    v_pk_add_f32 v[8:9], v[100:101], v[4:5] neg_lo:[0,1] neg_hi:[0,1]
    v_pk_fma_f32 v[6:7], v[8:9], v[8:9], v[6:7]
    v_pk_add_f32 v[8:9], v[102:103], v[4:5] neg_lo:[0,1] neg_hi:[0,1]
    v_pk_fma_f32 v[6:7], v[8:9], v[8:9], v[6:7]
    v_pk_add_f32 v[8:9], v[104:105], v[4:5] neg_lo:[0,1] neg_hi:[0,1]
    v_pk_fma_f32 v[6:7], v[8:9], v[8:9], v[6:7]
    v_pk_add_f32 v[8:9], v[106:107], v[4:5] neg_lo:[0,1] neg_hi:[0,1]
    v_pk_fma_f32 v[6:7], v[8:9], v[8:9], v[6:7]
    v_pk_add_f32 v[8:9], v[108:109], v[4:5] neg_lo:[0,1] neg_hi:[0,1]
    v_pk_fma_f32 v[6:7], v[8:9], v[8:9], v[6:7]
    v_pk_add_f32 v[8:9], v[110:111], v[4:5] neg_lo:[0,1] neg_hi:[0,1]
    v_pk_fma_f32 v[6:7], v[8:9], v[8:9], v[6:7]
    v_pk_add_f32 v[8:9], v[112:113], v[4:5] neg_lo:[0,1] neg_hi:[0,1]
    v_pk_fma_f32 v[6:7], v[8:9], v[8:9], v[6:7]
    v_pk_add_f32 v[8:9], v[114:115], v[4:5] neg_lo:[0,1] neg_hi:[0,1]
    v_pk_fma_f32 v[6:7], v[8:9], v[8:9], v[6:7]
    v_pk_add_f32 v[8:9], v[116:117], v[4:5] neg_lo:[0,1] neg_hi:[0,1]
    v_pk_fma_f32 v[6:7], v[8:9], v[8:9], v[6:7]
    v_pk_add_f32 v[8:9], v[118:119], v[4:5] neg_lo:[0,1] neg_hi:[0,1]
    v_pk_fma_f32 v[6:7], v[8:9], v[8:9], v[6:7]
    v_pk_add_f32 v[8:9], v[120:121], v[4:5] neg_lo:[0,1] neg_hi:[0,1]
    v_pk_fma_f32 v[6:7], v[8:9], v[8:9], v[6:7]
    v_pk_add_f32 v[8:9], v[122:123], v[4:5] neg_lo:[0,1] neg_hi:[0,1]
    v_pk_fma_f32 v[6:7], v[8:9], v[8:9], v[6:7]
    v_pk_add_f32 v[8:9], v[124:125], v[4:5] neg_lo:[0,1] neg_hi:[0,1]
    v_pk_fma_f32 v[6:7], v[8:9], v[8:9], v[6:7]
    v_pk_add_f32 v[8:9], v[126:127], v[4:5] neg_lo:[0,1] neg_hi:[0,1]
    v_pk_fma_f32 v[6:7], v[8:9], v[8:9], v[6:7]
    v_pk_add_f32 v[8:9], v[128:129], v[4:5] neg_lo:[0,1] neg_hi:[0,1]
    v_pk_fma_f32 v[6:7], v[8:9], v[8:9], v[6:7]
    v_pk_add_f32 v[8:9], v[130:131], v[4:5] neg_lo:[0,1] neg_hi:[0,1]
    v_pk_fma_f32 v[6:7], v[8:9], v[8:9], v[6:7]
    v_pk_add_f32 v[8:9], v[132:133], v[4:5] neg_lo:[0,1] neg_hi:[0,1]
    v_pk_fma_f32 v[6:7], v[8:9], v[8:9], v[6:7]
    v_pk_add_f32 v[8:9], v[134:135], v[4:5] neg_lo:[0,1] neg_hi:[0,1]
    v_pk_fma_f32 v[6:7], v[8:9], v[8:9], v[6:7]
    v_pk_add_f32 v[8:9], v[136:137], v[4:5] neg_lo:[0,1] neg_hi:[0,1]
    v_pk_fma_f32 v[6:7], v[8:9], v[8:9], v[6:7]
    v_pk_add_f32 v[8:9], v[138:139], v[4:5] neg_lo:[0,1] neg_hi:[0,1]
    v_pk_fma_f32 v[6:7], v[8:9], v[8:9], v[6:7]
    v_pk_add_f32 v[8:9], v[140:141], v[4:5] neg_lo:[0,1] neg_hi:[0,1]
    v_pk_fma_f32 v[6:7], v[8:9], v[8:9], v[6:7]
    v_pk_add_f32 v[8:9], v[142:143], v[4:5] neg_lo:[0,1] neg_hi:[0,1]
    v_pk_fma_f32 v[6:7], v[8:9], v[8:9], v[6:7]
    v_add_f32 v6, v6, v7
    s_nop 1
    v_add_f32_dpp v6, v6, v6 row_ror:8 row_mask:0xf bank_mask:0xf
    v_mov_b32 v7, v6
    s_nop 1
    v_permlane16_swap_b32 v6, v7
    v_add_f32 v6, v6, v7
    v_mov_b32 v7, v6
    s_nop 1
    v_permlane32_swap_b32 v6, v7
    v_add_f32 v6, v6, v7
    v_mul_f32 v6, 0x3acccccd, v6
    v_cvt_pk_bf16_f32 v4, v4, v6
    v_and_b32 v6, 0xffff0000, v4
    v_lshlrev_b32 v4, 16, v4
    v_mov_b32 v5, v4
    v_add_f32 v6, 0x3727c5ac, v6
    v_cvt_pk_bf16_f32 v6, v6, v6
    v_and_b32 v6, 0xffff0000, v6
    v_sqrt_f32 v6, v6
    s_nop 0
    v_cvt_pk_bf16_f32 v6, v6, v6
    v_and_b32 v6, 0xffff0000, v6
    v_rcp_f32 v6, v6
    s_nop 0
    v_mov_b32 v7, v6
    s_mul_i32 s62, s61, 40960
    s_add_u32 s62, s62, 0x100000
    v_pk_add_f32 v[64:65], v[64:65], v[4:5] neg_lo:[0,1] neg_hi:[0,1]
    v_cvt_pk_bf16_f32 v8, v64, v65
    v_lshlrev_b32 v64, 16, v8
    v_and_b32 v65, 0xffff0000, v8
    v_pk_mul_f32 v[64:65], v[64:65], v[6:7]
    v_cvt_pk_bf16_f32 v16, v64, v65
    v_pk_add_f32 v[66:67], v[66:67], v[4:5] neg_lo:[0,1] neg_hi:[0,1]
    v_cvt_pk_bf16_f32 v8, v66, v67
    v_lshlrev_b32 v66, 16, v8
    v_and_b32 v67, 0xffff0000, v8
    v_pk_mul_f32 v[66:67], v[66:67], v[6:7]
    v_cvt_pk_bf16_f32 v17, v66, v67
    v_pk_add_f32 v[68:69], v[68:69], v[4:5] neg_lo:[0,1] neg_hi:[0,1]
    v_cvt_pk_bf16_f32 v8, v68, v69
    v_lshlrev_b32 v68, 16, v8
    v_and_b32 v69, 0xffff0000, v8
    v_pk_mul_f32 v[68:69], v[68:69], v[6:7]
    v_cvt_pk_bf16_f32 v18, v68, v69
    v_pk_add_f32 v[70:71], v[70:71], v[4:5] neg_lo:[0,1] neg_hi:[0,1]
    v_cvt_pk_bf16_f32 v8, v70, v71
    v_lshlrev_b32 v70, 16, v8
    v_and_b32 v71, 0xffff0000, v8
    v_pk_mul_f32 v[70:71], v[70:71], v[6:7]
    v_cvt_pk_bf16_f32 v19, v70, v71
    buffer_store_dwordx4 v[16:19], v3, s[4:7], s62 offen sc1
    s_add_u32 s62, s62, 4096
    v_pk_add_f32 v[72:73], v[72:73], v[4:5] neg_lo:[0,1] neg_hi:[0,1]
    v_cvt_pk_bf16_f32 v8, v72, v73
    v_lshlrev_b32 v72, 16, v8
    v_and_b32 v73, 0xffff0000, v8
    v_pk_mul_f32 v[72:73], v[72:73], v[6:7]
    v_cvt_pk_bf16_f32 v20, v72, v73
    v_pk_add_f32 v[74:75], v[74:75], v[4:5] neg_lo:[0,1] neg_hi:[0,1]
    v_cvt_pk_bf16_f32 v8, v74, v75
    v_lshlrev_b32 v74, 16, v8
    v_and_b32 v75, 0xffff0000, v8
    v_pk_mul_f32 v[74:75], v[74:75], v[6:7]
    v_cvt_pk_bf16_f32 v21, v74, v75
    v_pk_add_f32 v[76:77], v[76:77], v[4:5] neg_lo:[0,1] neg_hi:[0,1]
    v_cvt_pk_bf16_f32 v8, v76, v77
    v_lshlrev_b32 v76, 16, v8
    v_and_b32 v77, 0xffff0000, v8
    v_pk_mul_f32 v[76:77], v[76:77], v[6:7]
    v_cvt_pk_bf16_f32 v22, v76, v77
    v_pk_add_f32 v[78:79], v[78:79], v[4:5] neg_lo:[0,1] neg_hi:[0,1]
    v_cvt_pk_bf16_f32 v8, v78, v79
    v_lshlrev_b32 v78, 16, v8
    v_and_b32 v79, 0xffff0000, v8
    v_pk_mul_f32 v[78:79], v[78:79], v[6:7]
    v_cvt_pk_bf16_f32 v23, v78, v79
    buffer_store_dwordx4 v[20:23], v3, s[4:7], s62 offen sc1
    s_add_u32 s62, s62, 4096
    v_pk_add_f32 v[80:81], v[80:81], v[4:5] neg_lo:[0,1] neg_hi:[0,1]
    v_cvt_pk_bf16_f32 v8, v80, v81
    v_lshlrev_b32 v80, 16, v8
    v_and_b32 v81, 0xffff0000, v8
    v_pk_mul_f32 v[80:81], v[80:81], v[6:7]
    v_cvt_pk_bf16_f32 v24, v80, v81
    v_pk_add_f32 v[82:83], v[82:83], v[4:5] neg_lo:[0,1] neg_hi:[0,1]
    v_cvt_pk_bf16_f32 v8, v82, v83
    v_lshlrev_b32 v82, 16, v8
    v_and_b32 v83, 0xffff0000, v8
    v_pk_mul_f32 v[82:83], v[82:83], v[6:7]
    v_cvt_pk_bf16_f32 v25, v82, v83
    v_pk_add_f32 v[84:85], v[84:85], v[4:5] neg_lo:[0,1] neg_hi:[0,1]
    v_cvt_pk_bf16_f32 v8, v84, v85
    v_lshlrev_b32 v84, 16, v8
    v_and_b32 v85, 0xffff0000, v8
    v_pk_mul_f32 v[84:85], v[84:85], v[6:7]
    v_cvt_pk_bf16_f32 v26, v84, v85
    v_pk_add_f32 v[86:87], v[86:87], v[4:5] neg_lo:[0,1] neg_hi:[0,1]
    v_cvt_pk_bf16_f32 v8, v86, v87
    v_lshlrev_b32 v86, 16, v8
    v_and_b32 v87, 0xffff0000, v8
    v_pk_mul_f32 v[86:87], v[86:87], v[6:7]
    v_cvt_pk_bf16_f32 v27, v86, v87
    buffer_store_dwordx4 v[24:27], v3, s[4:7], s62 offen sc1
    s_add_u32 s62, s62, 4096
    v_pk_add_f32 v[88:89], v[88:89], v[4:5] neg_lo:[0,1] neg_hi:[0,1]
    v_cvt_pk_bf16_f32 v8, v88, v89
    v_lshlrev_b32 v88, 16, v8
    v_and_b32 v89, 0xffff0000, v8
    v_pk_mul_f32 v[88:89], v[88:89], v[6:7]
    v_cvt_pk_bf16_f32 v28, v88, v89
    v_pk_add_f32 v[90:91], v[90:91], v[4:5] neg_lo:[0,1] neg_hi:[0,1]
    v_cvt_pk_bf16_f32 v8, v90, v91
    v_lshlrev_b32 v90, 16, v8
    v_and_b32 v91, 0xffff0000, v8
    v_pk_mul_f32 v[90:91], v[90:91], v[6:7]
    v_cvt_pk_bf16_f32 v29, v90, v91
    v_pk_add_f32 v[92:93], v[92:93], v[4:5] neg_lo:[0,1] neg_hi:[0,1]
    v_cvt_pk_bf16_f32 v8, v92, v93
    v_lshlrev_b32 v92, 16, v8
    v_and_b32 v93, 0xffff0000, v8
    v_pk_mul_f32 v[92:93], v[92:93], v[6:7]
    v_cvt_pk_bf16_f32 v30, v92, v93
    v_pk_add_f32 v[94:95], v[94:95], v[4:5] neg_lo:[0,1] neg_hi:[0,1]
    v_cvt_pk_bf16_f32 v8, v94, v95
    v_lshlrev_b32 v94, 16, v8
    v_and_b32 v95, 0xffff0000, v8
    v_pk_mul_f32 v[94:95], v[94:95], v[6:7]
    v_cvt_pk_bf16_f32 v31, v94, v95
    buffer_store_dwordx4 v[28:31], v3, s[4:7], s62 offen sc1
    s_add_u32 s62, s62, 4096
    v_pk_add_f32 v[96:97], v[96:97], v[4:5] neg_lo:[0,1] neg_hi:[0,1]
    v_cvt_pk_bf16_f32 v8, v96, v97
    v_lshlrev_b32 v96, 16, v8
    v_and_b32 v97, 0xffff0000, v8
    v_pk_mul_f32 v[96:97], v[96:97], v[6:7]
    v_cvt_pk_bf16_f32 v32, v96, v97
    v_pk_add_f32 v[98:99], v[98:99], v[4:5] neg_lo:[0,1] neg_hi:[0,1]
    v_cvt_pk_bf16_f32 v8, v98, v99
    v_lshlrev_b32 v98, 16, v8
    v_and_b32 v99, 0xffff0000, v8
    v_pk_mul_f32 v[98:99], v[98:99], v[6:7]
    v_cvt_pk_bf16_f32 v33, v98, v99
    v_pk_add_f32 v[100:101], v[100:101], v[4:5] neg_lo:[0,1] neg_hi:[0,1]
    v_cvt_pk_bf16_f32 v8, v100, v101
    v_lshlrev_b32 v100, 16, v8
    v_and_b32 v101, 0xffff0000, v8
    v_pk_mul_f32 v[100:101], v[100:101], v[6:7]
    v_cvt_pk_bf16_f32 v34, v100, v101
    v_pk_add_f32 v[102:103], v[102:103], v[4:5] neg_lo:[0,1] neg_hi:[0,1]
    v_cvt_pk_bf16_f32 v8, v102, v103
    v_lshlrev_b32 v102, 16, v8
    v_and_b32 v103, 0xffff0000, v8
    v_pk_mul_f32 v[102:103], v[102:103], v[6:7]
    v_cvt_pk_bf16_f32 v35, v102, v103
    buffer_store_dwordx4 v[32:35], v3, s[4:7], s62 offen sc1
    s_add_u32 s62, s62, 4096
    v_pk_add_f32 v[104:105], v[104:105], v[4:5] neg_lo:[0,1] neg_hi:[0,1]
    v_cvt_pk_bf16_f32 v8, v104, v105
    v_lshlrev_b32 v104, 16, v8
    v_and_b32 v105, 0xffff0000, v8
    v_pk_mul_f32 v[104:105], v[104:105], v[6:7]
    v_cvt_pk_bf16_f32 v36, v104, v105
    v_pk_add_f32 v[106:107], v[106:107], v[4:5] neg_lo:[0,1] neg_hi:[0,1]
    v_cvt_pk_bf16_f32 v8, v106, v107
    v_lshlrev_b32 v106, 16, v8
    v_and_b32 v107, 0xffff0000, v8
    v_pk_mul_f32 v[106:107], v[106:107], v[6:7]
    v_cvt_pk_bf16_f32 v37, v106, v107
    v_pk_add_f32 v[108:109], v[108:109], v[4:5] neg_lo:[0,1] neg_hi:[0,1]
    v_cvt_pk_bf16_f32 v8, v108, v109
    v_lshlrev_b32 v108, 16, v8
    v_and_b32 v109, 0xffff0000, v8
    v_pk_mul_f32 v[108:109], v[108:109], v[6:7]
    v_cvt_pk_bf16_f32 v38, v108, v109
    v_pk_add_f32 v[110:111], v[110:111], v[4:5] neg_lo:[0,1] neg_hi:[0,1]
    v_cvt_pk_bf16_f32 v8, v110, v111
    v_lshlrev_b32 v110, 16, v8
    v_and_b32 v111, 0xffff0000, v8
    v_pk_mul_f32 v[110:111], v[110:111], v[6:7]
    v_cvt_pk_bf16_f32 v39, v110, v111
    buffer_store_dwordx4 v[36:39], v3, s[4:7], s62 offen sc1
    s_add_u32 s62, s62, 4096
    v_pk_add_f32 v[112:113], v[112:113], v[4:5] neg_lo:[0,1] neg_hi:[0,1]
    v_cvt_pk_bf16_f32 v8, v112, v113
    v_lshlrev_b32 v112, 16, v8
    v_and_b32 v113, 0xffff0000, v8
    v_pk_mul_f32 v[112:113], v[112:113], v[6:7]
    v_cvt_pk_bf16_f32 v40, v112, v113
    v_pk_add_f32 v[114:115], v[114:115], v[4:5] neg_lo:[0,1] neg_hi:[0,1]
    v_cvt_pk_bf16_f32 v8, v114, v115
    v_lshlrev_b32 v114, 16, v8
    v_and_b32 v115, 0xffff0000, v8
    v_pk_mul_f32 v[114:115], v[114:115], v[6:7]
    v_cvt_pk_bf16_f32 v41, v114, v115
    v_pk_add_f32 v[116:117], v[116:117], v[4:5] neg_lo:[0,1] neg_hi:[0,1]
    v_cvt_pk_bf16_f32 v8, v116, v117
    v_lshlrev_b32 v116, 16, v8
    v_and_b32 v117, 0xffff0000, v8
    v_pk_mul_f32 v[116:117], v[116:117], v[6:7]
    v_cvt_pk_bf16_f32 v42, v116, v117
    v_pk_add_f32 v[118:119], v[118:119], v[4:5] neg_lo:[0,1] neg_hi:[0,1]
    v_cvt_pk_bf16_f32 v8, v118, v119
    v_lshlrev_b32 v118, 16, v8
    v_and_b32 v119, 0xffff0000, v8
    v_pk_mul_f32 v[118:119], v[118:119], v[6:7]
    v_cvt_pk_bf16_f32 v43, v118, v119
    buffer_store_dwordx4 v[40:43], v3, s[4:7], s62 offen sc1
    s_add_u32 s62, s62, 4096
    v_pk_add_f32 v[120:121], v[120:121], v[4:5] neg_lo:[0,1] neg_hi:[0,1]
    v_cvt_pk_bf16_f32 v8, v120, v121
    v_lshlrev_b32 v120, 16, v8
    v_and_b32 v121, 0xffff0000, v8
    v_pk_mul_f32 v[120:121], v[120:121], v[6:7]
    v_cvt_pk_bf16_f32 v44, v120, v121
    v_pk_add_f32 v[122:123], v[122:123], v[4:5] neg_lo:[0,1] neg_hi:[0,1]
    v_cvt_pk_bf16_f32 v8, v122, v123
    v_lshlrev_b32 v122, 16, v8
    v_and_b32 v123, 0xffff0000, v8
    v_pk_mul_f32 v[122:123], v[122:123], v[6:7]
    v_cvt_pk_bf16_f32 v45, v122, v123
    v_pk_add_f32 v[124:125], v[124:125], v[4:5] neg_lo:[0,1] neg_hi:[0,1]
    v_cvt_pk_bf16_f32 v8, v124, v125
    v_lshlrev_b32 v124, 16, v8
    v_and_b32 v125, 0xffff0000, v8
    v_pk_mul_f32 v[124:125], v[124:125], v[6:7]
    v_cvt_pk_bf16_f32 v46, v124, v125
    v_pk_add_f32 v[126:127], v[126:127], v[4:5] neg_lo:[0,1] neg_hi:[0,1]
    v_cvt_pk_bf16_f32 v8, v126, v127
    v_lshlrev_b32 v126, 16, v8
    v_and_b32 v127, 0xffff0000, v8
    v_pk_mul_f32 v[126:127], v[126:127], v[6:7]
    v_cvt_pk_bf16_f32 v47, v126, v127
    buffer_store_dwordx4 v[44:47], v3, s[4:7], s62 offen sc1
    s_add_u32 s62, s62, 4096
    v_pk_add_f32 v[128:129], v[128:129], v[4:5] neg_lo:[0,1] neg_hi:[0,1]
    v_cvt_pk_bf16_f32 v8, v128, v129
    v_lshlrev_b32 v128, 16, v8
    v_and_b32 v129, 0xffff0000, v8
    v_pk_mul_f32 v[128:129], v[128:129], v[6:7]
    v_cvt_pk_bf16_f32 v48, v128, v129
    v_pk_add_f32 v[130:131], v[130:131], v[4:5] neg_lo:[0,1] neg_hi:[0,1]
    v_cvt_pk_bf16_f32 v8, v130, v131
    v_lshlrev_b32 v130, 16, v8
    v_and_b32 v131, 0xffff0000, v8
    v_pk_mul_f32 v[130:131], v[130:131], v[6:7]
    v_cvt_pk_bf16_f32 v49, v130, v131
    v_pk_add_f32 v[132:133], v[132:133], v[4:5] neg_lo:[0,1] neg_hi:[0,1]
    v_cvt_pk_bf16_f32 v8, v132, v133
    v_lshlrev_b32 v132, 16, v8
    v_and_b32 v133, 0xffff0000, v8
    v_pk_mul_f32 v[132:133], v[132:133], v[6:7]
    v_cvt_pk_bf16_f32 v50, v132, v133
    v_pk_add_f32 v[134:135], v[134:135], v[4:5] neg_lo:[0,1] neg_hi:[0,1]
    v_cvt_pk_bf16_f32 v8, v134, v135
    v_lshlrev_b32 v134, 16, v8
    v_and_b32 v135, 0xffff0000, v8
    v_pk_mul_f32 v[134:135], v[134:135], v[6:7]
    v_cvt_pk_bf16_f32 v51, v134, v135
    buffer_store_dwordx4 v[48:51], v3, s[4:7], s62 offen sc1
    s_add_u32 s62, s62, 4096
    v_pk_add_f32 v[136:137], v[136:137], v[4:5] neg_lo:[0,1] neg_hi:[0,1]
    v_cvt_pk_bf16_f32 v8, v136, v137
    v_lshlrev_b32 v136, 16, v8
    v_and_b32 v137, 0xffff0000, v8
    v_pk_mul_f32 v[136:137], v[136:137], v[6:7]
    v_cvt_pk_bf16_f32 v52, v136, v137
    v_pk_add_f32 v[138:139], v[138:139], v[4:5] neg_lo:[0,1] neg_hi:[0,1]
    v_cvt_pk_bf16_f32 v8, v138, v139
    v_lshlrev_b32 v138, 16, v8
    v_and_b32 v139, 0xffff0000, v8
    v_pk_mul_f32 v[138:139], v[138:139], v[6:7]
    v_cvt_pk_bf16_f32 v53, v138, v139
    v_pk_add_f32 v[140:141], v[140:141], v[4:5] neg_lo:[0,1] neg_hi:[0,1]
    v_cvt_pk_bf16_f32 v8, v140, v141
    v_lshlrev_b32 v140, 16, v8
    v_and_b32 v141, 0xffff0000, v8
    v_pk_mul_f32 v[140:141], v[140:141], v[6:7]
    v_cvt_pk_bf16_f32 v54, v140, v141
    v_pk_add_f32 v[142:143], v[142:143], v[4:5] neg_lo:[0,1] neg_hi:[0,1]
    v_cvt_pk_bf16_f32 v8, v142, v143
    v_lshlrev_b32 v142, 16, v8
    v_and_b32 v143, 0xffff0000, v8
    v_pk_mul_f32 v[142:143], v[142:143], v[6:7]
    v_cvt_pk_bf16_f32 v55, v142, v143
    buffer_store_dwordx4 v[52:55], v3, s[4:7], s62 offen sc1
    s_add_u32 s62, s62, 4096
    v_and_b32 v1, 7, v0
    v_lshlrev_b32 v1, 5, v1
    v_and_b32 v2, 8, v0
    v_lshl_add_u32 v1, v2, 1, v1
    s_mov_b32 s60, 0
L_tk_18:
    buffer_load_dword v2, v1, s[48:51], 0 offen sc1
    s_waitcnt vmcnt(0)
    v_readlane_b32 s62, v2, 8
    v_readlane_b32 s52, v2, 9
    s_nop 0
    s_add_u32 s62, s62, s52
    v_readlane_b32 s52, v2, 10
    s_nop 0
    s_add_u32 s62, s62, s52
    v_readlane_b32 s52, v2, 11
    s_nop 0
    s_add_u32 s62, s62, s52
    v_readlane_b32 s52, v2, 12
    s_nop 0
    s_add_u32 s62, s62, s52
    v_readlane_b32 s52, v2, 13
    s_nop 0
    s_add_u32 s62, s62, s52
    v_readlane_b32 s52, v2, 14
    s_nop 0
    s_add_u32 s62, s62, s52
    v_readlane_b32 s52, v2, 15
    s_nop 0
    s_add_u32 s62, s62, s52
    s_cmp_ge_u32 s62, 256
    s_cbranch_scc1 L_tkd_19
    s_sleep 2
    s_add_u32 s60, s60, 1
    s_cmp_lt_u32 s60, 0x100000
    s_cbranch_scc1 L_tk_18
    s_movk_i32 s62, 1
    s_branch L_ABORT
L_tkd_19:
    s_barrier
    s_cmp_lg_u32 s44, 0
    s_cbranch_scc1 L_LN_DONE
    s_lshl_b32 s62, s61, 6
    v_mov_b32 v1, 0
    v_mov_b32 v2, 1
    s_mov_b64 exec, 1
    buffer_store_dword v2, v1, s[4:7], s62 offen sc1
    s_mov_b64 exec, -1
L_LN_DONE:
    s_cmp_lt_u32 s46, 20
    s_cbranch_scc0 L_NOT_OP
    s_branch L_OP
L_NOT_OP:
    s_cmp_lt_u32 s46, 30
    s_cbranch_scc0 L_END
    s_cmp_eq_u32 s45, 6
    s_cbranch_scc0 L_NOT_DP
    s_branch L_DP
L_NOT_DP:
    s_branch L_CB
L_ABORT:
    s_mov_b64 exec, 1
    v_mov_b32 v1, 8
    v_mov_b32 v2, s62
    buffer_store_dword v2, v1, s[48:51], 0 offen sc1
    s_endpgm
L_END2:
L_END:
    s_endpgm
L_CHAIN:
    s_mov_b32 s70, s45
    v_bfe_u32 v12, v0, 0, 4
    v_lshlrev_b32 v12, 4, v12
    v_bfe_u32 v31, v0, 4, 1
    v_lshlrev_b32 v31, 5, v31
    v_xor_b32 v12, v12, v31
    v_bfe_u32 v31, v0, 4, 2
    v_lshlrev_b32 v31, 13, v31
    v_bfe_u32 v30, v0, 6, 2
    v_lshl_add_u32 v31, v30, 17, v31
    v_add_u32 v12, v12, v31
    v_bfe_u32 v16, v0, 0, 4
    v_lshlrev_b32 v16, 4, v16
    v_bfe_u32 v31, v0, 4, 1
    v_lshlrev_b32 v31, 5, v31
    v_xor_b32 v16, v16, v31
    v_bfe_u32 v31, v0, 4, 2
    v_mul_u32_u24 v31, 0x500, v31
    v_bfe_u32 v30, v0, 6, 2
    v_mul_u32_u24 v30, 0x5000, v30
    v_add_u32 v31, v30, v31
    v_add_u32 v16, v16, v31
    v_bfe_u32 v13, v0, 0, 4
    v_lshlrev_b32 v13, 4, v13
    v_bfe_u32 v31, v0, 4, 1
    v_lshlrev_b32 v31, 5, v31
    v_add_u32 v31, 0x40, v31
    v_xor_b32 v13, v13, v31
    v_bfe_u32 v31, v0, 4, 2
    v_lshlrev_b32 v31, 13, v31
    v_bfe_u32 v30, v0, 6, 2
    v_lshl_add_u32 v31, v30, 17, v31
    v_add_u32 v31, 0x8000, v31
    v_add_u32 v13, v13, v31
    v_bfe_u32 v17, v0, 0, 4
    v_lshlrev_b32 v17, 4, v17
    v_bfe_u32 v31, v0, 4, 1
    v_lshlrev_b32 v31, 5, v31
    v_add_u32 v31, 0x40, v31
    v_xor_b32 v17, v17, v31
    v_bfe_u32 v31, v0, 4, 2
    v_mul_u32_u24 v31, 0x500, v31
    v_bfe_u32 v30, v0, 6, 2
    v_mul_u32_u24 v30, 0x5000, v30
    v_add_u32 v31, v30, v31
    v_add_u32 v31, 0x1400, v31
    v_add_u32 v17, v17, v31
    v_bfe_u32 v14, v0, 0, 4
    v_lshlrev_b32 v14, 4, v14
    v_bfe_u32 v31, v0, 4, 1
    v_lshlrev_b32 v31, 5, v31
    v_add_u32 v31, 0x80, v31
    v_xor_b32 v14, v14, v31
    v_bfe_u32 v31, v0, 4, 2
    v_lshlrev_b32 v31, 13, v31
    v_bfe_u32 v30, v0, 6, 2
    v_lshl_add_u32 v31, v30, 17, v31
    v_add_u32 v31, 0x10000, v31
    v_add_u32 v14, v14, v31
    v_bfe_u32 v18, v0, 0, 4
    v_lshlrev_b32 v18, 4, v18
    v_bfe_u32 v31, v0, 4, 1
    v_lshlrev_b32 v31, 5, v31
    v_add_u32 v31, 0x80, v31
    v_xor_b32 v18, v18, v31
    v_bfe_u32 v31, v0, 4, 2
    v_mul_u32_u24 v31, 0x500, v31
    v_bfe_u32 v30, v0, 6, 2
    v_mul_u32_u24 v30, 0x5000, v30
    v_add_u32 v31, v30, v31
    v_add_u32 v31, 0x2800, v31
    v_add_u32 v18, v18, v31
    v_bfe_u32 v15, v0, 0, 4
    v_lshlrev_b32 v15, 4, v15
    v_bfe_u32 v31, v0, 4, 1
    v_lshlrev_b32 v31, 5, v31
    v_add_u32 v31, 0xc0, v31
    v_xor_b32 v15, v15, v31
    v_bfe_u32 v31, v0, 4, 2
    v_lshlrev_b32 v31, 13, v31
    v_bfe_u32 v30, v0, 6, 2
    v_lshl_add_u32 v31, v30, 17, v31
    v_add_u32 v31, 0x18000, v31
    v_add_u32 v15, v15, v31
    v_bfe_u32 v19, v0, 0, 4
    v_lshlrev_b32 v19, 4, v19
    v_bfe_u32 v31, v0, 4, 1
    v_lshlrev_b32 v31, 5, v31
    v_add_u32 v31, 0xc0, v31
    v_xor_b32 v19, v19, v31
    v_bfe_u32 v31, v0, 4, 2
    v_mul_u32_u24 v31, 0x500, v31
    v_bfe_u32 v30, v0, 6, 2
    v_mul_u32_u24 v30, 0x5000, v30
    v_add_u32 v31, v30, v31
    v_add_u32 v31, 0x3c00, v31
    v_add_u32 v19, v19, v31
    v_bfe_u32 v20, v0, 0, 3
    v_lshlrev_b32 v20, 4, v20
    v_bfe_u32 v31, v0, 5, 1
    v_lshlrev_b32 v31, 5, v31
    v_xor_b32 v20, v20, v31
    v_bfe_u32 v31, v0, 3, 3
    v_mul_u32_u24 v31, 0x500, v31
    v_bfe_u32 v30, v0, 6, 2
    v_mul_u32_u24 v30, 0xa000, v30
    v_add_u32 v31, v30, v31
    v_add_u32 v20, v20, v31
    v_bfe_u32 v21, v0, 0, 3
    v_lshlrev_b32 v21, 4, v21
    v_bfe_u32 v31, v0, 5, 1
    v_lshlrev_b32 v31, 5, v31
    v_add_u32 v31, 0x40, v31
    v_xor_b32 v21, v21, v31
    v_bfe_u32 v31, v0, 3, 3
    v_mul_u32_u24 v31, 0x500, v31
    v_bfe_u32 v30, v0, 6, 2
    v_mul_u32_u24 v30, 0xa000, v30
    v_add_u32 v31, v30, v31
    v_add_u32 v31, 0x2800, v31
    v_add_u32 v21, v21, v31
    v_bfe_u32 v52, v0, 1, 1
    v_lshlrev_b32 v52, 4, v52
    v_bfe_u32 v30, v0, 6, 2
    v_lshl_add_u32 v52, v30, 6, v52
    v_bfe_u32 v31, v0, 2, 1
    v_lshlrev_b32 v31, 5, v31
    v_bfe_u32 v30, v0, 3, 1
    v_lshl_add_u32 v31, v30, 7, v31
    v_bfe_u32 v30, v0, 4, 1
    v_lshl_add_u32 v31, v30, 6, v31
    v_xor_b32 v52, v52, v31
    v_bfe_u32 v31, v0, 0, 1
    v_lshlrev_b32 v31, 3, v31
    v_bfe_u32 v30, v0, 2, 1
    v_lshl_add_u32 v31, v30, 8, v31
    v_bfe_u32 v30, v0, 3, 1
    v_lshl_add_u32 v31, v30, 11, v31
    v_bfe_u32 v30, v0, 4, 1
    v_lshl_add_u32 v31, v30, 10, v31
    v_bfe_u32 v30, v0, 5, 1
    v_lshl_add_u32 v31, v30, 12, v31
    v_add_u32 v52, v52, v31
    v_add_u32 v22, 0x10000, v52
    v_bfe_u32 v53, v0, 1, 1
    v_lshlrev_b32 v53, 4, v53
    v_bfe_u32 v30, v0, 6, 2
    v_lshl_add_u32 v53, v30, 6, v53
    v_add_u32 v53, 0x20, v53
    v_bfe_u32 v31, v0, 2, 1
    v_lshlrev_b32 v31, 5, v31
    v_bfe_u32 v30, v0, 3, 1
    v_lshl_add_u32 v31, v30, 7, v31
    v_bfe_u32 v30, v0, 4, 1
    v_lshl_add_u32 v31, v30, 6, v31
    v_xor_b32 v53, v53, v31
    v_bfe_u32 v31, v0, 0, 1
    v_lshlrev_b32 v31, 3, v31
    v_bfe_u32 v30, v0, 2, 1
    v_lshl_add_u32 v31, v30, 8, v31
    v_bfe_u32 v30, v0, 3, 1
    v_lshl_add_u32 v31, v30, 11, v31
    v_bfe_u32 v30, v0, 4, 1
    v_lshl_add_u32 v31, v30, 10, v31
    v_bfe_u32 v30, v0, 5, 1
    v_lshl_add_u32 v31, v30, 12, v31
    v_add_u32 v53, v53, v31
    v_add_u32 v23, 0x10000, v53
    v_bfe_u32 v24, v0, 0, 2
    v_lshlrev_b32 v24, 5, v24
    v_bfe_u32 v30, v0, 6, 1
    v_lshl_add_u32 v24, v30, 7, v24
    v_bfe_u32 v31, v0, 2, 2
    v_lshlrev_b32 v31, 5, v31
    v_bfe_u32 v30, v0, 5, 1
    v_lshl_add_u32 v31, v30, 7, v31
    v_xor_b32 v24, v24, v31
    v_bfe_u32 v31, v0, 2, 1
    v_lshlrev_b32 v31, 8, v31
    v_bfe_u32 v30, v0, 3, 1
    v_lshl_add_u32 v31, v30, 10, v31
    v_bfe_u32 v30, v0, 4, 1
    v_lshl_add_u32 v31, v30, 12, v31
    v_bfe_u32 v30, v0, 5, 1
    v_lshl_add_u32 v31, v30, 11, v31
    v_bfe_u32 v30, v0, 7, 1
    v_lshl_add_u32 v31, v30, 14, v31
    v_add_u32 v24, v24, v31
    v_bfe_u32 v26, v0, 1, 1
    v_lshlrev_b32 v26, 4, v26
    v_bfe_u32 v30, v0, 6, 2
    v_lshl_add_u32 v26, v30, 5, v26
    v_bfe_u32 v31, v0, 3, 1
    v_lshlrev_b32 v31, 5, v31
    v_bfe_u32 v30, v0, 5, 1
    v_lshl_add_u32 v31, v30, 6, v31
    v_xor_b32 v26, v26, v31
    v_bfe_u32 v31, v0, 0, 1
    v_lshlrev_b32 v31, 3, v31
    v_bfe_u32 v30, v0, 2, 1
    v_lshl_add_u32 v31, v30, 7, v31
    v_bfe_u32 v30, v0, 3, 1
    v_lshl_add_u32 v31, v30, 9, v31
    v_bfe_u32 v30, v0, 4, 1
    v_lshl_add_u32 v31, v30, 11, v31
    v_bfe_u32 v30, v0, 5, 1
    v_lshl_add_u32 v31, v30, 10, v31
    v_add_u32 v31, 0x14000, v31
    v_add_u32 v26, v26, v31
    s_mov_b32 s8, s20
    s_and_b32 s9, s21, 0xffff
    s_mov_b32 s10, 0x500000
    s_mov_b32 s11, 0x20000
    s_mov_b32 s12, s26
    s_and_b32 s13, s27, 0xffff
    s_mov_b32 s14, 0x500000
    s_mov_b32 s15, 0x20000
    s_lshl_b32 s62, s46, 8
    s_mul_i32 s37, s70, 2621440
    s_sub_u32 s84, 2621440, s37
    s_add_u32 s37, s37, s62
    s_add_u32 s84, s84, s62
    s_mul_i32 s66, s46, 163840
    s_mul_i32 s62, s70, 640
    s_add_u32 s66, s66, s62
    s_lshl_b32 s67, s44, 12
    v_bfe_u32 v9, v0, 0, 8
    v_lshlrev_b32 v9, 4, v9
    v_add_u32 v9, 0x20000, v9
    v_bfe_u32 v11, v0, 0, 4
    v_lshlrev_b32 v11, 4, v11
    v_bfe_u32 v30, v0, 6, 2
    v_lshl_add_u32 v11, v30, 8, v11
    v_add_u32 v11, 0x21000, v11
    s_mov_b32 s52, s18
    s_and_b32 s53, s19, 0xffff
    s_mov_b32 s54, 0x2800
    s_mov_b32 s55, 0x20000
    v_bfe_u32 v30, v0, 0, 1
    v_mul_u32_u24 v30, 0x500, v30
    v_bfe_u32 v32, v0, 1, 1
    v_lshl_add_u32 v30, v32, 4, v30
    v_bfe_u32 v32, v0, 2, 2
    v_mul_u32_u24 v32, 0xa00, v32
    v_add_u32 v30, v32, v30
    v_bfe_u32 v32, v0, 4, 4
    v_lshl_add_u32 v30, v32, 5, v30
    v_bfe_u32 v31, v0, 0, 1
    v_mul_u32_u24 v31, 0x500, v31
    v_bfe_u32 v32, v0, 1, 1
    v_lshl_add_u32 v31, v32, 4, v31
    v_bfe_u32 v32, v0, 2, 2
    v_mul_u32_u24 v32, 0xa00, v32
    v_add_u32 v31, v32, v31
    v_bfe_u32 v32, v0, 6, 2
    v_lshl_add_u32 v31, v32, 5, v31
    v_add_u32 v31, 0x200, v31
    s_mul_i32 s62, s70, 640
    s_sub_u32 s63, 640, s62
    buffer_load_dwordx4 v[36:39], v30, s[52:55], s62 offen
    buffer_load_dwordx4 v[40:43], v31, s[52:55], s62 offen
    buffer_load_dwordx4 v[44:47], v30, s[52:55], s63 offen
    buffer_load_dwordx4 v[48:51], v31, s[52:55], s63 offen
    s_add_u32 m0, s67, 0x14000
    s_add_u32 s63, s37, 0x0
    buffer_load_dwordx4 v12, s[8:11], s63 offen lds
    s_add_u32 m0, s67, 0x14400
    s_add_u32 s63, s37, 0x0
    buffer_load_dwordx4 v13, s[8:11], s63 offen lds
    s_add_u32 m0, s67, 0x14800
    s_add_u32 s63, s37, 0x0
    buffer_load_dwordx4 v14, s[8:11], s63 offen lds
    s_add_u32 m0, s67, 0x14c00
    s_add_u32 s63, s37, 0x0
    buffer_load_dwordx4 v15, s[8:11], s63 offen lds
    s_add_u32 m0, s67, 0x18000
    s_add_u32 s63, s37, 0x80000
    buffer_load_dwordx4 v12, s[8:11], s63 offen lds
    s_add_u32 m0, s67, 0x18400
    s_add_u32 s63, s37, 0x80000
    buffer_load_dwordx4 v13, s[8:11], s63 offen lds
    s_add_u32 m0, s67, 0x18800
    s_add_u32 s63, s37, 0x80000
    buffer_load_dwordx4 v14, s[8:11], s63 offen lds
    s_add_u32 m0, s67, 0x18c00
    s_add_u32 s63, s37, 0x80000
    buffer_load_dwordx4 v15, s[8:11], s63 offen lds
    s_add_u32 m0, s67, 0x1c000
    s_add_u32 s63, s37, 0x100000
    buffer_load_dwordx4 v12, s[8:11], s63 offen lds
    s_add_u32 m0, s67, 0x1c400
    s_add_u32 s63, s37, 0x100000
    buffer_load_dwordx4 v13, s[8:11], s63 offen lds
    s_add_u32 m0, s67, 0x1c800
    s_add_u32 s63, s37, 0x100000
    buffer_load_dwordx4 v14, s[8:11], s63 offen lds
    s_add_u32 m0, s67, 0x1cc00
    s_add_u32 s63, s37, 0x100000
    buffer_load_dwordx4 v15, s[8:11], s63 offen lds
    s_waitcnt vmcnt(8) lgkmcnt(0)
    s_barrier
    s_add_u32 m0, s67, 0x0
    s_add_u32 s63, s37, 0x180000
    buffer_load_dwordx4 v12, s[8:11], s63 offen lds
    s_add_u32 m0, s67, 0x400
    s_add_u32 s63, s37, 0x180000
    buffer_load_dwordx4 v13, s[8:11], s63 offen lds
    s_add_u32 m0, s67, 0x800
    s_add_u32 s63, s37, 0x180000
    buffer_load_dwordx4 v14, s[8:11], s63 offen lds
    s_add_u32 m0, s67, 0xc00
    s_add_u32 s63, s37, 0x180000
    buffer_load_dwordx4 v15, s[8:11], s63 offen lds
    ds_write_b128 v9, v[36:39]
    ds_write_b128 v11, v[40:43]
    ds_write_b128 v9, v[44:47] offset:5120
    ds_write_b128 v11, v[48:51] offset:5120
    ds_read_b64_tr_b16 a[0:1], v22 offset:16384
    ds_read_b64_tr_b16 a[2:3], v22 offset:16896
    ds_read_b64_tr_b16 a[4:5], v22 offset:24576
    ds_read_b64_tr_b16 a[6:7], v22 offset:25088
    ds_read_b64_tr_b16 a[8:9], v23 offset:16384
    ds_read_b64_tr_b16 a[10:11], v23 offset:16896
    ds_read_b64_tr_b16 a[12:13], v23 offset:24576
    ds_read_b64_tr_b16 a[14:15], v23 offset:25088
    s_waitcnt vmcnt(8) lgkmcnt(0)
    s_barrier
    s_add_u32 m0, s67, 0x4000
    s_add_u32 s63, s37, 0x200000
    buffer_load_dwordx4 v12, s[8:11], s63 offen lds
    s_add_u32 m0, s67, 0x4400
    s_add_u32 s63, s37, 0x200000
    buffer_load_dwordx4 v13, s[8:11], s63 offen lds
    s_add_u32 m0, s67, 0x4800
    s_add_u32 s63, s37, 0x200000
    buffer_load_dwordx4 v14, s[8:11], s63 offen lds
    s_add_u32 m0, s67, 0x4c00
    s_add_u32 s63, s37, 0x200000
    buffer_load_dwordx4 v15, s[8:11], s63 offen lds
    ds_read_b64_tr_b16 a[16:17], v22 offset:32768
    ds_read_b64_tr_b16 a[18:19], v22 offset:33280
    ds_read_b64_tr_b16 a[20:21], v22 offset:40960
    ds_read_b64_tr_b16 a[22:23], v22 offset:41472
    ds_read_b64_tr_b16 a[24:25], v23 offset:32768
    ds_read_b64_tr_b16 a[26:27], v23 offset:33280
    ds_read_b64_tr_b16 a[28:29], v23 offset:40960
    ds_read_b64_tr_b16 a[30:31], v23 offset:41472
    s_waitcnt vmcnt(8) lgkmcnt(0)
    s_barrier
    s_add_u32 m0, s67, 0x8000
    s_add_u32 s63, s84, 0x0
    buffer_load_dwordx4 v12, s[8:11], s63 offen lds
    s_add_u32 m0, s67, 0x8400
    s_add_u32 s63, s84, 0x0
    buffer_load_dwordx4 v13, s[8:11], s63 offen lds
    s_add_u32 m0, s67, 0x8800
    s_add_u32 s63, s84, 0x0
    buffer_load_dwordx4 v14, s[8:11], s63 offen lds
    s_add_u32 m0, s67, 0x8c00
    s_add_u32 s63, s84, 0x0
    buffer_load_dwordx4 v15, s[8:11], s63 offen lds
    ds_read_b64_tr_b16 a[32:33], v22 offset:49152
    ds_read_b64_tr_b16 a[34:35], v22 offset:49664
    ds_read_b64_tr_b16 a[36:37], v22 offset:57344
    ds_read_b64_tr_b16 a[38:39], v22 offset:57856
    ds_read_b64_tr_b16 a[40:41], v23 offset:49152
    ds_read_b64_tr_b16 a[42:43], v23 offset:49664
    ds_read_b64_tr_b16 a[44:45], v23 offset:57344
    ds_read_b64_tr_b16 a[46:47], v23 offset:57856
    s_waitcnt vmcnt(8) lgkmcnt(0)
    s_barrier
    s_add_u32 m0, s67, 0xc000
    s_add_u32 s63, s84, 0x80000
    buffer_load_dwordx4 v12, s[8:11], s63 offen lds
    s_add_u32 m0, s67, 0xc400
    s_add_u32 s63, s84, 0x80000
    buffer_load_dwordx4 v13, s[8:11], s63 offen lds
    s_add_u32 m0, s67, 0xc800
    s_add_u32 s63, s84, 0x80000
    buffer_load_dwordx4 v14, s[8:11], s63 offen lds
    s_add_u32 m0, s67, 0xcc00
    s_add_u32 s63, s84, 0x80000
    buffer_load_dwordx4 v15, s[8:11], s63 offen lds
    ds_read_b64_tr_b16 a[48:49], v52 offset:0
    ds_read_b64_tr_b16 a[50:51], v52 offset:512
    ds_read_b64_tr_b16 a[52:53], v52 offset:8192
    ds_read_b64_tr_b16 a[54:55], v52 offset:8704
    ds_read_b64_tr_b16 a[56:57], v53 offset:0
    ds_read_b64_tr_b16 a[58:59], v53 offset:512
    ds_read_b64_tr_b16 a[60:61], v53 offset:8192
    ds_read_b64_tr_b16 a[62:63], v53 offset:8704
    s_waitcnt vmcnt(8) lgkmcnt(0)
    s_barrier
    s_add_u32 m0, s67, 0x10000
    s_add_u32 s63, s84, 0x100000
    buffer_load_dwordx4 v12, s[8:11], s63 offen lds
    s_add_u32 m0, s67, 0x10400
    s_add_u32 s63, s84, 0x100000
    buffer_load_dwordx4 v13, s[8:11], s63 offen lds
    s_add_u32 m0, s67, 0x10800
    s_add_u32 s63, s84, 0x100000
    buffer_load_dwordx4 v14, s[8:11], s63 offen lds
    s_add_u32 m0, s67, 0x10c00
    s_add_u32 s63, s84, 0x100000
    buffer_load_dwordx4 v15, s[8:11], s63 offen lds
    ds_read_b64_tr_b16 a[64:65], v52 offset:16384
    ds_read_b64_tr_b16 a[66:67], v52 offset:16896
    ds_read_b64_tr_b16 a[68:69], v52 offset:24576
    ds_read_b64_tr_b16 a[70:71], v52 offset:25088
    ds_read_b64_tr_b16 a[72:73], v53 offset:16384
    ds_read_b64_tr_b16 a[74:75], v53 offset:16896
    ds_read_b64_tr_b16 a[76:77], v53 offset:24576
    ds_read_b64_tr_b16 a[78:79], v53 offset:25088
    s_waitcnt vmcnt(8) lgkmcnt(0)
    s_barrier
    s_add_u32 m0, s67, 0x14000
    s_add_u32 s63, s84, 0x180000
    buffer_load_dwordx4 v12, s[8:11], s63 offen lds
    s_add_u32 m0, s67, 0x14400
    s_add_u32 s63, s84, 0x180000
    buffer_load_dwordx4 v13, s[8:11], s63 offen lds
    s_add_u32 m0, s67, 0x14800
    s_add_u32 s63, s84, 0x180000
    buffer_load_dwordx4 v14, s[8:11], s63 offen lds
    s_add_u32 m0, s67, 0x14c00
    s_add_u32 s63, s84, 0x180000
    buffer_load_dwordx4 v15, s[8:11], s63 offen lds
    ds_read_b64_tr_b16 a[80:81], v52 offset:32768
    ds_read_b64_tr_b16 a[82:83], v52 offset:33280
    ds_read_b64_tr_b16 a[84:85], v52 offset:40960
    ds_read_b64_tr_b16 a[86:87], v52 offset:41472
    ds_read_b64_tr_b16 a[88:89], v53 offset:32768
    ds_read_b64_tr_b16 a[90:91], v53 offset:33280
    ds_read_b64_tr_b16 a[92:93], v53 offset:40960
    ds_read_b64_tr_b16 a[94:95], v53 offset:41472
    s_waitcnt vmcnt(8) lgkmcnt(0)
    s_barrier
    s_add_u32 m0, s67, 0x18000
    s_add_u32 s63, s84, 0x200000
    buffer_load_dwordx4 v12, s[8:11], s63 offen lds
    s_add_u32 m0, s67, 0x18400
    s_add_u32 s63, s84, 0x200000
    buffer_load_dwordx4 v13, s[8:11], s63 offen lds
    s_add_u32 m0, s67, 0x18800
    s_add_u32 s63, s84, 0x200000
    buffer_load_dwordx4 v14, s[8:11], s63 offen lds
    s_add_u32 m0, s67, 0x18c00
    s_add_u32 s63, s84, 0x200000
    buffer_load_dwordx4 v15, s[8:11], s63 offen lds
    ds_read_b64_tr_b16 a[96:97], v52 offset:49152
    ds_read_b64_tr_b16 a[98:99], v52 offset:49664
    ds_read_b64_tr_b16 a[100:101], v52 offset:57344
    ds_read_b64_tr_b16 a[102:103], v52 offset:57856
    ds_read_b64_tr_b16 a[104:105], v53 offset:49152
    ds_read_b64_tr_b16 a[106:107], v53 offset:49664
    ds_read_b64_tr_b16 a[108:109], v53 offset:57344
    ds_read_b64_tr_b16 a[110:111], v53 offset:57856
    s_waitcnt vmcnt(8) lgkmcnt(0)
    s_barrier
    s_mov_b32 s8, s22
    s_and_b32 s9, s23, 0xffff
    s_add_u32 m0, s67, 0x1c000
    s_add_u32 s63, s37, 0x80000
    buffer_load_dwordx4 v12, s[8:11], s63 offen lds
    s_add_u32 m0, s67, 0x1c400
    s_add_u32 s63, s37, 0x80000
    buffer_load_dwordx4 v13, s[8:11], s63 offen lds
    s_add_u32 m0, s67, 0x1c800
    s_add_u32 s63, s37, 0x80000
    buffer_load_dwordx4 v14, s[8:11], s63 offen lds
    s_add_u32 m0, s67, 0x1cc00
    s_add_u32 s63, s37, 0x80000
    buffer_load_dwordx4 v15, s[8:11], s63 offen lds
    ds_read_b64_tr_b16 a[112:113], v22 offset:0
    ds_read_b64_tr_b16 a[114:115], v22 offset:512
    ds_read_b64_tr_b16 a[116:117], v22 offset:8192
    ds_read_b64_tr_b16 a[118:119], v22 offset:8704
    ds_read_b64_tr_b16 a[120:121], v23 offset:0
    ds_read_b64_tr_b16 a[122:123], v23 offset:512
    ds_read_b64_tr_b16 a[124:125], v23 offset:8192
    ds_read_b64_tr_b16 a[126:127], v23 offset:8704
    s_waitcnt vmcnt(8) lgkmcnt(0)
    s_barrier
    s_add_u32 m0, s67, 0x0
    s_add_u32 s63, s37, 0x100000
    buffer_load_dwordx4 v12, s[8:11], s63 offen lds
    s_add_u32 m0, s67, 0x400
    s_add_u32 s63, s37, 0x100000
    buffer_load_dwordx4 v13, s[8:11], s63 offen lds
    s_add_u32 m0, s67, 0x800
    s_add_u32 s63, s37, 0x100000
    buffer_load_dwordx4 v14, s[8:11], s63 offen lds
    s_add_u32 m0, s67, 0xc00
    s_add_u32 s63, s37, 0x100000
    buffer_load_dwordx4 v15, s[8:11], s63 offen lds
    ds_read_b64_tr_b16 a[128:129], v22 offset:16384
    ds_read_b64_tr_b16 a[130:131], v22 offset:16896
    ds_read_b64_tr_b16 a[132:133], v22 offset:24576
    ds_read_b64_tr_b16 a[134:135], v22 offset:25088
    ds_read_b64_tr_b16 a[136:137], v23 offset:16384
    ds_read_b64_tr_b16 a[138:139], v23 offset:16896
    ds_read_b64_tr_b16 a[140:141], v23 offset:24576
    ds_read_b64_tr_b16 a[142:143], v23 offset:25088
    s_waitcnt vmcnt(8) lgkmcnt(0)
    s_barrier
    s_add_u32 m0, s67, 0x4000
    s_add_u32 s63, s37, 0x180000
    buffer_load_dwordx4 v12, s[8:11], s63 offen lds
    s_add_u32 m0, s67, 0x4400
    s_add_u32 s63, s37, 0x180000
    buffer_load_dwordx4 v13, s[8:11], s63 offen lds
    s_add_u32 m0, s67, 0x4800
    s_add_u32 s63, s37, 0x180000
    buffer_load_dwordx4 v14, s[8:11], s63 offen lds
    s_add_u32 m0, s67, 0x4c00
    s_add_u32 s63, s37, 0x180000
    buffer_load_dwordx4 v15, s[8:11], s63 offen lds
    ds_read_b64_tr_b16 a[144:145], v22 offset:32768
    ds_read_b64_tr_b16 a[146:147], v22 offset:33280
    ds_read_b64_tr_b16 a[148:149], v22 offset:40960
    ds_read_b64_tr_b16 a[150:151], v22 offset:41472
    ds_read_b64_tr_b16 a[152:153], v23 offset:32768
    ds_read_b64_tr_b16 a[154:155], v23 offset:33280
    ds_read_b64_tr_b16 a[156:157], v23 offset:40960
    ds_read_b64_tr_b16 a[158:159], v23 offset:41472
    s_waitcnt vmcnt(8) lgkmcnt(0)
    s_barrier
    s_add_u32 m0, s67, 0x8000
    s_add_u32 s63, s37, 0x200000
    buffer_load_dwordx4 v12, s[8:11], s63 offen lds
    s_add_u32 m0, s67, 0x8400
    s_add_u32 s63, s37, 0x200000
    buffer_load_dwordx4 v13, s[8:11], s63 offen lds
    s_add_u32 m0, s67, 0x8800
    s_add_u32 s63, s37, 0x200000
    buffer_load_dwordx4 v14, s[8:11], s63 offen lds
    s_add_u32 m0, s67, 0x8c00
    s_add_u32 s63, s37, 0x200000
    buffer_load_dwordx4 v15, s[8:11], s63 offen lds
    ds_read_b64_tr_b16 a[208:209], v22 offset:49152
    ds_read_b64_tr_b16 a[210:211], v22 offset:49664
    ds_read_b64_tr_b16 a[212:213], v22 offset:57344
    ds_read_b64_tr_b16 a[214:215], v22 offset:57856
    ds_read_b64_tr_b16 a[216:217], v23 offset:49152
    ds_read_b64_tr_b16 a[218:219], v23 offset:49664
    ds_read_b64_tr_b16 a[220:221], v23 offset:57344
    ds_read_b64_tr_b16 a[222:223], v23 offset:57856
    s_waitcnt vmcnt(8) lgkmcnt(0)
    s_barrier
    s_add_u32 m0, s67, 0xc000
    s_add_u32 s63, s84, 0x0
    buffer_load_dwordx4 v12, s[8:11], s63 offen lds
    s_add_u32 m0, s67, 0xc400
    s_add_u32 s63, s84, 0x0
    buffer_load_dwordx4 v13, s[8:11], s63 offen lds
    s_add_u32 m0, s67, 0xc800
    s_add_u32 s63, s84, 0x0
    buffer_load_dwordx4 v14, s[8:11], s63 offen lds
    s_add_u32 m0, s67, 0xcc00
    s_add_u32 s63, s84, 0x0
    buffer_load_dwordx4 v15, s[8:11], s63 offen lds
    ds_read_b64_tr_b16 a[224:225], v52 offset:0
    ds_read_b64_tr_b16 a[226:227], v52 offset:512
    ds_read_b64_tr_b16 a[228:229], v52 offset:8192
    ds_read_b64_tr_b16 a[230:231], v52 offset:8704
    ds_read_b64_tr_b16 a[232:233], v53 offset:0
    ds_read_b64_tr_b16 a[234:235], v53 offset:512
    ds_read_b64_tr_b16 a[236:237], v53 offset:8192
    ds_read_b64_tr_b16 a[238:239], v53 offset:8704
    s_waitcnt vmcnt(8) lgkmcnt(0)
    s_barrier
    s_add_u32 m0, s67, 0x10000
    s_add_u32 s63, s84, 0x80000
    buffer_load_dwordx4 v12, s[8:11], s63 offen lds
    s_add_u32 m0, s67, 0x10400
    s_add_u32 s63, s84, 0x80000
    buffer_load_dwordx4 v13, s[8:11], s63 offen lds
    s_add_u32 m0, s67, 0x10800
    s_add_u32 s63, s84, 0x80000
    buffer_load_dwordx4 v14, s[8:11], s63 offen lds
    s_add_u32 m0, s67, 0x10c00
    s_add_u32 s63, s84, 0x80000
    buffer_load_dwordx4 v15, s[8:11], s63 offen lds
    v_and_b32 v28, 7, v0
    v_lshlrev_b32 v28, 5, v28
    buffer_load_dword v66, v28, s[48:51], 0 offen offset:16 sc1
    ds_read_b64_tr_b16 v[144:145], v52 offset:16384
    ds_read_b64_tr_b16 v[146:147], v52 offset:16896
    ds_read_b64_tr_b16 v[148:149], v52 offset:24576
    ds_read_b64_tr_b16 v[150:151], v52 offset:25088
    ds_read_b64_tr_b16 v[152:153], v53 offset:16384
    ds_read_b64_tr_b16 v[154:155], v53 offset:16896
    ds_read_b64_tr_b16 v[156:157], v53 offset:24576
    ds_read_b64_tr_b16 v[158:159], v53 offset:25088
    s_waitcnt vmcnt(8) lgkmcnt(0)
    s_barrier
    s_add_u32 m0, s67, 0x14000
    s_add_u32 s63, s84, 0x100000
    buffer_load_dwordx4 v12, s[8:11], s63 offen lds
    s_add_u32 m0, s67, 0x14400
    s_add_u32 s63, s84, 0x100000
    buffer_load_dwordx4 v13, s[8:11], s63 offen lds
    s_add_u32 m0, s67, 0x14800
    s_add_u32 s63, s84, 0x100000
    buffer_load_dwordx4 v14, s[8:11], s63 offen lds
    s_add_u32 m0, s67, 0x14c00
    s_add_u32 s63, s84, 0x100000
    buffer_load_dwordx4 v15, s[8:11], s63 offen lds
    ds_read_b64_tr_b16 v[160:161], v52 offset:32768
    ds_read_b64_tr_b16 v[162:163], v52 offset:33280
    ds_read_b64_tr_b16 v[164:165], v52 offset:40960
    ds_read_b64_tr_b16 v[166:167], v52 offset:41472
    ds_read_b64_tr_b16 v[168:169], v53 offset:32768
    ds_read_b64_tr_b16 v[170:171], v53 offset:33280
    ds_read_b64_tr_b16 v[172:173], v53 offset:40960
    ds_read_b64_tr_b16 v[174:175], v53 offset:41472
    s_waitcnt vmcnt(8) lgkmcnt(0)
    s_barrier
    s_add_u32 m0, s67, 0x18000
    s_add_u32 s63, s84, 0x180000
    buffer_load_dwordx4 v12, s[8:11], s63 offen lds
    s_add_u32 m0, s67, 0x18400
    s_add_u32 s63, s84, 0x180000
    buffer_load_dwordx4 v13, s[8:11], s63 offen lds
    s_add_u32 m0, s67, 0x18800
    s_add_u32 s63, s84, 0x180000
    buffer_load_dwordx4 v14, s[8:11], s63 offen lds
    s_add_u32 m0, s67, 0x18c00
    s_add_u32 s63, s84, 0x180000
    buffer_load_dwordx4 v15, s[8:11], s63 offen lds
    ds_read_b64_tr_b16 v[176:177], v52 offset:49152
    ds_read_b64_tr_b16 v[178:179], v52 offset:49664
    ds_read_b64_tr_b16 v[180:181], v52 offset:57344
    ds_read_b64_tr_b16 v[182:183], v52 offset:57856
    ds_read_b64_tr_b16 v[184:185], v53 offset:49152
    ds_read_b64_tr_b16 v[186:187], v53 offset:49664
    ds_read_b64_tr_b16 v[188:189], v53 offset:57344
    ds_read_b64_tr_b16 v[190:191], v53 offset:57856
    s_waitcnt vmcnt(8) lgkmcnt(0)
    s_barrier
    s_add_u32 m0, s67, 0x1c000
    s_add_u32 s63, s84, 0x200000
    buffer_load_dwordx4 v12, s[8:11], s63 offen lds
    s_add_u32 m0, s67, 0x1c400
    s_add_u32 s63, s84, 0x200000
    buffer_load_dwordx4 v13, s[8:11], s63 offen lds
    s_add_u32 m0, s67, 0x1c800
    s_add_u32 s63, s84, 0x200000
    buffer_load_dwordx4 v14, s[8:11], s63 offen lds
    s_add_u32 m0, s67, 0x1cc00
    s_add_u32 s63, s84, 0x200000
    buffer_load_dwordx4 v15, s[8:11], s63 offen lds
    ds_read_b64_tr_b16 v[192:193], v22 offset:0
    ds_read_b64_tr_b16 v[194:195], v22 offset:512
    ds_read_b64_tr_b16 v[196:197], v22 offset:8192
    ds_read_b64_tr_b16 v[198:199], v22 offset:8704
    ds_read_b64_tr_b16 v[200:201], v23 offset:0
    ds_read_b64_tr_b16 v[202:203], v23 offset:512
    ds_read_b64_tr_b16 v[204:205], v23 offset:8192
    ds_read_b64_tr_b16 v[206:207], v23 offset:8704
    s_waitcnt vmcnt(8) lgkmcnt(0)
    s_barrier
    s_mov_b32 s8, s24
    s_and_b32 s9, s25, 0xffff
    s_add_u32 m0, s67, 0x0
    s_add_u32 s63, s84, 0x0
    buffer_load_dwordx4 v12, s[8:11], s63 offen lds
    s_add_u32 m0, s67, 0x400
    s_add_u32 s63, s84, 0x0
    buffer_load_dwordx4 v13, s[8:11], s63 offen lds
    s_add_u32 m0, s67, 0x800
    s_add_u32 s63, s84, 0x0
    buffer_load_dwordx4 v14, s[8:11], s63 offen lds
    s_add_u32 m0, s67, 0xc00
    s_add_u32 s63, s84, 0x0
    buffer_load_dwordx4 v15, s[8:11], s63 offen lds
    ds_read_b64_tr_b16 v[208:209], v22 offset:16384
    ds_read_b64_tr_b16 v[210:211], v22 offset:16896
    ds_read_b64_tr_b16 v[212:213], v22 offset:24576
    ds_read_b64_tr_b16 v[214:215], v22 offset:25088
    ds_read_b64_tr_b16 v[216:217], v23 offset:16384
    ds_read_b64_tr_b16 v[218:219], v23 offset:16896
    ds_read_b64_tr_b16 v[220:221], v23 offset:24576
    ds_read_b64_tr_b16 v[222:223], v23 offset:25088
    s_waitcnt vmcnt(8) lgkmcnt(0)
    s_barrier
    s_add_u32 m0, s67, 0x4000
    s_add_u32 s63, s66, 0x0
    buffer_load_dwordx4 v16, s[12:15], s63 offen lds
    s_add_u32 m0, s67, 0x4400
    s_add_u32 s63, s66, 0x0
    buffer_load_dwordx4 v17, s[12:15], s63 offen lds
    s_add_u32 m0, s67, 0x4800
    s_add_u32 s63, s66, 0x0
    buffer_load_dwordx4 v18, s[12:15], s63 offen lds
    s_add_u32 m0, s67, 0x4c00
    s_add_u32 s63, s66, 0x0
    buffer_load_dwordx4 v19, s[12:15], s63 offen lds
    ds_read_b64_tr_b16 v[224:225], v22 offset:32768
    ds_read_b64_tr_b16 v[226:227], v22 offset:33280
    ds_read_b64_tr_b16 v[228:229], v22 offset:40960
    ds_read_b64_tr_b16 v[230:231], v22 offset:41472
    ds_read_b64_tr_b16 v[232:233], v23 offset:32768
    ds_read_b64_tr_b16 v[234:235], v23 offset:33280
    ds_read_b64_tr_b16 v[236:237], v23 offset:40960
    ds_read_b64_tr_b16 v[238:239], v23 offset:41472
    s_waitcnt vmcnt(8) lgkmcnt(0)
    s_barrier
    s_add_u32 m0, s67, 0x8000
    s_add_u32 s63, s66, 0x100
    buffer_load_dwordx4 v16, s[12:15], s63 offen lds
    s_add_u32 m0, s67, 0x8400
    s_add_u32 s63, s66, 0x100
    buffer_load_dwordx4 v17, s[12:15], s63 offen lds
    s_add_u32 m0, s67, 0x8800
    s_add_u32 s63, s66, 0x100
    buffer_load_dwordx4 v18, s[12:15], s63 offen lds
    s_add_u32 m0, s67, 0x8c00
    s_add_u32 s63, s66, 0x100
    buffer_load_dwordx4 v19, s[12:15], s63 offen lds
    ds_read_b64_tr_b16 v[240:241], v22 offset:49152
    ds_read_b64_tr_b16 v[242:243], v22 offset:49664
    ds_read_b64_tr_b16 v[244:245], v22 offset:57344
    ds_read_b64_tr_b16 v[246:247], v22 offset:57856
    ds_read_b64_tr_b16 v[248:249], v23 offset:49152
    ds_read_b64_tr_b16 v[250:251], v23 offset:49664
    ds_read_b64_tr_b16 v[252:253], v23 offset:57344
    ds_read_b64_tr_b16 v[254:255], v23 offset:57856
    s_waitcnt vmcnt(8) lgkmcnt(0)
    s_barrier
    s_add_u32 m0, s67, 0xc000
    s_add_u32 s63, s66, 0x14000
    buffer_load_dwordx4 v16, s[12:15], s63 offen lds
    s_add_u32 m0, s67, 0xc400
    s_add_u32 s63, s66, 0x14000
    buffer_load_dwordx4 v17, s[12:15], s63 offen lds
    s_add_u32 m0, s67, 0xc800
    s_add_u32 s63, s66, 0x14000
    buffer_load_dwordx4 v18, s[12:15], s63 offen lds
    s_add_u32 m0, s67, 0xcc00
    s_add_u32 s63, s66, 0x14000
    buffer_load_dwordx4 v19, s[12:15], s63 offen lds
    v_and_b32 v28, 7, v0
    v_lshlrev_b32 v28, 5, v28
    buffer_load_dwordx2 v[64:65], v28, s[48:51], 0 offen sc1
    ds_read_b64_tr_b16 v[80:81], v52 offset:0
    ds_read_b64_tr_b16 v[82:83], v52 offset:512
    ds_read_b64_tr_b16 v[84:85], v52 offset:8192
    ds_read_b64_tr_b16 v[86:87], v52 offset:8704
    ds_read_b64_tr_b16 v[88:89], v53 offset:0
    ds_read_b64_tr_b16 v[90:91], v53 offset:512
    ds_read_b64_tr_b16 v[92:93], v53 offset:8192
    ds_read_b64_tr_b16 v[94:95], v53 offset:8704
    s_waitcnt vmcnt(4) lgkmcnt(0)
    s_barrier
    s_add_u32 m0, s67, 0x10000
    s_add_u32 s63, s66, 0x14100
    buffer_load_dwordx4 v16, s[12:15], s63 offen lds
    s_add_u32 m0, s67, 0x10400
    s_add_u32 s63, s66, 0x14100
    buffer_load_dwordx4 v17, s[12:15], s63 offen lds
    s_add_u32 m0, s67, 0x10800
    s_add_u32 s63, s66, 0x14100
    buffer_load_dwordx4 v18, s[12:15], s63 offen lds
    s_add_u32 m0, s67, 0x10c00
    s_add_u32 s63, s66, 0x14100
    buffer_load_dwordx4 v19, s[12:15], s63 offen lds
    ds_read_b64_tr_b16 v[40:41], v24 offset:16384
    ds_read_b64_tr_b16 v[42:43], v24 offset:16896
    ds_read_b64_tr_b16 v[44:45], v24 offset:24576
    ds_read_b64_tr_b16 v[46:47], v24 offset:25088
    ds_read_b64_tr_b16 a[160:161], v24 offset:16392
    ds_read_b64_tr_b16 a[162:163], v24 offset:16904
    ds_read_b64_tr_b16 a[164:165], v24 offset:24584
    ds_read_b64_tr_b16 a[166:167], v24 offset:25096
    s_waitcnt lgkmcnt(4)
    ds_read_b64_tr_b16 a[168:169], v24 offset:16400
    ds_read_b64_tr_b16 a[170:171], v24 offset:16912
    ds_read_b64_tr_b16 a[172:173], v24 offset:24592
    ds_read_b64_tr_b16 a[174:175], v24 offset:25104
    ds_read_b64_tr_b16 v[72:73], v24 offset:16408
    ds_read_b64_tr_b16 v[74:75], v24 offset:16920
    ds_read_b64_tr_b16 v[76:77], v24 offset:24600
    ds_read_b64_tr_b16 v[78:79], v24 offset:25112
    s_waitcnt vmcnt(0) lgkmcnt(0)
    s_barrier
    s_add_u32 m0, s67, 0x14000
    s_add_u32 s63, s66, 0x200
    buffer_load_dwordx4 v20, s[12:15], s63 offen lds
    s_add_u32 m0, s67, 0x14400
    s_add_u32 s63, s66, 0x200
    buffer_load_dwordx4 v21, s[12:15], s63 offen lds
    s_add_u32 m0, s67, 0x14800
    s_add_u32 s63, s66, 0x5200
    buffer_load_dwordx4 v20, s[12:15], s63 offen lds
    s_add_u32 m0, s67, 0x14c00
    s_add_u32 s63, s66, 0x5200
    buffer_load_dwordx4 v21, s[12:15], s63 offen lds
    s_add_u32 m0, s67, 0x18000
    s_add_u32 s63, s84, 0x80000
    buffer_load_dwordx4 v12, s[8:11], s63 offen lds
    s_add_u32 m0, s67, 0x18400
    s_add_u32 s63, s84, 0x80000
    buffer_load_dwordx4 v13, s[8:11], s63 offen lds
    s_add_u32 m0, s67, 0x18800
    s_add_u32 s63, s84, 0x80000
    buffer_load_dwordx4 v14, s[8:11], s63 offen lds
    s_add_u32 m0, s67, 0x18c00
    s_add_u32 s63, s84, 0x80000
    buffer_load_dwordx4 v15, s[8:11], s63 offen lds
    ds_read_b64_tr_b16 a[176:177], v24 offset:49152
    ds_read_b64_tr_b16 a[178:179], v24 offset:49664
    ds_read_b64_tr_b16 a[180:181], v24 offset:57344
    ds_read_b64_tr_b16 a[182:183], v24 offset:57856
    ds_read_b64_tr_b16 a[184:185], v24 offset:49160
    ds_read_b64_tr_b16 a[186:187], v24 offset:49672
    ds_read_b64_tr_b16 a[188:189], v24 offset:57352
    ds_read_b64_tr_b16 a[190:191], v24 offset:57864
    s_waitcnt lgkmcnt(4)
    ds_read_b64_tr_b16 a[192:193], v24 offset:49168
    ds_read_b64_tr_b16 a[194:195], v24 offset:49680
    ds_read_b64_tr_b16 a[196:197], v24 offset:57360
    ds_read_b64_tr_b16 a[198:199], v24 offset:57872
    ds_read_b64_tr_b16 v[56:57], v24 offset:49176
    ds_read_b64_tr_b16 v[58:59], v24 offset:49688
    ds_read_b64_tr_b16 v[60:61], v24 offset:57368
    ds_read_b64_tr_b16 v[62:63], v24 offset:57880
    s_waitcnt vmcnt(4) lgkmcnt(0)
    s_barrier
    s_add_u32 m0, s67, 0x1c000
    s_add_u32 s63, s84, 0x100000
    buffer_load_dwordx4 v12, s[8:11], s63 offen lds
    s_add_u32 m0, s67, 0x1c400
    s_add_u32 s63, s84, 0x100000
    buffer_load_dwordx4 v13, s[8:11], s63 offen lds
    s_add_u32 m0, s67, 0x1c800
    s_add_u32 s63, s84, 0x100000
    buffer_load_dwordx4 v14, s[8:11], s63 offen lds
    s_add_u32 m0, s67, 0x1cc00
    s_add_u32 s63, s84, 0x100000
    buffer_load_dwordx4 v15, s[8:11], s63 offen lds
    s_add_u32 m0, s67, 0x0
    s_add_u32 s63, s84, 0x180000
    buffer_load_dwordx4 v12, s[8:11], s63 offen lds
    s_add_u32 m0, s67, 0x400
    s_add_u32 s63, s84, 0x180000
    buffer_load_dwordx4 v13, s[8:11], s63 offen lds
    s_add_u32 m0, s67, 0x800
    s_add_u32 s63, s84, 0x180000
    buffer_load_dwordx4 v14, s[8:11], s63 offen lds
    s_add_u32 m0, s67, 0xc00
    s_add_u32 s63, s84, 0x180000
    buffer_load_dwordx4 v15, s[8:11], s63 offen lds
    ds_read_b64_tr_b16 v[32:33], v26 offset:0
    ds_read_b64_tr_b16 v[34:35], v26 offset:256
    ds_read_b64_tr_b16 v[36:37], v26 offset:4096
    ds_read_b64_tr_b16 v[38:39], v26 offset:4352
    ds_read_b64_tr_b16 a[200:201], v26 offset:8192
    ds_read_b64_tr_b16 a[202:203], v26 offset:8448
    ds_read_b64_tr_b16 a[204:205], v26 offset:12288
    ds_read_b64_tr_b16 a[206:207], v26 offset:12544
    s_waitcnt vmcnt(8) lgkmcnt(0)
    s_barrier
    s_add_u32 m0, s67, 0x4000
    s_add_u32 s63, s84, 0x200000
    buffer_load_dwordx4 v12, s[8:11], s63 offen lds
    s_add_u32 m0, s67, 0x4400
    s_add_u32 s63, s84, 0x200000
    buffer_load_dwordx4 v13, s[8:11], s63 offen lds
    s_add_u32 m0, s67, 0x4800
    s_add_u32 s63, s84, 0x200000
    buffer_load_dwordx4 v14, s[8:11], s63 offen lds
    s_add_u32 m0, s67, 0x4c00
    s_add_u32 s63, s84, 0x200000
    buffer_load_dwordx4 v15, s[8:11], s63 offen lds
    ds_read_b64_tr_b16 v[96:97], v22 offset:32768
    ds_read_b64_tr_b16 v[98:99], v22 offset:33280
    ds_read_b64_tr_b16 v[100:101], v22 offset:40960
    ds_read_b64_tr_b16 v[102:103], v22 offset:41472
    ds_read_b64_tr_b16 v[104:105], v23 offset:32768
    ds_read_b64_tr_b16 v[106:107], v23 offset:33280
    ds_read_b64_tr_b16 v[108:109], v23 offset:40960
    ds_read_b64_tr_b16 v[110:111], v23 offset:41472
    s_waitcnt vmcnt(8) lgkmcnt(0)
    s_barrier
    s_add_u32 m0, s67, 0x8000
    s_add_u32 s63, s37, 0x0
    buffer_load_dwordx4 v12, s[8:11], s63 offen lds
    s_add_u32 m0, s67, 0x8400
    s_add_u32 s63, s37, 0x0
    buffer_load_dwordx4 v13, s[8:11], s63 offen lds
    s_add_u32 m0, s67, 0x8800
    s_add_u32 s63, s37, 0x0
    buffer_load_dwordx4 v14, s[8:11], s63 offen lds
    s_add_u32 m0, s67, 0x8c00
    s_add_u32 s63, s37, 0x0
    buffer_load_dwordx4 v15, s[8:11], s63 offen lds
    v_bfe_u32 v1, v0, 0, 6
    v_lshlrev_b32 v1, 4, v1
    v_add_u32 v1, 0x20000, v1
    v_bfe_u32 v4, v0, 4, 2
    v_lshlrev_b32 v4, 3, v4
    v_bfe_u32 v31, v0, 2, 1
    v_lshlrev_b32 v31, 3, v31
    v_xor_b32 v4, v4, v31
    v_bfe_u32 v31, v0, 0, 3
    v_lshlrev_b32 v31, 5, v31
    v_bfe_u32 v30, v0, 3, 1
    v_mul_u32_u24 v30, 0x110, v30
    v_add_u32 v31, v30, v31
    v_bfe_u32 v30, v0, 6, 2
    v_mul_u32_u24 v30, 0x420, v30
    v_add_u32 v31, v30, v31
    v_add_u32 v31, 0x20000, v31
    v_add_u32 v4, v4, v31
    v_bfe_u32 v5, v0, 0, 2
    v_lshlrev_b32 v5, 3, v5
    v_bfe_u32 v31, v0, 4, 1
    v_lshlrev_b32 v31, 3, v31
    v_xor_b32 v5, v5, v31
    v_bfe_u32 v31, v0, 2, 3
    v_lshlrev_b32 v31, 5, v31
    v_bfe_u32 v30, v0, 5, 1
    v_mul_u32_u24 v30, 0x210, v30
    v_add_u32 v31, v30, v31
    v_add_u32 v31, 0x20000, v31
    v_add_u32 v5, v5, v31
    v_bfe_u32 v6, v0, 0, 1
    v_lshlrev_b32 v6, 4, v6
    v_bfe_u32 v30, v0, 2, 2
    v_lshl_add_u32 v6, v30, 6, v6
    v_bfe_u32 v30, v0, 4, 1
    v_lshl_add_u32 v6, v30, 5, v6
    v_bfe_u32 v30, v0, 5, 3
    v_lshl_add_u32 v6, v30, 8, v6
    v_add_u32 v6, 0x20000, v6
    v_bfe_u32 v7, v0, 0, 3
    v_lshlrev_b32 v7, 4, v7
    v_bfe_u32 v30, v0, 3, 1
    v_lshl_add_u32 v7, v30, 14, v7
    v_bfe_u32 v30, v0, 4, 2
    v_lshl_add_u32 v7, v30, 12, v7
    v_bfe_u32 v30, v0, 6, 2
    v_lshl_add_u32 v7, v30, 15, v7
    v_bfe_u32 v8, v0, 0, 2
    v_lshlrev_b32 v8, 4, v8
    v_bfe_u32 v30, v0, 2, 2
    v_lshl_add_u32 v8, v30, 2, v8
    v_bfe_u32 v30, v0, 4, 2
    v_lshl_add_u32 v8, v30, 12, v8
    v_bfe_u32 v30, v0, 6, 1
    v_lshl_add_u32 v8, v30, 6, v8
    v_bfe_u32 v30, v0, 7, 1
    v_lshl_add_u32 v8, v30, 14, v8
    v_add_u32 v8, 0x20000, v8
    v_bfe_u32 v3, v0, 0, 1
    v_lshlrev_b32 v3, 4, v3
    v_bfe_u32 v30, v0, 1, 1
    v_lshl_add_u32 v3, v30, 3, v3
    v_bfe_u32 v30, v0, 2, 1
    v_lshl_add_u32 v3, v30, 5, v3
    v_bfe_u32 v30, v0, 4, 1
    v_lshl_add_u32 v3, v30, 8, v3
    v_bfe_u32 v30, v0, 5, 1
    v_lshl_add_u32 v3, v30, 2, v3
    v_bfe_u32 v10, v0, 1, 1
    v_mul_u32_u24 v10, 0xaaaa, v10
    v_add_u32 v10, 0x4444, v10
    s_mov_b32 s86, 0x00ff00ff
    s_mov_b32 s87, 0x00ff00ff
    s_mov_b32 s94, 0x33333333
    s_mov_b32 s95, 0x33333333
    s_mov_b32 s82, 0x3e0293ee
    s_mov_b32 s83, 0x3e0293ee
    s_lshl_b32 s62, s46, 13
    s_lshl_b32 s63, s44, 11
    s_add_u32 s62, s62, s63
    s_add_u32 s73, s62, 0x3e0000
    s_add_u32 s76, s62, 0x13e0000
    s_add_u32 s74, s63, 0x22800
    s_lshl_b32 s62, s46, 2
    s_add_u32 s62, s62, s44
    s_lshl_b32 s64, s62, 10
    s_add_u32 s63, s64, 0x68e0000
    s_add_u32 s64, s64, 0x5de0000
    s_cmp_eq_u32 s70, 0
    s_cselect_b32 s3, s44, 4
    s_cmp_eq_u32 s70, 0
    s_cselect_b32 s77, s63, s64
    s_lshl_b32 s62, s46, 1
    s_add_u32 s62, s62, s70
    s_add_u32 s62, s62, 320
    s_lshl_b32 s62, s62, 6
    s_lshl_b32 s63, s44, 2
    s_add_u32 s78, s62, s63
    s_mul_i32 s62, s70, 327680
    s_add_u32 s62, s62, 0x6600000
    s_lshl_b32 s63, s46, 7
    s_add_u32 s79, s62, s63
    s_add_u32 s92, s79, 163840
    s_xor_b32 s92, s92, s79
    s_and_b32 s65, s44, 1
    s_lshl_b32 s65, s65, 5
    s_add_u32 s65, s65, s46
    s_cmp_lt_u32 s65, 40
    s_cselect_b32 s100, 1, 0
    s_cmp_lt_u32 s44, 2
    s_cselect_b32 s72, s100, 0
    s_lshl_b32 s63, s65, 12
    s_add_u32 s80, s62, s63
    s_sub_u32 s80, s80, 131072
    s_add_u32 s93, s80, 163840
    s_xor_b32 s93, s93, s80
    s_lshl_b32 s62, s70, 13
    s_add_u32 s88, s62, 0x66e0000
    s_lshr_b32 s63, s65, 2
    s_lshl_b32 s63, s63, 9
    s_and_b32 s64, s65, 3
    s_lshl_b32 s64, s64, 6
    s_add_u32 s63, s63, s64
    s_add_u32 s64, s62, s63
    s_add_u32 s90, s64, 0x6700000
    s_lshl_b32 s62, s62, 1
    s_add_u32 s64, s62, s63
    s_add_u32 s91, s64, 0x7200000
    s_xor_b32 s62, s62, 16384
    s_add_u32 s89, s62, 0x71e0000
    s_mov_b32 s81, 0
    s_add_u32 s64, s46, 64
    s_lshl_b32 s64, s64, 6
    s_add_u32 s65, s64, 2048
    s_add_u32 s69, s74, 8192
    s_xor_b32 s69, s69, s74
    ds_read_b64_tr_b16 v[112:113], v22 offset:49152
    ds_read_b64_tr_b16 v[114:115], v22 offset:49664
    ds_read_b64_tr_b16 v[116:117], v22 offset:57344
    ds_read_b64_tr_b16 v[118:119], v22 offset:57856
    ds_read_b64_tr_b16 v[120:121], v23 offset:49152
    ds_read_b64_tr_b16 v[122:123], v23 offset:49664
    ds_read_b64_tr_b16 v[124:125], v23 offset:57344
    ds_read_b64_tr_b16 v[126:127], v23 offset:57856
    s_waitcnt vmcnt(8) lgkmcnt(0)
    s_barrier
    s_mov_b32 s8, s22
    s_and_b32 s9, s23, 0xffff
    s_add_u32 m0, s67, 0xc000
    s_add_u32 s63, s37, 0x0
    buffer_load_dwordx4 v12, s[8:11], s63 offen lds
    s_add_u32 m0, s67, 0xc400
    s_add_u32 s63, s37, 0x0
    buffer_load_dwordx4 v13, s[8:11], s63 offen lds
    s_add_u32 m0, s67, 0xc800
    s_add_u32 s63, s37, 0x0
    buffer_load_dwordx4 v14, s[8:11], s63 offen lds
    s_add_u32 m0, s67, 0xcc00
    s_add_u32 s63, s37, 0x0
    buffer_load_dwordx4 v15, s[8:11], s63 offen lds
    v_bfe_u32 v28, v1, 4, 6
    v_min_u32 v28, 10, v28
    v_add_u32 v28, 256, v28
    v_lshlrev_b32 v28, 6, v28
    v_writelane_b32 v28, s64, 11
    v_writelane_b32 v28, s65, 12
    v_readlane_b32 s26, v64, 0
    v_readlane_b32 s27, v64, 1
    v_readlane_b32 s28, v64, 2
    v_readlane_b32 s29, v64, 3
    v_readlane_b32 s30, v64, 4
    v_readlane_b32 s31, v64, 5
    v_readlane_b32 s32, v64, 6
    v_readlane_b32 s33, v64, 7
    v_readlane_b32 s34, v65, 0
    v_readlane_b32 s60, v66, 0
    v_readlane_b32 s62, v66, 1
    s_nop 0
    s_add_u32 s60, s60, s62
    v_readlane_b32 s62, v66, 2
    s_nop 0
    s_add_u32 s60, s60, s62
    v_readlane_b32 s62, v66, 3
    s_nop 0
    s_add_u32 s60, s60, s62
    v_readlane_b32 s62, v66, 4
    s_nop 0
    s_add_u32 s60, s60, s62
    v_readlane_b32 s62, v66, 5
    s_nop 0
    s_add_u32 s60, s60, s62
    v_readlane_b32 s62, v66, 6
    s_nop 0
    s_add_u32 s60, s60, s62
    v_readlane_b32 s62, v66, 7
    s_nop 0
    s_add_u32 s60, s60, s62
    buffer_load_dword v29, v28, s[4:7], 0 offen sc1
    ds_read_b64_tr_b16 v[128:129], v52 offset:0
    ds_read_b64_tr_b16 v[130:131], v52 offset:512
    ds_read_b64_tr_b16 v[132:133], v52 offset:8192
    ds_read_b64_tr_b16 v[134:135], v52 offset:8704
    ds_read_b64_tr_b16 v[136:137], v53 offset:0
    ds_read_b64_tr_b16 v[138:139], v53 offset:512
    ds_read_b64_tr_b16 v[140:141], v53 offset:8192
    ds_read_b64_tr_b16 v[142:143], v53 offset:8704
    s_waitcnt vmcnt(8) lgkmcnt(0)
    s_barrier
    s_mov_b32 s8, s24
    s_and_b32 s9, s25, 0xffff
    s_add_u32 m0, s67, 0x10000
    s_add_u32 s63, s37, 0x80000
    buffer_load_dwordx4 v12, s[8:11], s63 offen lds
    s_add_u32 m0, s67, 0x10400
    s_add_u32 s63, s37, 0x80000
    buffer_load_dwordx4 v13, s[8:11], s63 offen lds
    s_add_u32 m0, s67, 0x10800
    s_add_u32 s63, s37, 0x80000
    buffer_load_dwordx4 v14, s[8:11], s63 offen lds
    s_add_u32 m0, s67, 0x10c00
    s_add_u32 s63, s37, 0x80000
    buffer_load_dwordx4 v15, s[8:11], s63 offen lds
    ds_read_b64_tr_b16 a[240:241], v52 offset:16384
    ds_read_b64_tr_b16 a[242:243], v52 offset:16896
    ds_read_b64_tr_b16 a[244:245], v52 offset:24576
    ds_read_b64_tr_b16 a[246:247], v52 offset:25088
    ds_read_b64_tr_b16 a[248:249], v53 offset:16384
    ds_read_b64_tr_b16 a[250:251], v53 offset:16896
    ds_read_b64_tr_b16 a[252:253], v53 offset:24576
    ds_read_b64_tr_b16 a[254:255], v53 offset:25088
    v_bfe_u32 v2, v0, 0, 6
    v_lshlrev_b32 v2, 4, v2
    v_bfe_u32 v30, v0, 6, 2
    v_lshl_add_u32 v2, v30, 12, v2
    v_add_u32 v27, 0x10000, v2
    s_waitcnt vmcnt(8) lgkmcnt(0)
    s_barrier
    s_add_u32 m0, s67, 0x14000
    s_add_u32 s63, s37, 0x100000
    buffer_load_dwordx4 v12, s[8:11], s63 offen lds
    s_add_u32 m0, s67, 0x14400
    s_add_u32 s63, s37, 0x100000
    buffer_load_dwordx4 v13, s[8:11], s63 offen lds
    s_add_u32 m0, s67, 0x14800
    s_add_u32 s63, s37, 0x100000
    buffer_load_dwordx4 v14, s[8:11], s63 offen lds
    s_add_u32 m0, s67, 0x14c00
    s_add_u32 s63, s37, 0x100000
    buffer_load_dwordx4 v15, s[8:11], s63 offen lds
    ds_write_b128 v2, v[32:35] offset:0
    ds_write_b128 v2, v[36:39] offset:1024
    ds_write_b128 v2, v[40:43] offset:2048
    ds_write_b128 v2, v[44:47] offset:3072
    ds_write_b128 v2, v[72:75] offset:16384
    ds_write_b128 v2, v[76:79] offset:17408
    ds_write_b128 v2, v[56:59] offset:18432
    ds_write_b128 v2, v[60:63] offset:19456
    s_waitcnt lgkmcnt(0)
    ds_read_b64_tr_b16 v[56:57], v52 offset:32768
    ds_read_b64_tr_b16 v[58:59], v52 offset:33280
    ds_read_b64_tr_b16 v[60:61], v52 offset:40960
    ds_read_b64_tr_b16 v[62:63], v52 offset:41472
    ds_read_b64_tr_b16 v[64:65], v53 offset:32768
    ds_read_b64_tr_b16 v[66:67], v53 offset:33280
    ds_read_b64_tr_b16 v[68:69], v53 offset:40960
    ds_read_b64_tr_b16 v[70:71], v53 offset:41472
    s_waitcnt lgkmcnt(0)
    s_barrier
    ds_write_b128 v2, v[56:59] offset:32768
    ds_write_b128 v2, v[60:63] offset:33792
    ds_write_b128 v2, v[64:67] offset:34816
    ds_write_b128 v2, v[68:71] offset:35840
    s_waitcnt vmcnt(8) lgkmcnt(0)
    s_barrier
    s_add_u32 m0, s67, 0x18000
    s_add_u32 s63, s37, 0x180000
    buffer_load_dwordx4 v12, s[8:11], s63 offen lds
    s_add_u32 m0, s67, 0x18400
    s_add_u32 s63, s37, 0x180000
    buffer_load_dwordx4 v13, s[8:11], s63 offen lds
    s_add_u32 m0, s67, 0x18800
    s_add_u32 s63, s37, 0x180000
    buffer_load_dwordx4 v14, s[8:11], s63 offen lds
    s_add_u32 m0, s67, 0x18c00
    s_add_u32 s63, s37, 0x180000
    buffer_load_dwordx4 v15, s[8:11], s63 offen lds
    ds_read_b64_tr_b16 v[56:57], v52 offset:49152
    ds_read_b64_tr_b16 v[58:59], v52 offset:49664
    ds_read_b64_tr_b16 v[60:61], v52 offset:57344
    ds_read_b64_tr_b16 v[62:63], v52 offset:57856
    ds_read_b64_tr_b16 v[64:65], v53 offset:49152
    ds_read_b64_tr_b16 v[66:67], v53 offset:49664
    ds_read_b64_tr_b16 v[68:69], v53 offset:57344
    ds_read_b64_tr_b16 v[70:71], v53 offset:57856
    s_waitcnt lgkmcnt(0)
    s_barrier
    ds_write_b128 v2, v[56:59] offset:49152
    ds_write_b128 v2, v[60:63] offset:50176
    ds_write_b128 v2, v[64:67] offset:51200
    ds_write_b128 v2, v[68:71] offset:52224
    s_waitcnt vmcnt(8) lgkmcnt(0)
    s_barrier
    s_add_u32 m0, s67, 0x1c000
    s_add_u32 s63, s37, 0x200000
    buffer_load_dwordx4 v12, s[8:11], s63 offen lds
    s_add_u32 m0, s67, 0x1c400
    s_add_u32 s63, s37, 0x200000
    buffer_load_dwordx4 v13, s[8:11], s63 offen lds
    s_add_u32 m0, s67, 0x1c800
    s_add_u32 s63, s37, 0x200000
    buffer_load_dwordx4 v14, s[8:11], s63 offen lds
    s_add_u32 m0, s67, 0x1cc00
    s_add_u32 s63, s37, 0x200000
    buffer_load_dwordx4 v15, s[8:11], s63 offen lds
    ds_read_b64_tr_b16 v[56:57], v22 offset:0
    ds_read_b64_tr_b16 v[58:59], v22 offset:512
    ds_read_b64_tr_b16 v[60:61], v22 offset:8192
    ds_read_b64_tr_b16 v[62:63], v22 offset:8704
    ds_read_b64_tr_b16 v[64:65], v23 offset:0
    ds_read_b64_tr_b16 v[66:67], v23 offset:512
    ds_read_b64_tr_b16 v[68:69], v23 offset:8192
    ds_read_b64_tr_b16 v[70:71], v23 offset:8704
    s_waitcnt lgkmcnt(0)
    s_barrier
    ds_write_b128 v27, v[56:59] offset:0
    ds_write_b128 v27, v[60:63] offset:1024
    ds_write_b128 v27, v[64:67] offset:2048
    ds_write_b128 v27, v[68:71] offset:3072
    s_waitcnt vmcnt(8) lgkmcnt(0)
    s_barrier
    s_mov_b32 s62, s60
    v_readlane_b32 s35, v29, 10
    v_readlane_b32 s0, v29, 11
    v_readlane_b32 s1, v29, 12
    v_cmp_eq_u32 vcc, 0, v29
    s_nop 0
    s_cmp_eq_u64 vcc, 0
    s_cselect_b32 s60, 1, 0
    s_cmp_ge_u32 s62, 256
    s_cselect_b32 s60, s60, 0
    s_cmp_eq_u32 s60, 0
    s_cbranch_scc1 L_ek_20
    s_mov_b32 m0, s74
    s_xor_b32 s74, s74, s69
    buffer_load_dwordx4 v1, s[4:7], s73 offen sc1 lds
    buffer_load_dwordx4 v1, s[4:7], s73 offen offset:1024 sc1 lds
    s_add_u32 s73, s73, 262144
L_ek_20:
    ds_read_b64_tr_b16 v[56:57], v22 offset:16384
    ds_read_b64_tr_b16 v[58:59], v22 offset:16896
    ds_read_b64_tr_b16 v[60:61], v22 offset:24576
    ds_read_b64_tr_b16 v[62:63], v22 offset:25088
    ds_read_b64_tr_b16 v[64:65], v23 offset:16384
    ds_read_b64_tr_b16 v[66:67], v23 offset:16896
    ds_read_b64_tr_b16 v[68:69], v23 offset:24576
    ds_read_b64_tr_b16 v[70:71], v23 offset:25088
    s_waitcnt lgkmcnt(0)
    s_barrier
    ds_write_b128 v27, v[56:59] offset:16384
    ds_write_b128 v27, v[60:63] offset:17408
    ds_write_b128 v27, v[64:67] offset:18432
    ds_write_b128 v27, v[68:71] offset:19456
    s_waitcnt vmcnt(4) lgkmcnt(0)
    s_barrier
    ds_read_b64_tr_b16 v[56:57], v22 offset:32768
    ds_read_b64_tr_b16 v[58:59], v22 offset:33280
    ds_read_b64_tr_b16 v[60:61], v22 offset:40960
    ds_read_b64_tr_b16 v[62:63], v22 offset:41472
    ds_read_b64_tr_b16 v[64:65], v23 offset:32768
    ds_read_b64_tr_b16 v[66:67], v23 offset:33280
    ds_read_b64_tr_b16 v[68:69], v23 offset:40960
    ds_read_b64_tr_b16 v[70:71], v23 offset:41472
    s_waitcnt lgkmcnt(0)
    s_barrier
    ds_write_b128 v27, v[56:59] offset:32768
    ds_write_b128 v27, v[60:63] offset:33792
    ds_write_b128 v27, v[64:67] offset:34816
    ds_write_b128 v27, v[68:71] offset:35840
    s_waitcnt vmcnt(0) lgkmcnt(0)
    s_barrier
    ds_read_b64_tr_b16 v[56:57], v22 offset:49152
    ds_read_b64_tr_b16 v[58:59], v22 offset:49664
    ds_read_b64_tr_b16 v[60:61], v22 offset:57344
    ds_read_b64_tr_b16 v[62:63], v22 offset:57856
    ds_read_b64_tr_b16 v[64:65], v23 offset:49152
    ds_read_b64_tr_b16 v[66:67], v23 offset:49664
    ds_read_b64_tr_b16 v[68:69], v23 offset:57344
    ds_read_b64_tr_b16 v[70:71], v23 offset:57856
    s_waitcnt lgkmcnt(0)
    s_barrier
    ds_write_b128 v27, v[56:59] offset:49152
    ds_write_b128 v27, v[60:63] offset:50176
    ds_write_b128 v27, v[64:67] offset:51200
    ds_write_b128 v27, v[68:71] offset:52224
    s_mov_b32 s37, s69
    s_mov_b32 s75, 0x6000
    s_mov_b32 s68, 0
    s_cmp_lg_u32 s60, 0
    s_cbranch_scc1 L_CH_SEEN
    v_and_b32 v30, 7, v0
    v_lshlrev_b32 v30, 5, v30
    v_and_b32 v31, 8, v0
    v_lshl_add_u32 v30, v31, 1, v30
    s_mov_b32 s60, 0
L_tk_21:
    buffer_load_dword v31, v30, s[48:51], 0 offen sc1
    s_waitcnt vmcnt(0)
    v_readlane_b32 s62, v31, 8
    v_readlane_b32 s52, v31, 9
    s_nop 0
    s_add_u32 s62, s62, s52
    v_readlane_b32 s52, v31, 10
    s_nop 0
    s_add_u32 s62, s62, s52
    v_readlane_b32 s52, v31, 11
    s_nop 0
    s_add_u32 s62, s62, s52
    v_readlane_b32 s52, v31, 12
    s_nop 0
    s_add_u32 s62, s62, s52
    v_readlane_b32 s52, v31, 13
    s_nop 0
    s_add_u32 s62, s62, s52
    v_readlane_b32 s52, v31, 14
    s_nop 0
    s_add_u32 s62, s62, s52
    v_readlane_b32 s52, v31, 15
    s_nop 0
    s_add_u32 s62, s62, s52
    s_cmp_ge_u32 s62, 256
    s_cbranch_scc1 L_tkd_22
    s_sleep 2
    s_add_u32 s60, s60, 1
    s_cmp_lt_u32 s60, 0x100000
    s_cbranch_scc1 L_tk_21
    s_movk_i32 s62, 1
    s_branch L_ABORT
L_tkd_22:
    buffer_load_dword v31, v30, s[48:51], 0 offen sc1
    s_waitcnt vmcnt(0)
    v_readlane_b32 s52, v31, 0
    v_readlane_b32 s53, v31, 1
    v_readlane_b32 s54, v31, 2
    v_readlane_b32 s55, v31, 3
    v_readlane_b32 s56, v31, 4
    v_readlane_b32 s57, v31, 5
    v_readlane_b32 s58, v31, 6
    v_readlane_b32 s59, v31, 7
    s_mov_b32 s26, s52
    s_mov_b32 s27, s53
    v_mov_b32 v30, 4
    buffer_load_dword v32, v30, s[48:51], 0 offen sc1
    v_bfe_u32 v30, v1, 4, 6
    v_min_u32 v30, 10, v30
    v_add_u32 v30, 256, v30
    v_lshlrev_b32 v30, 6, v30
    s_mov_b32 s60, 0
L_pf_23:
    buffer_load_dword v31, v30, s[4:7], 0 offen sc1
    s_waitcnt vmcnt(0)
    v_cmp_gt_u32 vcc, 1, v31
    s_nop 0
    s_cbranch_vccz L_pfd_24
    s_sleep 1
    s_add_u32 s60, s60, 1
    s_cmp_lt_u32 s60, 0x100000
    s_cbranch_scc1 L_pf_23
    s_movk_i32 s62, 12
    s_branch L_ABORT
L_pfd_24:
    v_readfirstlane_b32 s34, v32
    v_readlane_b32 s35, v31, 10
    s_cmp_lt_u32 s68, 1
    s_cbranch_scc1 L_kv_25
L_kvr_26:
    s_mov_b32 m0, s74
    s_xor_b32 s74, s74, s69
    buffer_load_dwordx4 v1, s[4:7], s73 offen sc1 lds
    buffer_load_dwordx4 v1, s[4:7], s73 offen offset:1024 sc1 lds
    s_add_u32 s73, s73, 262144
    s_mov_b32 s0, 0
    s_mov_b32 s1, 0
L_CH_SEEN:
    s_min_u32 s62, s0, s1
    s_max_u32 s68, s68, s62
    s_min_u32 s63, s26, s27
    s_cmp_ge_u32 s63, 32
    s_cselect_b32 s71, 1, 0
    s_cmp_eq_u32 s34, 0
    s_cselect_b32 s71, s71, 0
    s_cmp_eq_u32 s35, 2
    s_cselect_b32 s62, 8192, 0
    s_add_u32 s91, s91, s62
    s_add_u32 s89, s89, s62
    s_mov_b32 s52, 0x03030303
    s_mov_b32 s53, 0x03030303
    s_mov_b32 s54, 0x0c0c0c0c
    s_mov_b32 s55, 0x0c0c0c0c
    s_mov_b32 s56, 0x30303030
    s_mov_b32 s57, 0x30303030
    s_mov_b32 s58, 0xc0c0c0c0
    s_mov_b32 s59, 0xc0c0c0c0
    v_add_u32 v0, 10240, v1
    v_mov_b64 v[12:13], 0
    v_mov_b64 v[14:15], 0
    v_mov_b64 v[16:17], 0
    v_mov_b64 v[18:19], 0
    v_mov_b64 v[20:21], 0
    v_mov_b64 v[22:23], 0
    v_mov_b64 v[24:25], 0
    v_mov_b64 v[26:27], 0
    v_mov_b64 v[28:29], 0
    v_mov_b64 v[30:31], 0
    v_mov_b64 v[32:33], 0
    v_mov_b64 v[34:35], 0
    s_mov_b32 s61, 0
    s_waitcnt vmcnt(0) lgkmcnt(0)
    s_barrier
    ds_read_b128 v[56:59], v2 offset:32768
    ds_read_b128 v[60:63], v2 offset:33792
    ds_read_b128 v[64:67], v2 offset:49152
    ds_read_b128 v[68:71], v2 offset:50176
    ds_read_b128 v[48:51], v2 offset:34816
    ds_read_b128 v[52:55], v2 offset:35840
    s_lshl_b32 s62, s44, 10
    s_mov_b32 s2, s62
    s_add_u32 s85, s62, 136192
    s_add_u32 s98, s62, s89
    s_mul_i32 s99, s44, 768
    s_sub_u32 s99, 4096, s99
    s_mul_i32 s63, s70, 327680
    s_lshl_b32 s64, s46, 12
    s_add_u32 s63, s63, s64
    s_add_u32 s63, s63, s2
    s_add_u32 s101, s63, 0x65e0000
    s_add_u32 s64, s101, 163840
    s_xor_b32 s40, s101, s64
    s_lshl_b32 s63, s70, 13
    s_lshr_b32 s64, s46, 2
    s_lshl_b32 s64, s64, 9
    s_and_b32 s62, s46, 3
    s_lshl_b32 s62, s62, 6
    s_add_u32 s64, s64, s62
    s_add_u32 s63, s63, s64
    s_add_u32 s41, s63, 0x6700000
    s_cmp_lt_u32 s46, 8
    s_cselect_b32 s10, 131072, 0
    s_cselect_b64 s[42:43], -1, 15
    s_movk_i32 s66, 0xff
    s_cselect_b32 s66, 0xffff, s66
    s_mov_b32 s67, 0
    v_bfe_u32 v11, v1, 4, 2
    v_lshlrev_b32 v11, 4, v11
    v_bfe_u32 v40, v1, 6, 1
    v_lshl_add_u32 v11, v40, 8, v11
    v_bfe_u32 v40, v1, 7, 1
    v_lshl_add_u32 v11, v40, 12, v11
    s_mov_b32 s38, 0x3f803f80
    s_mov_b32 s39, 0x3f803f80
    s_mov_b32 s8, 0x3f003f00
    s_mov_b32 s9, 0x3f003f00
    s_add_u32 s88, s88, s2
    s_add_u32 s100, s2, 131072
    s_add_u32 s84, s46, 64
    s_lshl_b32 s84, s84, 6
    s_add_u32 s36, s84, 2048
    s_cmp_eq_u32 s71, 0
    s_cbranch_scc1 L_CH_FIRST_G
    s_lshl_b32 s62, s70, 2
    s_add_u32 s62, s62, s44
    s_cmp_eq_u32 s62, 0
    s_cbranch_scc1 L_CH_FIRST_00
    s_cmp_eq_u32 s62, 1
    s_cbranch_scc1 L_CH_FIRST_10
    s_cmp_eq_u32 s62, 2
    s_cbranch_scc1 L_CH_FIRST_20
    s_cmp_eq_u32 s62, 3
    s_cbranch_scc1 L_CH_FIRST_30
    s_cmp_eq_u32 s62, 4
    s_cbranch_scc1 L_CH_FIRST_01
    s_cmp_eq_u32 s62, 5
    s_cbranch_scc1 L_CH_FIRST_11
    s_cmp_eq_u32 s62, 6
    s_cbranch_scc1 L_CH_FIRST_21
    s_cmp_eq_u32 s62, 7
    s_cbranch_scc1 L_CH_FIRST_31
    s_branch L_CH_FIRST_G
L_CH_FIRST_00:
    ds_read_b128 v[36:39], v1 offset:0
    ds_read_b128 v[40:43], v1 offset:1024
    ds_read_b128 v[44:47], v1 offset:2048
    ds_read_b128 v[72:75], v1 offset:3072
    ds_read_b128 v[76:79], v1 offset:4096
    s_waitcnt lgkmcnt(4)
    v_smfmac_f32_16x16x64_bf16 v[12:15], v[36:39], a[0:7], v10
    s_waitcnt lgkmcnt(3)
    v_smfmac_f32_16x16x64_bf16 v[12:15], v[40:43], a[16:23], v10
    s_waitcnt lgkmcnt(2)
    v_smfmac_f32_16x16x64_bf16 v[12:15], v[44:47], a[32:39], v10
    s_waitcnt lgkmcnt(1)
    v_smfmac_f32_16x16x64_bf16 v[12:15], v[72:75], a[48:55], v10
    s_waitcnt lgkmcnt(0)
    v_smfmac_f32_16x16x64_bf16 v[12:15], v[76:79], a[64:71], v10
    v_smfmac_f32_16x16x64_bf16 v[16:19], v[36:39], a[8:15], v10
    v_smfmac_f32_16x16x64_bf16 v[16:19], v[40:43], a[24:31], v10
    v_smfmac_f32_16x16x64_bf16 v[16:19], v[44:47], a[40:47], v10
    v_smfmac_f32_16x16x64_bf16 v[16:19], v[72:75], a[56:63], v10
    v_smfmac_f32_16x16x64_bf16 v[16:19], v[76:79], a[72:79], v10
    v_smfmac_f32_16x16x64_bf16 v[28:31], v[36:39], v[56:63], v10
    ds_read_b128 v[56:59], v2 offset:51200
    ds_read_b128 v[60:63], v2 offset:52224
    v_smfmac_f32_16x16x64_bf16 v[20:23], v[36:39], v[64:71], v10
    v_xor_b32 v2, 0x10000, v2
    ds_read_b128 v[64:67], v2 offset:0
    ds_read_b128 v[68:71], v2 offset:1024
    v_smfmac_f32_16x16x64_bf16 v[32:35], v[36:39], v[48:55], v10
    ds_read_b128 v[48:51], v2 offset:2048
    ds_read_b128 v[52:55], v2 offset:3072
    v_smfmac_f32_16x16x64_bf16 v[20:23], v[40:43], a[208:215], v10
    s_waitcnt lgkmcnt(4)
    v_smfmac_f32_16x16x64_bf16 v[24:27], v[36:39], v[56:63], v10
    ds_read_b128 v[56:59], v2 offset:16384
    ds_read_b128 v[60:63], v2 offset:17408
    v_smfmac_f32_16x16x64_bf16 v[24:27], v[40:43], a[216:223], v10
    s_waitcnt lgkmcnt(4)
    v_smfmac_f32_16x16x64_bf16 v[28:31], v[40:43], v[64:71], v10
    ds_read_b128 v[64:67], v2 offset:18432
    ds_read_b128 v[68:71], v2 offset:19456
    v_smfmac_f32_16x16x64_bf16 v[20:23], v[44:47], a[224:231], v10
    s_waitcnt lgkmcnt(4)
    v_smfmac_f32_16x16x64_bf16 v[32:35], v[40:43], v[48:55], v10
    ds_read_b128 v[48:51], v2 offset:32768
    ds_read_b128 v[52:55], v2 offset:33792
    v_smfmac_f32_16x16x64_bf16 v[24:27], v[44:47], a[232:239], v10
    s_waitcnt lgkmcnt(4)
    v_smfmac_f32_16x16x64_bf16 v[28:31], v[44:47], v[56:63], v10
    ds_read_b128 v[56:59], v2 offset:34816
    ds_read_b128 v[60:63], v2 offset:35840
    s_waitcnt lgkmcnt(4)
    v_smfmac_f32_16x16x64_bf16 v[32:35], v[44:47], v[64:71], v10
    ds_read_b128 v[64:67], v2 offset:49152
    ds_read_b128 v[68:71], v2 offset:50176
    s_waitcnt lgkmcnt(4)
    v_smfmac_f32_16x16x64_bf16 v[28:31], v[72:75], v[48:55], v10
    ds_read_b128 v[48:51], v2 offset:51200
    ds_read_b128 v[52:55], v2 offset:52224
    s_waitcnt lgkmcnt(4)
    v_smfmac_f32_16x16x64_bf16 v[32:35], v[72:75], v[56:63], v10
    s_barrier
    s_mov_b32 s69, 2
    ds_read_b128 v[56:59], v1 offset:8192
    ds_read_b128 v[60:63], v1 offset:9216
    s_waitcnt lgkmcnt(4)
    v_smfmac_f32_16x16x64_bf16 v[28:31], v[76:79], v[64:71], v10
    ds_read_b128 v[64:67], v1 offset:5120
    ds_read_b128 v[68:71], v1 offset:6144
    s_waitcnt lgkmcnt(4)
    v_smfmac_f32_16x16x64_bf16 v[32:35], v[76:79], v[48:55], v10
    ds_read_b128 v[48:51], v1 offset:7168
    v_smfmac_f32_16x16x64_bf16 v[20:23], v[72:75], v[144:151], v10
    s_waitcnt lgkmcnt(4)
    v_smfmac_f32_16x16x64_bf16 v[12:15], v[56:59], a[128:135], v10
    s_waitcnt lgkmcnt(3)
    v_smfmac_f32_16x16x64_bf16 v[12:15], v[60:63], a[144:151], v10
    s_waitcnt lgkmcnt(2)
    v_smfmac_f32_16x16x64_bf16 v[12:15], v[64:67], a[80:87], v10
    s_waitcnt lgkmcnt(1)
    v_smfmac_f32_16x16x64_bf16 v[12:15], v[68:71], a[96:103], v10
    s_waitcnt lgkmcnt(0)
    v_smfmac_f32_16x16x64_bf16 v[12:15], v[48:51], a[112:119], v10
    s_cmp_lt_u32 s68, s69
    s_cbranch_scc1 L_kv_27
L_kvr_28:
    v_smfmac_f32_16x16x64_bf16 v[24:27], v[72:75], v[152:159], v10
    v_smfmac_f32_16x16x64_bf16 v[20:23], v[76:79], v[160:167], v10
    v_smfmac_f32_16x16x64_bf16 v[24:27], v[76:79], v[168:175], v10
    s_branch L_CH_C_00
    .p2align 6
L_CH_B1_00:
    s_barrier
L_CH_LOOP_00:
    ds_read_b128 v[36:39], v1 offset:0
    ds_read_b128 v[40:43], v1 offset:1024
    ds_read_b128 v[44:47], v1 offset:2048
    ds_read_b128 v[72:75], v1 offset:3072
    ds_read_b128 v[76:79], v1 offset:4096
L_CH_A1_00:
    s_waitcnt lgkmcnt(4)
    v_smfmac_f32_16x16x64_bf16 v[12:15], v[36:39], a[0:7], v10
    s_waitcnt lgkmcnt(3)
    v_smfmac_f32_16x16x64_bf16 v[12:15], v[40:43], a[16:23], v10
    s_waitcnt lgkmcnt(2)
    v_smfmac_f32_16x16x64_bf16 v[12:15], v[44:47], a[32:39], v10
    s_waitcnt lgkmcnt(1)
    v_smfmac_f32_16x16x64_bf16 v[12:15], v[72:75], a[48:55], v10
    s_waitcnt lgkmcnt(0)
    v_smfmac_f32_16x16x64_bf16 v[12:15], v[76:79], a[64:71], v10
    v_smfmac_f32_16x16x64_bf16 v[16:19], v[36:39], a[8:15], v10
    v_smfmac_f32_16x16x64_bf16 v[16:19], v[40:43], a[24:31], v10
    s_add_u32 s69, s61, 2
    s_min_u32 s69, s69, 64
    s_mov_b32 m0, s85
    s_add_u32 s64, s98, s99
    s_nop 1
    v_cmp_u_f32 vcc, v12, v13
    v_cmp_u_f32 s[62:63], v14, v15
    v_smfmac_f32_16x16x64_bf16 v[16:19], v[44:47], a[40:47], v10
    s_or_b64 vcc, vcc, s[62:63]
    s_cbranch_scc1 L_CH_LRETRY_00
L_CH_LGO_00:
    buffer_load_dwordx4 v1, s[4:7], s98 offen sc1 lds
    s_add_u32 m0, s85, s99
    s_mov_b64 exec, 0xffff
    buffer_load_dwordx4 v1, s[4:7], s64 offen sc1 lds
    s_mov_b64 exec, -1
    v_smfmac_f32_16x16x64_bf16 v[16:19], v[72:75], a[56:63], v10
    v_smfmac_f32_16x16x64_bf16 v[16:19], v[76:79], a[72:79], v10
    v_smfmac_f32_16x16x64_bf16 v[28:31], v[36:39], v[56:63], v10
    ds_read_b128 v[56:59], v2 offset:51200
    ds_read_b128 v[60:63], v2 offset:52224
    v_smfmac_f32_16x16x64_bf16 v[20:23], v[36:39], v[64:71], v10
    v_xor_b32 v2, 0x10000, v2
    ds_read_b128 v[64:67], v2 offset:0
    ds_read_b128 v[68:71], v2 offset:1024
    v_smfmac_f32_16x16x64_bf16 v[32:35], v[36:39], v[48:55], v10
    ds_read_b128 v[48:51], v2 offset:2048
    ds_read_b128 v[52:55], v2 offset:3072
    v_smfmac_f32_16x16x64_bf16 v[20:23], v[40:43], a[208:215], v10
    v_mov_b32 v9, s61
    s_mov_b64 exec, 1
    buffer_store_dword v9, off, s[4:7], s78 sc1
    s_mov_b64 exec, -1
    s_waitcnt lgkmcnt(4)
    v_smfmac_f32_16x16x64_bf16 v[24:27], v[36:39], v[56:63], v10
    ds_read_b128 v[56:59], v2 offset:16384
    ds_read_b128 v[60:63], v2 offset:17408
    v_smfmac_f32_16x16x64_bf16 v[24:27], v[40:43], a[216:223], v10
    s_waitcnt lgkmcnt(4)
    v_smfmac_f32_16x16x64_bf16 v[28:31], v[40:43], v[64:71], v10
    ds_read_b128 v[64:67], v2 offset:18432
    ds_read_b128 v[68:71], v2 offset:19456
    v_smfmac_f32_16x16x64_bf16 v[20:23], v[44:47], a[224:231], v10
    s_waitcnt lgkmcnt(4)
    v_smfmac_f32_16x16x64_bf16 v[32:35], v[40:43], v[48:55], v10
    ds_read_b128 v[48:51], v2 offset:32768
    ds_read_b128 v[52:55], v2 offset:33792
    v_smfmac_f32_16x16x64_bf16 v[24:27], v[44:47], a[232:239], v10
    s_waitcnt lgkmcnt(4)
    v_smfmac_f32_16x16x64_bf16 v[28:31], v[44:47], v[56:63], v10
    ds_read_b128 v[56:59], v2 offset:34816
    ds_read_b128 v[60:63], v2 offset:35840
    s_waitcnt lgkmcnt(4)
    v_smfmac_f32_16x16x64_bf16 v[32:35], v[44:47], v[64:71], v10
    ds_read_b128 v[64:67], v2 offset:49152
    ds_read_b128 v[68:71], v2 offset:50176
    s_waitcnt lgkmcnt(4)
    v_smfmac_f32_16x16x64_bf16 v[28:31], v[72:75], v[48:55], v10
    ds_read_b128 v[48:51], v2 offset:51200
    ds_read_b128 v[52:55], v2 offset:52224
    s_waitcnt lgkmcnt(4)
    v_smfmac_f32_16x16x64_bf16 v[32:35], v[72:75], v[56:63], v10
    s_waitcnt vmcnt(1)
    s_barrier
    ds_read_b128 v[56:59], v1 offset:8192
    ds_read_b128 v[60:63], v1 offset:9216
    s_waitcnt lgkmcnt(4)
    v_smfmac_f32_16x16x64_bf16 v[28:31], v[76:79], v[64:71], v10
    ds_read_b128 v[64:67], v1 offset:5120
    ds_read_b128 v[68:71], v1 offset:6144
    s_waitcnt lgkmcnt(4)
    v_smfmac_f32_16x16x64_bf16 v[32:35], v[76:79], v[48:55], v10
    ds_read_b128 v[48:51], v1 offset:7168
    v_smfmac_f32_16x16x64_bf16 v[20:23], v[72:75], v[144:151], v10
    s_waitcnt lgkmcnt(4)
    v_smfmac_f32_16x16x64_bf16 v[12:15], v[56:59], a[128:135], v10
    s_waitcnt lgkmcnt(3)
    v_smfmac_f32_16x16x64_bf16 v[12:15], v[60:63], a[144:151], v10
    s_waitcnt lgkmcnt(2)
    v_smfmac_f32_16x16x64_bf16 v[12:15], v[64:67], a[80:87], v10
    s_waitcnt lgkmcnt(1)
    v_smfmac_f32_16x16x64_bf16 v[12:15], v[68:71], a[96:103], v10
    s_waitcnt lgkmcnt(0)
    v_smfmac_f32_16x16x64_bf16 v[12:15], v[48:51], a[112:119], v10
    s_cmp_lt_u32 s68, s69
    s_cbranch_scc1 L_kv_29
L_kvr_30:
    v_smfmac_f32_16x16x64_bf16 v[24:27], v[72:75], v[152:159], v10
    v_smfmac_f32_16x16x64_bf16 v[20:23], v[76:79], v[160:167], v10
    v_smfmac_f32_16x16x64_bf16 v[24:27], v[76:79], v[168:175], v10
    s_nop 2
    v_cmp_u_f32 vcc, v12, v13
    v_cmp_u_f32 s[62:63], v14, v15
    s_nop 0
    s_or_b64 vcc, vcc, s[62:63]
    s_cbranch_scc1 L_CH_RETRY_00
L_CH_C_00:
    v_smfmac_f32_16x16x64_bf16 v[16:19], v[64:67], a[88:95], v10
    buffer_load_dwordx4 v[72:75], v1, s[4:7], s76 offen sc1
    v_smfmac_f32_16x16x64_bf16 v[16:19], v[68:71], a[104:111], v10
    v_smfmac_f32_16x16x64_bf16 v[16:19], v[48:51], a[120:127], v10
    buffer_load_dwordx4 v[76:79], v1, s[4:7], s76 offen offset:1024 sc1
    s_add_u32 s76, s76, 262144
    v_smfmac_f32_16x16x64_bf16 v[16:19], v[56:59], a[136:143], v10
    v_pk_add_f32 v[12:13], v[12:13], v[14:15]
    v_smfmac_f32_16x16x64_bf16 v[16:19], v[60:63], a[152:159], v10
    ds_read_b128 v[36:39], v0 offset:0
    ds_read_b128 v[40:43], v0 offset:1024
    v_cvt_pk_bf16_f32 v14, v12, v13
    v_smfmac_f32_16x16x64_bf16 v[20:23], v[64:67], v[176:183], v10
    ds_read_b128 v[44:47], v0 offset:2048
    ds_read_b128 v[52:55], v0 offset:3072
    v_smfmac_f32_16x16x64_bf16 v[24:27], v[64:67], v[184:191], v10
    v_smfmac_f32_16x16x64_bf16 v[20:23], v[68:71], v[192:199], v10
    v_pk_add_f32 v[16:17], v[16:17], v[18:19]
    v_smfmac_f32_16x16x64_bf16 v[24:27], v[68:71], v[200:207], v10
    v_cvt_pk_bf16_f32 v18, v16, v17
    v_smfmac_f32_16x16x64_bf16 v[20:23], v[48:51], v[208:215], v10
    ds_write_b32 v4, v14 offset:0
    ds_write_b32 v4, v18 offset:528
    v_smfmac_f32_16x16x64_bf16 v[24:27], v[48:51], v[216:223], v10
    v_smfmac_f32_16x16x64_bf16 v[20:23], v[56:59], v[224:231], v10
    s_mov_b32 m0, s74
    s_xor_b32 s74, s74, s37
    buffer_load_dwordx4 v1, s[4:7], s73 offen sc1 lds
    v_smfmac_f32_16x16x64_bf16 v[24:27], v[56:59], v[232:239], v10
    v_smfmac_f32_16x16x64_bf16 v[20:23], v[60:63], v[240:247], v10
    buffer_load_dwordx4 v1, s[4:7], s73 offen offset:1024 sc1 lds
    s_add_u32 s73, s73, 262144
    v_smfmac_f32_16x16x64_bf16 v[24:27], v[60:63], v[248:255], v10
    s_waitcnt lgkmcnt(0)
    s_barrier
    ds_read_b64_tr_b16 v[12:13], v5 offset:0
    ds_read_b64_tr_b16 v[14:15], v5 offset:272
    v_smfmac_f32_16x16x64_bf16 v[28:31], v[64:67], v[80:87], v10
    ds_read_b64_tr_b16 v[16:17], v5 offset:1056
    ds_read_b64_tr_b16 v[18:19], v5 offset:1328
    v_pk_add_f32 v[20:21], v[20:21], v[22:23]
    v_smfmac_f32_16x16x64_bf16 v[32:35], v[64:67], v[88:95], v10
    ds_read_b64_tr_b16 v[64:65], v5 offset:2112
    ds_read_b64_tr_b16 v[66:67], v5 offset:2384
    v_pk_add_f32 v[24:25], v[24:25], v[26:27]
    v_cvt_pk_bf16_f32 v22, v20, v21
    v_smfmac_f32_16x16x64_bf16 v[28:31], v[68:71], v[96:103], v10
    v_cvt_pk_bf16_f32 v26, v24, v25
    ds_write_b32 v4, v22 offset:26624
    ds_write_b32 v4, v26 offset:27152
    v_smfmac_f32_16x16x64_bf16 v[32:35], v[68:71], v[104:111], v10
    ds_read_b64_tr_b16 v[68:69], v5 offset:3168
    ds_read_b64_tr_b16 v[70:71], v5 offset:3440
    v_smfmac_f32_16x16x64_bf16 v[28:31], v[48:51], v[112:119], v10
    v_smfmac_f32_16x16x64_bf16 v[32:35], v[48:51], v[120:127], v10
    ds_read_b128 v[48:51], v0 offset:4096
    v_smfmac_f32_16x16x64_bf16 v[28:31], v[56:59], v[128:135], v10
    v_smfmac_f32_16x16x64_bf16 v[32:35], v[56:59], v[136:143], v10
    ds_read_b128 v[56:59], v0 offset:5120
    v_smfmac_f32_16x16x64_bf16 v[28:31], v[60:63], a[240:247], v10
    v_smfmac_f32_16x16x64_bf16 v[32:35], v[60:63], a[248:255], v10
    s_waitcnt lgkmcnt(10)
    v_mfma_f32_16x16x32_bf16 v[60:63], v[36:39], v[12:15], 0
    ds_read_b128 v[36:39], v0 offset:6144
    s_waitcnt lgkmcnt(9)
    v_mfma_f32_16x16x32_bf16 v[60:63], v[40:43], v[16:19], v[60:63]
    ds_read_b128 v[40:43], v0 offset:7168
    s_waitcnt lgkmcnt(8)
    v_mfma_f32_16x16x32_bf16 v[60:63], v[44:47], v[64:67], v[60:63]
    v_cvt_pk_bf16_f32 v28, v28, v29
    v_cvt_pk_bf16_f32 v29, v30, v31
    s_waitcnt lgkmcnt(4)
    v_mfma_f32_16x16x32_bf16 v[60:63], v[52:55], v[68:71], v[60:63]
    v_cvt_pk_bf16_f32 v30, v32, v33
    v_cvt_pk_bf16_f32 v31, v34, v35
    s_cmp_eq_u32 s61, 63
    s_barrier
    s_cbranch_scc1 L_CH_LAST_00
    ds_read_b64_tr_b16 v[44:45], v5 offset:26624
    ds_read_b64_tr_b16 v[46:47], v5 offset:26896
    ds_read_b64_tr_b16 v[52:53], v5 offset:27680
    ds_read_b64_tr_b16 v[54:55], v5 offset:27952
    s_waitcnt lgkmcnt(7)
    v_mfma_f32_16x16x32_bf16 v[20:23], v[48:51], v[12:15], 0
    ds_read_b64_tr_b16 v[48:49], v5 offset:28736
    ds_read_b64_tr_b16 v[50:51], v5 offset:29008
    s_waitcnt lgkmcnt(8)
    v_mfma_f32_16x16x32_bf16 v[20:23], v[56:59], v[16:19], v[20:23]
    ds_read_b64_tr_b16 v[56:57], v5 offset:29792
    ds_read_b64_tr_b16 v[58:59], v5 offset:30064
    s_waitcnt lgkmcnt(9)
    v_mfma_f32_16x16x32_bf16 v[20:23], v[36:39], v[64:67], v[20:23]
    s_waitcnt lgkmcnt(8)
    v_mfma_f32_16x16x32_bf16 v[20:23], v[40:43], v[68:71], v[20:23]
    v_xor_b32 v0, s75, v0
    s_waitcnt lgkmcnt(6)
    v_mfma_f32_16x16x32_bf16 v[24:27], v[44:47], v[12:15], 0
    v_max3_f32 v32, v60, v61, v62
    buffer_store_dwordx4 v[44:47], v1, s[4:7], s77 offen sc1
    s_waitcnt lgkmcnt(4)
    v_mfma_f32_16x16x32_bf16 v[24:27], v[52:55], v[16:19], v[24:27]
    s_waitcnt lgkmcnt(2)
    v_mfma_f32_16x16x32_bf16 v[24:27], v[48:51], v[64:67], v[24:27]
    s_waitcnt lgkmcnt(0)
    v_mfma_f32_16x16x32_bf16 v[24:27], v[56:59], v[68:71], v[24:27]
    v_max3_f32 v32, v32, v63, v20
    v_max3_f32 v33, v21, v22, v23
    v_mov_b64 v[18:19], s[8:9]
    s_add_u32 s77, s77, 131072
    v_mov_b64 v[44:45], 0
    v_mov_b64 v[46:47], 0
    v_mov_b64 v[48:49], s[38:39]
    v_mov_b64 v[50:51], s[38:39]
    v_max_f32 v32, v32, v33
    v_max3_f32 v33, v32, v24, v25
    v_max3_f32 v32, v32, v24, v25
    v_mov_b64 v[56:57], 0
    v_mov_b64 v[58:59], 0
    v_permlane16_swap_b32 v32, v33
    v_max_f32 v34, v32, v33
    v_max_f32 v35, v32, v33
    v_mov_b64 v[64:65], 0
    v_mov_b64 v[66:67], 0
    v_permlane32_swap_b32 v34, v35
    v_max_f32 v32, v34, v35
    v_mul_f32 v32, s82, v32
    v_pk_fma_f32 v[60:61], v[60:61], s[82:83], v[32:33] op_sel_hi:[1,0,0] neg_lo:[0,0,1] neg_hi:[0,0,1]
    v_pk_fma_f32 v[62:63], v[62:63], s[82:83], v[32:33] op_sel_hi:[1,0,0] neg_lo:[0,0,1] neg_hi:[0,0,1]
    v_pk_fma_f32 v[20:21], v[20:21], s[82:83], v[32:33] op_sel_hi:[1,0,0] neg_lo:[0,0,1] neg_hi:[0,0,1]
    v_pk_fma_f32 v[22:23], v[22:23], s[82:83], v[32:33] op_sel_hi:[1,0,0] neg_lo:[0,0,1] neg_hi:[0,0,1]
    v_pk_fma_f32 v[24:25], v[24:25], s[82:83], v[32:33] op_sel_hi:[1,0,0] neg_lo:[0,0,1] neg_hi:[0,0,1]
    v_exp_f32 v60, v60
    v_exp_f32 v61, v61
    v_exp_f32 v62, v62
    v_cvt_pk_bf16_f32 v12, v60, v61
    v_exp_f32 v63, v63
    v_exp_f32 v20, v20
    v_cvt_pk_bf16_f32 v13, v62, v63
    v_exp_f32 v21, v21
    v_exp_f32 v22, v22
    v_cvt_pk_bf16_f32 v14, v20, v21
    v_exp_f32 v23, v23
    v_exp_f32 v24, v24
    v_cvt_pk_bf16_f32 v15, v22, v23
    v_exp_f32 v25, v25
    s_waitcnt vmcnt(3)
    v_mfma_f32_16x16x32_bf16 v[36:39], v[72:75], v[12:15], 0
    v_cvt_pk_bf16_f32 v16, v24, v25
    v_cvt_pk_bf16_f32 v17, v24, v25
    v_mfma_f32_16x16x32_bf16 v[40:43], v[76:79], v[12:15], 0
    s_add_u32 s81, s81, 16384
    s_and_b32 s81, s81, 0xffff
    s_add_u32 s61, s61, 1
    v_mfma_f32_16x16x16_bf16 v[36:39], v[28:29], v[16:17], v[36:39]
    v_mov_b64 v[68:69], 0
    v_mov_b64 v[70:71], 0
    v_mfma_f32_16x16x16_bf16 v[40:43], v[30:31], v[16:17], v[40:43]
    v_mfma_f32_16x16x32_bf16 v[24:27], v[12:15], v[48:51], 0
    v_xor_b32 v2, 0x10000, v2
    ds_read_b128 v[72:75], v2 offset:0
    ds_read_b128 v[76:79], v2 offset:1024
    v_mov_b64 v[52:53], 0
    v_mov_b64 v[54:55], 0
    s_mov_b64 exec, s[94:95]
    v_cvt_pk_bf16_f32 v36, v36, v37
    v_cvt_pk_bf16_f32 v37, v38, v39
    v_cvt_pk_bf16_f32 v38, v40, v41
    v_cvt_pk_bf16_f32 v39, v42, v43
    ds_write_b128 v6, v[36:39]
    s_mov_b64 exec, -1
    v_mfma_f32_16x16x16_bf16 v[24:27], v[16:17], v[18:19], v[24:27]
    ds_read_b128 v[12:15], v2 offset:2048
    ds_read_b128 v[16:19], v2 offset:3072
    s_add_u32 s63, s90, s81
    s_add_u32 s91, s91, 32768
    s_add_u32 s98, s98, 32768
    s_add_u32 s89, s89, 32768
    s_add_u32 s65, s88, s81
    s_mov_b32 s60, 0
    v_rcp_f32 v60, v24
    v_rcp_f32 v61, v25
    s_waitcnt lgkmcnt(2)
    s_barrier
    ds_read_b128 v[48:51], v1 offset:0
    ds_read_b128 v[32:35], v1 offset:1024
    s_waitcnt lgkmcnt(1)
    v_smfmac_f32_16x16x64_bf16 v[68:71], v[48:51], v[72:79], v10
    ds_read_b128 v[72:75], v2 offset:16384
    ds_read_b128 v[76:79], v2 offset:17408
    v_smfmac_f32_16x16x64_bf16 v[44:47], v[48:51], v[12:19], v10
    ds_read_b128 v[12:15], v2 offset:18432
    ds_read_b128 v[16:19], v2 offset:19456
    s_waitcnt lgkmcnt(4)
    v_smfmac_f32_16x16x64_bf16 v[68:71], v[32:35], a[200:207], v10
    v_smfmac_f32_16x16x64_bf16 v[44:47], v[32:35], a[176:183], v10
    v_smfmac_f32_16x16x64_bf16 v[52:55], v[48:51], a[160:167], v10
    v_smfmac_f32_16x16x64_bf16 v[52:55], v[32:35], a[184:191], v10
    v_smfmac_f32_16x16x64_bf16 v[56:59], v[48:51], a[168:175], v10
    v_smfmac_f32_16x16x64_bf16 v[56:59], v[32:35], a[192:199], v10
    s_waitcnt lgkmcnt(2)
    v_smfmac_f32_16x16x64_bf16 v[64:67], v[48:51], v[72:79], v10
    s_waitcnt lgkmcnt(0)
    v_smfmac_f32_16x16x64_bf16 v[64:67], v[32:35], v[12:19], v10
    v_pk_add_f32 v[68:69], v[68:69], v[70:71]
    v_pk_add_f32 v[44:45], v[44:45], v[46:47]
    v_pk_add_f32 v[52:53], v[52:53], v[54:55]
    s_nop 0
    v_pk_add_f32 v[56:57], v[56:57], v[58:59]
    v_pk_mul_f32 v[68:69], v[68:69], v[60:61]
    v_pk_mul_f32 v[44:45], v[44:45], v[60:61]
    v_pk_mul_f32 v[52:53], v[52:53], v[60:61]
    v_pk_mul_f32 v[56:57], v[56:57], v[60:61]
    v_pk_add_f32 v[64:65], v[64:65], v[66:67]
    v_cvt_pk_bf16_f32 v40, v68, v69
    v_cvt_pk_bf16_f32 v36, v44, v45
    v_pk_mul_f32 v[64:65], v[64:65], v[60:61]
    buffer_store_dword v40, v8, s[4:7], s79 offen
    v_cvt_pk_bf16_f32 v37, v52, v53
    v_cvt_pk_bf16_f32 v38, v56, v57
    v_cvt_pk_bf16_f32 v39, v64, v65
    buffer_store_dwordx4 v[36:39], v7, s[4:7], s79 offen
    s_xor_b32 s79, s79, s92
    v_mov_b64 v[32:33], 0
    v_mov_b64 v[34:35], 0
    s_min_u32 s62, s0, s1
    s_max_u32 s68, s68, s62
    s_buffer_load_dword s0, s[4:7], s84 glc
    s_buffer_load_dword s1, s[4:7], s36 glc
L_sr_31:
    v_bfe_u32 v62, v1, 4, 1
    v_mov_b32 v63, 0x3f80
    v_lshlrev_b32 v62, 4, v62
    v_lshlrev_b32 v62, v62, v63
    v_cndmask_b32 v20, 0, v62, s[52:53]
    v_cndmask_b32 v21, 0, v62, s[54:55]
    v_cndmask_b32 v22, 0, v62, s[56:57]
    v_cndmask_b32 v23, 0, v62, s[58:59]
    s_sleep 1
    s_sleep 1
    s_sleep 1
    buffer_load_dwordx4 v[36:39], v1, s[4:7], s80 offen offset:0 sc1
    buffer_load_dwordx4 v[40:43], v1, s[4:7], s80 offen offset:1024 sc1
    buffer_load_dwordx4 v[44:47], v1, s[4:7], s80 offen offset:2048 sc1
    buffer_load_dwordx4 v[48:51], v1, s[4:7], s80 offen offset:3072 sc1
    s_sleep 1
    s_sleep 1
    buffer_load_dwordx4 v[52:55], v1, s[4:7], s80 offen offset:0 sc1
    buffer_load_dwordx4 v[56:59], v1, s[4:7], s80 offen offset:1024 sc1
    buffer_load_dwordx4 v[60:63], v1, s[4:7], s80 offen offset:2048 sc1
    buffer_load_dwordx4 v[64:67], v1, s[4:7], s80 offen offset:3072 sc1
L_CH_RED_00:
    s_waitcnt vmcnt(7)
    v_max3_u32 v76, v36, v37, v38
    v_max_u32 v76, v76, v39
    v_mfma_f32_16x16x32_bf16 v[68:71], v[36:39], v[20:23], 0
    s_waitcnt vmcnt(6)
    v_max3_u32 v76, v76, v40, v41
    v_max3_u32 v76, v76, v42, v43
    v_mfma_f32_16x16x32_bf16 v[68:71], v[40:43], v[20:23], v[68:71]
    s_waitcnt vmcnt(5)
    v_max3_u32 v76, v76, v44, v45
    v_max3_u32 v76, v76, v46, v47
    v_mfma_f32_16x16x32_bf16 v[68:71], v[44:47], v[20:23], v[68:71]
    s_waitcnt vmcnt(4)
    v_max3_u32 v76, v76, v48, v49
    v_max3_u32 v76, v76, v50, v51
    v_mfma_f32_16x16x32_bf16 v[68:71], v[48:51], v[20:23], v[68:71]
    v_cmp_eq_u32 vcc, -1, v76
    s_nop 0
    s_cbranch_vccz L_CH_REDOK_00
    buffer_load_dwordx4 v[36:39], v1, s[4:7], s80 offen offset:0 sc1
    buffer_load_dwordx4 v[40:43], v1, s[4:7], s80 offen offset:1024 sc1
    buffer_load_dwordx4 v[44:47], v1, s[4:7], s80 offen offset:2048 sc1
    buffer_load_dwordx4 v[48:51], v1, s[4:7], s80 offen offset:3072 sc1
    s_waitcnt vmcnt(7)
    v_max3_u32 v76, v52, v53, v54
    v_max_u32 v76, v76, v55
    v_mfma_f32_16x16x32_bf16 v[68:71], v[52:55], v[20:23], 0
    s_waitcnt vmcnt(6)
    v_max3_u32 v76, v76, v56, v57
    v_max3_u32 v76, v76, v58, v59
    v_mfma_f32_16x16x32_bf16 v[68:71], v[56:59], v[20:23], v[68:71]
    s_waitcnt vmcnt(5)
    v_max3_u32 v76, v76, v60, v61
    v_max3_u32 v76, v76, v62, v63
    v_mfma_f32_16x16x32_bf16 v[68:71], v[60:63], v[20:23], v[68:71]
    s_waitcnt vmcnt(4)
    v_max3_u32 v76, v76, v64, v65
    v_max3_u32 v76, v76, v66, v67
    v_mfma_f32_16x16x32_bf16 v[68:71], v[64:67], v[20:23], v[68:71]
    v_cmp_eq_u32 vcc, -1, v76
    s_nop 0
    s_cbranch_vccnz L_CH_REDX_00
L_CH_REDOK_00:
    s_nop 5
    v_permlane32_swap_b32 v68, v70
    v_permlane32_swap_b32 v69, v71
    v_pk_add_f32 v[68:69], v[68:69], v[70:71]
    v_cvt_pk_bf16_f32 v20, v68, v69
    s_mov_b64 exec, s[86:87]
    buffer_store_dword v20, v3, s[4:7], s63 offen
    buffer_store_dword v20, v3, s[4:7], s91 offen sc1
    s_mov_b64 exec, -1
    s_barrier
    s_xor_b32 s80, s80, s93
    s_mov_b32 s60, 0
    s_waitcnt vmcnt(2)
    ds_read_b128 v[56:59], v2 offset:32768
    ds_read_b128 v[60:63], v2 offset:33792
    ds_read_b128 v[64:67], v2 offset:49152
    ds_read_b128 v[68:71], v2 offset:50176
    ds_read_b128 v[48:51], v2 offset:34816
    ds_read_b128 v[52:55], v2 offset:35840
    v_mov_b64 v[12:13], 0
    v_mov_b64 v[14:15], 0
    v_mov_b64 v[16:17], 0
    v_mov_b64 v[18:19], 0
    v_mov_b64 v[20:21], 0
    v_mov_b64 v[22:23], 0
    v_mov_b64 v[24:25], 0
    v_mov_b64 v[26:27], 0
    v_mov_b64 v[28:29], 0
    v_mov_b64 v[30:31], 0
    v_mov_b64 v[36:37], -1
    v_mov_b64 v[38:39], -1
    s_sleep 1
    s_sleep 1
    s_sleep 1
    s_mov_b32 m0, s100
    s_add_u32 s64, s65, s99
    buffer_load_dwordx4 v1, s[4:7], s65 offen sc1 lds
    s_add_u32 m0, s100, s99
    s_mov_b64 exec, 0xffff
    buffer_load_dwordx4 v1, s[4:7], s64 offen sc1 lds
    s_mov_b64 exec, -1
    s_nop 11
    s_mov_b32 m0, s100
    s_add_u32 s64, s65, s99
    buffer_load_dwordx4 v1, s[4:7], s65 offen sc1 lds
    s_add_u32 m0, s100, s99
    s_mov_b64 exec, 0xffff
    buffer_load_dwordx4 v1, s[4:7], s64 offen sc1 lds
    s_mov_b64 exec, -1
    s_add_u32 s63, s101, s10
    buffer_store_dwordx4 v[36:39], v1, s[4:7], s101 offen
    s_mov_b64 exec, s[42:43]
    buffer_store_dwordx4 v[36:39], v1, s[4:7], s63 offen
    s_xor_b32 s101, s101, s40
    s_xor_b32 s62, s81, 0x8000
    s_add_u32 s62, s62, s41
    s_mov_b64 exec, s[66:67]
    buffer_store_dwordx4 v[36:39], v11, s[4:7], s62 offen
    s_mov_b64 exec, -1
    s_waitcnt vmcnt(5)
    s_barrier
    ds_read_b128 v[36:39], v1 offset:0
    ds_read_b128 v[40:43], v1 offset:1024
    ds_read_b128 v[44:47], v1 offset:2048
    ds_read_b128 v[72:75], v1 offset:3072
    ds_read_b128 v[76:79], v1 offset:4096
    s_branch L_CH_A1_00
L_CH_LRETRY_00:
    s_add_u32 s60, s60, 1
    s_cmp_lg_u32 s60, 1
    s_cbranch_scc1 L_ln_32
    v_mov_b64 v[12:13], 0
    v_mov_b64 v[14:15], 0
    s_nop 0
    v_mov_b64 v[16:17], 0
    v_mov_b64 v[18:19], 0
    s_waitcnt vmcnt(0)
    s_branch L_CH_LOOP_00
L_ln_32:
    v_max3_u32 v9, v36, v37, v38
    v_max3_u32 v9, v9, v38, v39
    v_max3_u32 v9, v9, v40, v41
    v_max3_u32 v9, v9, v42, v43
    v_max3_u32 v9, v9, v44, v45
    v_max3_u32 v9, v9, v46, v47
    v_max3_u32 v9, v9, v72, v73
    v_max3_u32 v9, v9, v74, v75
    v_max3_u32 v9, v9, v76, v77
    v_max3_u32 v9, v9, v78, v79
    v_cmp_eq_u32 vcc, -1, v9
    s_nop 0
    s_cbranch_vccz L_CH_LGO_00
    s_cmp_ge_u32 s60, 0x100000
    s_movk_i32 s62, 15
    s_cbranch_scc1 L_ABORT
    s_sub_u32 s63, s65, s2
    s_mov_b32 m0, 131072
    s_add_u32 s64, s63, 4096
    buffer_load_dwordx4 v1, s[4:7], s63 offen offset:0 sc1 lds
    buffer_load_dwordx4 v1, s[4:7], s63 offen offset:1024 sc1 lds
    buffer_load_dwordx4 v1, s[4:7], s63 offen offset:2048 sc1 lds
    buffer_load_dwordx4 v1, s[4:7], s63 offen offset:3072 sc1 lds
    s_mov_b32 m0, 135168
    s_nop 0
    buffer_load_dwordx4 v1, s[4:7], s64 offen sc1 lds
    v_mov_b64 v[12:13], 0
    v_mov_b64 v[14:15], 0
    v_mov_b64 v[16:17], 0
    v_mov_b64 v[18:19], 0
    s_waitcnt vmcnt(0)
    s_branch L_CH_LOOP_00
L_CH_RETRY_00:
    s_mov_b32 s60, 0
    s_sleep 1
    s_sleep 1
    s_mov_b32 m0, s85
    s_add_u32 s64, s98, s99
    buffer_load_dwordx4 v1, s[4:7], s98 offen sc1 lds
    s_add_u32 m0, s85, s99
    s_mov_b64 exec, 0xffff
    buffer_load_dwordx4 v1, s[4:7], s64 offen sc1 lds
    s_mov_b64 exec, -1
    s_branch L_CH_RETRY2_00
L_CH_RETRY1_00:
    s_mov_b32 s63, s89
    s_mov_b32 m0, 136192
    s_add_u32 s64, s63, 4096
    buffer_load_dwordx4 v1, s[4:7], s63 offen offset:0 sc1 lds
    buffer_load_dwordx4 v1, s[4:7], s63 offen offset:1024 sc1 lds
    buffer_load_dwordx4 v1, s[4:7], s63 offen offset:2048 sc1 lds
    buffer_load_dwordx4 v1, s[4:7], s63 offen offset:3072 sc1 lds
    s_mov_b32 m0, 140288
    s_nop 0
    buffer_load_dwordx4 v1, s[4:7], s64 offen sc1 lds
L_CH_RETRY2_00:
    s_waitcnt vmcnt(0)
    ds_read_b128 v[64:67], v1 offset:5120
    ds_read_b128 v[68:71], v1 offset:6144
    ds_read_b128 v[48:51], v1 offset:7168
    ds_read_b128 v[56:59], v1 offset:8192
    ds_read_b128 v[60:63], v1 offset:9216
    s_waitcnt lgkmcnt(0)
L_CH_RETRY3_00:
    v_max3_u32 v9, v64, v65, v66
    v_max_u32 v9, v9, v67
    v_max3_u32 v9, v9, v68, v69
    v_max3_u32 v9, v9, v70, v71
    v_max3_u32 v9, v9, v48, v49
    v_max3_u32 v9, v9, v50, v51
    v_max3_u32 v9, v9, v56, v57
    v_max3_u32 v9, v9, v58, v59
    v_max3_u32 v9, v9, v60, v61
    v_max3_u32 v9, v9, v62, v63
    v_cmp_eq_u32 vcc, -1, v9
    s_nop 0
    s_cbranch_vccz L_CH_REDO_00
    s_add_u32 s60, s60, 1
    s_cmp_lt_u32 s60, 0x100000
    s_cbranch_scc1 L_CH_RETRY1_00
    s_movk_i32 s62, 13
    s_branch L_ABORT
L_CH_REDO_00:
    v_mov_b64 v[12:13], 0
    v_mov_b64 v[14:15], 0
    s_nop 1
    v_smfmac_f32_16x16x64_bf16 v[12:15], v[36:39], a[0:7], v10
    v_smfmac_f32_16x16x64_bf16 v[12:15], v[40:43], a[16:23], v10
    v_smfmac_f32_16x16x64_bf16 v[12:15], v[44:47], a[32:39], v10
    v_smfmac_f32_16x16x64_bf16 v[12:15], v[72:75], a[48:55], v10
    v_smfmac_f32_16x16x64_bf16 v[12:15], v[76:79], a[64:71], v10
    v_smfmac_f32_16x16x64_bf16 v[12:15], v[56:59], a[128:135], v10
    v_smfmac_f32_16x16x64_bf16 v[12:15], v[60:63], a[144:151], v10
    v_smfmac_f32_16x16x64_bf16 v[12:15], v[64:67], a[80:87], v10
    v_smfmac_f32_16x16x64_bf16 v[12:15], v[68:71], a[96:103], v10
    v_smfmac_f32_16x16x64_bf16 v[12:15], v[48:51], a[112:119], v10
    s_branch L_CH_C_00
L_CH_LAST_00:
    s_mul_i32 s62, s44, 1056
    v_add_u32 v9, s62, v5
    ds_read_b64_tr_b16 v[28:29], v9 offset:26624
    ds_read_b64_tr_b16 v[30:31], v9 offset:26896
    s_waitcnt lgkmcnt(0)
    buffer_store_dwordx4 v[28:31], v1, s[4:7], s77 offen sc1
    s_add_u32 s77, s77, 131072
    s_waitcnt vmcnt(0)
    v_mov_b32 v62, 0
    v_mov_b32 v63, 64
    s_mov_b64 exec, 1
    buffer_store_dword v63, v62, s[4:7], s78 offen sc1
    s_mov_b64 exec, -1
    s_branch L_END2
L_CH_REDX_00:
    buffer_load_dwordx4 v[52:55], v1, s[4:7], s80 offen offset:0 sc1
    buffer_load_dwordx4 v[56:59], v1, s[4:7], s80 offen offset:1024 sc1
    buffer_load_dwordx4 v[60:63], v1, s[4:7], s80 offen offset:2048 sc1
    buffer_load_dwordx4 v[64:67], v1, s[4:7], s80 offen offset:3072 sc1
    s_add_u32 s60, s60, 1
    s_cmp_lt_u32 s60, 0x100000
    s_cbranch_scc1 L_CH_RED_00
    s_movk_i32 s62, 14
    s_branch L_ABORT
L_kv_29:
    v_bfe_u32 v52, v1, 4, 1
    v_lshlrev_b32 v52, 5, v52
    v_add_u32 v52, s46, v52
    v_add_u32 v52, 64, v52
    v_lshlrev_b32 v52, 6, v52
    s_mov_b32 s60, 0
L_pf_33:
    buffer_load_dword v53, v52, s[4:7], 0 offen sc1
    s_waitcnt vmcnt(0)
    v_cmp_gt_u32 vcc, s69, v53
    s_nop 0
    s_cbranch_vccz L_pfd_34
    s_sleep 1
    s_add_u32 s60, s60, 1
    s_cmp_lt_u32 s60, 0x100000
    s_cbranch_scc1 L_pf_33
    s_movk_i32 s62, 11
    s_branch L_ABORT
L_pfd_34:
    v_readlane_b32 s68, v53, 0
    v_readlane_b32 s62, v53, 1
    s_nop 0
    s_min_u32 s68, s68, s62
    s_branch L_kvr_30
L_kv_27:
    v_bfe_u32 v52, v1, 4, 1
    v_lshlrev_b32 v52, 5, v52
    v_add_u32 v52, s46, v52
    v_add_u32 v52, 64, v52
    v_lshlrev_b32 v52, 6, v52
    s_mov_b32 s60, 0
L_pf_35:
    buffer_load_dword v53, v52, s[4:7], 0 offen sc1
    s_waitcnt vmcnt(0)
    v_cmp_gt_u32 vcc, s69, v53
    s_nop 0
    s_cbranch_vccz L_pfd_36
    s_sleep 1
    s_add_u32 s60, s60, 1
    s_cmp_lt_u32 s60, 0x100000
    s_cbranch_scc1 L_pf_35
    s_movk_i32 s62, 11
    s_branch L_ABORT
L_pfd_36:
    v_readlane_b32 s68, v53, 0
    v_readlane_b32 s62, v53, 1
    s_nop 0
    s_min_u32 s68, s68, s62
    s_branch L_kvr_28
L_kv_25:
    v_bfe_u32 v52, v1, 4, 1
    v_lshlrev_b32 v52, 5, v52
    v_add_u32 v52, s46, v52
    v_add_u32 v52, 64, v52
    v_lshlrev_b32 v52, 6, v52
    s_mov_b32 s60, 0
L_pf_37:
    buffer_load_dword v53, v52, s[4:7], 0 offen sc1
    s_waitcnt vmcnt(0)
    v_cmp_gt_u32 vcc, 1, v53
    s_nop 0
    s_cbranch_vccz L_pfd_38
    s_sleep 1
    s_add_u32 s60, s60, 1
    s_cmp_lt_u32 s60, 0x100000
    s_cbranch_scc1 L_pf_37
    s_movk_i32 s62, 11
    s_branch L_ABORT
L_pfd_38:
    v_readlane_b32 s68, v53, 0
    v_readlane_b32 s62, v53, 1
    s_nop 0
    s_min_u32 s68, s68, s62
    s_branch L_kvr_26
L_CH_FIRST_10:
    ds_read_b128 v[36:39], v1 offset:0
    ds_read_b128 v[40:43], v1 offset:1024
    ds_read_b128 v[44:47], v1 offset:2048
    ds_read_b128 v[72:75], v1 offset:3072
    ds_read_b128 v[76:79], v1 offset:4096
    s_waitcnt lgkmcnt(4)
    v_smfmac_f32_16x16x64_bf16 v[12:15], v[36:39], a[0:7], v10
    s_waitcnt lgkmcnt(3)
    v_smfmac_f32_16x16x64_bf16 v[12:15], v[40:43], a[16:23], v10
    s_waitcnt lgkmcnt(2)
    v_smfmac_f32_16x16x64_bf16 v[12:15], v[44:47], a[32:39], v10
    s_waitcnt lgkmcnt(1)
    v_smfmac_f32_16x16x64_bf16 v[12:15], v[72:75], a[48:55], v10
    s_waitcnt lgkmcnt(0)
    v_smfmac_f32_16x16x64_bf16 v[12:15], v[76:79], a[64:71], v10
    v_smfmac_f32_16x16x64_bf16 v[16:19], v[36:39], a[8:15], v10
    v_smfmac_f32_16x16x64_bf16 v[16:19], v[40:43], a[24:31], v10
    v_smfmac_f32_16x16x64_bf16 v[16:19], v[44:47], a[40:47], v10
    v_smfmac_f32_16x16x64_bf16 v[16:19], v[72:75], a[56:63], v10
    v_smfmac_f32_16x16x64_bf16 v[16:19], v[76:79], a[72:79], v10
    v_smfmac_f32_16x16x64_bf16 v[28:31], v[36:39], v[56:63], v10
    ds_read_b128 v[56:59], v2 offset:51200
    ds_read_b128 v[60:63], v2 offset:52224
    v_smfmac_f32_16x16x64_bf16 v[20:23], v[36:39], v[64:71], v10
    v_xor_b32 v2, 0x10000, v2
    ds_read_b128 v[64:67], v2 offset:0
    ds_read_b128 v[68:71], v2 offset:1024
    v_smfmac_f32_16x16x64_bf16 v[32:35], v[36:39], v[48:55], v10
    ds_read_b128 v[48:51], v2 offset:2048
    ds_read_b128 v[52:55], v2 offset:3072
    v_smfmac_f32_16x16x64_bf16 v[20:23], v[40:43], a[208:215], v10
    s_waitcnt lgkmcnt(4)
    v_smfmac_f32_16x16x64_bf16 v[24:27], v[36:39], v[56:63], v10
    ds_read_b128 v[56:59], v2 offset:16384
    ds_read_b128 v[60:63], v2 offset:17408
    v_smfmac_f32_16x16x64_bf16 v[24:27], v[40:43], a[216:223], v10
    s_waitcnt lgkmcnt(4)
    v_smfmac_f32_16x16x64_bf16 v[28:31], v[40:43], v[64:71], v10
    ds_read_b128 v[64:67], v2 offset:18432
    ds_read_b128 v[68:71], v2 offset:19456
    v_smfmac_f32_16x16x64_bf16 v[20:23], v[44:47], a[224:231], v10
    s_waitcnt lgkmcnt(4)
    v_smfmac_f32_16x16x64_bf16 v[32:35], v[40:43], v[48:55], v10
    ds_read_b128 v[48:51], v2 offset:32768
    ds_read_b128 v[52:55], v2 offset:33792
    v_smfmac_f32_16x16x64_bf16 v[24:27], v[44:47], a[232:239], v10
    s_waitcnt lgkmcnt(4)
    v_smfmac_f32_16x16x64_bf16 v[28:31], v[44:47], v[56:63], v10
    ds_read_b128 v[56:59], v2 offset:34816
    ds_read_b128 v[60:63], v2 offset:35840
    s_waitcnt lgkmcnt(4)
    v_smfmac_f32_16x16x64_bf16 v[32:35], v[44:47], v[64:71], v10
    ds_read_b128 v[64:67], v2 offset:49152
    ds_read_b128 v[68:71], v2 offset:50176
    s_waitcnt lgkmcnt(4)
    v_smfmac_f32_16x16x64_bf16 v[28:31], v[72:75], v[48:55], v10
    ds_read_b128 v[48:51], v2 offset:51200
    ds_read_b128 v[52:55], v2 offset:52224
    s_waitcnt lgkmcnt(4)
    v_smfmac_f32_16x16x64_bf16 v[32:35], v[72:75], v[56:63], v10
    s_barrier
    s_mov_b32 s69, 2
    ds_read_b128 v[56:59], v1 offset:8192
    ds_read_b128 v[60:63], v1 offset:9216
    s_waitcnt lgkmcnt(4)
    v_smfmac_f32_16x16x64_bf16 v[28:31], v[76:79], v[64:71], v10
    ds_read_b128 v[64:67], v1 offset:5120
    ds_read_b128 v[68:71], v1 offset:6144
    s_waitcnt lgkmcnt(4)
    v_smfmac_f32_16x16x64_bf16 v[32:35], v[76:79], v[48:55], v10
    ds_read_b128 v[48:51], v1 offset:7168
    v_smfmac_f32_16x16x64_bf16 v[20:23], v[72:75], v[144:151], v10
    s_waitcnt lgkmcnt(4)
    v_smfmac_f32_16x16x64_bf16 v[12:15], v[56:59], a[128:135], v10
    s_waitcnt lgkmcnt(3)
    v_smfmac_f32_16x16x64_bf16 v[12:15], v[60:63], a[144:151], v10
    s_waitcnt lgkmcnt(2)
    v_smfmac_f32_16x16x64_bf16 v[12:15], v[64:67], a[80:87], v10
    s_waitcnt lgkmcnt(1)
    v_smfmac_f32_16x16x64_bf16 v[12:15], v[68:71], a[96:103], v10
    s_waitcnt lgkmcnt(0)
    v_smfmac_f32_16x16x64_bf16 v[12:15], v[48:51], a[112:119], v10
    s_cmp_lt_u32 s68, s69
    s_cbranch_scc1 L_kv_39
L_kvr_40:
    v_smfmac_f32_16x16x64_bf16 v[24:27], v[72:75], v[152:159], v10
    v_smfmac_f32_16x16x64_bf16 v[20:23], v[76:79], v[160:167], v10
    v_smfmac_f32_16x16x64_bf16 v[24:27], v[76:79], v[168:175], v10
    s_branch L_CH_C_10
    .p2align 6
L_CH_B1_10:
    s_barrier
L_CH_LOOP_10:
    ds_read_b128 v[36:39], v1 offset:0
    ds_read_b128 v[40:43], v1 offset:1024
    ds_read_b128 v[44:47], v1 offset:2048
    ds_read_b128 v[72:75], v1 offset:3072
    ds_read_b128 v[76:79], v1 offset:4096
L_CH_A1_10:
    s_waitcnt lgkmcnt(4)
    v_smfmac_f32_16x16x64_bf16 v[12:15], v[36:39], a[0:7], v10
    s_waitcnt lgkmcnt(3)
    v_smfmac_f32_16x16x64_bf16 v[12:15], v[40:43], a[16:23], v10
    s_waitcnt lgkmcnt(2)
    v_smfmac_f32_16x16x64_bf16 v[12:15], v[44:47], a[32:39], v10
    s_waitcnt lgkmcnt(1)
    v_smfmac_f32_16x16x64_bf16 v[12:15], v[72:75], a[48:55], v10
    s_waitcnt lgkmcnt(0)
    v_smfmac_f32_16x16x64_bf16 v[12:15], v[76:79], a[64:71], v10
    v_smfmac_f32_16x16x64_bf16 v[16:19], v[36:39], a[8:15], v10
    v_smfmac_f32_16x16x64_bf16 v[16:19], v[40:43], a[24:31], v10
    s_add_u32 s69, s61, 2
    s_min_u32 s69, s69, 64
    s_mov_b32 m0, s85
    s_add_u32 s64, s98, s99
    s_nop 1
    v_cmp_u_f32 vcc, v12, v13
    v_cmp_u_f32 s[62:63], v14, v15
    v_smfmac_f32_16x16x64_bf16 v[16:19], v[44:47], a[40:47], v10
    s_or_b64 vcc, vcc, s[62:63]
    s_cbranch_scc1 L_CH_LRETRY_10
L_CH_LGO_10:
    buffer_load_dwordx4 v1, s[4:7], s98 offen sc1 lds
    s_add_u32 m0, s85, s99
    s_mov_b64 exec, 0xffff
    buffer_load_dwordx4 v1, s[4:7], s64 offen sc1 lds
    s_mov_b64 exec, -1
    v_smfmac_f32_16x16x64_bf16 v[16:19], v[72:75], a[56:63], v10
    v_smfmac_f32_16x16x64_bf16 v[16:19], v[76:79], a[72:79], v10
    v_smfmac_f32_16x16x64_bf16 v[28:31], v[36:39], v[56:63], v10
    ds_read_b128 v[56:59], v2 offset:51200
    ds_read_b128 v[60:63], v2 offset:52224
    v_smfmac_f32_16x16x64_bf16 v[20:23], v[36:39], v[64:71], v10
    v_xor_b32 v2, 0x10000, v2
    ds_read_b128 v[64:67], v2 offset:0
    ds_read_b128 v[68:71], v2 offset:1024
    v_smfmac_f32_16x16x64_bf16 v[32:35], v[36:39], v[48:55], v10
    ds_read_b128 v[48:51], v2 offset:2048
    ds_read_b128 v[52:55], v2 offset:3072
    v_smfmac_f32_16x16x64_bf16 v[20:23], v[40:43], a[208:215], v10
    v_mov_b32 v9, s61
    s_mov_b64 exec, 1
    buffer_store_dword v9, off, s[4:7], s78 sc1
    s_mov_b64 exec, -1
    s_waitcnt lgkmcnt(4)
    v_smfmac_f32_16x16x64_bf16 v[24:27], v[36:39], v[56:63], v10
    ds_read_b128 v[56:59], v2 offset:16384
    ds_read_b128 v[60:63], v2 offset:17408
    v_smfmac_f32_16x16x64_bf16 v[24:27], v[40:43], a[216:223], v10
    s_waitcnt lgkmcnt(4)
    v_smfmac_f32_16x16x64_bf16 v[28:31], v[40:43], v[64:71], v10
    ds_read_b128 v[64:67], v2 offset:18432
    ds_read_b128 v[68:71], v2 offset:19456
    v_smfmac_f32_16x16x64_bf16 v[20:23], v[44:47], a[224:231], v10
    s_waitcnt lgkmcnt(4)
    v_smfmac_f32_16x16x64_bf16 v[32:35], v[40:43], v[48:55], v10
    ds_read_b128 v[48:51], v2 offset:32768
    ds_read_b128 v[52:55], v2 offset:33792
    v_smfmac_f32_16x16x64_bf16 v[24:27], v[44:47], a[232:239], v10
    s_waitcnt lgkmcnt(4)
    v_smfmac_f32_16x16x64_bf16 v[28:31], v[44:47], v[56:63], v10
    ds_read_b128 v[56:59], v2 offset:34816
    ds_read_b128 v[60:63], v2 offset:35840
    s_waitcnt lgkmcnt(4)
    v_smfmac_f32_16x16x64_bf16 v[32:35], v[44:47], v[64:71], v10
    ds_read_b128 v[64:67], v2 offset:49152
    ds_read_b128 v[68:71], v2 offset:50176
    s_waitcnt lgkmcnt(4)
    v_smfmac_f32_16x16x64_bf16 v[28:31], v[72:75], v[48:55], v10
    ds_read_b128 v[48:51], v2 offset:51200
    ds_read_b128 v[52:55], v2 offset:52224
    s_waitcnt lgkmcnt(4)
    v_smfmac_f32_16x16x64_bf16 v[32:35], v[72:75], v[56:63], v10
    s_waitcnt vmcnt(1)
    s_barrier
    ds_read_b128 v[56:59], v1 offset:8192
    ds_read_b128 v[60:63], v1 offset:9216
    s_waitcnt lgkmcnt(4)
    v_smfmac_f32_16x16x64_bf16 v[28:31], v[76:79], v[64:71], v10
    ds_read_b128 v[64:67], v1 offset:5120
    ds_read_b128 v[68:71], v1 offset:6144
    s_waitcnt lgkmcnt(4)
    v_smfmac_f32_16x16x64_bf16 v[32:35], v[76:79], v[48:55], v10
    ds_read_b128 v[48:51], v1 offset:7168
    v_smfmac_f32_16x16x64_bf16 v[20:23], v[72:75], v[144:151], v10
    s_waitcnt lgkmcnt(4)
    v_smfmac_f32_16x16x64_bf16 v[12:15], v[56:59], a[128:135], v10
    s_waitcnt lgkmcnt(3)
    v_smfmac_f32_16x16x64_bf16 v[12:15], v[60:63], a[144:151], v10
    s_waitcnt lgkmcnt(2)
    v_smfmac_f32_16x16x64_bf16 v[12:15], v[64:67], a[80:87], v10
    s_waitcnt lgkmcnt(1)
    v_smfmac_f32_16x16x64_bf16 v[12:15], v[68:71], a[96:103], v10
    s_waitcnt lgkmcnt(0)
    v_smfmac_f32_16x16x64_bf16 v[12:15], v[48:51], a[112:119], v10
    s_cmp_lt_u32 s68, s69
    s_cbranch_scc1 L_kv_41
L_kvr_42:
    v_smfmac_f32_16x16x64_bf16 v[24:27], v[72:75], v[152:159], v10
    v_smfmac_f32_16x16x64_bf16 v[20:23], v[76:79], v[160:167], v10
    v_smfmac_f32_16x16x64_bf16 v[24:27], v[76:79], v[168:175], v10
    s_nop 2
    v_cmp_u_f32 vcc, v12, v13
    v_cmp_u_f32 s[62:63], v14, v15
    s_nop 0
    s_or_b64 vcc, vcc, s[62:63]
    s_cbranch_scc1 L_CH_RETRY_10
L_CH_C_10:
    v_smfmac_f32_16x16x64_bf16 v[16:19], v[64:67], a[88:95], v10
    buffer_load_dwordx4 v[72:75], v1, s[4:7], s76 offen sc1
    v_smfmac_f32_16x16x64_bf16 v[16:19], v[68:71], a[104:111], v10
    v_smfmac_f32_16x16x64_bf16 v[16:19], v[48:51], a[120:127], v10
    buffer_load_dwordx4 v[76:79], v1, s[4:7], s76 offen offset:1024 sc1
    s_add_u32 s76, s76, 262144
    v_smfmac_f32_16x16x64_bf16 v[16:19], v[56:59], a[136:143], v10
    v_pk_add_f32 v[12:13], v[12:13], v[14:15]
    v_smfmac_f32_16x16x64_bf16 v[16:19], v[60:63], a[152:159], v10
    ds_read_b128 v[36:39], v0 offset:0
    ds_read_b128 v[40:43], v0 offset:1024
    v_cvt_pk_bf16_f32 v14, v12, v13
    v_smfmac_f32_16x16x64_bf16 v[20:23], v[64:67], v[176:183], v10
    ds_read_b128 v[44:47], v0 offset:2048
    ds_read_b128 v[52:55], v0 offset:3072
    v_smfmac_f32_16x16x64_bf16 v[24:27], v[64:67], v[184:191], v10
    v_smfmac_f32_16x16x64_bf16 v[20:23], v[68:71], v[192:199], v10
    v_pk_add_f32 v[16:17], v[16:17], v[18:19]
    v_smfmac_f32_16x16x64_bf16 v[24:27], v[68:71], v[200:207], v10
    v_cvt_pk_bf16_f32 v18, v16, v17
    v_smfmac_f32_16x16x64_bf16 v[20:23], v[48:51], v[208:215], v10
    ds_write_b32 v4, v14 offset:0
    ds_write_b32 v4, v18 offset:528
    v_smfmac_f32_16x16x64_bf16 v[24:27], v[48:51], v[216:223], v10
    v_smfmac_f32_16x16x64_bf16 v[20:23], v[56:59], v[224:231], v10
    s_mov_b32 m0, s74
    s_xor_b32 s74, s74, s37
    buffer_load_dwordx4 v1, s[4:7], s73 offen sc1 lds
    v_smfmac_f32_16x16x64_bf16 v[24:27], v[56:59], v[232:239], v10
    v_smfmac_f32_16x16x64_bf16 v[20:23], v[60:63], v[240:247], v10
    buffer_load_dwordx4 v1, s[4:7], s73 offen offset:1024 sc1 lds
    s_add_u32 s73, s73, 262144
    v_smfmac_f32_16x16x64_bf16 v[24:27], v[60:63], v[248:255], v10
    s_waitcnt lgkmcnt(0)
    s_barrier
    ds_read_b64_tr_b16 v[12:13], v5 offset:0
    ds_read_b64_tr_b16 v[14:15], v5 offset:272
    v_smfmac_f32_16x16x64_bf16 v[28:31], v[64:67], v[80:87], v10
    ds_read_b64_tr_b16 v[16:17], v5 offset:1056
    ds_read_b64_tr_b16 v[18:19], v5 offset:1328
    v_pk_add_f32 v[20:21], v[20:21], v[22:23]
    v_smfmac_f32_16x16x64_bf16 v[32:35], v[64:67], v[88:95], v10
    ds_read_b64_tr_b16 v[64:65], v5 offset:2112
    ds_read_b64_tr_b16 v[66:67], v5 offset:2384
    v_pk_add_f32 v[24:25], v[24:25], v[26:27]
    v_cvt_pk_bf16_f32 v22, v20, v21
    v_smfmac_f32_16x16x64_bf16 v[28:31], v[68:71], v[96:103], v10
    v_cvt_pk_bf16_f32 v26, v24, v25
    ds_write_b32 v4, v22 offset:26624
    ds_write_b32 v4, v26 offset:27152
    v_smfmac_f32_16x16x64_bf16 v[32:35], v[68:71], v[104:111], v10
    ds_read_b64_tr_b16 v[68:69], v5 offset:3168
    ds_read_b64_tr_b16 v[70:71], v5 offset:3440
    v_smfmac_f32_16x16x64_bf16 v[28:31], v[48:51], v[112:119], v10
    v_smfmac_f32_16x16x64_bf16 v[32:35], v[48:51], v[120:127], v10
    ds_read_b128 v[48:51], v0 offset:4096
    v_smfmac_f32_16x16x64_bf16 v[28:31], v[56:59], v[128:135], v10
    v_smfmac_f32_16x16x64_bf16 v[32:35], v[56:59], v[136:143], v10
    ds_read_b128 v[56:59], v0 offset:5120
    v_smfmac_f32_16x16x64_bf16 v[28:31], v[60:63], a[240:247], v10
    v_smfmac_f32_16x16x64_bf16 v[32:35], v[60:63], a[248:255], v10
    s_waitcnt lgkmcnt(10)
    v_mfma_f32_16x16x32_bf16 v[60:63], v[36:39], v[12:15], 0
    ds_read_b128 v[36:39], v0 offset:6144
    s_waitcnt lgkmcnt(9)
    v_mfma_f32_16x16x32_bf16 v[60:63], v[40:43], v[16:19], v[60:63]
    ds_read_b128 v[40:43], v0 offset:7168
    s_waitcnt lgkmcnt(8)
    v_mfma_f32_16x16x32_bf16 v[60:63], v[44:47], v[64:67], v[60:63]
    v_cvt_pk_bf16_f32 v28, v28, v29
    v_cvt_pk_bf16_f32 v29, v30, v31
    s_waitcnt lgkmcnt(4)
    v_mfma_f32_16x16x32_bf16 v[60:63], v[52:55], v[68:71], v[60:63]
    v_cvt_pk_bf16_f32 v30, v32, v33
    v_cvt_pk_bf16_f32 v31, v34, v35
    s_cmp_eq_u32 s61, 63
    s_barrier
    s_cbranch_scc1 L_CH_LAST_10
    ds_read_b64_tr_b16 v[44:45], v5 offset:26624
    ds_read_b64_tr_b16 v[46:47], v5 offset:26896
    ds_read_b64_tr_b16 v[52:53], v5 offset:27680
    ds_read_b64_tr_b16 v[54:55], v5 offset:27952
    s_waitcnt lgkmcnt(7)
    v_mfma_f32_16x16x32_bf16 v[20:23], v[48:51], v[12:15], 0
    ds_read_b64_tr_b16 v[48:49], v5 offset:28736
    ds_read_b64_tr_b16 v[50:51], v5 offset:29008
    s_waitcnt lgkmcnt(8)
    v_mfma_f32_16x16x32_bf16 v[20:23], v[56:59], v[16:19], v[20:23]
    ds_read_b64_tr_b16 v[56:57], v5 offset:29792
    ds_read_b64_tr_b16 v[58:59], v5 offset:30064
    s_waitcnt lgkmcnt(9)
    v_mfma_f32_16x16x32_bf16 v[20:23], v[36:39], v[64:67], v[20:23]
    s_waitcnt lgkmcnt(8)
    v_mfma_f32_16x16x32_bf16 v[20:23], v[40:43], v[68:71], v[20:23]
    v_xor_b32 v0, s75, v0
    s_waitcnt lgkmcnt(6)
    v_mfma_f32_16x16x32_bf16 v[24:27], v[44:47], v[12:15], 0
    v_max3_f32 v32, v60, v61, v62
    s_waitcnt lgkmcnt(4)
    v_mfma_f32_16x16x32_bf16 v[24:27], v[52:55], v[16:19], v[24:27]
    buffer_store_dwordx4 v[52:55], v1, s[4:7], s77 offen sc1
    s_waitcnt lgkmcnt(2)
    v_mfma_f32_16x16x32_bf16 v[24:27], v[48:51], v[64:67], v[24:27]
    s_waitcnt lgkmcnt(0)
    v_mfma_f32_16x16x32_bf16 v[24:27], v[56:59], v[68:71], v[24:27]
    v_max3_f32 v32, v32, v63, v20
    v_max3_f32 v33, v21, v22, v23
    v_mov_b64 v[18:19], s[8:9]
    s_add_u32 s77, s77, 131072
    v_mov_b64 v[44:45], 0
    v_mov_b64 v[46:47], 0
    v_mov_b64 v[48:49], s[38:39]
    v_mov_b64 v[50:51], s[38:39]
    v_max_f32 v32, v32, v33
    v_max3_f32 v33, v32, v24, v25
    v_max3_f32 v32, v32, v24, v25
    v_mov_b64 v[56:57], 0
    v_mov_b64 v[58:59], 0
    v_permlane16_swap_b32 v32, v33
    v_max_f32 v34, v32, v33
    v_max_f32 v35, v32, v33
    v_mov_b64 v[64:65], 0
    v_mov_b64 v[66:67], 0
    v_permlane32_swap_b32 v34, v35
    v_max_f32 v32, v34, v35
    v_mul_f32 v32, s82, v32
    v_pk_fma_f32 v[60:61], v[60:61], s[82:83], v[32:33] op_sel_hi:[1,0,0] neg_lo:[0,0,1] neg_hi:[0,0,1]
    v_pk_fma_f32 v[62:63], v[62:63], s[82:83], v[32:33] op_sel_hi:[1,0,0] neg_lo:[0,0,1] neg_hi:[0,0,1]
    v_pk_fma_f32 v[20:21], v[20:21], s[82:83], v[32:33] op_sel_hi:[1,0,0] neg_lo:[0,0,1] neg_hi:[0,0,1]
    v_pk_fma_f32 v[22:23], v[22:23], s[82:83], v[32:33] op_sel_hi:[1,0,0] neg_lo:[0,0,1] neg_hi:[0,0,1]
    v_pk_fma_f32 v[24:25], v[24:25], s[82:83], v[32:33] op_sel_hi:[1,0,0] neg_lo:[0,0,1] neg_hi:[0,0,1]
    v_exp_f32 v60, v60
    v_exp_f32 v61, v61
    v_exp_f32 v62, v62
    v_cvt_pk_bf16_f32 v12, v60, v61
    v_exp_f32 v63, v63
    v_exp_f32 v20, v20
    v_cvt_pk_bf16_f32 v13, v62, v63
    v_exp_f32 v21, v21
    v_exp_f32 v22, v22
    v_cvt_pk_bf16_f32 v14, v20, v21
    v_exp_f32 v23, v23
    v_exp_f32 v24, v24
    v_cvt_pk_bf16_f32 v15, v22, v23
    v_exp_f32 v25, v25
    s_waitcnt vmcnt(3)
    v_mfma_f32_16x16x32_bf16 v[36:39], v[72:75], v[12:15], 0
    v_cvt_pk_bf16_f32 v16, v24, v25
    v_cvt_pk_bf16_f32 v17, v24, v25
    v_mfma_f32_16x16x32_bf16 v[40:43], v[76:79], v[12:15], 0
    s_add_u32 s81, s81, 16384
    s_and_b32 s81, s81, 0xffff
    s_add_u32 s61, s61, 1
    v_mfma_f32_16x16x16_bf16 v[36:39], v[28:29], v[16:17], v[36:39]
    v_mov_b64 v[68:69], 0
    v_mov_b64 v[70:71], 0
    v_mfma_f32_16x16x16_bf16 v[40:43], v[30:31], v[16:17], v[40:43]
    v_mfma_f32_16x16x32_bf16 v[24:27], v[12:15], v[48:51], 0
    v_xor_b32 v2, 0x10000, v2
    ds_read_b128 v[72:75], v2 offset:0
    ds_read_b128 v[76:79], v2 offset:1024
    v_mov_b64 v[52:53], 0
    v_mov_b64 v[54:55], 0
    s_mov_b64 exec, s[94:95]
    v_cvt_pk_bf16_f32 v36, v36, v37
    v_cvt_pk_bf16_f32 v37, v38, v39
    v_cvt_pk_bf16_f32 v38, v40, v41
    v_cvt_pk_bf16_f32 v39, v42, v43
    ds_write_b128 v6, v[36:39]
    s_mov_b64 exec, -1
    v_mfma_f32_16x16x16_bf16 v[24:27], v[16:17], v[18:19], v[24:27]
    ds_read_b128 v[12:15], v2 offset:2048
    ds_read_b128 v[16:19], v2 offset:3072
    s_add_u32 s63, s90, s81
    s_add_u32 s91, s91, 32768
    s_add_u32 s98, s98, 32768
    s_add_u32 s89, s89, 32768
    s_add_u32 s65, s88, s81
    s_mov_b32 s60, 0
    v_rcp_f32 v60, v24
    v_rcp_f32 v61, v25
    s_waitcnt lgkmcnt(2)
    s_barrier
    ds_read_b128 v[48:51], v1 offset:0
    ds_read_b128 v[32:35], v1 offset:1024
    s_waitcnt lgkmcnt(1)
    v_smfmac_f32_16x16x64_bf16 v[68:71], v[48:51], v[72:79], v10
    ds_read_b128 v[72:75], v2 offset:16384
    ds_read_b128 v[76:79], v2 offset:17408
    v_smfmac_f32_16x16x64_bf16 v[44:47], v[48:51], v[12:19], v10
    ds_read_b128 v[12:15], v2 offset:18432
    ds_read_b128 v[16:19], v2 offset:19456
    s_waitcnt lgkmcnt(4)
    v_smfmac_f32_16x16x64_bf16 v[68:71], v[32:35], a[200:207], v10
    v_smfmac_f32_16x16x64_bf16 v[44:47], v[32:35], a[176:183], v10
    v_smfmac_f32_16x16x64_bf16 v[52:55], v[48:51], a[160:167], v10
    v_smfmac_f32_16x16x64_bf16 v[52:55], v[32:35], a[184:191], v10
    v_smfmac_f32_16x16x64_bf16 v[56:59], v[48:51], a[168:175], v10
    v_smfmac_f32_16x16x64_bf16 v[56:59], v[32:35], a[192:199], v10
    s_waitcnt lgkmcnt(2)
    v_smfmac_f32_16x16x64_bf16 v[64:67], v[48:51], v[72:79], v10
    s_waitcnt lgkmcnt(0)
    v_smfmac_f32_16x16x64_bf16 v[64:67], v[32:35], v[12:19], v10
    v_pk_add_f32 v[68:69], v[68:69], v[70:71]
    v_pk_add_f32 v[44:45], v[44:45], v[46:47]
    v_pk_add_f32 v[52:53], v[52:53], v[54:55]
    s_nop 0
    v_pk_add_f32 v[56:57], v[56:57], v[58:59]
    v_pk_mul_f32 v[68:69], v[68:69], v[60:61]
    v_pk_mul_f32 v[44:45], v[44:45], v[60:61]
    v_pk_mul_f32 v[52:53], v[52:53], v[60:61]
    v_pk_mul_f32 v[56:57], v[56:57], v[60:61]
    v_pk_add_f32 v[64:65], v[64:65], v[66:67]
    v_cvt_pk_bf16_f32 v40, v68, v69
    v_cvt_pk_bf16_f32 v36, v44, v45
    v_pk_mul_f32 v[64:65], v[64:65], v[60:61]
    buffer_store_dword v40, v8, s[4:7], s79 offen
    v_cvt_pk_bf16_f32 v37, v52, v53
    v_cvt_pk_bf16_f32 v38, v56, v57
    v_cvt_pk_bf16_f32 v39, v64, v65
    buffer_store_dwordx4 v[36:39], v7, s[4:7], s79 offen
    s_xor_b32 s79, s79, s92
    v_mov_b64 v[32:33], 0
    v_mov_b64 v[34:35], 0
    s_min_u32 s62, s0, s1
    s_max_u32 s68, s68, s62
    s_buffer_load_dword s0, s[4:7], s84 glc
    s_buffer_load_dword s1, s[4:7], s36 glc
L_sr_43:
    s_cmp_eq_u32 s72, 0
    s_cbranch_scc1 L_CH_NORED_10
    v_bfe_u32 v62, v1, 4, 1
    v_mov_b32 v63, 0x3f80
    v_lshlrev_b32 v62, 4, v62
    v_lshlrev_b32 v62, v62, v63
    v_cndmask_b32 v20, 0, v62, s[52:53]
    v_cndmask_b32 v21, 0, v62, s[54:55]
    v_cndmask_b32 v22, 0, v62, s[56:57]
    v_cndmask_b32 v23, 0, v62, s[58:59]
    s_sleep 1
    s_sleep 1
    s_sleep 1
    buffer_load_dwordx4 v[36:39], v1, s[4:7], s80 offen offset:0 sc1
    buffer_load_dwordx4 v[40:43], v1, s[4:7], s80 offen offset:1024 sc1
    buffer_load_dwordx4 v[44:47], v1, s[4:7], s80 offen offset:2048 sc1
    buffer_load_dwordx4 v[48:51], v1, s[4:7], s80 offen offset:3072 sc1
    s_sleep 1
    s_sleep 1
    buffer_load_dwordx4 v[52:55], v1, s[4:7], s80 offen offset:0 sc1
    buffer_load_dwordx4 v[56:59], v1, s[4:7], s80 offen offset:1024 sc1
    buffer_load_dwordx4 v[60:63], v1, s[4:7], s80 offen offset:2048 sc1
    buffer_load_dwordx4 v[64:67], v1, s[4:7], s80 offen offset:3072 sc1
L_CH_RED_10:
    s_waitcnt vmcnt(7)
    v_max3_u32 v76, v36, v37, v38
    v_max_u32 v76, v76, v39
    v_mfma_f32_16x16x32_bf16 v[68:71], v[36:39], v[20:23], 0
    s_waitcnt vmcnt(6)
    v_max3_u32 v76, v76, v40, v41
    v_max3_u32 v76, v76, v42, v43
    v_mfma_f32_16x16x32_bf16 v[68:71], v[40:43], v[20:23], v[68:71]
    s_waitcnt vmcnt(5)
    v_max3_u32 v76, v76, v44, v45
    v_max3_u32 v76, v76, v46, v47
    v_mfma_f32_16x16x32_bf16 v[68:71], v[44:47], v[20:23], v[68:71]
    s_waitcnt vmcnt(4)
    v_max3_u32 v76, v76, v48, v49
    v_max3_u32 v76, v76, v50, v51
    v_mfma_f32_16x16x32_bf16 v[68:71], v[48:51], v[20:23], v[68:71]
    v_cmp_eq_u32 vcc, -1, v76
    s_nop 0
    s_cbranch_vccz L_CH_REDOK_10
    buffer_load_dwordx4 v[36:39], v1, s[4:7], s80 offen offset:0 sc1
    buffer_load_dwordx4 v[40:43], v1, s[4:7], s80 offen offset:1024 sc1
    buffer_load_dwordx4 v[44:47], v1, s[4:7], s80 offen offset:2048 sc1
    buffer_load_dwordx4 v[48:51], v1, s[4:7], s80 offen offset:3072 sc1
    s_waitcnt vmcnt(7)
    v_max3_u32 v76, v52, v53, v54
    v_max_u32 v76, v76, v55
    v_mfma_f32_16x16x32_bf16 v[68:71], v[52:55], v[20:23], 0
    s_waitcnt vmcnt(6)
    v_max3_u32 v76, v76, v56, v57
    v_max3_u32 v76, v76, v58, v59
    v_mfma_f32_16x16x32_bf16 v[68:71], v[56:59], v[20:23], v[68:71]
    s_waitcnt vmcnt(5)
    v_max3_u32 v76, v76, v60, v61
    v_max3_u32 v76, v76, v62, v63
    v_mfma_f32_16x16x32_bf16 v[68:71], v[60:63], v[20:23], v[68:71]
    s_waitcnt vmcnt(4)
    v_max3_u32 v76, v76, v64, v65
    v_max3_u32 v76, v76, v66, v67
    v_mfma_f32_16x16x32_bf16 v[68:71], v[64:67], v[20:23], v[68:71]
    v_cmp_eq_u32 vcc, -1, v76
    s_nop 0
    s_cbranch_vccnz L_CH_REDX_10
L_CH_REDOK_10:
    s_nop 5
    v_permlane32_swap_b32 v68, v70
    v_permlane32_swap_b32 v69, v71
    v_pk_add_f32 v[68:69], v[68:69], v[70:71]
    v_cvt_pk_bf16_f32 v20, v68, v69
    s_mov_b64 exec, s[86:87]
    buffer_store_dword v20, v3, s[4:7], s63 offen
    buffer_store_dword v20, v3, s[4:7], s91 offen sc1
    s_mov_b64 exec, -1
    s_barrier
    s_xor_b32 s80, s80, s93
    s_mov_b32 s60, 0
    s_waitcnt vmcnt(2)
    ds_read_b128 v[56:59], v2 offset:32768
    ds_read_b128 v[60:63], v2 offset:33792
    ds_read_b128 v[64:67], v2 offset:49152
    ds_read_b128 v[68:71], v2 offset:50176
    ds_read_b128 v[48:51], v2 offset:34816
    ds_read_b128 v[52:55], v2 offset:35840
    v_mov_b64 v[12:13], 0
    v_mov_b64 v[14:15], 0
    v_mov_b64 v[16:17], 0
    v_mov_b64 v[18:19], 0
    v_mov_b64 v[20:21], 0
    v_mov_b64 v[22:23], 0
    v_mov_b64 v[24:25], 0
    v_mov_b64 v[26:27], 0
    v_mov_b64 v[28:29], 0
    v_mov_b64 v[30:31], 0
    v_mov_b64 v[36:37], -1
    v_mov_b64 v[38:39], -1
    s_sleep 1
    s_sleep 1
    s_sleep 1
    s_mov_b32 m0, s100
    s_add_u32 s64, s65, s99
    buffer_load_dwordx4 v1, s[4:7], s65 offen sc1 lds
    s_add_u32 m0, s100, s99
    s_mov_b64 exec, 0xffff
    buffer_load_dwordx4 v1, s[4:7], s64 offen sc1 lds
    s_mov_b64 exec, -1
    s_nop 11
    s_mov_b32 m0, s100
    s_add_u32 s64, s65, s99
    buffer_load_dwordx4 v1, s[4:7], s65 offen sc1 lds
    s_add_u32 m0, s100, s99
    s_mov_b64 exec, 0xffff
    buffer_load_dwordx4 v1, s[4:7], s64 offen sc1 lds
    s_mov_b64 exec, -1
    s_add_u32 s63, s101, s10
    buffer_store_dwordx4 v[36:39], v1, s[4:7], s101 offen
    s_mov_b64 exec, s[42:43]
    buffer_store_dwordx4 v[36:39], v1, s[4:7], s63 offen
    s_xor_b32 s101, s101, s40
    s_mov_b64 exec, -1
    s_waitcnt vmcnt(4)
    s_barrier
    ds_read_b128 v[36:39], v1 offset:0
    ds_read_b128 v[40:43], v1 offset:1024
    ds_read_b128 v[44:47], v1 offset:2048
    ds_read_b128 v[72:75], v1 offset:3072
    ds_read_b128 v[76:79], v1 offset:4096
    s_branch L_CH_A1_10
L_CH_NORED_10:
    v_mov_b64 v[12:13], 0
    v_mov_b64 v[14:15], 0
    v_mov_b64 v[16:17], 0
    v_mov_b64 v[18:19], 0
    v_mov_b64 v[20:21], 0
    v_mov_b64 v[22:23], 0
    v_mov_b64 v[24:25], 0
    v_mov_b64 v[26:27], 0
    v_mov_b64 v[28:29], 0
    v_mov_b64 v[30:31], 0
    ds_read_b128 v[56:59], v2 offset:32768
    ds_read_b128 v[60:63], v2 offset:33792
    ds_read_b128 v[64:67], v2 offset:49152
    ds_read_b128 v[68:71], v2 offset:50176
    ds_read_b128 v[48:51], v2 offset:34816
    ds_read_b128 v[52:55], v2 offset:35840
    s_barrier
    v_mov_b64 v[36:37], -1
    v_mov_b64 v[38:39], -1
    s_sleep 1
    s_sleep 1
    s_sleep 1
    s_sleep 1
    s_nop 11
    s_mov_b32 m0, s100
    s_add_u32 s64, s65, s99
    buffer_load_dwordx4 v1, s[4:7], s65 offen sc1 lds
    s_add_u32 m0, s100, s99
    s_mov_b64 exec, 0xffff
    buffer_load_dwordx4 v1, s[4:7], s64 offen sc1 lds
    s_mov_b64 exec, -1
    s_nop 11
    s_mov_b32 m0, s100
    s_add_u32 s64, s65, s99
    buffer_load_dwordx4 v1, s[4:7], s65 offen sc1 lds
    s_add_u32 m0, s100, s99
    s_mov_b64 exec, 0xffff
    buffer_load_dwordx4 v1, s[4:7], s64 offen sc1 lds
    s_mov_b64 exec, -1
    s_add_u32 s63, s101, s10
    buffer_store_dwordx4 v[36:39], v1, s[4:7], s101 offen
    s_mov_b64 exec, s[42:43]
    buffer_store_dwordx4 v[36:39], v1, s[4:7], s63 offen
    s_xor_b32 s101, s101, s40
    s_mov_b64 exec, -1
    s_waitcnt vmcnt(4)
    s_barrier
    ds_read_b128 v[36:39], v1 offset:0
    ds_read_b128 v[40:43], v1 offset:1024
    ds_read_b128 v[44:47], v1 offset:2048
    ds_read_b128 v[72:75], v1 offset:3072
    ds_read_b128 v[76:79], v1 offset:4096
    s_branch L_CH_A1_10
L_CH_LRETRY_10:
    s_add_u32 s60, s60, 1
    s_cmp_lg_u32 s60, 1
    s_cbranch_scc1 L_ln_44
    v_mov_b64 v[12:13], 0
    v_mov_b64 v[14:15], 0
    s_nop 0
    v_mov_b64 v[16:17], 0
    v_mov_b64 v[18:19], 0
    s_waitcnt vmcnt(0)
    s_branch L_CH_LOOP_10
L_ln_44:
    v_max3_u32 v9, v36, v37, v38
    v_max3_u32 v9, v9, v38, v39
    v_max3_u32 v9, v9, v40, v41
    v_max3_u32 v9, v9, v42, v43
    v_max3_u32 v9, v9, v44, v45
    v_max3_u32 v9, v9, v46, v47
    v_max3_u32 v9, v9, v72, v73
    v_max3_u32 v9, v9, v74, v75
    v_max3_u32 v9, v9, v76, v77
    v_max3_u32 v9, v9, v78, v79
    v_cmp_eq_u32 vcc, -1, v9
    s_nop 0
    s_cbranch_vccz L_CH_LGO_10
    s_cmp_ge_u32 s60, 0x100000
    s_movk_i32 s62, 15
    s_cbranch_scc1 L_ABORT
    s_sub_u32 s63, s65, s2
    s_mov_b32 m0, 131072
    s_add_u32 s64, s63, 4096
    buffer_load_dwordx4 v1, s[4:7], s63 offen offset:0 sc1 lds
    buffer_load_dwordx4 v1, s[4:7], s63 offen offset:1024 sc1 lds
    buffer_load_dwordx4 v1, s[4:7], s63 offen offset:2048 sc1 lds
    buffer_load_dwordx4 v1, s[4:7], s63 offen offset:3072 sc1 lds
    s_mov_b32 m0, 135168
    s_nop 0
    buffer_load_dwordx4 v1, s[4:7], s64 offen sc1 lds
    v_mov_b64 v[12:13], 0
    v_mov_b64 v[14:15], 0
    v_mov_b64 v[16:17], 0
    v_mov_b64 v[18:19], 0
    s_waitcnt vmcnt(0)
    s_branch L_CH_LOOP_10
L_CH_RETRY_10:
    s_mov_b32 s60, 0
    s_sleep 1
    s_sleep 1
    s_mov_b32 m0, s85
    s_add_u32 s64, s98, s99
    buffer_load_dwordx4 v1, s[4:7], s98 offen sc1 lds
    s_add_u32 m0, s85, s99
    s_mov_b64 exec, 0xffff
    buffer_load_dwordx4 v1, s[4:7], s64 offen sc1 lds
    s_mov_b64 exec, -1
    s_branch L_CH_RETRY2_10
L_CH_RETRY1_10:
    s_mov_b32 s63, s89
    s_mov_b32 m0, 136192
    s_add_u32 s64, s63, 4096
    buffer_load_dwordx4 v1, s[4:7], s63 offen offset:0 sc1 lds
    buffer_load_dwordx4 v1, s[4:7], s63 offen offset:1024 sc1 lds
    buffer_load_dwordx4 v1, s[4:7], s63 offen offset:2048 sc1 lds
    buffer_load_dwordx4 v1, s[4:7], s63 offen offset:3072 sc1 lds
    s_mov_b32 m0, 140288
    s_nop 0
    buffer_load_dwordx4 v1, s[4:7], s64 offen sc1 lds
L_CH_RETRY2_10:
    s_waitcnt vmcnt(0)
    ds_read_b128 v[64:67], v1 offset:5120
    ds_read_b128 v[68:71], v1 offset:6144
    ds_read_b128 v[48:51], v1 offset:7168
    ds_read_b128 v[56:59], v1 offset:8192
    ds_read_b128 v[60:63], v1 offset:9216
    s_waitcnt lgkmcnt(0)
L_CH_RETRY3_10:
    v_max3_u32 v9, v64, v65, v66
    v_max_u32 v9, v9, v67
    v_max3_u32 v9, v9, v68, v69
    v_max3_u32 v9, v9, v70, v71
    v_max3_u32 v9, v9, v48, v49
    v_max3_u32 v9, v9, v50, v51
    v_max3_u32 v9, v9, v56, v57
    v_max3_u32 v9, v9, v58, v59
    v_max3_u32 v9, v9, v60, v61
    v_max3_u32 v9, v9, v62, v63
    v_cmp_eq_u32 vcc, -1, v9
    s_nop 0
    s_cbranch_vccz L_CH_REDO_10
    s_add_u32 s60, s60, 1
    s_cmp_lt_u32 s60, 0x100000
    s_cbranch_scc1 L_CH_RETRY1_10
    s_movk_i32 s62, 13
    s_branch L_ABORT
L_CH_REDO_10:
    v_mov_b64 v[12:13], 0
    v_mov_b64 v[14:15], 0
    s_nop 1
    v_smfmac_f32_16x16x64_bf16 v[12:15], v[36:39], a[0:7], v10
    v_smfmac_f32_16x16x64_bf16 v[12:15], v[40:43], a[16:23], v10
    v_smfmac_f32_16x16x64_bf16 v[12:15], v[44:47], a[32:39], v10
    v_smfmac_f32_16x16x64_bf16 v[12:15], v[72:75], a[48:55], v10
    v_smfmac_f32_16x16x64_bf16 v[12:15], v[76:79], a[64:71], v10
    v_smfmac_f32_16x16x64_bf16 v[12:15], v[56:59], a[128:135], v10
    v_smfmac_f32_16x16x64_bf16 v[12:15], v[60:63], a[144:151], v10
    v_smfmac_f32_16x16x64_bf16 v[12:15], v[64:67], a[80:87], v10
    v_smfmac_f32_16x16x64_bf16 v[12:15], v[68:71], a[96:103], v10
    v_smfmac_f32_16x16x64_bf16 v[12:15], v[48:51], a[112:119], v10
    s_branch L_CH_C_10
L_CH_LAST_10:
    s_mul_i32 s62, s44, 1056
    v_add_u32 v9, s62, v5
    ds_read_b64_tr_b16 v[28:29], v9 offset:26624
    ds_read_b64_tr_b16 v[30:31], v9 offset:26896
    s_waitcnt lgkmcnt(0)
    buffer_store_dwordx4 v[28:31], v1, s[4:7], s77 offen sc1
    s_add_u32 s77, s77, 131072
    s_waitcnt vmcnt(0)
    v_mov_b32 v62, 0
    v_mov_b32 v63, 64
    s_mov_b64 exec, 1
    buffer_store_dword v63, v62, s[4:7], s78 offen sc1
    s_mov_b64 exec, -1
    s_branch L_END2
L_CH_REDX_10:
    buffer_load_dwordx4 v[52:55], v1, s[4:7], s80 offen offset:0 sc1
    buffer_load_dwordx4 v[56:59], v1, s[4:7], s80 offen offset:1024 sc1
    buffer_load_dwordx4 v[60:63], v1, s[4:7], s80 offen offset:2048 sc1
    buffer_load_dwordx4 v[64:67], v1, s[4:7], s80 offen offset:3072 sc1
    s_add_u32 s60, s60, 1
    s_cmp_lt_u32 s60, 0x100000
    s_cbranch_scc1 L_CH_RED_10
    s_movk_i32 s62, 14
    s_branch L_ABORT
L_kv_41:
    v_bfe_u32 v52, v1, 4, 1
    v_lshlrev_b32 v52, 5, v52
    v_add_u32 v52, s46, v52
    v_add_u32 v52, 64, v52
    v_lshlrev_b32 v52, 6, v52
    s_mov_b32 s60, 0
L_pf_45:
    buffer_load_dword v53, v52, s[4:7], 0 offen sc1
    s_waitcnt vmcnt(0)
    v_cmp_gt_u32 vcc, s69, v53
    s_nop 0
    s_cbranch_vccz L_pfd_46
    s_sleep 1
    s_add_u32 s60, s60, 1
    s_cmp_lt_u32 s60, 0x100000
    s_cbranch_scc1 L_pf_45
    s_movk_i32 s62, 11
    s_branch L_ABORT
L_pfd_46:
    v_readlane_b32 s68, v53, 0
    v_readlane_b32 s62, v53, 1
    s_nop 0
    s_min_u32 s68, s68, s62
    s_branch L_kvr_42
L_kv_39:
    v_bfe_u32 v52, v1, 4, 1
    v_lshlrev_b32 v52, 5, v52
    v_add_u32 v52, s46, v52
    v_add_u32 v52, 64, v52
    v_lshlrev_b32 v52, 6, v52
    s_mov_b32 s60, 0
L_pf_47:
    buffer_load_dword v53, v52, s[4:7], 0 offen sc1
    s_waitcnt vmcnt(0)
    v_cmp_gt_u32 vcc, s69, v53
    s_nop 0
    s_cbranch_vccz L_pfd_48
    s_sleep 1
    s_add_u32 s60, s60, 1
    s_cmp_lt_u32 s60, 0x100000
    s_cbranch_scc1 L_pf_47
    s_movk_i32 s62, 11
    s_branch L_ABORT
L_pfd_48:
    v_readlane_b32 s68, v53, 0
    v_readlane_b32 s62, v53, 1
    s_nop 0
    s_min_u32 s68, s68, s62
    s_branch L_kvr_40
L_CH_FIRST_20:
    ds_read_b128 v[36:39], v1 offset:0
    ds_read_b128 v[40:43], v1 offset:1024
    ds_read_b128 v[44:47], v1 offset:2048
    ds_read_b128 v[72:75], v1 offset:3072
    ds_read_b128 v[76:79], v1 offset:4096
    s_waitcnt lgkmcnt(4)
    v_smfmac_f32_16x16x64_bf16 v[12:15], v[36:39], a[0:7], v10
    s_waitcnt lgkmcnt(3)
    v_smfmac_f32_16x16x64_bf16 v[12:15], v[40:43], a[16:23], v10
    s_waitcnt lgkmcnt(2)
    v_smfmac_f32_16x16x64_bf16 v[12:15], v[44:47], a[32:39], v10
    s_waitcnt lgkmcnt(1)
    v_smfmac_f32_16x16x64_bf16 v[12:15], v[72:75], a[48:55], v10
    s_waitcnt lgkmcnt(0)
    v_smfmac_f32_16x16x64_bf16 v[12:15], v[76:79], a[64:71], v10
    v_smfmac_f32_16x16x64_bf16 v[16:19], v[36:39], a[8:15], v10
    v_smfmac_f32_16x16x64_bf16 v[16:19], v[40:43], a[24:31], v10
    v_smfmac_f32_16x16x64_bf16 v[16:19], v[44:47], a[40:47], v10
    v_smfmac_f32_16x16x64_bf16 v[16:19], v[72:75], a[56:63], v10
    v_smfmac_f32_16x16x64_bf16 v[16:19], v[76:79], a[72:79], v10
    v_smfmac_f32_16x16x64_bf16 v[28:31], v[36:39], v[56:63], v10
    ds_read_b128 v[56:59], v2 offset:51200
    ds_read_b128 v[60:63], v2 offset:52224
    v_smfmac_f32_16x16x64_bf16 v[20:23], v[36:39], v[64:71], v10
    v_xor_b32 v2, 0x10000, v2
    ds_read_b128 v[64:67], v2 offset:0
    ds_read_b128 v[68:71], v2 offset:1024
    v_smfmac_f32_16x16x64_bf16 v[32:35], v[36:39], v[48:55], v10
    ds_read_b128 v[48:51], v2 offset:2048
    ds_read_b128 v[52:55], v2 offset:3072
    v_smfmac_f32_16x16x64_bf16 v[20:23], v[40:43], a[208:215], v10
    s_waitcnt lgkmcnt(4)
    v_smfmac_f32_16x16x64_bf16 v[24:27], v[36:39], v[56:63], v10
    ds_read_b128 v[56:59], v2 offset:16384
    ds_read_b128 v[60:63], v2 offset:17408
    v_smfmac_f32_16x16x64_bf16 v[24:27], v[40:43], a[216:223], v10
    s_waitcnt lgkmcnt(4)
    v_smfmac_f32_16x16x64_bf16 v[28:31], v[40:43], v[64:71], v10
    ds_read_b128 v[64:67], v2 offset:18432
    ds_read_b128 v[68:71], v2 offset:19456
    v_smfmac_f32_16x16x64_bf16 v[20:23], v[44:47], a[224:231], v10
    s_waitcnt lgkmcnt(4)
    v_smfmac_f32_16x16x64_bf16 v[32:35], v[40:43], v[48:55], v10
    ds_read_b128 v[48:51], v2 offset:32768
    ds_read_b128 v[52:55], v2 offset:33792
    v_smfmac_f32_16x16x64_bf16 v[24:27], v[44:47], a[232:239], v10
    s_waitcnt lgkmcnt(4)
    v_smfmac_f32_16x16x64_bf16 v[28:31], v[44:47], v[56:63], v10
    ds_read_b128 v[56:59], v2 offset:34816
    ds_read_b128 v[60:63], v2 offset:35840
    s_waitcnt lgkmcnt(4)
    v_smfmac_f32_16x16x64_bf16 v[32:35], v[44:47], v[64:71], v10
    ds_read_b128 v[64:67], v2 offset:49152
    ds_read_b128 v[68:71], v2 offset:50176
    s_waitcnt lgkmcnt(4)
    v_smfmac_f32_16x16x64_bf16 v[28:31], v[72:75], v[48:55], v10
    ds_read_b128 v[48:51], v2 offset:51200
    ds_read_b128 v[52:55], v2 offset:52224
    s_waitcnt lgkmcnt(4)
    v_smfmac_f32_16x16x64_bf16 v[32:35], v[72:75], v[56:63], v10
    s_barrier
    s_mov_b32 s69, 2
    ds_read_b128 v[56:59], v1 offset:8192
    ds_read_b128 v[60:63], v1 offset:9216
    s_waitcnt lgkmcnt(4)
    v_smfmac_f32_16x16x64_bf16 v[28:31], v[76:79], v[64:71], v10
    ds_read_b128 v[64:67], v1 offset:5120
    ds_read_b128 v[68:71], v1 offset:6144
    s_waitcnt lgkmcnt(4)
    v_smfmac_f32_16x16x64_bf16 v[32:35], v[76:79], v[48:55], v10
    ds_read_b128 v[48:51], v1 offset:7168
    v_smfmac_f32_16x16x64_bf16 v[20:23], v[72:75], v[144:151], v10
    s_waitcnt lgkmcnt(4)
    v_smfmac_f32_16x16x64_bf16 v[12:15], v[56:59], a[128:135], v10
    s_waitcnt lgkmcnt(3)
    v_smfmac_f32_16x16x64_bf16 v[12:15], v[60:63], a[144:151], v10
    s_waitcnt lgkmcnt(2)
    v_smfmac_f32_16x16x64_bf16 v[12:15], v[64:67], a[80:87], v10
    s_waitcnt lgkmcnt(1)
    v_smfmac_f32_16x16x64_bf16 v[12:15], v[68:71], a[96:103], v10
    s_waitcnt lgkmcnt(0)
    v_smfmac_f32_16x16x64_bf16 v[12:15], v[48:51], a[112:119], v10
    s_cmp_lt_u32 s68, s69
    s_cbranch_scc1 L_kv_49
L_kvr_50:
    v_smfmac_f32_16x16x64_bf16 v[24:27], v[72:75], v[152:159], v10
    v_smfmac_f32_16x16x64_bf16 v[20:23], v[76:79], v[160:167], v10
    v_smfmac_f32_16x16x64_bf16 v[24:27], v[76:79], v[168:175], v10
    s_branch L_CH_C_20
    .p2align 6
L_CH_B1_20:
    s_barrier
L_CH_LOOP_20:
    ds_read_b128 v[36:39], v1 offset:0
    ds_read_b128 v[40:43], v1 offset:1024
    ds_read_b128 v[44:47], v1 offset:2048
    ds_read_b128 v[72:75], v1 offset:3072
    ds_read_b128 v[76:79], v1 offset:4096
L_CH_A1_20:
    s_waitcnt lgkmcnt(4)
    v_smfmac_f32_16x16x64_bf16 v[12:15], v[36:39], a[0:7], v10
    s_waitcnt lgkmcnt(3)
    v_smfmac_f32_16x16x64_bf16 v[12:15], v[40:43], a[16:23], v10
    s_waitcnt lgkmcnt(2)
    v_smfmac_f32_16x16x64_bf16 v[12:15], v[44:47], a[32:39], v10
    s_waitcnt lgkmcnt(1)
    v_smfmac_f32_16x16x64_bf16 v[12:15], v[72:75], a[48:55], v10
    s_waitcnt lgkmcnt(0)
    v_smfmac_f32_16x16x64_bf16 v[12:15], v[76:79], a[64:71], v10
    v_smfmac_f32_16x16x64_bf16 v[16:19], v[36:39], a[8:15], v10
    v_smfmac_f32_16x16x64_bf16 v[16:19], v[40:43], a[24:31], v10
    s_add_u32 s69, s61, 2
    s_min_u32 s69, s69, 64
    s_mov_b32 m0, s85
    s_add_u32 s64, s98, s99
    s_nop 1
    v_cmp_u_f32 vcc, v12, v13
    v_cmp_u_f32 s[62:63], v14, v15
    v_smfmac_f32_16x16x64_bf16 v[16:19], v[44:47], a[40:47], v10
    s_or_b64 vcc, vcc, s[62:63]
    s_cbranch_scc1 L_CH_LRETRY_20
L_CH_LGO_20:
    buffer_load_dwordx4 v1, s[4:7], s98 offen sc1 lds
    s_add_u32 m0, s85, s99
    s_mov_b64 exec, 0xffff
    buffer_load_dwordx4 v1, s[4:7], s64 offen sc1 lds
    s_mov_b64 exec, -1
    v_smfmac_f32_16x16x64_bf16 v[16:19], v[72:75], a[56:63], v10
    v_smfmac_f32_16x16x64_bf16 v[16:19], v[76:79], a[72:79], v10
    v_smfmac_f32_16x16x64_bf16 v[28:31], v[36:39], v[56:63], v10
    ds_read_b128 v[56:59], v2 offset:51200
    ds_read_b128 v[60:63], v2 offset:52224
    v_smfmac_f32_16x16x64_bf16 v[20:23], v[36:39], v[64:71], v10
    v_xor_b32 v2, 0x10000, v2
    ds_read_b128 v[64:67], v2 offset:0
    ds_read_b128 v[68:71], v2 offset:1024
    v_smfmac_f32_16x16x64_bf16 v[32:35], v[36:39], v[48:55], v10
    ds_read_b128 v[48:51], v2 offset:2048
    ds_read_b128 v[52:55], v2 offset:3072
    v_smfmac_f32_16x16x64_bf16 v[20:23], v[40:43], a[208:215], v10
    v_mov_b32 v9, s61
    s_mov_b64 exec, 1
    buffer_store_dword v9, off, s[4:7], s78 sc1
    s_mov_b64 exec, -1
    s_waitcnt lgkmcnt(4)
    v_smfmac_f32_16x16x64_bf16 v[24:27], v[36:39], v[56:63], v10
    ds_read_b128 v[56:59], v2 offset:16384
    ds_read_b128 v[60:63], v2 offset:17408
    v_smfmac_f32_16x16x64_bf16 v[24:27], v[40:43], a[216:223], v10
    s_waitcnt lgkmcnt(4)
    v_smfmac_f32_16x16x64_bf16 v[28:31], v[40:43], v[64:71], v10
    ds_read_b128 v[64:67], v2 offset:18432
    ds_read_b128 v[68:71], v2 offset:19456
    v_smfmac_f32_16x16x64_bf16 v[20:23], v[44:47], a[224:231], v10
    s_waitcnt lgkmcnt(4)
    v_smfmac_f32_16x16x64_bf16 v[32:35], v[40:43], v[48:55], v10
    ds_read_b128 v[48:51], v2 offset:32768
    ds_read_b128 v[52:55], v2 offset:33792
    v_smfmac_f32_16x16x64_bf16 v[24:27], v[44:47], a[232:239], v10
    s_waitcnt lgkmcnt(4)
    v_smfmac_f32_16x16x64_bf16 v[28:31], v[44:47], v[56:63], v10
    ds_read_b128 v[56:59], v2 offset:34816
    ds_read_b128 v[60:63], v2 offset:35840
    s_waitcnt lgkmcnt(4)
    v_smfmac_f32_16x16x64_bf16 v[32:35], v[44:47], v[64:71], v10
    ds_read_b128 v[64:67], v2 offset:49152
    ds_read_b128 v[68:71], v2 offset:50176
    s_waitcnt lgkmcnt(4)
    v_smfmac_f32_16x16x64_bf16 v[28:31], v[72:75], v[48:55], v10
    ds_read_b128 v[48:51], v2 offset:51200
    ds_read_b128 v[52:55], v2 offset:52224
    s_waitcnt lgkmcnt(4)
    v_smfmac_f32_16x16x64_bf16 v[32:35], v[72:75], v[56:63], v10
    s_waitcnt vmcnt(1)
    s_barrier
    ds_read_b128 v[56:59], v1 offset:8192
    ds_read_b128 v[60:63], v1 offset:9216
    s_waitcnt lgkmcnt(4)
    v_smfmac_f32_16x16x64_bf16 v[28:31], v[76:79], v[64:71], v10
    ds_read_b128 v[64:67], v1 offset:5120
    ds_read_b128 v[68:71], v1 offset:6144
    s_waitcnt lgkmcnt(4)
    v_smfmac_f32_16x16x64_bf16 v[32:35], v[76:79], v[48:55], v10
    ds_read_b128 v[48:51], v1 offset:7168
    v_smfmac_f32_16x16x64_bf16 v[20:23], v[72:75], v[144:151], v10
    s_waitcnt lgkmcnt(4)
    v_smfmac_f32_16x16x64_bf16 v[12:15], v[56:59], a[128:135], v10
    s_waitcnt lgkmcnt(3)
    v_smfmac_f32_16x16x64_bf16 v[12:15], v[60:63], a[144:151], v10
    s_waitcnt lgkmcnt(2)
    v_smfmac_f32_16x16x64_bf16 v[12:15], v[64:67], a[80:87], v10
    s_waitcnt lgkmcnt(1)
    v_smfmac_f32_16x16x64_bf16 v[12:15], v[68:71], a[96:103], v10
    s_waitcnt lgkmcnt(0)
    v_smfmac_f32_16x16x64_bf16 v[12:15], v[48:51], a[112:119], v10
    s_cmp_lt_u32 s68, s69
    s_cbranch_scc1 L_kv_51
L_kvr_52:
    v_smfmac_f32_16x16x64_bf16 v[24:27], v[72:75], v[152:159], v10
    v_smfmac_f32_16x16x64_bf16 v[20:23], v[76:79], v[160:167], v10
    v_smfmac_f32_16x16x64_bf16 v[24:27], v[76:79], v[168:175], v10
    s_nop 2
    v_cmp_u_f32 vcc, v12, v13
    v_cmp_u_f32 s[62:63], v14, v15
    s_nop 0
    s_or_b64 vcc, vcc, s[62:63]
    s_cbranch_scc1 L_CH_RETRY_20
L_CH_C_20:
    v_smfmac_f32_16x16x64_bf16 v[16:19], v[64:67], a[88:95], v10
    buffer_load_dwordx4 v[72:75], v1, s[4:7], s76 offen sc1
    v_smfmac_f32_16x16x64_bf16 v[16:19], v[68:71], a[104:111], v10
    v_smfmac_f32_16x16x64_bf16 v[16:19], v[48:51], a[120:127], v10
    buffer_load_dwordx4 v[76:79], v1, s[4:7], s76 offen offset:1024 sc1
    s_add_u32 s76, s76, 262144
    v_smfmac_f32_16x16x64_bf16 v[16:19], v[56:59], a[136:143], v10
    v_pk_add_f32 v[12:13], v[12:13], v[14:15]
    v_smfmac_f32_16x16x64_bf16 v[16:19], v[60:63], a[152:159], v10
    ds_read_b128 v[36:39], v0 offset:0
    ds_read_b128 v[40:43], v0 offset:1024
    v_cvt_pk_bf16_f32 v14, v12, v13
    v_smfmac_f32_16x16x64_bf16 v[20:23], v[64:67], v[176:183], v10
    ds_read_b128 v[44:47], v0 offset:2048
    ds_read_b128 v[52:55], v0 offset:3072
    v_smfmac_f32_16x16x64_bf16 v[24:27], v[64:67], v[184:191], v10
    v_smfmac_f32_16x16x64_bf16 v[20:23], v[68:71], v[192:199], v10
    v_pk_add_f32 v[16:17], v[16:17], v[18:19]
    v_smfmac_f32_16x16x64_bf16 v[24:27], v[68:71], v[200:207], v10
    v_cvt_pk_bf16_f32 v18, v16, v17
    v_smfmac_f32_16x16x64_bf16 v[20:23], v[48:51], v[208:215], v10
    ds_write_b32 v4, v14 offset:0
    ds_write_b32 v4, v18 offset:528
    v_smfmac_f32_16x16x64_bf16 v[24:27], v[48:51], v[216:223], v10
    v_smfmac_f32_16x16x64_bf16 v[20:23], v[56:59], v[224:231], v10
    s_mov_b32 m0, s74
    s_xor_b32 s74, s74, s37
    buffer_load_dwordx4 v1, s[4:7], s73 offen sc1 lds
    v_smfmac_f32_16x16x64_bf16 v[24:27], v[56:59], v[232:239], v10
    v_smfmac_f32_16x16x64_bf16 v[20:23], v[60:63], v[240:247], v10
    buffer_load_dwordx4 v1, s[4:7], s73 offen offset:1024 sc1 lds
    s_add_u32 s73, s73, 262144
    v_smfmac_f32_16x16x64_bf16 v[24:27], v[60:63], v[248:255], v10
    s_waitcnt lgkmcnt(0)
    s_barrier
    ds_read_b64_tr_b16 v[12:13], v5 offset:0
    ds_read_b64_tr_b16 v[14:15], v5 offset:272
    v_smfmac_f32_16x16x64_bf16 v[28:31], v[64:67], v[80:87], v10
    ds_read_b64_tr_b16 v[16:17], v5 offset:1056
    ds_read_b64_tr_b16 v[18:19], v5 offset:1328
    v_pk_add_f32 v[20:21], v[20:21], v[22:23]
    v_smfmac_f32_16x16x64_bf16 v[32:35], v[64:67], v[88:95], v10
    ds_read_b64_tr_b16 v[64:65], v5 offset:2112
    ds_read_b64_tr_b16 v[66:67], v5 offset:2384
    v_pk_add_f32 v[24:25], v[24:25], v[26:27]
    v_cvt_pk_bf16_f32 v22, v20, v21
    v_smfmac_f32_16x16x64_bf16 v[28:31], v[68:71], v[96:103], v10
    v_cvt_pk_bf16_f32 v26, v24, v25
    ds_write_b32 v4, v22 offset:26624
    ds_write_b32 v4, v26 offset:27152
    v_smfmac_f32_16x16x64_bf16 v[32:35], v[68:71], v[104:111], v10
    ds_read_b64_tr_b16 v[68:69], v5 offset:3168
    ds_read_b64_tr_b16 v[70:71], v5 offset:3440
    v_smfmac_f32_16x16x64_bf16 v[28:31], v[48:51], v[112:119], v10
    v_smfmac_f32_16x16x64_bf16 v[32:35], v[48:51], v[120:127], v10
    ds_read_b128 v[48:51], v0 offset:4096
    v_smfmac_f32_16x16x64_bf16 v[28:31], v[56:59], v[128:135], v10
    v_smfmac_f32_16x16x64_bf16 v[32:35], v[56:59], v[136:143], v10
    ds_read_b128 v[56:59], v0 offset:5120
    v_smfmac_f32_16x16x64_bf16 v[28:31], v[60:63], a[240:247], v10
    v_smfmac_f32_16x16x64_bf16 v[32:35], v[60:63], a[248:255], v10
    s_waitcnt lgkmcnt(10)
    v_mfma_f32_16x16x32_bf16 v[60:63], v[36:39], v[12:15], 0
    ds_read_b128 v[36:39], v0 offset:6144
    s_waitcnt lgkmcnt(9)
    v_mfma_f32_16x16x32_bf16 v[60:63], v[40:43], v[16:19], v[60:63]
    ds_read_b128 v[40:43], v0 offset:7168
    s_waitcnt lgkmcnt(8)
    v_mfma_f32_16x16x32_bf16 v[60:63], v[44:47], v[64:67], v[60:63]
    v_cvt_pk_bf16_f32 v28, v28, v29
    v_cvt_pk_bf16_f32 v29, v30, v31
    s_waitcnt lgkmcnt(4)
    v_mfma_f32_16x16x32_bf16 v[60:63], v[52:55], v[68:71], v[60:63]
    v_cvt_pk_bf16_f32 v30, v32, v33
    v_cvt_pk_bf16_f32 v31, v34, v35
    s_cmp_eq_u32 s61, 63
    s_barrier
    s_cbranch_scc1 L_CH_LAST_20
    ds_read_b64_tr_b16 v[44:45], v5 offset:26624
    ds_read_b64_tr_b16 v[46:47], v5 offset:26896
    ds_read_b64_tr_b16 v[52:53], v5 offset:27680
    ds_read_b64_tr_b16 v[54:55], v5 offset:27952
    s_waitcnt lgkmcnt(7)
    v_mfma_f32_16x16x32_bf16 v[20:23], v[48:51], v[12:15], 0
    ds_read_b64_tr_b16 v[48:49], v5 offset:28736
    ds_read_b64_tr_b16 v[50:51], v5 offset:29008
    s_waitcnt lgkmcnt(8)
    v_mfma_f32_16x16x32_bf16 v[20:23], v[56:59], v[16:19], v[20:23]
    ds_read_b64_tr_b16 v[56:57], v5 offset:29792
    ds_read_b64_tr_b16 v[58:59], v5 offset:30064
    s_waitcnt lgkmcnt(9)
    v_mfma_f32_16x16x32_bf16 v[20:23], v[36:39], v[64:67], v[20:23]
    s_waitcnt lgkmcnt(8)
    v_mfma_f32_16x16x32_bf16 v[20:23], v[40:43], v[68:71], v[20:23]
    v_xor_b32 v0, s75, v0
    s_waitcnt lgkmcnt(6)
    v_mfma_f32_16x16x32_bf16 v[24:27], v[44:47], v[12:15], 0
    v_max3_f32 v32, v60, v61, v62
    s_waitcnt lgkmcnt(4)
    v_mfma_f32_16x16x32_bf16 v[24:27], v[52:55], v[16:19], v[24:27]
    s_waitcnt lgkmcnt(2)
    v_mfma_f32_16x16x32_bf16 v[24:27], v[48:51], v[64:67], v[24:27]
    buffer_store_dwordx4 v[48:51], v1, s[4:7], s77 offen sc1
    s_waitcnt lgkmcnt(0)
    v_mfma_f32_16x16x32_bf16 v[24:27], v[56:59], v[68:71], v[24:27]
    v_max3_f32 v32, v32, v63, v20
    v_max3_f32 v33, v21, v22, v23
    v_mov_b64 v[18:19], s[8:9]
    s_add_u32 s77, s77, 131072
    v_mov_b64 v[44:45], 0
    v_mov_b64 v[46:47], 0
    v_mov_b64 v[48:49], s[38:39]
    v_mov_b64 v[50:51], s[38:39]
    v_max_f32 v32, v32, v33
    v_max3_f32 v33, v32, v24, v25
    v_max3_f32 v32, v32, v24, v25
    v_mov_b64 v[56:57], 0
    v_mov_b64 v[58:59], 0
    v_permlane16_swap_b32 v32, v33
    v_max_f32 v34, v32, v33
    v_max_f32 v35, v32, v33
    v_mov_b64 v[64:65], 0
    v_mov_b64 v[66:67], 0
    v_permlane32_swap_b32 v34, v35
    v_max_f32 v32, v34, v35
    v_mul_f32 v32, s82, v32
    v_pk_fma_f32 v[60:61], v[60:61], s[82:83], v[32:33] op_sel_hi:[1,0,0] neg_lo:[0,0,1] neg_hi:[0,0,1]
    v_pk_fma_f32 v[62:63], v[62:63], s[82:83], v[32:33] op_sel_hi:[1,0,0] neg_lo:[0,0,1] neg_hi:[0,0,1]
    v_pk_fma_f32 v[20:21], v[20:21], s[82:83], v[32:33] op_sel_hi:[1,0,0] neg_lo:[0,0,1] neg_hi:[0,0,1]
    v_pk_fma_f32 v[22:23], v[22:23], s[82:83], v[32:33] op_sel_hi:[1,0,0] neg_lo:[0,0,1] neg_hi:[0,0,1]
    v_pk_fma_f32 v[24:25], v[24:25], s[82:83], v[32:33] op_sel_hi:[1,0,0] neg_lo:[0,0,1] neg_hi:[0,0,1]
    v_exp_f32 v60, v60
    v_exp_f32 v61, v61
    v_exp_f32 v62, v62
    v_cvt_pk_bf16_f32 v12, v60, v61
    v_exp_f32 v63, v63
    v_exp_f32 v20, v20
    v_cvt_pk_bf16_f32 v13, v62, v63
    v_exp_f32 v21, v21
    v_exp_f32 v22, v22
    v_cvt_pk_bf16_f32 v14, v20, v21
    v_exp_f32 v23, v23
    v_exp_f32 v24, v24
    v_cvt_pk_bf16_f32 v15, v22, v23
    v_exp_f32 v25, v25
    s_waitcnt vmcnt(3)
    v_mfma_f32_16x16x32_bf16 v[36:39], v[72:75], v[12:15], 0
    v_cvt_pk_bf16_f32 v16, v24, v25
    v_cvt_pk_bf16_f32 v17, v24, v25
    v_mfma_f32_16x16x32_bf16 v[40:43], v[76:79], v[12:15], 0
    s_add_u32 s81, s81, 16384
    s_and_b32 s81, s81, 0xffff
    s_add_u32 s61, s61, 1
    v_mfma_f32_16x16x16_bf16 v[36:39], v[28:29], v[16:17], v[36:39]
    v_mov_b64 v[68:69], 0
    v_mov_b64 v[70:71], 0
    v_mfma_f32_16x16x16_bf16 v[40:43], v[30:31], v[16:17], v[40:43]
    v_mfma_f32_16x16x32_bf16 v[24:27], v[12:15], v[48:51], 0
    v_xor_b32 v2, 0x10000, v2
    ds_read_b128 v[72:75], v2 offset:0
    ds_read_b128 v[76:79], v2 offset:1024
    v_mov_b64 v[52:53], 0
    v_mov_b64 v[54:55], 0
    s_mov_b64 exec, s[94:95]
    v_cvt_pk_bf16_f32 v36, v36, v37
    v_cvt_pk_bf16_f32 v37, v38, v39
    v_cvt_pk_bf16_f32 v38, v40, v41
    v_cvt_pk_bf16_f32 v39, v42, v43
    ds_write_b128 v6, v[36:39]
    s_mov_b64 exec, -1
    v_mfma_f32_16x16x16_bf16 v[24:27], v[16:17], v[18:19], v[24:27]
    ds_read_b128 v[12:15], v2 offset:2048
    ds_read_b128 v[16:19], v2 offset:3072
    s_add_u32 s63, s90, s81
    s_add_u32 s91, s91, 32768
    s_add_u32 s98, s98, 32768
    s_add_u32 s89, s89, 32768
    s_add_u32 s65, s88, s81
    s_mov_b32 s60, 0
    v_rcp_f32 v60, v24
    v_rcp_f32 v61, v25
    s_waitcnt lgkmcnt(2)
    s_barrier
    ds_read_b128 v[48:51], v1 offset:0
    ds_read_b128 v[32:35], v1 offset:1024
    s_waitcnt lgkmcnt(1)
    v_smfmac_f32_16x16x64_bf16 v[68:71], v[48:51], v[72:79], v10
    ds_read_b128 v[72:75], v2 offset:16384
    ds_read_b128 v[76:79], v2 offset:17408
    v_smfmac_f32_16x16x64_bf16 v[44:47], v[48:51], v[12:19], v10
    ds_read_b128 v[12:15], v2 offset:18432
    ds_read_b128 v[16:19], v2 offset:19456
    s_waitcnt lgkmcnt(4)
    v_smfmac_f32_16x16x64_bf16 v[68:71], v[32:35], a[200:207], v10
    v_smfmac_f32_16x16x64_bf16 v[44:47], v[32:35], a[176:183], v10
    v_smfmac_f32_16x16x64_bf16 v[52:55], v[48:51], a[160:167], v10
    v_smfmac_f32_16x16x64_bf16 v[52:55], v[32:35], a[184:191], v10
    v_smfmac_f32_16x16x64_bf16 v[56:59], v[48:51], a[168:175], v10
    v_smfmac_f32_16x16x64_bf16 v[56:59], v[32:35], a[192:199], v10
    s_waitcnt lgkmcnt(2)
    v_smfmac_f32_16x16x64_bf16 v[64:67], v[48:51], v[72:79], v10
    s_waitcnt lgkmcnt(0)
    v_smfmac_f32_16x16x64_bf16 v[64:67], v[32:35], v[12:19], v10
    v_pk_add_f32 v[68:69], v[68:69], v[70:71]
    v_pk_add_f32 v[44:45], v[44:45], v[46:47]
    v_pk_add_f32 v[52:53], v[52:53], v[54:55]
    s_nop 0
    v_pk_add_f32 v[56:57], v[56:57], v[58:59]
    v_pk_mul_f32 v[68:69], v[68:69], v[60:61]
    v_pk_mul_f32 v[44:45], v[44:45], v[60:61]
    v_pk_mul_f32 v[52:53], v[52:53], v[60:61]
    v_pk_mul_f32 v[56:57], v[56:57], v[60:61]
    v_pk_add_f32 v[64:65], v[64:65], v[66:67]
    v_cvt_pk_bf16_f32 v40, v68, v69
    v_cvt_pk_bf16_f32 v36, v44, v45
    v_pk_mul_f32 v[64:65], v[64:65], v[60:61]
    buffer_store_dword v40, v8, s[4:7], s79 offen
    v_cvt_pk_bf16_f32 v37, v52, v53
    v_cvt_pk_bf16_f32 v38, v56, v57
    v_cvt_pk_bf16_f32 v39, v64, v65
    buffer_store_dwordx4 v[36:39], v7, s[4:7], s79 offen
    s_xor_b32 s79, s79, s92
    v_mov_b64 v[32:33], 0
    v_mov_b64 v[34:35], 0
    v_mov_b64 v[12:13], 0
    v_mov_b64 v[14:15], 0
    v_mov_b64 v[16:17], 0
    v_mov_b64 v[18:19], 0
    v_mov_b64 v[20:21], 0
    v_mov_b64 v[22:23], 0
    v_mov_b64 v[24:25], 0
    v_mov_b64 v[26:27], 0
    v_mov_b64 v[28:29], 0
    v_mov_b64 v[30:31], 0
    s_min_u32 s62, s0, s1
    s_max_u32 s68, s68, s62
    s_buffer_load_dword s0, s[4:7], s84 glc
    s_buffer_load_dword s1, s[4:7], s36 glc
L_sr_53:
L_CH_NORED_20:
    ds_read_b128 v[56:59], v2 offset:32768
    ds_read_b128 v[60:63], v2 offset:33792
    ds_read_b128 v[64:67], v2 offset:49152
    ds_read_b128 v[68:71], v2 offset:50176
    ds_read_b128 v[48:51], v2 offset:34816
    ds_read_b128 v[52:55], v2 offset:35840
    s_barrier
    v_mov_b64 v[36:37], -1
    v_mov_b64 v[38:39], -1
    s_sleep 1
    s_sleep 1
    s_sleep 1
    s_sleep 1
    s_nop 11
    s_mov_b32 m0, s100
    s_add_u32 s64, s65, s99
    buffer_load_dwordx4 v1, s[4:7], s65 offen sc1 lds
    s_add_u32 m0, s100, s99
    s_mov_b64 exec, 0xffff
    buffer_load_dwordx4 v1, s[4:7], s64 offen sc1 lds
    s_mov_b64 exec, -1
    s_nop 11
    s_mov_b32 m0, s100
    s_add_u32 s64, s65, s99
    buffer_load_dwordx4 v1, s[4:7], s65 offen sc1 lds
    s_add_u32 m0, s100, s99
    s_mov_b64 exec, 0xffff
    buffer_load_dwordx4 v1, s[4:7], s64 offen sc1 lds
    s_mov_b64 exec, -1
    s_add_u32 s63, s101, s10
    buffer_store_dwordx4 v[36:39], v1, s[4:7], s101 offen
    s_mov_b64 exec, s[42:43]
    buffer_store_dwordx4 v[36:39], v1, s[4:7], s63 offen
    s_xor_b32 s101, s101, s40
    s_mov_b64 exec, -1
    s_waitcnt vmcnt(4)
    s_barrier
    ds_read_b128 v[36:39], v1 offset:0
    ds_read_b128 v[40:43], v1 offset:1024
    ds_read_b128 v[44:47], v1 offset:2048
    ds_read_b128 v[72:75], v1 offset:3072
    ds_read_b128 v[76:79], v1 offset:4096
    s_branch L_CH_A1_20
L_CH_LRETRY_20:
    s_add_u32 s60, s60, 1
    s_cmp_lg_u32 s60, 1
    s_cbranch_scc1 L_ln_54
    v_mov_b64 v[12:13], 0
    v_mov_b64 v[14:15], 0
    s_nop 0
    v_mov_b64 v[16:17], 0
    v_mov_b64 v[18:19], 0
    s_waitcnt vmcnt(0)
    s_branch L_CH_LOOP_20
L_ln_54:
    v_max3_u32 v9, v36, v37, v38
    v_max3_u32 v9, v9, v38, v39
    v_max3_u32 v9, v9, v40, v41
    v_max3_u32 v9, v9, v42, v43
    v_max3_u32 v9, v9, v44, v45
    v_max3_u32 v9, v9, v46, v47
    v_max3_u32 v9, v9, v72, v73
    v_max3_u32 v9, v9, v74, v75
    v_max3_u32 v9, v9, v76, v77
    v_max3_u32 v9, v9, v78, v79
    v_cmp_eq_u32 vcc, -1, v9
    s_nop 0
    s_cbranch_vccz L_CH_LGO_20
    s_cmp_ge_u32 s60, 0x100000
    s_movk_i32 s62, 15
    s_cbranch_scc1 L_ABORT
    s_sub_u32 s63, s65, s2
    s_mov_b32 m0, 131072
    s_add_u32 s64, s63, 4096
    buffer_load_dwordx4 v1, s[4:7], s63 offen offset:0 sc1 lds
    buffer_load_dwordx4 v1, s[4:7], s63 offen offset:1024 sc1 lds
    buffer_load_dwordx4 v1, s[4:7], s63 offen offset:2048 sc1 lds
    buffer_load_dwordx4 v1, s[4:7], s63 offen offset:3072 sc1 lds
    s_mov_b32 m0, 135168
    s_nop 0
    buffer_load_dwordx4 v1, s[4:7], s64 offen sc1 lds
    v_mov_b64 v[12:13], 0
    v_mov_b64 v[14:15], 0
    v_mov_b64 v[16:17], 0
    v_mov_b64 v[18:19], 0
    s_waitcnt vmcnt(0)
    s_branch L_CH_LOOP_20
L_CH_RETRY_20:
    s_mov_b32 s60, 0
    s_sleep 1
    s_sleep 1
    s_mov_b32 m0, s85
    s_add_u32 s64, s98, s99
    buffer_load_dwordx4 v1, s[4:7], s98 offen sc1 lds
    s_add_u32 m0, s85, s99
    s_mov_b64 exec, 0xffff
    buffer_load_dwordx4 v1, s[4:7], s64 offen sc1 lds
    s_mov_b64 exec, -1
    s_branch L_CH_RETRY2_20
L_CH_RETRY1_20:
    s_mov_b32 s63, s89
    s_mov_b32 m0, 136192
    s_add_u32 s64, s63, 4096
    buffer_load_dwordx4 v1, s[4:7], s63 offen offset:0 sc1 lds
    buffer_load_dwordx4 v1, s[4:7], s63 offen offset:1024 sc1 lds
    buffer_load_dwordx4 v1, s[4:7], s63 offen offset:2048 sc1 lds
    buffer_load_dwordx4 v1, s[4:7], s63 offen offset:3072 sc1 lds
    s_mov_b32 m0, 140288
    s_nop 0
    buffer_load_dwordx4 v1, s[4:7], s64 offen sc1 lds
L_CH_RETRY2_20:
    s_waitcnt vmcnt(0)
    ds_read_b128 v[64:67], v1 offset:5120
    ds_read_b128 v[68:71], v1 offset:6144
    ds_read_b128 v[48:51], v1 offset:7168
    ds_read_b128 v[56:59], v1 offset:8192
    ds_read_b128 v[60:63], v1 offset:9216
    s_waitcnt lgkmcnt(0)
L_CH_RETRY3_20:
    v_max3_u32 v9, v64, v65, v66
    v_max_u32 v9, v9, v67
    v_max3_u32 v9, v9, v68, v69
    v_max3_u32 v9, v9, v70, v71
    v_max3_u32 v9, v9, v48, v49
    v_max3_u32 v9, v9, v50, v51
    v_max3_u32 v9, v9, v56, v57
    v_max3_u32 v9, v9, v58, v59
    v_max3_u32 v9, v9, v60, v61
    v_max3_u32 v9, v9, v62, v63
    v_cmp_eq_u32 vcc, -1, v9
    s_nop 0
    s_cbranch_vccz L_CH_REDO_20
    s_add_u32 s60, s60, 1
    s_cmp_lt_u32 s60, 0x100000
    s_cbranch_scc1 L_CH_RETRY1_20
    s_movk_i32 s62, 13
    s_branch L_ABORT
L_CH_REDO_20:
    v_mov_b64 v[12:13], 0
    v_mov_b64 v[14:15], 0
    s_nop 1
    v_smfmac_f32_16x16x64_bf16 v[12:15], v[36:39], a[0:7], v10
    v_smfmac_f32_16x16x64_bf16 v[12:15], v[40:43], a[16:23], v10
    v_smfmac_f32_16x16x64_bf16 v[12:15], v[44:47], a[32:39], v10
    v_smfmac_f32_16x16x64_bf16 v[12:15], v[72:75], a[48:55], v10
    v_smfmac_f32_16x16x64_bf16 v[12:15], v[76:79], a[64:71], v10
    v_smfmac_f32_16x16x64_bf16 v[12:15], v[56:59], a[128:135], v10
    v_smfmac_f32_16x16x64_bf16 v[12:15], v[60:63], a[144:151], v10
    v_smfmac_f32_16x16x64_bf16 v[12:15], v[64:67], a[80:87], v10
    v_smfmac_f32_16x16x64_bf16 v[12:15], v[68:71], a[96:103], v10
    v_smfmac_f32_16x16x64_bf16 v[12:15], v[48:51], a[112:119], v10
    s_branch L_CH_C_20
L_CH_LAST_20:
    s_mul_i32 s62, s44, 1056
    v_add_u32 v9, s62, v5
    ds_read_b64_tr_b16 v[28:29], v9 offset:26624
    ds_read_b64_tr_b16 v[30:31], v9 offset:26896
    s_waitcnt lgkmcnt(0)
    buffer_store_dwordx4 v[28:31], v1, s[4:7], s77 offen sc1
    s_add_u32 s77, s77, 131072
    s_waitcnt vmcnt(0)
    v_mov_b32 v62, 0
    v_mov_b32 v63, 64
    s_mov_b64 exec, 1
    buffer_store_dword v63, v62, s[4:7], s78 offen sc1
    s_mov_b64 exec, -1
    s_branch L_END2
L_kv_51:
    v_bfe_u32 v52, v1, 4, 1
    v_lshlrev_b32 v52, 5, v52
    v_add_u32 v52, s46, v52
    v_add_u32 v52, 64, v52
    v_lshlrev_b32 v52, 6, v52
    s_mov_b32 s60, 0
L_pf_55:
    buffer_load_dword v53, v52, s[4:7], 0 offen sc1
    s_waitcnt vmcnt(0)
    v_cmp_gt_u32 vcc, s69, v53
    s_nop 0
    s_cbranch_vccz L_pfd_56
    s_sleep 1
    s_add_u32 s60, s60, 1
    s_cmp_lt_u32 s60, 0x100000
    s_cbranch_scc1 L_pf_55
    s_movk_i32 s62, 11
    s_branch L_ABORT
L_pfd_56:
    v_readlane_b32 s68, v53, 0
    v_readlane_b32 s62, v53, 1
    s_nop 0
    s_min_u32 s68, s68, s62
    s_branch L_kvr_52
L_kv_49:
    v_bfe_u32 v52, v1, 4, 1
    v_lshlrev_b32 v52, 5, v52
    v_add_u32 v52, s46, v52
    v_add_u32 v52, 64, v52
    v_lshlrev_b32 v52, 6, v52
    s_mov_b32 s60, 0
L_pf_57:
    buffer_load_dword v53, v52, s[4:7], 0 offen sc1
    s_waitcnt vmcnt(0)
    v_cmp_gt_u32 vcc, s69, v53
    s_nop 0
    s_cbranch_vccz L_pfd_58
    s_sleep 1
    s_add_u32 s60, s60, 1
    s_cmp_lt_u32 s60, 0x100000
    s_cbranch_scc1 L_pf_57
    s_movk_i32 s62, 11
    s_branch L_ABORT
L_pfd_58:
    v_readlane_b32 s68, v53, 0
    v_readlane_b32 s62, v53, 1
    s_nop 0
    s_min_u32 s68, s68, s62
    s_branch L_kvr_50
L_CH_FIRST_30:
    ds_read_b128 v[36:39], v1 offset:0
    ds_read_b128 v[40:43], v1 offset:1024
    ds_read_b128 v[44:47], v1 offset:2048
    ds_read_b128 v[72:75], v1 offset:3072
    ds_read_b128 v[76:79], v1 offset:4096
    s_waitcnt lgkmcnt(4)
    v_smfmac_f32_16x16x64_bf16 v[12:15], v[36:39], a[0:7], v10
    s_waitcnt lgkmcnt(3)
    v_smfmac_f32_16x16x64_bf16 v[12:15], v[40:43], a[16:23], v10
    s_waitcnt lgkmcnt(2)
    v_smfmac_f32_16x16x64_bf16 v[12:15], v[44:47], a[32:39], v10
    s_waitcnt lgkmcnt(1)
    v_smfmac_f32_16x16x64_bf16 v[12:15], v[72:75], a[48:55], v10
    s_waitcnt lgkmcnt(0)
    v_smfmac_f32_16x16x64_bf16 v[12:15], v[76:79], a[64:71], v10
    v_smfmac_f32_16x16x64_bf16 v[16:19], v[36:39], a[8:15], v10
    v_smfmac_f32_16x16x64_bf16 v[16:19], v[40:43], a[24:31], v10
    v_smfmac_f32_16x16x64_bf16 v[16:19], v[44:47], a[40:47], v10
    v_smfmac_f32_16x16x64_bf16 v[16:19], v[72:75], a[56:63], v10
    v_smfmac_f32_16x16x64_bf16 v[16:19], v[76:79], a[72:79], v10
    v_smfmac_f32_16x16x64_bf16 v[28:31], v[36:39], v[56:63], v10
    ds_read_b128 v[56:59], v2 offset:51200
    ds_read_b128 v[60:63], v2 offset:52224
    v_smfmac_f32_16x16x64_bf16 v[20:23], v[36:39], v[64:71], v10
    v_xor_b32 v2, 0x10000, v2
    ds_read_b128 v[64:67], v2 offset:0
    ds_read_b128 v[68:71], v2 offset:1024
    v_smfmac_f32_16x16x64_bf16 v[32:35], v[36:39], v[48:55], v10
    ds_read_b128 v[48:51], v2 offset:2048
    ds_read_b128 v[52:55], v2 offset:3072
    v_smfmac_f32_16x16x64_bf16 v[20:23], v[40:43], a[208:215], v10
    s_waitcnt lgkmcnt(4)
    v_smfmac_f32_16x16x64_bf16 v[24:27], v[36:39], v[56:63], v10
    ds_read_b128 v[56:59], v2 offset:16384
    ds_read_b128 v[60:63], v2 offset:17408
    v_smfmac_f32_16x16x64_bf16 v[24:27], v[40:43], a[216:223], v10
    s_waitcnt lgkmcnt(4)
    v_smfmac_f32_16x16x64_bf16 v[28:31], v[40:43], v[64:71], v10
    ds_read_b128 v[64:67], v2 offset:18432
    ds_read_b128 v[68:71], v2 offset:19456
    v_smfmac_f32_16x16x64_bf16 v[20:23], v[44:47], a[224:231], v10
    s_waitcnt lgkmcnt(4)
    v_smfmac_f32_16x16x64_bf16 v[32:35], v[40:43], v[48:55], v10
    ds_read_b128 v[48:51], v2 offset:32768
    ds_read_b128 v[52:55], v2 offset:33792
    v_smfmac_f32_16x16x64_bf16 v[24:27], v[44:47], a[232:239], v10
    s_waitcnt lgkmcnt(4)
    v_smfmac_f32_16x16x64_bf16 v[28:31], v[44:47], v[56:63], v10
    ds_read_b128 v[56:59], v2 offset:34816
    ds_read_b128 v[60:63], v2 offset:35840
    s_waitcnt lgkmcnt(4)
    v_smfmac_f32_16x16x64_bf16 v[32:35], v[44:47], v[64:71], v10
    ds_read_b128 v[64:67], v2 offset:49152
    ds_read_b128 v[68:71], v2 offset:50176
    s_waitcnt lgkmcnt(4)
    v_smfmac_f32_16x16x64_bf16 v[28:31], v[72:75], v[48:55], v10
    ds_read_b128 v[48:51], v2 offset:51200
    ds_read_b128 v[52:55], v2 offset:52224
    s_waitcnt lgkmcnt(4)
    v_smfmac_f32_16x16x64_bf16 v[32:35], v[72:75], v[56:63], v10
    s_barrier
    s_mov_b32 s69, 2
    ds_read_b128 v[56:59], v1 offset:8192
    ds_read_b128 v[60:63], v1 offset:9216
    s_waitcnt lgkmcnt(4)
    v_smfmac_f32_16x16x64_bf16 v[28:31], v[76:79], v[64:71], v10
    ds_read_b128 v[64:67], v1 offset:5120
    ds_read_b128 v[68:71], v1 offset:6144
    s_waitcnt lgkmcnt(4)
    v_smfmac_f32_16x16x64_bf16 v[32:35], v[76:79], v[48:55], v10
    ds_read_b128 v[48:51], v1 offset:7168
    v_smfmac_f32_16x16x64_bf16 v[20:23], v[72:75], v[144:151], v10
    s_waitcnt lgkmcnt(4)
    v_smfmac_f32_16x16x64_bf16 v[12:15], v[56:59], a[128:135], v10
    s_waitcnt lgkmcnt(3)
    v_smfmac_f32_16x16x64_bf16 v[12:15], v[60:63], a[144:151], v10
    s_waitcnt lgkmcnt(2)
    v_smfmac_f32_16x16x64_bf16 v[12:15], v[64:67], a[80:87], v10
    s_waitcnt lgkmcnt(1)
    v_smfmac_f32_16x16x64_bf16 v[12:15], v[68:71], a[96:103], v10
    s_waitcnt lgkmcnt(0)
    v_smfmac_f32_16x16x64_bf16 v[12:15], v[48:51], a[112:119], v10
    s_cmp_lt_u32 s68, s69
    s_cbranch_scc1 L_kv_59
L_kvr_60:
    v_smfmac_f32_16x16x64_bf16 v[24:27], v[72:75], v[152:159], v10
    v_smfmac_f32_16x16x64_bf16 v[20:23], v[76:79], v[160:167], v10
    v_smfmac_f32_16x16x64_bf16 v[24:27], v[76:79], v[168:175], v10
    s_branch L_CH_C_30
    .p2align 6
L_CH_B1_30:
    s_barrier
L_CH_LOOP_30:
    ds_read_b128 v[36:39], v1 offset:0
    ds_read_b128 v[40:43], v1 offset:1024
    ds_read_b128 v[44:47], v1 offset:2048
    ds_read_b128 v[72:75], v1 offset:3072
    ds_read_b128 v[76:79], v1 offset:4096
L_CH_A1_30:
    s_waitcnt lgkmcnt(4)
    v_smfmac_f32_16x16x64_bf16 v[12:15], v[36:39], a[0:7], v10
    s_waitcnt lgkmcnt(3)
    v_smfmac_f32_16x16x64_bf16 v[12:15], v[40:43], a[16:23], v10
    s_waitcnt lgkmcnt(2)
    v_smfmac_f32_16x16x64_bf16 v[12:15], v[44:47], a[32:39], v10
    s_waitcnt lgkmcnt(1)
    v_smfmac_f32_16x16x64_bf16 v[12:15], v[72:75], a[48:55], v10
    s_waitcnt lgkmcnt(0)
    v_smfmac_f32_16x16x64_bf16 v[12:15], v[76:79], a[64:71], v10
    v_smfmac_f32_16x16x64_bf16 v[16:19], v[36:39], a[8:15], v10
    v_smfmac_f32_16x16x64_bf16 v[16:19], v[40:43], a[24:31], v10
    s_add_u32 s69, s61, 2
    s_min_u32 s69, s69, 64
    s_mov_b32 m0, s85
    s_add_u32 s64, s98, s99
    s_nop 1
    v_cmp_u_f32 vcc, v12, v13
    v_cmp_u_f32 s[62:63], v14, v15
    v_smfmac_f32_16x16x64_bf16 v[16:19], v[44:47], a[40:47], v10
    s_or_b64 vcc, vcc, s[62:63]
    s_cbranch_scc1 L_CH_LRETRY_30
L_CH_LGO_30:
    buffer_load_dwordx4 v1, s[4:7], s98 offen sc1 lds
    s_add_u32 m0, s85, s99
    s_mov_b64 exec, 0xffff
    buffer_load_dwordx4 v1, s[4:7], s64 offen sc1 lds
    s_mov_b64 exec, -1
    v_smfmac_f32_16x16x64_bf16 v[16:19], v[72:75], a[56:63], v10
    v_smfmac_f32_16x16x64_bf16 v[16:19], v[76:79], a[72:79], v10
    v_smfmac_f32_16x16x64_bf16 v[28:31], v[36:39], v[56:63], v10
    ds_read_b128 v[56:59], v2 offset:51200
    ds_read_b128 v[60:63], v2 offset:52224
    v_smfmac_f32_16x16x64_bf16 v[20:23], v[36:39], v[64:71], v10
    v_xor_b32 v2, 0x10000, v2
    ds_read_b128 v[64:67], v2 offset:0
    ds_read_b128 v[68:71], v2 offset:1024
    v_smfmac_f32_16x16x64_bf16 v[32:35], v[36:39], v[48:55], v10
    ds_read_b128 v[48:51], v2 offset:2048
    ds_read_b128 v[52:55], v2 offset:3072
    v_smfmac_f32_16x16x64_bf16 v[20:23], v[40:43], a[208:215], v10
    v_mov_b32 v9, s61
    s_mov_b64 exec, 1
    buffer_store_dword v9, off, s[4:7], s78 sc1
    s_mov_b64 exec, -1
    s_waitcnt lgkmcnt(4)
    v_smfmac_f32_16x16x64_bf16 v[24:27], v[36:39], v[56:63], v10
    ds_read_b128 v[56:59], v2 offset:16384
    ds_read_b128 v[60:63], v2 offset:17408
    v_smfmac_f32_16x16x64_bf16 v[24:27], v[40:43], a[216:223], v10
    s_waitcnt lgkmcnt(4)
    v_smfmac_f32_16x16x64_bf16 v[28:31], v[40:43], v[64:71], v10
    ds_read_b128 v[64:67], v2 offset:18432
    ds_read_b128 v[68:71], v2 offset:19456
    v_smfmac_f32_16x16x64_bf16 v[20:23], v[44:47], a[224:231], v10
    s_waitcnt lgkmcnt(4)
    v_smfmac_f32_16x16x64_bf16 v[32:35], v[40:43], v[48:55], v10
    ds_read_b128 v[48:51], v2 offset:32768
    ds_read_b128 v[52:55], v2 offset:33792
    v_smfmac_f32_16x16x64_bf16 v[24:27], v[44:47], a[232:239], v10
    s_waitcnt lgkmcnt(4)
    v_smfmac_f32_16x16x64_bf16 v[28:31], v[44:47], v[56:63], v10
    ds_read_b128 v[56:59], v2 offset:34816
    ds_read_b128 v[60:63], v2 offset:35840
    s_waitcnt lgkmcnt(4)
    v_smfmac_f32_16x16x64_bf16 v[32:35], v[44:47], v[64:71], v10
    ds_read_b128 v[64:67], v2 offset:49152
    ds_read_b128 v[68:71], v2 offset:50176
    s_waitcnt lgkmcnt(4)
    v_smfmac_f32_16x16x64_bf16 v[28:31], v[72:75], v[48:55], v10
    ds_read_b128 v[48:51], v2 offset:51200
    ds_read_b128 v[52:55], v2 offset:52224
    s_waitcnt lgkmcnt(4)
    v_smfmac_f32_16x16x64_bf16 v[32:35], v[72:75], v[56:63], v10
    s_waitcnt vmcnt(1)
    s_barrier
    ds_read_b128 v[56:59], v1 offset:8192
    ds_read_b128 v[60:63], v1 offset:9216
    s_waitcnt lgkmcnt(4)
    v_smfmac_f32_16x16x64_bf16 v[28:31], v[76:79], v[64:71], v10
    ds_read_b128 v[64:67], v1 offset:5120
    ds_read_b128 v[68:71], v1 offset:6144
    s_waitcnt lgkmcnt(4)
    v_smfmac_f32_16x16x64_bf16 v[32:35], v[76:79], v[48:55], v10
    ds_read_b128 v[48:51], v1 offset:7168
    v_smfmac_f32_16x16x64_bf16 v[20:23], v[72:75], v[144:151], v10
    s_waitcnt lgkmcnt(4)
    v_smfmac_f32_16x16x64_bf16 v[12:15], v[56:59], a[128:135], v10
    s_waitcnt lgkmcnt(3)
    v_smfmac_f32_16x16x64_bf16 v[12:15], v[60:63], a[144:151], v10
    s_waitcnt lgkmcnt(2)
    v_smfmac_f32_16x16x64_bf16 v[12:15], v[64:67], a[80:87], v10
    s_waitcnt lgkmcnt(1)
    v_smfmac_f32_16x16x64_bf16 v[12:15], v[68:71], a[96:103], v10
    s_waitcnt lgkmcnt(0)
    v_smfmac_f32_16x16x64_bf16 v[12:15], v[48:51], a[112:119], v10
    s_cmp_lt_u32 s68, s69
    s_cbranch_scc1 L_kv_61
L_kvr_62:
    v_smfmac_f32_16x16x64_bf16 v[24:27], v[72:75], v[152:159], v10
    v_smfmac_f32_16x16x64_bf16 v[20:23], v[76:79], v[160:167], v10
    v_smfmac_f32_16x16x64_bf16 v[24:27], v[76:79], v[168:175], v10
    s_nop 2
    v_cmp_u_f32 vcc, v12, v13
    v_cmp_u_f32 s[62:63], v14, v15
    s_nop 0
    s_or_b64 vcc, vcc, s[62:63]
    s_cbranch_scc1 L_CH_RETRY_30
L_CH_C_30:
    v_smfmac_f32_16x16x64_bf16 v[16:19], v[64:67], a[88:95], v10
    buffer_load_dwordx4 v[72:75], v1, s[4:7], s76 offen sc1
    v_smfmac_f32_16x16x64_bf16 v[16:19], v[68:71], a[104:111], v10
    v_smfmac_f32_16x16x64_bf16 v[16:19], v[48:51], a[120:127], v10
    buffer_load_dwordx4 v[76:79], v1, s[4:7], s76 offen offset:1024 sc1
    s_add_u32 s76, s76, 262144
    v_smfmac_f32_16x16x64_bf16 v[16:19], v[56:59], a[136:143], v10
    v_pk_add_f32 v[12:13], v[12:13], v[14:15]
    v_smfmac_f32_16x16x64_bf16 v[16:19], v[60:63], a[152:159], v10
    ds_read_b128 v[36:39], v0 offset:0
    ds_read_b128 v[40:43], v0 offset:1024
    v_cvt_pk_bf16_f32 v14, v12, v13
    v_smfmac_f32_16x16x64_bf16 v[20:23], v[64:67], v[176:183], v10
    ds_read_b128 v[44:47], v0 offset:2048
    ds_read_b128 v[52:55], v0 offset:3072
    v_smfmac_f32_16x16x64_bf16 v[24:27], v[64:67], v[184:191], v10
    v_smfmac_f32_16x16x64_bf16 v[20:23], v[68:71], v[192:199], v10
    v_pk_add_f32 v[16:17], v[16:17], v[18:19]
    v_smfmac_f32_16x16x64_bf16 v[24:27], v[68:71], v[200:207], v10
    v_cvt_pk_bf16_f32 v18, v16, v17
    v_smfmac_f32_16x16x64_bf16 v[20:23], v[48:51], v[208:215], v10
    ds_write_b32 v4, v14 offset:0
    ds_write_b32 v4, v18 offset:528
    v_smfmac_f32_16x16x64_bf16 v[24:27], v[48:51], v[216:223], v10
    v_smfmac_f32_16x16x64_bf16 v[20:23], v[56:59], v[224:231], v10
    s_mov_b32 m0, s74
    s_xor_b32 s74, s74, s37
    buffer_load_dwordx4 v1, s[4:7], s73 offen sc1 lds
    v_smfmac_f32_16x16x64_bf16 v[24:27], v[56:59], v[232:239], v10
    v_smfmac_f32_16x16x64_bf16 v[20:23], v[60:63], v[240:247], v10
    buffer_load_dwordx4 v1, s[4:7], s73 offen offset:1024 sc1 lds
    s_add_u32 s73, s73, 262144
    v_smfmac_f32_16x16x64_bf16 v[24:27], v[60:63], v[248:255], v10
    s_waitcnt lgkmcnt(0)
    s_barrier
    ds_read_b64_tr_b16 v[12:13], v5 offset:0
    ds_read_b64_tr_b16 v[14:15], v5 offset:272
    v_smfmac_f32_16x16x64_bf16 v[28:31], v[64:67], v[80:87], v10
    ds_read_b64_tr_b16 v[16:17], v5 offset:1056
    ds_read_b64_tr_b16 v[18:19], v5 offset:1328
    v_pk_add_f32 v[20:21], v[20:21], v[22:23]
    v_smfmac_f32_16x16x64_bf16 v[32:35], v[64:67], v[88:95], v10
    ds_read_b64_tr_b16 v[64:65], v5 offset:2112
    ds_read_b64_tr_b16 v[66:67], v5 offset:2384
    v_pk_add_f32 v[24:25], v[24:25], v[26:27]
    v_cvt_pk_bf16_f32 v22, v20, v21
    v_smfmac_f32_16x16x64_bf16 v[28:31], v[68:71], v[96:103], v10
    v_cvt_pk_bf16_f32 v26, v24, v25
    ds_write_b32 v4, v22 offset:26624
    ds_write_b32 v4, v26 offset:27152
    v_smfmac_f32_16x16x64_bf16 v[32:35], v[68:71], v[104:111], v10
    ds_read_b64_tr_b16 v[68:69], v5 offset:3168
    ds_read_b64_tr_b16 v[70:71], v5 offset:3440
    v_smfmac_f32_16x16x64_bf16 v[28:31], v[48:51], v[112:119], v10
    v_smfmac_f32_16x16x64_bf16 v[32:35], v[48:51], v[120:127], v10
    ds_read_b128 v[48:51], v0 offset:4096
    v_smfmac_f32_16x16x64_bf16 v[28:31], v[56:59], v[128:135], v10
    v_smfmac_f32_16x16x64_bf16 v[32:35], v[56:59], v[136:143], v10
    ds_read_b128 v[56:59], v0 offset:5120
    v_smfmac_f32_16x16x64_bf16 v[28:31], v[60:63], a[240:247], v10
    v_smfmac_f32_16x16x64_bf16 v[32:35], v[60:63], a[248:255], v10
    s_waitcnt lgkmcnt(10)
    v_mfma_f32_16x16x32_bf16 v[60:63], v[36:39], v[12:15], 0
    ds_read_b128 v[36:39], v0 offset:6144
    s_waitcnt lgkmcnt(9)
    v_mfma_f32_16x16x32_bf16 v[60:63], v[40:43], v[16:19], v[60:63]
    ds_read_b128 v[40:43], v0 offset:7168
    s_waitcnt lgkmcnt(8)
    v_mfma_f32_16x16x32_bf16 v[60:63], v[44:47], v[64:67], v[60:63]
    v_cvt_pk_bf16_f32 v28, v28, v29
    v_cvt_pk_bf16_f32 v29, v30, v31
    s_waitcnt lgkmcnt(4)
    v_mfma_f32_16x16x32_bf16 v[60:63], v[52:55], v[68:71], v[60:63]
    v_cvt_pk_bf16_f32 v30, v32, v33
    v_cvt_pk_bf16_f32 v31, v34, v35
    s_cmp_eq_u32 s61, 63
    s_barrier
    s_cbranch_scc1 L_CH_LAST_30
    ds_read_b64_tr_b16 v[44:45], v5 offset:26624
    ds_read_b64_tr_b16 v[46:47], v5 offset:26896
    ds_read_b64_tr_b16 v[52:53], v5 offset:27680
    ds_read_b64_tr_b16 v[54:55], v5 offset:27952
    s_waitcnt lgkmcnt(7)
    v_mfma_f32_16x16x32_bf16 v[20:23], v[48:51], v[12:15], 0
    ds_read_b64_tr_b16 v[48:49], v5 offset:28736
    ds_read_b64_tr_b16 v[50:51], v5 offset:29008
    s_waitcnt lgkmcnt(8)
    v_mfma_f32_16x16x32_bf16 v[20:23], v[56:59], v[16:19], v[20:23]
    ds_read_b64_tr_b16 v[56:57], v5 offset:29792
    ds_read_b64_tr_b16 v[58:59], v5 offset:30064
    s_waitcnt lgkmcnt(9)
    v_mfma_f32_16x16x32_bf16 v[20:23], v[36:39], v[64:67], v[20:23]
    s_waitcnt lgkmcnt(8)
    v_mfma_f32_16x16x32_bf16 v[20:23], v[40:43], v[68:71], v[20:23]
    v_xor_b32 v0, s75, v0
    s_waitcnt lgkmcnt(6)
    v_mfma_f32_16x16x32_bf16 v[24:27], v[44:47], v[12:15], 0
    v_max3_f32 v32, v60, v61, v62
    s_waitcnt lgkmcnt(4)
    v_mfma_f32_16x16x32_bf16 v[24:27], v[52:55], v[16:19], v[24:27]
    s_waitcnt lgkmcnt(2)
    v_mfma_f32_16x16x32_bf16 v[24:27], v[48:51], v[64:67], v[24:27]
    s_waitcnt lgkmcnt(0)
    v_mfma_f32_16x16x32_bf16 v[24:27], v[56:59], v[68:71], v[24:27]
    buffer_store_dwordx4 v[56:59], v1, s[4:7], s77 offen sc1
    v_max3_f32 v32, v32, v63, v20
    v_max3_f32 v33, v21, v22, v23
    v_mov_b64 v[18:19], s[8:9]
    s_add_u32 s77, s77, 131072
    v_mov_b64 v[44:45], 0
    v_mov_b64 v[46:47], 0
    v_mov_b64 v[48:49], s[38:39]
    v_mov_b64 v[50:51], s[38:39]
    v_max_f32 v32, v32, v33
    v_max3_f32 v33, v32, v24, v25
    v_max3_f32 v32, v32, v24, v25
    v_mov_b64 v[56:57], 0
    v_mov_b64 v[58:59], 0
    v_permlane16_swap_b32 v32, v33
    v_max_f32 v34, v32, v33
    v_max_f32 v35, v32, v33
    v_mov_b64 v[64:65], 0
    v_mov_b64 v[66:67], 0
    v_permlane32_swap_b32 v34, v35
    v_max_f32 v32, v34, v35
    v_mul_f32 v32, s82, v32
    v_pk_fma_f32 v[60:61], v[60:61], s[82:83], v[32:33] op_sel_hi:[1,0,0] neg_lo:[0,0,1] neg_hi:[0,0,1]
    v_pk_fma_f32 v[62:63], v[62:63], s[82:83], v[32:33] op_sel_hi:[1,0,0] neg_lo:[0,0,1] neg_hi:[0,0,1]
    v_pk_fma_f32 v[20:21], v[20:21], s[82:83], v[32:33] op_sel_hi:[1,0,0] neg_lo:[0,0,1] neg_hi:[0,0,1]
    v_pk_fma_f32 v[22:23], v[22:23], s[82:83], v[32:33] op_sel_hi:[1,0,0] neg_lo:[0,0,1] neg_hi:[0,0,1]
    v_pk_fma_f32 v[24:25], v[24:25], s[82:83], v[32:33] op_sel_hi:[1,0,0] neg_lo:[0,0,1] neg_hi:[0,0,1]
    v_exp_f32 v60, v60
    v_exp_f32 v61, v61
    v_exp_f32 v62, v62
    v_cvt_pk_bf16_f32 v12, v60, v61
    v_exp_f32 v63, v63
    v_exp_f32 v20, v20
    v_cvt_pk_bf16_f32 v13, v62, v63
    v_exp_f32 v21, v21
    v_exp_f32 v22, v22
    v_cvt_pk_bf16_f32 v14, v20, v21
    v_exp_f32 v23, v23
    v_exp_f32 v24, v24
    v_cvt_pk_bf16_f32 v15, v22, v23
    v_exp_f32 v25, v25
    s_waitcnt vmcnt(3)
    v_mfma_f32_16x16x32_bf16 v[36:39], v[72:75], v[12:15], 0
    v_cvt_pk_bf16_f32 v16, v24, v25
    v_cvt_pk_bf16_f32 v17, v24, v25
    v_mfma_f32_16x16x32_bf16 v[40:43], v[76:79], v[12:15], 0
    s_add_u32 s81, s81, 16384
    s_and_b32 s81, s81, 0xffff
    s_add_u32 s61, s61, 1
    v_mfma_f32_16x16x16_bf16 v[36:39], v[28:29], v[16:17], v[36:39]
    v_mov_b64 v[68:69], 0
    v_mov_b64 v[70:71], 0
    v_mfma_f32_16x16x16_bf16 v[40:43], v[30:31], v[16:17], v[40:43]
    v_mfma_f32_16x16x32_bf16 v[24:27], v[12:15], v[48:51], 0
    v_xor_b32 v2, 0x10000, v2
    ds_read_b128 v[72:75], v2 offset:0
    ds_read_b128 v[76:79], v2 offset:1024
    v_mov_b64 v[52:53], 0
    v_mov_b64 v[54:55], 0
    s_mov_b64 exec, s[94:95]
    v_cvt_pk_bf16_f32 v36, v36, v37
    v_cvt_pk_bf16_f32 v37, v38, v39
    v_cvt_pk_bf16_f32 v38, v40, v41
    v_cvt_pk_bf16_f32 v39, v42, v43
    ds_write_b128 v6, v[36:39]
    s_mov_b64 exec, -1
    v_mfma_f32_16x16x16_bf16 v[24:27], v[16:17], v[18:19], v[24:27]
    ds_read_b128 v[12:15], v2 offset:2048
    ds_read_b128 v[16:19], v2 offset:3072
    s_add_u32 s63, s90, s81
    s_add_u32 s91, s91, 32768
    s_add_u32 s98, s98, 32768
    s_add_u32 s89, s89, 32768
    s_add_u32 s65, s88, s81
    s_mov_b32 s60, 0
    v_rcp_f32 v60, v24
    v_rcp_f32 v61, v25
    s_waitcnt lgkmcnt(2)
    s_barrier
    ds_read_b128 v[48:51], v1 offset:0
    ds_read_b128 v[32:35], v1 offset:1024
    s_waitcnt lgkmcnt(1)
    v_smfmac_f32_16x16x64_bf16 v[68:71], v[48:51], v[72:79], v10
    ds_read_b128 v[72:75], v2 offset:16384
    ds_read_b128 v[76:79], v2 offset:17408
    v_smfmac_f32_16x16x64_bf16 v[44:47], v[48:51], v[12:19], v10
    ds_read_b128 v[12:15], v2 offset:18432
    ds_read_b128 v[16:19], v2 offset:19456
    s_waitcnt lgkmcnt(4)
    v_smfmac_f32_16x16x64_bf16 v[68:71], v[32:35], a[200:207], v10
    v_smfmac_f32_16x16x64_bf16 v[44:47], v[32:35], a[176:183], v10
    v_smfmac_f32_16x16x64_bf16 v[52:55], v[48:51], a[160:167], v10
    v_smfmac_f32_16x16x64_bf16 v[52:55], v[32:35], a[184:191], v10
    v_smfmac_f32_16x16x64_bf16 v[56:59], v[48:51], a[168:175], v10
    v_smfmac_f32_16x16x64_bf16 v[56:59], v[32:35], a[192:199], v10
    s_waitcnt lgkmcnt(2)
    v_smfmac_f32_16x16x64_bf16 v[64:67], v[48:51], v[72:79], v10
    s_waitcnt lgkmcnt(0)
    v_smfmac_f32_16x16x64_bf16 v[64:67], v[32:35], v[12:19], v10
    v_pk_add_f32 v[68:69], v[68:69], v[70:71]
    v_pk_add_f32 v[44:45], v[44:45], v[46:47]
    v_pk_add_f32 v[52:53], v[52:53], v[54:55]
    s_nop 0
    v_pk_add_f32 v[56:57], v[56:57], v[58:59]
    v_pk_mul_f32 v[68:69], v[68:69], v[60:61]
    v_pk_mul_f32 v[44:45], v[44:45], v[60:61]
    v_pk_mul_f32 v[52:53], v[52:53], v[60:61]
    v_pk_mul_f32 v[56:57], v[56:57], v[60:61]
    v_pk_add_f32 v[64:65], v[64:65], v[66:67]
    v_cvt_pk_bf16_f32 v40, v68, v69
    v_cvt_pk_bf16_f32 v36, v44, v45
    v_pk_mul_f32 v[64:65], v[64:65], v[60:61]
    buffer_store_dword v40, v8, s[4:7], s79 offen
    v_cvt_pk_bf16_f32 v37, v52, v53
    v_cvt_pk_bf16_f32 v38, v56, v57
    v_cvt_pk_bf16_f32 v39, v64, v65
    buffer_store_dwordx4 v[36:39], v7, s[4:7], s79 offen
    s_xor_b32 s79, s79, s92
    v_mov_b64 v[32:33], 0
    v_mov_b64 v[34:35], 0
    v_mov_b64 v[12:13], 0
    v_mov_b64 v[14:15], 0
    v_mov_b64 v[16:17], 0
    v_mov_b64 v[18:19], 0
    v_mov_b64 v[20:21], 0
    v_mov_b64 v[22:23], 0
    v_mov_b64 v[24:25], 0
    v_mov_b64 v[26:27], 0
    v_mov_b64 v[28:29], 0
    v_mov_b64 v[30:31], 0
    s_min_u32 s62, s0, s1
    s_max_u32 s68, s68, s62
    s_buffer_load_dword s0, s[4:7], s84 glc
    s_buffer_load_dword s1, s[4:7], s36 glc
L_sr_63:
L_CH_NORED_30:
    ds_read_b128 v[56:59], v2 offset:32768
    ds_read_b128 v[60:63], v2 offset:33792
    ds_read_b128 v[64:67], v2 offset:49152
    ds_read_b128 v[68:71], v2 offset:50176
    ds_read_b128 v[48:51], v2 offset:34816
    ds_read_b128 v[52:55], v2 offset:35840
    s_barrier
    v_mov_b64 v[36:37], -1
    v_mov_b64 v[38:39], -1
    s_sleep 1
    s_sleep 1
    s_sleep 1
    s_sleep 1
    s_nop 11
    s_mov_b32 m0, s100
    s_add_u32 s64, s65, s99
    buffer_load_dwordx4 v1, s[4:7], s65 offen sc1 lds
    s_add_u32 m0, s100, s99
    s_mov_b64 exec, 0xffff
    buffer_load_dwordx4 v1, s[4:7], s64 offen sc1 lds
    s_mov_b64 exec, -1
    s_nop 11
    s_mov_b32 m0, s100
    s_add_u32 s64, s65, s99
    buffer_load_dwordx4 v1, s[4:7], s65 offen sc1 lds
    s_add_u32 m0, s100, s99
    s_mov_b64 exec, 0xffff
    buffer_load_dwordx4 v1, s[4:7], s64 offen sc1 lds
    s_mov_b64 exec, -1
    s_add_u32 s63, s101, s10
    buffer_store_dwordx4 v[36:39], v1, s[4:7], s101 offen
    s_mov_b64 exec, s[42:43]
    buffer_store_dwordx4 v[36:39], v1, s[4:7], s63 offen
    s_xor_b32 s101, s101, s40
    s_mov_b64 exec, -1
    s_waitcnt vmcnt(4)
    s_barrier
    ds_read_b128 v[36:39], v1 offset:0
    ds_read_b128 v[40:43], v1 offset:1024
    ds_read_b128 v[44:47], v1 offset:2048
    ds_read_b128 v[72:75], v1 offset:3072
    ds_read_b128 v[76:79], v1 offset:4096
    s_branch L_CH_A1_30
L_CH_LRETRY_30:
    s_add_u32 s60, s60, 1
    s_cmp_lg_u32 s60, 1
    s_cbranch_scc1 L_ln_64
    v_mov_b64 v[12:13], 0
    v_mov_b64 v[14:15], 0
    s_nop 0
    v_mov_b64 v[16:17], 0
    v_mov_b64 v[18:19], 0
    s_waitcnt vmcnt(0)
    s_branch L_CH_LOOP_30
L_ln_64:
    v_max3_u32 v9, v36, v37, v38
    v_max3_u32 v9, v9, v38, v39
    v_max3_u32 v9, v9, v40, v41
    v_max3_u32 v9, v9, v42, v43
    v_max3_u32 v9, v9, v44, v45
    v_max3_u32 v9, v9, v46, v47
    v_max3_u32 v9, v9, v72, v73
    v_max3_u32 v9, v9, v74, v75
    v_max3_u32 v9, v9, v76, v77
    v_max3_u32 v9, v9, v78, v79
    v_cmp_eq_u32 vcc, -1, v9
    s_nop 0
    s_cbranch_vccz L_CH_LGO_30
    s_cmp_ge_u32 s60, 0x100000
    s_movk_i32 s62, 15
    s_cbranch_scc1 L_ABORT
    s_sub_u32 s63, s65, s2
    s_mov_b32 m0, 131072
    s_add_u32 s64, s63, 4096
    buffer_load_dwordx4 v1, s[4:7], s63 offen offset:0 sc1 lds
    buffer_load_dwordx4 v1, s[4:7], s63 offen offset:1024 sc1 lds
    buffer_load_dwordx4 v1, s[4:7], s63 offen offset:2048 sc1 lds
    buffer_load_dwordx4 v1, s[4:7], s63 offen offset:3072 sc1 lds
    s_mov_b32 m0, 135168
    s_nop 0
    buffer_load_dwordx4 v1, s[4:7], s64 offen sc1 lds
    v_mov_b64 v[12:13], 0
    v_mov_b64 v[14:15], 0
    v_mov_b64 v[16:17], 0
    v_mov_b64 v[18:19], 0
    s_waitcnt vmcnt(0)
    s_branch L_CH_LOOP_30
L_CH_RETRY_30:
    s_mov_b32 s60, 0
    s_sleep 1
    s_sleep 1
    s_mov_b32 m0, s85
    s_add_u32 s64, s98, s99
    buffer_load_dwordx4 v1, s[4:7], s98 offen sc1 lds
    s_add_u32 m0, s85, s99
    s_mov_b64 exec, 0xffff
    buffer_load_dwordx4 v1, s[4:7], s64 offen sc1 lds
    s_mov_b64 exec, -1
    s_branch L_CH_RETRY2_30
L_CH_RETRY1_30:
    s_mov_b32 s63, s89
    s_mov_b32 m0, 136192
    s_add_u32 s64, s63, 4096
    buffer_load_dwordx4 v1, s[4:7], s63 offen offset:0 sc1 lds
    buffer_load_dwordx4 v1, s[4:7], s63 offen offset:1024 sc1 lds
    buffer_load_dwordx4 v1, s[4:7], s63 offen offset:2048 sc1 lds
    buffer_load_dwordx4 v1, s[4:7], s63 offen offset:3072 sc1 lds
    s_mov_b32 m0, 140288
    s_nop 0
    buffer_load_dwordx4 v1, s[4:7], s64 offen sc1 lds
L_CH_RETRY2_30:
    s_waitcnt vmcnt(0)
    ds_read_b128 v[64:67], v1 offset:5120
    ds_read_b128 v[68:71], v1 offset:6144
    ds_read_b128 v[48:51], v1 offset:7168
    ds_read_b128 v[56:59], v1 offset:8192
    ds_read_b128 v[60:63], v1 offset:9216
    s_waitcnt lgkmcnt(0)
L_CH_RETRY3_30:
    v_max3_u32 v9, v64, v65, v66
    v_max_u32 v9, v9, v67
    v_max3_u32 v9, v9, v68, v69
    v_max3_u32 v9, v9, v70, v71
    v_max3_u32 v9, v9, v48, v49
    v_max3_u32 v9, v9, v50, v51
    v_max3_u32 v9, v9, v56, v57
    v_max3_u32 v9, v9, v58, v59
    v_max3_u32 v9, v9, v60, v61
    v_max3_u32 v9, v9, v62, v63
    v_cmp_eq_u32 vcc, -1, v9
    s_nop 0
    s_cbranch_vccz L_CH_REDO_30
    s_add_u32 s60, s60, 1
    s_cmp_lt_u32 s60, 0x100000
    s_cbranch_scc1 L_CH_RETRY1_30
    s_movk_i32 s62, 13
    s_branch L_ABORT
L_CH_REDO_30:
    v_mov_b64 v[12:13], 0
    v_mov_b64 v[14:15], 0
    s_nop 1
    v_smfmac_f32_16x16x64_bf16 v[12:15], v[36:39], a[0:7], v10
    v_smfmac_f32_16x16x64_bf16 v[12:15], v[40:43], a[16:23], v10
    v_smfmac_f32_16x16x64_bf16 v[12:15], v[44:47], a[32:39], v10
    v_smfmac_f32_16x16x64_bf16 v[12:15], v[72:75], a[48:55], v10
    v_smfmac_f32_16x16x64_bf16 v[12:15], v[76:79], a[64:71], v10
    v_smfmac_f32_16x16x64_bf16 v[12:15], v[56:59], a[128:135], v10
    v_smfmac_f32_16x16x64_bf16 v[12:15], v[60:63], a[144:151], v10
    v_smfmac_f32_16x16x64_bf16 v[12:15], v[64:67], a[80:87], v10
    v_smfmac_f32_16x16x64_bf16 v[12:15], v[68:71], a[96:103], v10
    v_smfmac_f32_16x16x64_bf16 v[12:15], v[48:51], a[112:119], v10
    s_branch L_CH_C_30
L_CH_LAST_30:
    s_mul_i32 s62, s44, 1056
    v_add_u32 v9, s62, v5
    ds_read_b64_tr_b16 v[28:29], v9 offset:26624
    ds_read_b64_tr_b16 v[30:31], v9 offset:26896
    s_waitcnt lgkmcnt(0)
    buffer_store_dwordx4 v[28:31], v1, s[4:7], s77 offen sc1
    s_add_u32 s77, s77, 131072
    s_waitcnt vmcnt(0)
    v_mov_b32 v62, 0
    v_mov_b32 v63, 64
    s_mov_b64 exec, 1
    buffer_store_dword v63, v62, s[4:7], s78 offen sc1
    s_mov_b64 exec, -1
    s_branch L_END2
L_kv_61:
    v_bfe_u32 v52, v1, 4, 1
    v_lshlrev_b32 v52, 5, v52
    v_add_u32 v52, s46, v52
    v_add_u32 v52, 64, v52
    v_lshlrev_b32 v52, 6, v52
    s_mov_b32 s60, 0
L_pf_65:
    buffer_load_dword v53, v52, s[4:7], 0 offen sc1
    s_waitcnt vmcnt(0)
    v_cmp_gt_u32 vcc, s69, v53
    s_nop 0
    s_cbranch_vccz L_pfd_66
    s_sleep 1
    s_add_u32 s60, s60, 1
    s_cmp_lt_u32 s60, 0x100000
    s_cbranch_scc1 L_pf_65
    s_movk_i32 s62, 11
    s_branch L_ABORT
L_pfd_66:
    v_readlane_b32 s68, v53, 0
    v_readlane_b32 s62, v53, 1
    s_nop 0
    s_min_u32 s68, s68, s62
    s_branch L_kvr_62
L_kv_59:
    v_bfe_u32 v52, v1, 4, 1
    v_lshlrev_b32 v52, 5, v52
    v_add_u32 v52, s46, v52
    v_add_u32 v52, 64, v52
    v_lshlrev_b32 v52, 6, v52
    s_mov_b32 s60, 0
L_pf_67:
    buffer_load_dword v53, v52, s[4:7], 0 offen sc1
    s_waitcnt vmcnt(0)
    v_cmp_gt_u32 vcc, s69, v53
    s_nop 0
    s_cbranch_vccz L_pfd_68
    s_sleep 1
    s_add_u32 s60, s60, 1
    s_cmp_lt_u32 s60, 0x100000
    s_cbranch_scc1 L_pf_67
    s_movk_i32 s62, 11
    s_branch L_ABORT
L_pfd_68:
    v_readlane_b32 s68, v53, 0
    v_readlane_b32 s62, v53, 1
    s_nop 0
    s_min_u32 s68, s68, s62
    s_branch L_kvr_60
L_CH_FIRST_01:
    ds_read_b128 v[36:39], v1 offset:0
    ds_read_b128 v[40:43], v1 offset:1024
    ds_read_b128 v[44:47], v1 offset:2048
    ds_read_b128 v[72:75], v1 offset:3072
    ds_read_b128 v[76:79], v1 offset:4096
    s_waitcnt lgkmcnt(4)
    v_smfmac_f32_16x16x64_bf16 v[12:15], v[36:39], a[0:7], v10
    s_waitcnt lgkmcnt(3)
    v_smfmac_f32_16x16x64_bf16 v[12:15], v[40:43], a[16:23], v10
    s_waitcnt lgkmcnt(2)
    v_smfmac_f32_16x16x64_bf16 v[12:15], v[44:47], a[32:39], v10
    s_waitcnt lgkmcnt(1)
    v_smfmac_f32_16x16x64_bf16 v[12:15], v[72:75], a[48:55], v10
    s_waitcnt lgkmcnt(0)
    v_smfmac_f32_16x16x64_bf16 v[12:15], v[76:79], a[64:71], v10
    v_smfmac_f32_16x16x64_bf16 v[16:19], v[36:39], a[8:15], v10
    v_smfmac_f32_16x16x64_bf16 v[16:19], v[40:43], a[24:31], v10
    v_smfmac_f32_16x16x64_bf16 v[16:19], v[44:47], a[40:47], v10
    v_smfmac_f32_16x16x64_bf16 v[16:19], v[72:75], a[56:63], v10
    v_smfmac_f32_16x16x64_bf16 v[16:19], v[76:79], a[72:79], v10
    v_smfmac_f32_16x16x64_bf16 v[28:31], v[36:39], v[56:63], v10
    ds_read_b128 v[56:59], v2 offset:51200
    ds_read_b128 v[60:63], v2 offset:52224
    v_smfmac_f32_16x16x64_bf16 v[20:23], v[36:39], v[64:71], v10
    v_xor_b32 v2, 0x10000, v2
    ds_read_b128 v[64:67], v2 offset:0
    ds_read_b128 v[68:71], v2 offset:1024
    v_smfmac_f32_16x16x64_bf16 v[32:35], v[36:39], v[48:55], v10
    ds_read_b128 v[48:51], v2 offset:2048
    ds_read_b128 v[52:55], v2 offset:3072
    v_smfmac_f32_16x16x64_bf16 v[20:23], v[40:43], a[208:215], v10
    s_waitcnt lgkmcnt(4)
    v_smfmac_f32_16x16x64_bf16 v[24:27], v[36:39], v[56:63], v10
    ds_read_b128 v[56:59], v2 offset:16384
    ds_read_b128 v[60:63], v2 offset:17408
    v_smfmac_f32_16x16x64_bf16 v[24:27], v[40:43], a[216:223], v10
    s_waitcnt lgkmcnt(4)
    v_smfmac_f32_16x16x64_bf16 v[28:31], v[40:43], v[64:71], v10
    ds_read_b128 v[64:67], v2 offset:18432
    ds_read_b128 v[68:71], v2 offset:19456
    v_smfmac_f32_16x16x64_bf16 v[20:23], v[44:47], a[224:231], v10
    s_waitcnt lgkmcnt(4)
    v_smfmac_f32_16x16x64_bf16 v[32:35], v[40:43], v[48:55], v10
    ds_read_b128 v[48:51], v2 offset:32768
    ds_read_b128 v[52:55], v2 offset:33792
    v_smfmac_f32_16x16x64_bf16 v[24:27], v[44:47], a[232:239], v10
    s_waitcnt lgkmcnt(4)
    v_smfmac_f32_16x16x64_bf16 v[28:31], v[44:47], v[56:63], v10
    ds_read_b128 v[56:59], v2 offset:34816
    ds_read_b128 v[60:63], v2 offset:35840
    s_waitcnt lgkmcnt(4)
    v_smfmac_f32_16x16x64_bf16 v[32:35], v[44:47], v[64:71], v10
    ds_read_b128 v[64:67], v2 offset:49152
    ds_read_b128 v[68:71], v2 offset:50176
    s_waitcnt lgkmcnt(4)
    v_smfmac_f32_16x16x64_bf16 v[28:31], v[72:75], v[48:55], v10
    ds_read_b128 v[48:51], v2 offset:51200
    ds_read_b128 v[52:55], v2 offset:52224
    s_waitcnt lgkmcnt(4)
    v_smfmac_f32_16x16x64_bf16 v[32:35], v[72:75], v[56:63], v10
    s_barrier
    s_mov_b32 s69, 2
    ds_read_b128 v[56:59], v1 offset:8192
    ds_read_b128 v[60:63], v1 offset:9216
    s_waitcnt lgkmcnt(4)
    v_smfmac_f32_16x16x64_bf16 v[28:31], v[76:79], v[64:71], v10
    ds_read_b128 v[64:67], v1 offset:5120
    ds_read_b128 v[68:71], v1 offset:6144
    s_waitcnt lgkmcnt(4)
    v_smfmac_f32_16x16x64_bf16 v[32:35], v[76:79], v[48:55], v10
    ds_read_b128 v[48:51], v1 offset:7168
    v_smfmac_f32_16x16x64_bf16 v[20:23], v[72:75], v[144:151], v10
    s_waitcnt lgkmcnt(4)
    v_smfmac_f32_16x16x64_bf16 v[12:15], v[56:59], a[128:135], v10
    s_waitcnt lgkmcnt(3)
    v_smfmac_f32_16x16x64_bf16 v[12:15], v[60:63], a[144:151], v10
    s_waitcnt lgkmcnt(2)
    v_smfmac_f32_16x16x64_bf16 v[12:15], v[64:67], a[80:87], v10
    s_waitcnt lgkmcnt(1)
    v_smfmac_f32_16x16x64_bf16 v[12:15], v[68:71], a[96:103], v10
    s_waitcnt lgkmcnt(0)
    v_smfmac_f32_16x16x64_bf16 v[12:15], v[48:51], a[112:119], v10
    s_cmp_lt_u32 s68, s69
    s_cbranch_scc1 L_kv_69
L_kvr_70:
    v_smfmac_f32_16x16x64_bf16 v[24:27], v[72:75], v[152:159], v10
    v_smfmac_f32_16x16x64_bf16 v[20:23], v[76:79], v[160:167], v10
    v_smfmac_f32_16x16x64_bf16 v[24:27], v[76:79], v[168:175], v10
    s_branch L_CH_C_01
    .p2align 6
L_CH_B1_01:
    s_barrier
L_CH_LOOP_01:
    ds_read_b128 v[36:39], v1 offset:0
    ds_read_b128 v[40:43], v1 offset:1024
    ds_read_b128 v[44:47], v1 offset:2048
    ds_read_b128 v[72:75], v1 offset:3072
    ds_read_b128 v[76:79], v1 offset:4096
L_CH_A1_01:
    s_waitcnt lgkmcnt(4)
    v_smfmac_f32_16x16x64_bf16 v[12:15], v[36:39], a[0:7], v10
    s_waitcnt lgkmcnt(3)
    v_smfmac_f32_16x16x64_bf16 v[12:15], v[40:43], a[16:23], v10
    s_waitcnt lgkmcnt(2)
    v_smfmac_f32_16x16x64_bf16 v[12:15], v[44:47], a[32:39], v10
    s_waitcnt lgkmcnt(1)
    v_smfmac_f32_16x16x64_bf16 v[12:15], v[72:75], a[48:55], v10
    s_waitcnt lgkmcnt(0)
    v_smfmac_f32_16x16x64_bf16 v[12:15], v[76:79], a[64:71], v10
    v_smfmac_f32_16x16x64_bf16 v[16:19], v[36:39], a[8:15], v10
    v_smfmac_f32_16x16x64_bf16 v[16:19], v[40:43], a[24:31], v10
    s_add_u32 s69, s61, 2
    s_min_u32 s69, s69, 64
    s_mov_b32 m0, s85
    s_add_u32 s64, s98, s99
    s_nop 1
    v_cmp_u_f32 vcc, v12, v13
    v_cmp_u_f32 s[62:63], v14, v15
    v_smfmac_f32_16x16x64_bf16 v[16:19], v[44:47], a[40:47], v10
    s_or_b64 vcc, vcc, s[62:63]
    s_cbranch_scc1 L_CH_LRETRY_01
L_CH_LGO_01:
    buffer_load_dwordx4 v1, s[4:7], s98 offen sc1 lds
    s_add_u32 m0, s85, s99
    s_mov_b64 exec, 0xffff
    buffer_load_dwordx4 v1, s[4:7], s64 offen sc1 lds
    s_mov_b64 exec, -1
    v_smfmac_f32_16x16x64_bf16 v[16:19], v[72:75], a[56:63], v10
    v_smfmac_f32_16x16x64_bf16 v[16:19], v[76:79], a[72:79], v10
    v_smfmac_f32_16x16x64_bf16 v[28:31], v[36:39], v[56:63], v10
    ds_read_b128 v[56:59], v2 offset:51200
    ds_read_b128 v[60:63], v2 offset:52224
    v_smfmac_f32_16x16x64_bf16 v[20:23], v[36:39], v[64:71], v10
    v_xor_b32 v2, 0x10000, v2
    ds_read_b128 v[64:67], v2 offset:0
    ds_read_b128 v[68:71], v2 offset:1024
    v_smfmac_f32_16x16x64_bf16 v[32:35], v[36:39], v[48:55], v10
    ds_read_b128 v[48:51], v2 offset:2048
    ds_read_b128 v[52:55], v2 offset:3072
    v_smfmac_f32_16x16x64_bf16 v[20:23], v[40:43], a[208:215], v10
    v_mov_b32 v9, s61
    s_mov_b64 exec, 1
    buffer_store_dword v9, off, s[4:7], s78 sc1
    s_mov_b64 exec, -1
    s_waitcnt lgkmcnt(4)
    v_smfmac_f32_16x16x64_bf16 v[24:27], v[36:39], v[56:63], v10
    ds_read_b128 v[56:59], v2 offset:16384
    ds_read_b128 v[60:63], v2 offset:17408
    v_smfmac_f32_16x16x64_bf16 v[24:27], v[40:43], a[216:223], v10
    s_waitcnt lgkmcnt(4)
    v_smfmac_f32_16x16x64_bf16 v[28:31], v[40:43], v[64:71], v10
    ds_read_b128 v[64:67], v2 offset:18432
    ds_read_b128 v[68:71], v2 offset:19456
    v_smfmac_f32_16x16x64_bf16 v[20:23], v[44:47], a[224:231], v10
    s_waitcnt lgkmcnt(4)
    v_smfmac_f32_16x16x64_bf16 v[32:35], v[40:43], v[48:55], v10
    ds_read_b128 v[48:51], v2 offset:32768
    ds_read_b128 v[52:55], v2 offset:33792
    v_smfmac_f32_16x16x64_bf16 v[24:27], v[44:47], a[232:239], v10
    s_waitcnt lgkmcnt(4)
    v_smfmac_f32_16x16x64_bf16 v[28:31], v[44:47], v[56:63], v10
    ds_read_b128 v[56:59], v2 offset:34816
    ds_read_b128 v[60:63], v2 offset:35840
    s_waitcnt lgkmcnt(4)
    v_smfmac_f32_16x16x64_bf16 v[32:35], v[44:47], v[64:71], v10
    ds_read_b128 v[64:67], v2 offset:49152
    ds_read_b128 v[68:71], v2 offset:50176
    s_waitcnt lgkmcnt(4)
    v_smfmac_f32_16x16x64_bf16 v[28:31], v[72:75], v[48:55], v10
    ds_read_b128 v[48:51], v2 offset:51200
    ds_read_b128 v[52:55], v2 offset:52224
    s_waitcnt lgkmcnt(4)
    v_smfmac_f32_16x16x64_bf16 v[32:35], v[72:75], v[56:63], v10
    s_waitcnt vmcnt(1)
    s_barrier
    ds_read_b128 v[56:59], v1 offset:8192
    ds_read_b128 v[60:63], v1 offset:9216
    s_waitcnt lgkmcnt(4)
    v_smfmac_f32_16x16x64_bf16 v[28:31], v[76:79], v[64:71], v10
    ds_read_b128 v[64:67], v1 offset:5120
    ds_read_b128 v[68:71], v1 offset:6144
    s_waitcnt lgkmcnt(4)
    v_smfmac_f32_16x16x64_bf16 v[32:35], v[76:79], v[48:55], v10
    ds_read_b128 v[48:51], v1 offset:7168
    v_smfmac_f32_16x16x64_bf16 v[20:23], v[72:75], v[144:151], v10
    s_waitcnt lgkmcnt(4)
    v_smfmac_f32_16x16x64_bf16 v[12:15], v[56:59], a[128:135], v10
    s_waitcnt lgkmcnt(3)
    v_smfmac_f32_16x16x64_bf16 v[12:15], v[60:63], a[144:151], v10
    s_waitcnt lgkmcnt(2)
    v_smfmac_f32_16x16x64_bf16 v[12:15], v[64:67], a[80:87], v10
    s_waitcnt lgkmcnt(1)
    v_smfmac_f32_16x16x64_bf16 v[12:15], v[68:71], a[96:103], v10
    s_waitcnt lgkmcnt(0)
    v_smfmac_f32_16x16x64_bf16 v[12:15], v[48:51], a[112:119], v10
    s_cmp_lt_u32 s68, s69
    s_cbranch_scc1 L_kv_71
L_kvr_72:
    v_smfmac_f32_16x16x64_bf16 v[24:27], v[72:75], v[152:159], v10
    v_smfmac_f32_16x16x64_bf16 v[20:23], v[76:79], v[160:167], v10
    v_smfmac_f32_16x16x64_bf16 v[24:27], v[76:79], v[168:175], v10
    s_nop 2
    v_cmp_u_f32 vcc, v12, v13
    v_cmp_u_f32 s[62:63], v14, v15
    s_nop 0
    s_or_b64 vcc, vcc, s[62:63]
    s_cbranch_scc1 L_CH_RETRY_01
L_CH_C_01:
    v_smfmac_f32_16x16x64_bf16 v[16:19], v[64:67], a[88:95], v10
    buffer_load_dwordx4 v[72:75], v1, s[4:7], s76 offen sc1
    v_smfmac_f32_16x16x64_bf16 v[16:19], v[68:71], a[104:111], v10
    v_smfmac_f32_16x16x64_bf16 v[16:19], v[48:51], a[120:127], v10
    buffer_load_dwordx4 v[76:79], v1, s[4:7], s76 offen offset:1024 sc1
    s_add_u32 s76, s76, 262144
    v_smfmac_f32_16x16x64_bf16 v[16:19], v[56:59], a[136:143], v10
    v_pk_add_f32 v[12:13], v[12:13], v[14:15]
    v_smfmac_f32_16x16x64_bf16 v[16:19], v[60:63], a[152:159], v10
    ds_read_b128 v[36:39], v0 offset:0
    ds_read_b128 v[40:43], v0 offset:1024
    v_cvt_pk_bf16_f32 v14, v12, v13
    v_smfmac_f32_16x16x64_bf16 v[20:23], v[64:67], v[176:183], v10
    ds_read_b128 v[44:47], v0 offset:2048
    ds_read_b128 v[52:55], v0 offset:3072
    v_smfmac_f32_16x16x64_bf16 v[24:27], v[64:67], v[184:191], v10
    v_smfmac_f32_16x16x64_bf16 v[20:23], v[68:71], v[192:199], v10
    v_pk_add_f32 v[16:17], v[16:17], v[18:19]
    v_smfmac_f32_16x16x64_bf16 v[24:27], v[68:71], v[200:207], v10
    v_cvt_pk_bf16_f32 v18, v16, v17
    v_smfmac_f32_16x16x64_bf16 v[20:23], v[48:51], v[208:215], v10
    ds_write_b32 v4, v14 offset:0
    ds_write_b32 v4, v18 offset:528
    v_smfmac_f32_16x16x64_bf16 v[24:27], v[48:51], v[216:223], v10
    v_smfmac_f32_16x16x64_bf16 v[20:23], v[56:59], v[224:231], v10
    s_mov_b32 m0, s74
    s_xor_b32 s74, s74, s37
    buffer_load_dwordx4 v1, s[4:7], s73 offen sc1 lds
    v_smfmac_f32_16x16x64_bf16 v[24:27], v[56:59], v[232:239], v10
    v_smfmac_f32_16x16x64_bf16 v[20:23], v[60:63], v[240:247], v10
    buffer_load_dwordx4 v1, s[4:7], s73 offen offset:1024 sc1 lds
    s_add_u32 s73, s73, 262144
    v_smfmac_f32_16x16x64_bf16 v[24:27], v[60:63], v[248:255], v10
    s_waitcnt lgkmcnt(0)
    s_barrier
    ds_read_b64_tr_b16 v[12:13], v5 offset:0
    ds_read_b64_tr_b16 v[14:15], v5 offset:272
    v_smfmac_f32_16x16x64_bf16 v[28:31], v[64:67], v[80:87], v10
    ds_read_b64_tr_b16 v[16:17], v5 offset:1056
    ds_read_b64_tr_b16 v[18:19], v5 offset:1328
    v_pk_add_f32 v[20:21], v[20:21], v[22:23]
    v_smfmac_f32_16x16x64_bf16 v[32:35], v[64:67], v[88:95], v10
    ds_read_b64_tr_b16 v[64:65], v5 offset:2112
    ds_read_b64_tr_b16 v[66:67], v5 offset:2384
    v_pk_add_f32 v[24:25], v[24:25], v[26:27]
    v_cvt_pk_bf16_f32 v22, v20, v21
    v_smfmac_f32_16x16x64_bf16 v[28:31], v[68:71], v[96:103], v10
    v_cvt_pk_bf16_f32 v26, v24, v25
    ds_write_b32 v4, v22 offset:26624
    ds_write_b32 v4, v26 offset:27152
    v_smfmac_f32_16x16x64_bf16 v[32:35], v[68:71], v[104:111], v10
    ds_read_b64_tr_b16 v[68:69], v5 offset:3168
    ds_read_b64_tr_b16 v[70:71], v5 offset:3440
    v_smfmac_f32_16x16x64_bf16 v[28:31], v[48:51], v[112:119], v10
    v_smfmac_f32_16x16x64_bf16 v[32:35], v[48:51], v[120:127], v10
    ds_read_b128 v[48:51], v0 offset:4096
    v_smfmac_f32_16x16x64_bf16 v[28:31], v[56:59], v[128:135], v10
    v_smfmac_f32_16x16x64_bf16 v[32:35], v[56:59], v[136:143], v10
    ds_read_b128 v[56:59], v0 offset:5120
    v_smfmac_f32_16x16x64_bf16 v[28:31], v[60:63], a[240:247], v10
    v_smfmac_f32_16x16x64_bf16 v[32:35], v[60:63], a[248:255], v10
    s_waitcnt lgkmcnt(10)
    v_mfma_f32_16x16x32_bf16 v[60:63], v[36:39], v[12:15], 0
    ds_read_b128 v[36:39], v0 offset:6144
    s_waitcnt lgkmcnt(9)
    v_mfma_f32_16x16x32_bf16 v[60:63], v[40:43], v[16:19], v[60:63]
    ds_read_b128 v[40:43], v0 offset:7168
    s_waitcnt lgkmcnt(8)
    v_mfma_f32_16x16x32_bf16 v[60:63], v[44:47], v[64:67], v[60:63]
    v_cvt_pk_bf16_f32 v28, v28, v29
    v_cvt_pk_bf16_f32 v29, v30, v31
    s_waitcnt lgkmcnt(4)
    v_mfma_f32_16x16x32_bf16 v[60:63], v[52:55], v[68:71], v[60:63]
    v_cvt_pk_bf16_f32 v30, v32, v33
    v_cvt_pk_bf16_f32 v31, v34, v35
    s_cmp_eq_u32 s61, 63
    s_barrier
    s_cbranch_scc1 L_CH_LAST_01
    ds_read_b64_tr_b16 v[44:45], v5 offset:26624
    ds_read_b64_tr_b16 v[46:47], v5 offset:26896
    ds_read_b64_tr_b16 v[52:53], v5 offset:27680
    ds_read_b64_tr_b16 v[54:55], v5 offset:27952
    s_waitcnt lgkmcnt(7)
    v_mfma_f32_16x16x32_bf16 v[20:23], v[48:51], v[12:15], 0
    ds_read_b64_tr_b16 v[48:49], v5 offset:28736
    ds_read_b64_tr_b16 v[50:51], v5 offset:29008
    s_waitcnt lgkmcnt(8)
    v_mfma_f32_16x16x32_bf16 v[20:23], v[56:59], v[16:19], v[20:23]
    ds_read_b64_tr_b16 v[56:57], v5 offset:29792
    ds_read_b64_tr_b16 v[58:59], v5 offset:30064
    s_waitcnt lgkmcnt(9)
    v_mfma_f32_16x16x32_bf16 v[20:23], v[36:39], v[64:67], v[20:23]
    buffer_store_dwordx4 v[28:31], v1, s[4:7], s77 offen sc1
    s_waitcnt lgkmcnt(8)
    v_mfma_f32_16x16x32_bf16 v[20:23], v[40:43], v[68:71], v[20:23]
    v_xor_b32 v0, s75, v0
    s_waitcnt lgkmcnt(6)
    v_mfma_f32_16x16x32_bf16 v[24:27], v[44:47], v[12:15], 0
    v_max3_f32 v32, v60, v61, v62
    s_waitcnt lgkmcnt(4)
    v_mfma_f32_16x16x32_bf16 v[24:27], v[52:55], v[16:19], v[24:27]
    s_waitcnt lgkmcnt(2)
    v_mfma_f32_16x16x32_bf16 v[24:27], v[48:51], v[64:67], v[24:27]
    s_waitcnt lgkmcnt(0)
    v_mfma_f32_16x16x32_bf16 v[24:27], v[56:59], v[68:71], v[24:27]
    v_max3_f32 v32, v32, v63, v20
    v_max3_f32 v33, v21, v22, v23
    v_mov_b64 v[18:19], s[8:9]
    s_add_u32 s77, s77, 131072
    v_mov_b64 v[44:45], 0
    v_mov_b64 v[46:47], 0
    v_mov_b64 v[48:49], s[38:39]
    v_mov_b64 v[50:51], s[38:39]
    v_max_f32 v32, v32, v33
    v_max3_f32 v33, v32, v24, v25
    v_max3_f32 v32, v32, v24, v25
    v_mov_b64 v[56:57], 0
    v_mov_b64 v[58:59], 0
    v_permlane16_swap_b32 v32, v33
    v_max_f32 v34, v32, v33
    v_max_f32 v35, v32, v33
    v_mov_b64 v[64:65], 0
    v_mov_b64 v[66:67], 0
    v_permlane32_swap_b32 v34, v35
    v_max_f32 v32, v34, v35
    v_mul_f32 v32, s82, v32
    v_pk_fma_f32 v[60:61], v[60:61], s[82:83], v[32:33] op_sel_hi:[1,0,0] neg_lo:[0,0,1] neg_hi:[0,0,1]
    v_pk_fma_f32 v[62:63], v[62:63], s[82:83], v[32:33] op_sel_hi:[1,0,0] neg_lo:[0,0,1] neg_hi:[0,0,1]
    v_pk_fma_f32 v[20:21], v[20:21], s[82:83], v[32:33] op_sel_hi:[1,0,0] neg_lo:[0,0,1] neg_hi:[0,0,1]
    v_pk_fma_f32 v[22:23], v[22:23], s[82:83], v[32:33] op_sel_hi:[1,0,0] neg_lo:[0,0,1] neg_hi:[0,0,1]
    v_pk_fma_f32 v[24:25], v[24:25], s[82:83], v[32:33] op_sel_hi:[1,0,0] neg_lo:[0,0,1] neg_hi:[0,0,1]
    v_exp_f32 v60, v60
    v_exp_f32 v61, v61
    v_exp_f32 v62, v62
    v_cvt_pk_bf16_f32 v12, v60, v61
    v_exp_f32 v63, v63
    v_exp_f32 v20, v20
    v_cvt_pk_bf16_f32 v13, v62, v63
    v_exp_f32 v21, v21
    v_exp_f32 v22, v22
    v_cvt_pk_bf16_f32 v14, v20, v21
    v_exp_f32 v23, v23
    v_exp_f32 v24, v24
    v_cvt_pk_bf16_f32 v15, v22, v23
    v_exp_f32 v25, v25
    s_waitcnt vmcnt(3)
    v_mfma_f32_16x16x32_bf16 v[36:39], v[72:75], v[12:15], 0
    v_cvt_pk_bf16_f32 v16, v24, v25
    v_cvt_pk_bf16_f32 v17, v24, v25
    v_mfma_f32_16x16x32_bf16 v[40:43], v[76:79], v[12:15], 0
    s_add_u32 s81, s81, 16384
    s_and_b32 s81, s81, 0xffff
    s_add_u32 s61, s61, 1
    v_mfma_f32_16x16x16_bf16 v[36:39], v[28:29], v[16:17], v[36:39]
    v_mov_b64 v[68:69], 0
    v_mov_b64 v[70:71], 0
    v_mfma_f32_16x16x16_bf16 v[40:43], v[30:31], v[16:17], v[40:43]
    v_mfma_f32_16x16x32_bf16 v[24:27], v[12:15], v[48:51], 0
    v_xor_b32 v2, 0x10000, v2
    ds_read_b128 v[72:75], v2 offset:0
    ds_read_b128 v[76:79], v2 offset:1024
    v_mov_b64 v[52:53], 0
    v_mov_b64 v[54:55], 0
    s_mov_b64 exec, s[94:95]
    v_cvt_pk_bf16_f32 v36, v36, v37
    v_cvt_pk_bf16_f32 v37, v38, v39
    v_cvt_pk_bf16_f32 v38, v40, v41
    v_cvt_pk_bf16_f32 v39, v42, v43
    ds_write_b128 v6, v[36:39]
    s_mov_b64 exec, -1
    v_mfma_f32_16x16x16_bf16 v[24:27], v[16:17], v[18:19], v[24:27]
    ds_read_b128 v[12:15], v2 offset:2048
    ds_read_b128 v[16:19], v2 offset:3072
    s_add_u32 s63, s90, s81
    s_add_u32 s91, s91, 32768
    s_add_u32 s98, s98, 32768
    s_add_u32 s89, s89, 32768
    s_add_u32 s65, s88, s81
    s_mov_b32 s60, 0
    v_rcp_f32 v60, v24
    v_rcp_f32 v61, v25
    s_waitcnt lgkmcnt(2)
    s_barrier
    ds_read_b128 v[48:51], v1 offset:0
    ds_read_b128 v[32:35], v1 offset:1024
    s_waitcnt lgkmcnt(1)
    v_smfmac_f32_16x16x64_bf16 v[68:71], v[48:51], v[72:79], v10
    ds_read_b128 v[72:75], v2 offset:16384
    ds_read_b128 v[76:79], v2 offset:17408
    v_smfmac_f32_16x16x64_bf16 v[44:47], v[48:51], v[12:19], v10
    ds_read_b128 v[12:15], v2 offset:18432
    ds_read_b128 v[16:19], v2 offset:19456
    s_waitcnt lgkmcnt(4)
    v_smfmac_f32_16x16x64_bf16 v[68:71], v[32:35], a[200:207], v10
    v_smfmac_f32_16x16x64_bf16 v[44:47], v[32:35], a[176:183], v10
    v_smfmac_f32_16x16x64_bf16 v[52:55], v[48:51], a[160:167], v10
    v_smfmac_f32_16x16x64_bf16 v[52:55], v[32:35], a[184:191], v10
    v_smfmac_f32_16x16x64_bf16 v[56:59], v[48:51], a[168:175], v10
    v_smfmac_f32_16x16x64_bf16 v[56:59], v[32:35], a[192:199], v10
    s_waitcnt lgkmcnt(2)
    v_smfmac_f32_16x16x64_bf16 v[64:67], v[48:51], v[72:79], v10
    s_waitcnt lgkmcnt(0)
    v_smfmac_f32_16x16x64_bf16 v[64:67], v[32:35], v[12:19], v10
    v_pk_add_f32 v[68:69], v[68:69], v[70:71]
    v_pk_add_f32 v[44:45], v[44:45], v[46:47]
    v_pk_add_f32 v[52:53], v[52:53], v[54:55]
    s_nop 0
    v_pk_add_f32 v[56:57], v[56:57], v[58:59]
    v_pk_mul_f32 v[68:69], v[68:69], v[60:61]
    v_pk_mul_f32 v[44:45], v[44:45], v[60:61]
    v_pk_mul_f32 v[52:53], v[52:53], v[60:61]
    v_pk_mul_f32 v[56:57], v[56:57], v[60:61]
    v_pk_add_f32 v[64:65], v[64:65], v[66:67]
    v_cvt_pk_bf16_f32 v40, v68, v69
    v_cvt_pk_bf16_f32 v36, v44, v45
    v_pk_mul_f32 v[64:65], v[64:65], v[60:61]
    buffer_store_dword v40, v8, s[4:7], s79 offen
    v_cvt_pk_bf16_f32 v37, v52, v53
    v_cvt_pk_bf16_f32 v38, v56, v57
    v_cvt_pk_bf16_f32 v39, v64, v65
    buffer_store_dwordx4 v[36:39], v7, s[4:7], s79 offen
    s_xor_b32 s79, s79, s92
    v_mov_b64 v[32:33], 0
    v_mov_b64 v[34:35], 0
    s_min_u32 s62, s0, s1
    s_max_u32 s68, s68, s62
    s_buffer_load_dword s0, s[4:7], s84 glc
    s_buffer_load_dword s1, s[4:7], s36 glc
L_sr_73:
    v_bfe_u32 v62, v1, 4, 1
    v_mov_b32 v63, 0x3f80
    v_lshlrev_b32 v62, 4, v62
    v_lshlrev_b32 v62, v62, v63
    v_cndmask_b32 v20, 0, v62, s[52:53]
    v_cndmask_b32 v21, 0, v62, s[54:55]
    v_cndmask_b32 v22, 0, v62, s[56:57]
    v_cndmask_b32 v23, 0, v62, s[58:59]
    s_sleep 1
    s_sleep 1
    s_sleep 1
    buffer_load_dwordx4 v[36:39], v1, s[4:7], s80 offen offset:0 sc1
    buffer_load_dwordx4 v[40:43], v1, s[4:7], s80 offen offset:1024 sc1
    buffer_load_dwordx4 v[44:47], v1, s[4:7], s80 offen offset:2048 sc1
    buffer_load_dwordx4 v[48:51], v1, s[4:7], s80 offen offset:3072 sc1
    s_sleep 1
    s_sleep 1
    buffer_load_dwordx4 v[52:55], v1, s[4:7], s80 offen offset:0 sc1
    buffer_load_dwordx4 v[56:59], v1, s[4:7], s80 offen offset:1024 sc1
    buffer_load_dwordx4 v[60:63], v1, s[4:7], s80 offen offset:2048 sc1
    buffer_load_dwordx4 v[64:67], v1, s[4:7], s80 offen offset:3072 sc1
L_CH_RED_01:
    s_waitcnt vmcnt(7)
    v_max3_u32 v76, v36, v37, v38
    v_max_u32 v76, v76, v39
    v_mfma_f32_16x16x32_bf16 v[68:71], v[36:39], v[20:23], 0
    s_waitcnt vmcnt(6)
    v_max3_u32 v76, v76, v40, v41
    v_max3_u32 v76, v76, v42, v43
    v_mfma_f32_16x16x32_bf16 v[68:71], v[40:43], v[20:23], v[68:71]
    s_waitcnt vmcnt(5)
    v_max3_u32 v76, v76, v44, v45
    v_max3_u32 v76, v76, v46, v47
    v_mfma_f32_16x16x32_bf16 v[68:71], v[44:47], v[20:23], v[68:71]
    s_waitcnt vmcnt(4)
    v_max3_u32 v76, v76, v48, v49
    v_max3_u32 v76, v76, v50, v51
    v_mfma_f32_16x16x32_bf16 v[68:71], v[48:51], v[20:23], v[68:71]
    v_cmp_eq_u32 vcc, -1, v76
    s_nop 0
    s_cbranch_vccz L_CH_REDOK_01
    buffer_load_dwordx4 v[36:39], v1, s[4:7], s80 offen offset:0 sc1
    buffer_load_dwordx4 v[40:43], v1, s[4:7], s80 offen offset:1024 sc1
    buffer_load_dwordx4 v[44:47], v1, s[4:7], s80 offen offset:2048 sc1
    buffer_load_dwordx4 v[48:51], v1, s[4:7], s80 offen offset:3072 sc1
    s_waitcnt vmcnt(7)
    v_max3_u32 v76, v52, v53, v54
    v_max_u32 v76, v76, v55
    v_mfma_f32_16x16x32_bf16 v[68:71], v[52:55], v[20:23], 0
    s_waitcnt vmcnt(6)
    v_max3_u32 v76, v76, v56, v57
    v_max3_u32 v76, v76, v58, v59
    v_mfma_f32_16x16x32_bf16 v[68:71], v[56:59], v[20:23], v[68:71]
    s_waitcnt vmcnt(5)
    v_max3_u32 v76, v76, v60, v61
    v_max3_u32 v76, v76, v62, v63
    v_mfma_f32_16x16x32_bf16 v[68:71], v[60:63], v[20:23], v[68:71]
    s_waitcnt vmcnt(4)
    v_max3_u32 v76, v76, v64, v65
    v_max3_u32 v76, v76, v66, v67
    v_mfma_f32_16x16x32_bf16 v[68:71], v[64:67], v[20:23], v[68:71]
    v_cmp_eq_u32 vcc, -1, v76
    s_nop 0
    s_cbranch_vccnz L_CH_REDX_01
L_CH_REDOK_01:
    s_nop 5
    v_permlane32_swap_b32 v68, v70
    v_permlane32_swap_b32 v69, v71
    v_pk_add_f32 v[68:69], v[68:69], v[70:71]
    v_cvt_pk_bf16_f32 v20, v68, v69
    s_mov_b64 exec, s[86:87]
    buffer_store_dword v20, v3, s[4:7], s63 offen
    buffer_store_dword v20, v3, s[4:7], s91 offen sc1
    s_mov_b64 exec, -1
    s_barrier
    s_xor_b32 s80, s80, s93
    s_mov_b32 s60, 0
    s_waitcnt vmcnt(2)
    ds_read_b128 v[56:59], v2 offset:32768
    ds_read_b128 v[60:63], v2 offset:33792
    ds_read_b128 v[64:67], v2 offset:49152
    ds_read_b128 v[68:71], v2 offset:50176
    ds_read_b128 v[48:51], v2 offset:34816
    ds_read_b128 v[52:55], v2 offset:35840
    v_mov_b64 v[12:13], 0
    v_mov_b64 v[14:15], 0
    v_mov_b64 v[16:17], 0
    v_mov_b64 v[18:19], 0
    v_mov_b64 v[20:21], 0
    v_mov_b64 v[22:23], 0
    v_mov_b64 v[24:25], 0
    v_mov_b64 v[26:27], 0
    v_mov_b64 v[28:29], 0
    v_mov_b64 v[30:31], 0
    v_mov_b64 v[36:37], -1
    v_mov_b64 v[38:39], -1
    s_sleep 1
    s_sleep 1
    s_sleep 1
    s_mov_b32 m0, s100
    s_add_u32 s64, s65, s99
    buffer_load_dwordx4 v1, s[4:7], s65 offen sc1 lds
    s_add_u32 m0, s100, s99
    s_mov_b64 exec, 0xffff
    buffer_load_dwordx4 v1, s[4:7], s64 offen sc1 lds
    s_mov_b64 exec, -1
    s_nop 11
    s_mov_b32 m0, s100
    s_add_u32 s64, s65, s99
    buffer_load_dwordx4 v1, s[4:7], s65 offen sc1 lds
    s_add_u32 m0, s100, s99
    s_mov_b64 exec, 0xffff
    buffer_load_dwordx4 v1, s[4:7], s64 offen sc1 lds
    s_mov_b64 exec, -1
    s_add_u32 s63, s101, s10
    buffer_store_dwordx4 v[36:39], v1, s[4:7], s101 offen
    s_mov_b64 exec, s[42:43]
    buffer_store_dwordx4 v[36:39], v1, s[4:7], s63 offen
    s_xor_b32 s101, s101, s40
    s_xor_b32 s62, s81, 0x8000
    s_add_u32 s62, s62, s41
    s_mov_b64 exec, s[66:67]
    buffer_store_dwordx4 v[36:39], v11, s[4:7], s62 offen
    s_mov_b64 exec, -1
    s_waitcnt vmcnt(5)
    s_barrier
    ds_read_b128 v[36:39], v1 offset:0
    ds_read_b128 v[40:43], v1 offset:1024
    ds_read_b128 v[44:47], v1 offset:2048
    ds_read_b128 v[72:75], v1 offset:3072
    ds_read_b128 v[76:79], v1 offset:4096
    s_branch L_CH_A1_01
L_CH_LRETRY_01:
    s_add_u32 s60, s60, 1
    s_cmp_lg_u32 s60, 1
    s_cbranch_scc1 L_ln_74
    v_mov_b64 v[12:13], 0
    v_mov_b64 v[14:15], 0
    s_nop 0
    v_mov_b64 v[16:17], 0
    v_mov_b64 v[18:19], 0
    s_waitcnt vmcnt(0)
    s_branch L_CH_LOOP_01
L_ln_74:
    v_max3_u32 v9, v36, v37, v38
    v_max3_u32 v9, v9, v38, v39
    v_max3_u32 v9, v9, v40, v41
    v_max3_u32 v9, v9, v42, v43
    v_max3_u32 v9, v9, v44, v45
    v_max3_u32 v9, v9, v46, v47
    v_max3_u32 v9, v9, v72, v73
    v_max3_u32 v9, v9, v74, v75
    v_max3_u32 v9, v9, v76, v77
    v_max3_u32 v9, v9, v78, v79
    v_cmp_eq_u32 vcc, -1, v9
    s_nop 0
    s_cbranch_vccz L_CH_LGO_01
    s_cmp_ge_u32 s60, 0x100000
    s_movk_i32 s62, 15
    s_cbranch_scc1 L_ABORT
    s_sub_u32 s63, s65, s2
    s_mov_b32 m0, 131072
    s_add_u32 s64, s63, 4096
    buffer_load_dwordx4 v1, s[4:7], s63 offen offset:0 sc1 lds
    buffer_load_dwordx4 v1, s[4:7], s63 offen offset:1024 sc1 lds
    buffer_load_dwordx4 v1, s[4:7], s63 offen offset:2048 sc1 lds
    buffer_load_dwordx4 v1, s[4:7], s63 offen offset:3072 sc1 lds
    s_mov_b32 m0, 135168
    s_nop 0
    buffer_load_dwordx4 v1, s[4:7], s64 offen sc1 lds
    v_mov_b64 v[12:13], 0
    v_mov_b64 v[14:15], 0
    v_mov_b64 v[16:17], 0
    v_mov_b64 v[18:19], 0
    s_waitcnt vmcnt(0)
    s_branch L_CH_LOOP_01
L_CH_RETRY_01:
    s_mov_b32 s60, 0
    s_sleep 1
    s_sleep 1
    s_mov_b32 m0, s85
    s_add_u32 s64, s98, s99
    buffer_load_dwordx4 v1, s[4:7], s98 offen sc1 lds
    s_add_u32 m0, s85, s99
    s_mov_b64 exec, 0xffff
    buffer_load_dwordx4 v1, s[4:7], s64 offen sc1 lds
    s_mov_b64 exec, -1
    s_branch L_CH_RETRY2_01
L_CH_RETRY1_01:
    s_mov_b32 s63, s89
    s_mov_b32 m0, 136192
    s_add_u32 s64, s63, 4096
    buffer_load_dwordx4 v1, s[4:7], s63 offen offset:0 sc1 lds
    buffer_load_dwordx4 v1, s[4:7], s63 offen offset:1024 sc1 lds
    buffer_load_dwordx4 v1, s[4:7], s63 offen offset:2048 sc1 lds
    buffer_load_dwordx4 v1, s[4:7], s63 offen offset:3072 sc1 lds
    s_mov_b32 m0, 140288
    s_nop 0
    buffer_load_dwordx4 v1, s[4:7], s64 offen sc1 lds
L_CH_RETRY2_01:
    s_waitcnt vmcnt(0)
    ds_read_b128 v[64:67], v1 offset:5120
    ds_read_b128 v[68:71], v1 offset:6144
    ds_read_b128 v[48:51], v1 offset:7168
    ds_read_b128 v[56:59], v1 offset:8192
    ds_read_b128 v[60:63], v1 offset:9216
    s_waitcnt lgkmcnt(0)
L_CH_RETRY3_01:
    v_max3_u32 v9, v64, v65, v66
    v_max_u32 v9, v9, v67
    v_max3_u32 v9, v9, v68, v69
    v_max3_u32 v9, v9, v70, v71
    v_max3_u32 v9, v9, v48, v49
    v_max3_u32 v9, v9, v50, v51
    v_max3_u32 v9, v9, v56, v57
    v_max3_u32 v9, v9, v58, v59
    v_max3_u32 v9, v9, v60, v61
    v_max3_u32 v9, v9, v62, v63
    v_cmp_eq_u32 vcc, -1, v9
    s_nop 0
    s_cbranch_vccz L_CH_REDO_01
    s_add_u32 s60, s60, 1
    s_cmp_lt_u32 s60, 0x100000
    s_cbranch_scc1 L_CH_RETRY1_01
    s_movk_i32 s62, 13
    s_branch L_ABORT
L_CH_REDO_01:
    v_mov_b64 v[12:13], 0
    v_mov_b64 v[14:15], 0
    s_nop 1
    v_smfmac_f32_16x16x64_bf16 v[12:15], v[36:39], a[0:7], v10
    v_smfmac_f32_16x16x64_bf16 v[12:15], v[40:43], a[16:23], v10
    v_smfmac_f32_16x16x64_bf16 v[12:15], v[44:47], a[32:39], v10
    v_smfmac_f32_16x16x64_bf16 v[12:15], v[72:75], a[48:55], v10
    v_smfmac_f32_16x16x64_bf16 v[12:15], v[76:79], a[64:71], v10
    v_smfmac_f32_16x16x64_bf16 v[12:15], v[56:59], a[128:135], v10
    v_smfmac_f32_16x16x64_bf16 v[12:15], v[60:63], a[144:151], v10
    v_smfmac_f32_16x16x64_bf16 v[12:15], v[64:67], a[80:87], v10
    v_smfmac_f32_16x16x64_bf16 v[12:15], v[68:71], a[96:103], v10
    v_smfmac_f32_16x16x64_bf16 v[12:15], v[48:51], a[112:119], v10
    s_branch L_CH_C_01
L_CH_LAST_01:
    buffer_store_dwordx4 v[28:31], v1, s[4:7], s77 offen sc1
    s_add_u32 s77, s77, 131072
    s_waitcnt vmcnt(0)
    v_mov_b32 v62, 0
    v_mov_b32 v63, 64
    s_mov_b64 exec, 1
    buffer_store_dword v63, v62, s[4:7], s78 offen sc1
    s_mov_b64 exec, -1
    s_branch L_END2
L_CH_REDX_01:
    buffer_load_dwordx4 v[52:55], v1, s[4:7], s80 offen offset:0 sc1
    buffer_load_dwordx4 v[56:59], v1, s[4:7], s80 offen offset:1024 sc1
    buffer_load_dwordx4 v[60:63], v1, s[4:7], s80 offen offset:2048 sc1
    buffer_load_dwordx4 v[64:67], v1, s[4:7], s80 offen offset:3072 sc1
    s_add_u32 s60, s60, 1
    s_cmp_lt_u32 s60, 0x100000
    s_cbranch_scc1 L_CH_RED_01
    s_movk_i32 s62, 14
    s_branch L_ABORT
L_kv_71:
    v_bfe_u32 v52, v1, 4, 1
    v_lshlrev_b32 v52, 5, v52
    v_add_u32 v52, s46, v52
    v_add_u32 v52, 64, v52
    v_lshlrev_b32 v52, 6, v52
    s_mov_b32 s60, 0
L_pf_75:
    buffer_load_dword v53, v52, s[4:7], 0 offen sc1
    s_waitcnt vmcnt(0)
    v_cmp_gt_u32 vcc, s69, v53
    s_nop 0
    s_cbranch_vccz L_pfd_76
    s_sleep 1
    s_add_u32 s60, s60, 1
    s_cmp_lt_u32 s60, 0x100000
    s_cbranch_scc1 L_pf_75
    s_movk_i32 s62, 11
    s_branch L_ABORT
L_pfd_76:
    v_readlane_b32 s68, v53, 0
    v_readlane_b32 s62, v53, 1
    s_nop 0
    s_min_u32 s68, s68, s62
    s_branch L_kvr_72
L_kv_69:
    v_bfe_u32 v52, v1, 4, 1
    v_lshlrev_b32 v52, 5, v52
    v_add_u32 v52, s46, v52
    v_add_u32 v52, 64, v52
    v_lshlrev_b32 v52, 6, v52
    s_mov_b32 s60, 0
L_pf_77:
    buffer_load_dword v53, v52, s[4:7], 0 offen sc1
    s_waitcnt vmcnt(0)
    v_cmp_gt_u32 vcc, s69, v53
    s_nop 0
    s_cbranch_vccz L_pfd_78
    s_sleep 1
    s_add_u32 s60, s60, 1
    s_cmp_lt_u32 s60, 0x100000
    s_cbranch_scc1 L_pf_77
    s_movk_i32 s62, 11
    s_branch L_ABORT
L_pfd_78:
    v_readlane_b32 s68, v53, 0
    v_readlane_b32 s62, v53, 1
    s_nop 0
    s_min_u32 s68, s68, s62
    s_branch L_kvr_70
L_CH_FIRST_11:
    ds_read_b128 v[36:39], v1 offset:0
    ds_read_b128 v[40:43], v1 offset:1024
    ds_read_b128 v[44:47], v1 offset:2048
    ds_read_b128 v[72:75], v1 offset:3072
    ds_read_b128 v[76:79], v1 offset:4096
    s_waitcnt lgkmcnt(4)
    v_smfmac_f32_16x16x64_bf16 v[12:15], v[36:39], a[0:7], v10
    s_waitcnt lgkmcnt(3)
    v_smfmac_f32_16x16x64_bf16 v[12:15], v[40:43], a[16:23], v10
    s_waitcnt lgkmcnt(2)
    v_smfmac_f32_16x16x64_bf16 v[12:15], v[44:47], a[32:39], v10
    s_waitcnt lgkmcnt(1)
    v_smfmac_f32_16x16x64_bf16 v[12:15], v[72:75], a[48:55], v10
    s_waitcnt lgkmcnt(0)
    v_smfmac_f32_16x16x64_bf16 v[12:15], v[76:79], a[64:71], v10
    v_smfmac_f32_16x16x64_bf16 v[16:19], v[36:39], a[8:15], v10
    v_smfmac_f32_16x16x64_bf16 v[16:19], v[40:43], a[24:31], v10
    v_smfmac_f32_16x16x64_bf16 v[16:19], v[44:47], a[40:47], v10
    v_smfmac_f32_16x16x64_bf16 v[16:19], v[72:75], a[56:63], v10
    v_smfmac_f32_16x16x64_bf16 v[16:19], v[76:79], a[72:79], v10
    v_smfmac_f32_16x16x64_bf16 v[28:31], v[36:39], v[56:63], v10
    ds_read_b128 v[56:59], v2 offset:51200
    ds_read_b128 v[60:63], v2 offset:52224
    v_smfmac_f32_16x16x64_bf16 v[20:23], v[36:39], v[64:71], v10
    v_xor_b32 v2, 0x10000, v2
    ds_read_b128 v[64:67], v2 offset:0
    ds_read_b128 v[68:71], v2 offset:1024
    v_smfmac_f32_16x16x64_bf16 v[32:35], v[36:39], v[48:55], v10
    ds_read_b128 v[48:51], v2 offset:2048
    ds_read_b128 v[52:55], v2 offset:3072
    v_smfmac_f32_16x16x64_bf16 v[20:23], v[40:43], a[208:215], v10
    s_waitcnt lgkmcnt(4)
    v_smfmac_f32_16x16x64_bf16 v[24:27], v[36:39], v[56:63], v10
    ds_read_b128 v[56:59], v2 offset:16384
    ds_read_b128 v[60:63], v2 offset:17408
    v_smfmac_f32_16x16x64_bf16 v[24:27], v[40:43], a[216:223], v10
    s_waitcnt lgkmcnt(4)
    v_smfmac_f32_16x16x64_bf16 v[28:31], v[40:43], v[64:71], v10
    ds_read_b128 v[64:67], v2 offset:18432
    ds_read_b128 v[68:71], v2 offset:19456
    v_smfmac_f32_16x16x64_bf16 v[20:23], v[44:47], a[224:231], v10
    s_waitcnt lgkmcnt(4)
    v_smfmac_f32_16x16x64_bf16 v[32:35], v[40:43], v[48:55], v10
    ds_read_b128 v[48:51], v2 offset:32768
    ds_read_b128 v[52:55], v2 offset:33792
    v_smfmac_f32_16x16x64_bf16 v[24:27], v[44:47], a[232:239], v10
    s_waitcnt lgkmcnt(4)
    v_smfmac_f32_16x16x64_bf16 v[28:31], v[44:47], v[56:63], v10
    ds_read_b128 v[56:59], v2 offset:34816
    ds_read_b128 v[60:63], v2 offset:35840
    s_waitcnt lgkmcnt(4)
    v_smfmac_f32_16x16x64_bf16 v[32:35], v[44:47], v[64:71], v10
    ds_read_b128 v[64:67], v2 offset:49152
    ds_read_b128 v[68:71], v2 offset:50176
    s_waitcnt lgkmcnt(4)
    v_smfmac_f32_16x16x64_bf16 v[28:31], v[72:75], v[48:55], v10
    ds_read_b128 v[48:51], v2 offset:51200
    ds_read_b128 v[52:55], v2 offset:52224
    s_waitcnt lgkmcnt(4)
    v_smfmac_f32_16x16x64_bf16 v[32:35], v[72:75], v[56:63], v10
    s_barrier
    s_mov_b32 s69, 2
    ds_read_b128 v[56:59], v1 offset:8192
    ds_read_b128 v[60:63], v1 offset:9216
    s_waitcnt lgkmcnt(4)
    v_smfmac_f32_16x16x64_bf16 v[28:31], v[76:79], v[64:71], v10
    ds_read_b128 v[64:67], v1 offset:5120
    ds_read_b128 v[68:71], v1 offset:6144
    s_waitcnt lgkmcnt(4)
    v_smfmac_f32_16x16x64_bf16 v[32:35], v[76:79], v[48:55], v10
    ds_read_b128 v[48:51], v1 offset:7168
    v_smfmac_f32_16x16x64_bf16 v[20:23], v[72:75], v[144:151], v10
    s_waitcnt lgkmcnt(4)
    v_smfmac_f32_16x16x64_bf16 v[12:15], v[56:59], a[128:135], v10
    s_waitcnt lgkmcnt(3)
    v_smfmac_f32_16x16x64_bf16 v[12:15], v[60:63], a[144:151], v10
    s_waitcnt lgkmcnt(2)
    v_smfmac_f32_16x16x64_bf16 v[12:15], v[64:67], a[80:87], v10
    s_waitcnt lgkmcnt(1)
    v_smfmac_f32_16x16x64_bf16 v[12:15], v[68:71], a[96:103], v10
    s_waitcnt lgkmcnt(0)
    v_smfmac_f32_16x16x64_bf16 v[12:15], v[48:51], a[112:119], v10
    s_cmp_lt_u32 s68, s69
    s_cbranch_scc1 L_kv_79
L_kvr_80:
    v_smfmac_f32_16x16x64_bf16 v[24:27], v[72:75], v[152:159], v10
    v_smfmac_f32_16x16x64_bf16 v[20:23], v[76:79], v[160:167], v10
    v_smfmac_f32_16x16x64_bf16 v[24:27], v[76:79], v[168:175], v10
    s_branch L_CH_C_11
    .p2align 6
L_CH_B1_11:
    s_barrier
L_CH_LOOP_11:
    ds_read_b128 v[36:39], v1 offset:0
    ds_read_b128 v[40:43], v1 offset:1024
    ds_read_b128 v[44:47], v1 offset:2048
    ds_read_b128 v[72:75], v1 offset:3072
    ds_read_b128 v[76:79], v1 offset:4096
L_CH_A1_11:
    s_waitcnt lgkmcnt(4)
    v_smfmac_f32_16x16x64_bf16 v[12:15], v[36:39], a[0:7], v10
    s_waitcnt lgkmcnt(3)
    v_smfmac_f32_16x16x64_bf16 v[12:15], v[40:43], a[16:23], v10
    s_waitcnt lgkmcnt(2)
    v_smfmac_f32_16x16x64_bf16 v[12:15], v[44:47], a[32:39], v10
    s_waitcnt lgkmcnt(1)
    v_smfmac_f32_16x16x64_bf16 v[12:15], v[72:75], a[48:55], v10
    s_waitcnt lgkmcnt(0)
    v_smfmac_f32_16x16x64_bf16 v[12:15], v[76:79], a[64:71], v10
    v_smfmac_f32_16x16x64_bf16 v[16:19], v[36:39], a[8:15], v10
    v_smfmac_f32_16x16x64_bf16 v[16:19], v[40:43], a[24:31], v10
    s_add_u32 s69, s61, 2
    s_min_u32 s69, s69, 64
    s_mov_b32 m0, s85
    s_add_u32 s64, s98, s99
    s_nop 1
    v_cmp_u_f32 vcc, v12, v13
    v_cmp_u_f32 s[62:63], v14, v15
    v_smfmac_f32_16x16x64_bf16 v[16:19], v[44:47], a[40:47], v10
    s_or_b64 vcc, vcc, s[62:63]
    s_cbranch_scc1 L_CH_LRETRY_11
L_CH_LGO_11:
    buffer_load_dwordx4 v1, s[4:7], s98 offen sc1 lds
    s_add_u32 m0, s85, s99
    s_mov_b64 exec, 0xffff
    buffer_load_dwordx4 v1, s[4:7], s64 offen sc1 lds
    s_mov_b64 exec, -1
    v_smfmac_f32_16x16x64_bf16 v[16:19], v[72:75], a[56:63], v10
    v_smfmac_f32_16x16x64_bf16 v[16:19], v[76:79], a[72:79], v10
    v_smfmac_f32_16x16x64_bf16 v[28:31], v[36:39], v[56:63], v10
    ds_read_b128 v[56:59], v2 offset:51200
    ds_read_b128 v[60:63], v2 offset:52224
    v_smfmac_f32_16x16x64_bf16 v[20:23], v[36:39], v[64:71], v10
    v_xor_b32 v2, 0x10000, v2
    ds_read_b128 v[64:67], v2 offset:0
    ds_read_b128 v[68:71], v2 offset:1024
    v_smfmac_f32_16x16x64_bf16 v[32:35], v[36:39], v[48:55], v10
    ds_read_b128 v[48:51], v2 offset:2048
    ds_read_b128 v[52:55], v2 offset:3072
    v_smfmac_f32_16x16x64_bf16 v[20:23], v[40:43], a[208:215], v10
    v_mov_b32 v9, s61
    s_mov_b64 exec, 1
    buffer_store_dword v9, off, s[4:7], s78 sc1
    s_mov_b64 exec, -1
    s_waitcnt lgkmcnt(4)
    v_smfmac_f32_16x16x64_bf16 v[24:27], v[36:39], v[56:63], v10
    ds_read_b128 v[56:59], v2 offset:16384
    ds_read_b128 v[60:63], v2 offset:17408
    v_smfmac_f32_16x16x64_bf16 v[24:27], v[40:43], a[216:223], v10
    s_waitcnt lgkmcnt(4)
    v_smfmac_f32_16x16x64_bf16 v[28:31], v[40:43], v[64:71], v10
    ds_read_b128 v[64:67], v2 offset:18432
    ds_read_b128 v[68:71], v2 offset:19456
    v_smfmac_f32_16x16x64_bf16 v[20:23], v[44:47], a[224:231], v10
    s_waitcnt lgkmcnt(4)
    v_smfmac_f32_16x16x64_bf16 v[32:35], v[40:43], v[48:55], v10
    ds_read_b128 v[48:51], v2 offset:32768
    ds_read_b128 v[52:55], v2 offset:33792
    v_smfmac_f32_16x16x64_bf16 v[24:27], v[44:47], a[232:239], v10
    s_waitcnt lgkmcnt(4)
    v_smfmac_f32_16x16x64_bf16 v[28:31], v[44:47], v[56:63], v10
    ds_read_b128 v[56:59], v2 offset:34816
    ds_read_b128 v[60:63], v2 offset:35840
    s_waitcnt lgkmcnt(4)
    v_smfmac_f32_16x16x64_bf16 v[32:35], v[44:47], v[64:71], v10
    ds_read_b128 v[64:67], v2 offset:49152
    ds_read_b128 v[68:71], v2 offset:50176
    s_waitcnt lgkmcnt(4)
    v_smfmac_f32_16x16x64_bf16 v[28:31], v[72:75], v[48:55], v10
    ds_read_b128 v[48:51], v2 offset:51200
    ds_read_b128 v[52:55], v2 offset:52224
    s_waitcnt lgkmcnt(4)
    v_smfmac_f32_16x16x64_bf16 v[32:35], v[72:75], v[56:63], v10
    s_waitcnt vmcnt(1)
    s_barrier
    ds_read_b128 v[56:59], v1 offset:8192
    ds_read_b128 v[60:63], v1 offset:9216
    s_waitcnt lgkmcnt(4)
    v_smfmac_f32_16x16x64_bf16 v[28:31], v[76:79], v[64:71], v10
    ds_read_b128 v[64:67], v1 offset:5120
    ds_read_b128 v[68:71], v1 offset:6144
    s_waitcnt lgkmcnt(4)
    v_smfmac_f32_16x16x64_bf16 v[32:35], v[76:79], v[48:55], v10
    ds_read_b128 v[48:51], v1 offset:7168
    v_smfmac_f32_16x16x64_bf16 v[20:23], v[72:75], v[144:151], v10
    s_waitcnt lgkmcnt(4)
    v_smfmac_f32_16x16x64_bf16 v[12:15], v[56:59], a[128:135], v10
    s_waitcnt lgkmcnt(3)
    v_smfmac_f32_16x16x64_bf16 v[12:15], v[60:63], a[144:151], v10
    s_waitcnt lgkmcnt(2)
    v_smfmac_f32_16x16x64_bf16 v[12:15], v[64:67], a[80:87], v10
    s_waitcnt lgkmcnt(1)
    v_smfmac_f32_16x16x64_bf16 v[12:15], v[68:71], a[96:103], v10
    s_waitcnt lgkmcnt(0)
    v_smfmac_f32_16x16x64_bf16 v[12:15], v[48:51], a[112:119], v10
    s_cmp_lt_u32 s68, s69
    s_cbranch_scc1 L_kv_81
L_kvr_82:
    v_smfmac_f32_16x16x64_bf16 v[24:27], v[72:75], v[152:159], v10
    v_smfmac_f32_16x16x64_bf16 v[20:23], v[76:79], v[160:167], v10
    v_smfmac_f32_16x16x64_bf16 v[24:27], v[76:79], v[168:175], v10
    s_nop 2
    v_cmp_u_f32 vcc, v12, v13
    v_cmp_u_f32 s[62:63], v14, v15
    s_nop 0
    s_or_b64 vcc, vcc, s[62:63]
    s_cbranch_scc1 L_CH_RETRY_11
L_CH_C_11:
    v_smfmac_f32_16x16x64_bf16 v[16:19], v[64:67], a[88:95], v10
    buffer_load_dwordx4 v[72:75], v1, s[4:7], s76 offen sc1
    v_smfmac_f32_16x16x64_bf16 v[16:19], v[68:71], a[104:111], v10
    v_smfmac_f32_16x16x64_bf16 v[16:19], v[48:51], a[120:127], v10
    buffer_load_dwordx4 v[76:79], v1, s[4:7], s76 offen offset:1024 sc1
    s_add_u32 s76, s76, 262144
    v_smfmac_f32_16x16x64_bf16 v[16:19], v[56:59], a[136:143], v10
    v_pk_add_f32 v[12:13], v[12:13], v[14:15]
    v_smfmac_f32_16x16x64_bf16 v[16:19], v[60:63], a[152:159], v10
    ds_read_b128 v[36:39], v0 offset:0
    ds_read_b128 v[40:43], v0 offset:1024
    v_cvt_pk_bf16_f32 v14, v12, v13
    v_smfmac_f32_16x16x64_bf16 v[20:23], v[64:67], v[176:183], v10
    ds_read_b128 v[44:47], v0 offset:2048
    ds_read_b128 v[52:55], v0 offset:3072
    v_smfmac_f32_16x16x64_bf16 v[24:27], v[64:67], v[184:191], v10
    v_smfmac_f32_16x16x64_bf16 v[20:23], v[68:71], v[192:199], v10
    v_pk_add_f32 v[16:17], v[16:17], v[18:19]
    v_smfmac_f32_16x16x64_bf16 v[24:27], v[68:71], v[200:207], v10
    v_cvt_pk_bf16_f32 v18, v16, v17
    v_smfmac_f32_16x16x64_bf16 v[20:23], v[48:51], v[208:215], v10
    ds_write_b32 v4, v14 offset:0
    ds_write_b32 v4, v18 offset:528
    v_smfmac_f32_16x16x64_bf16 v[24:27], v[48:51], v[216:223], v10
    v_smfmac_f32_16x16x64_bf16 v[20:23], v[56:59], v[224:231], v10
    s_mov_b32 m0, s74
    s_xor_b32 s74, s74, s37
    buffer_load_dwordx4 v1, s[4:7], s73 offen sc1 lds
    v_smfmac_f32_16x16x64_bf16 v[24:27], v[56:59], v[232:239], v10
    v_smfmac_f32_16x16x64_bf16 v[20:23], v[60:63], v[240:247], v10
    buffer_load_dwordx4 v1, s[4:7], s73 offen offset:1024 sc1 lds
    s_add_u32 s73, s73, 262144
    v_smfmac_f32_16x16x64_bf16 v[24:27], v[60:63], v[248:255], v10
    s_waitcnt lgkmcnt(0)
    s_barrier
    ds_read_b64_tr_b16 v[12:13], v5 offset:0
    ds_read_b64_tr_b16 v[14:15], v5 offset:272
    v_smfmac_f32_16x16x64_bf16 v[28:31], v[64:67], v[80:87], v10
    ds_read_b64_tr_b16 v[16:17], v5 offset:1056
    ds_read_b64_tr_b16 v[18:19], v5 offset:1328
    v_pk_add_f32 v[20:21], v[20:21], v[22:23]
    v_smfmac_f32_16x16x64_bf16 v[32:35], v[64:67], v[88:95], v10
    ds_read_b64_tr_b16 v[64:65], v5 offset:2112
    ds_read_b64_tr_b16 v[66:67], v5 offset:2384
    v_pk_add_f32 v[24:25], v[24:25], v[26:27]
    v_cvt_pk_bf16_f32 v22, v20, v21
    v_smfmac_f32_16x16x64_bf16 v[28:31], v[68:71], v[96:103], v10
    v_cvt_pk_bf16_f32 v26, v24, v25
    ds_write_b32 v4, v22 offset:26624
    ds_write_b32 v4, v26 offset:27152
    v_smfmac_f32_16x16x64_bf16 v[32:35], v[68:71], v[104:111], v10
    ds_read_b64_tr_b16 v[68:69], v5 offset:3168
    ds_read_b64_tr_b16 v[70:71], v5 offset:3440
    v_smfmac_f32_16x16x64_bf16 v[28:31], v[48:51], v[112:119], v10
    v_smfmac_f32_16x16x64_bf16 v[32:35], v[48:51], v[120:127], v10
    ds_read_b128 v[48:51], v0 offset:4096
    v_smfmac_f32_16x16x64_bf16 v[28:31], v[56:59], v[128:135], v10
    v_smfmac_f32_16x16x64_bf16 v[32:35], v[56:59], v[136:143], v10
    ds_read_b128 v[56:59], v0 offset:5120
    v_smfmac_f32_16x16x64_bf16 v[28:31], v[60:63], a[240:247], v10
    v_smfmac_f32_16x16x64_bf16 v[32:35], v[60:63], a[248:255], v10
    s_waitcnt lgkmcnt(10)
    v_mfma_f32_16x16x32_bf16 v[60:63], v[36:39], v[12:15], 0
    ds_read_b128 v[36:39], v0 offset:6144
    s_waitcnt lgkmcnt(9)
    v_mfma_f32_16x16x32_bf16 v[60:63], v[40:43], v[16:19], v[60:63]
    ds_read_b128 v[40:43], v0 offset:7168
    s_waitcnt lgkmcnt(8)
    v_mfma_f32_16x16x32_bf16 v[60:63], v[44:47], v[64:67], v[60:63]
    v_cvt_pk_bf16_f32 v28, v28, v29
    v_cvt_pk_bf16_f32 v29, v30, v31
    s_waitcnt lgkmcnt(4)
    v_mfma_f32_16x16x32_bf16 v[60:63], v[52:55], v[68:71], v[60:63]
    v_cvt_pk_bf16_f32 v30, v32, v33
    v_cvt_pk_bf16_f32 v31, v34, v35
    s_cmp_eq_u32 s61, 63
    s_barrier
    s_cbranch_scc1 L_CH_LAST_11
    ds_read_b64_tr_b16 v[44:45], v5 offset:26624
    ds_read_b64_tr_b16 v[46:47], v5 offset:26896
    ds_read_b64_tr_b16 v[52:53], v5 offset:27680
    ds_read_b64_tr_b16 v[54:55], v5 offset:27952
    s_waitcnt lgkmcnt(7)
    v_mfma_f32_16x16x32_bf16 v[20:23], v[48:51], v[12:15], 0
    ds_read_b64_tr_b16 v[48:49], v5 offset:28736
    ds_read_b64_tr_b16 v[50:51], v5 offset:29008
    s_waitcnt lgkmcnt(8)
    v_mfma_f32_16x16x32_bf16 v[20:23], v[56:59], v[16:19], v[20:23]
    ds_read_b64_tr_b16 v[56:57], v5 offset:29792
    ds_read_b64_tr_b16 v[58:59], v5 offset:30064
    s_waitcnt lgkmcnt(9)
    v_mfma_f32_16x16x32_bf16 v[20:23], v[36:39], v[64:67], v[20:23]
    buffer_store_dwordx4 v[28:31], v1, s[4:7], s77 offen sc1
    s_waitcnt lgkmcnt(8)
    v_mfma_f32_16x16x32_bf16 v[20:23], v[40:43], v[68:71], v[20:23]
    v_xor_b32 v0, s75, v0
    s_waitcnt lgkmcnt(6)
    v_mfma_f32_16x16x32_bf16 v[24:27], v[44:47], v[12:15], 0
    v_max3_f32 v32, v60, v61, v62
    s_waitcnt lgkmcnt(4)
    v_mfma_f32_16x16x32_bf16 v[24:27], v[52:55], v[16:19], v[24:27]
    s_waitcnt lgkmcnt(2)
    v_mfma_f32_16x16x32_bf16 v[24:27], v[48:51], v[64:67], v[24:27]
    s_waitcnt lgkmcnt(0)
    v_mfma_f32_16x16x32_bf16 v[24:27], v[56:59], v[68:71], v[24:27]
    v_max3_f32 v32, v32, v63, v20
    v_max3_f32 v33, v21, v22, v23
    v_mov_b64 v[18:19], s[8:9]
    s_add_u32 s77, s77, 131072
    v_mov_b64 v[44:45], 0
    v_mov_b64 v[46:47], 0
    v_mov_b64 v[48:49], s[38:39]
    v_mov_b64 v[50:51], s[38:39]
    v_max_f32 v32, v32, v33
    v_max3_f32 v33, v32, v24, v25
    v_max3_f32 v32, v32, v24, v25
    v_mov_b64 v[56:57], 0
    v_mov_b64 v[58:59], 0
    v_permlane16_swap_b32 v32, v33
    v_max_f32 v34, v32, v33
    v_max_f32 v35, v32, v33
    v_mov_b64 v[64:65], 0
    v_mov_b64 v[66:67], 0
    v_permlane32_swap_b32 v34, v35
    v_max_f32 v32, v34, v35
    v_mul_f32 v32, s82, v32
    v_pk_fma_f32 v[60:61], v[60:61], s[82:83], v[32:33] op_sel_hi:[1,0,0] neg_lo:[0,0,1] neg_hi:[0,0,1]
    v_pk_fma_f32 v[62:63], v[62:63], s[82:83], v[32:33] op_sel_hi:[1,0,0] neg_lo:[0,0,1] neg_hi:[0,0,1]
    v_pk_fma_f32 v[20:21], v[20:21], s[82:83], v[32:33] op_sel_hi:[1,0,0] neg_lo:[0,0,1] neg_hi:[0,0,1]
    v_pk_fma_f32 v[22:23], v[22:23], s[82:83], v[32:33] op_sel_hi:[1,0,0] neg_lo:[0,0,1] neg_hi:[0,0,1]
    v_pk_fma_f32 v[24:25], v[24:25], s[82:83], v[32:33] op_sel_hi:[1,0,0] neg_lo:[0,0,1] neg_hi:[0,0,1]
    v_exp_f32 v60, v60
    v_exp_f32 v61, v61
    v_exp_f32 v62, v62
    v_cvt_pk_bf16_f32 v12, v60, v61
    v_exp_f32 v63, v63
    v_exp_f32 v20, v20
    v_cvt_pk_bf16_f32 v13, v62, v63
    v_exp_f32 v21, v21
    v_exp_f32 v22, v22
    v_cvt_pk_bf16_f32 v14, v20, v21
    v_exp_f32 v23, v23
    v_exp_f32 v24, v24
    v_cvt_pk_bf16_f32 v15, v22, v23
    v_exp_f32 v25, v25
    s_waitcnt vmcnt(3)
    v_mfma_f32_16x16x32_bf16 v[36:39], v[72:75], v[12:15], 0
    v_cvt_pk_bf16_f32 v16, v24, v25
    v_cvt_pk_bf16_f32 v17, v24, v25
    v_mfma_f32_16x16x32_bf16 v[40:43], v[76:79], v[12:15], 0
    s_add_u32 s81, s81, 16384
    s_and_b32 s81, s81, 0xffff
    s_add_u32 s61, s61, 1
    v_mfma_f32_16x16x16_bf16 v[36:39], v[28:29], v[16:17], v[36:39]
    v_mov_b64 v[68:69], 0
    v_mov_b64 v[70:71], 0
    v_mfma_f32_16x16x16_bf16 v[40:43], v[30:31], v[16:17], v[40:43]
    v_mfma_f32_16x16x32_bf16 v[24:27], v[12:15], v[48:51], 0
    v_xor_b32 v2, 0x10000, v2
    ds_read_b128 v[72:75], v2 offset:0
    ds_read_b128 v[76:79], v2 offset:1024
    v_mov_b64 v[52:53], 0
    v_mov_b64 v[54:55], 0
    s_mov_b64 exec, s[94:95]
    v_cvt_pk_bf16_f32 v36, v36, v37
    v_cvt_pk_bf16_f32 v37, v38, v39
    v_cvt_pk_bf16_f32 v38, v40, v41
    v_cvt_pk_bf16_f32 v39, v42, v43
    ds_write_b128 v6, v[36:39]
    s_mov_b64 exec, -1
    v_mfma_f32_16x16x16_bf16 v[24:27], v[16:17], v[18:19], v[24:27]
    ds_read_b128 v[12:15], v2 offset:2048
    ds_read_b128 v[16:19], v2 offset:3072
    s_add_u32 s63, s90, s81
    s_add_u32 s91, s91, 32768
    s_add_u32 s98, s98, 32768
    s_add_u32 s89, s89, 32768
    s_add_u32 s65, s88, s81
    s_mov_b32 s60, 0
    v_rcp_f32 v60, v24
    v_rcp_f32 v61, v25
    s_waitcnt lgkmcnt(2)
    s_barrier
    ds_read_b128 v[48:51], v1 offset:0
    ds_read_b128 v[32:35], v1 offset:1024
    s_waitcnt lgkmcnt(1)
    v_smfmac_f32_16x16x64_bf16 v[68:71], v[48:51], v[72:79], v10
    ds_read_b128 v[72:75], v2 offset:16384
    ds_read_b128 v[76:79], v2 offset:17408
    v_smfmac_f32_16x16x64_bf16 v[44:47], v[48:51], v[12:19], v10
    ds_read_b128 v[12:15], v2 offset:18432
    ds_read_b128 v[16:19], v2 offset:19456
    s_waitcnt lgkmcnt(4)
    v_smfmac_f32_16x16x64_bf16 v[68:71], v[32:35], a[200:207], v10
    v_smfmac_f32_16x16x64_bf16 v[44:47], v[32:35], a[176:183], v10
    v_smfmac_f32_16x16x64_bf16 v[52:55], v[48:51], a[160:167], v10
    v_smfmac_f32_16x16x64_bf16 v[52:55], v[32:35], a[184:191], v10
    v_smfmac_f32_16x16x64_bf16 v[56:59], v[48:51], a[168:175], v10
    v_smfmac_f32_16x16x64_bf16 v[56:59], v[32:35], a[192:199], v10
    s_waitcnt lgkmcnt(2)
    v_smfmac_f32_16x16x64_bf16 v[64:67], v[48:51], v[72:79], v10
    s_waitcnt lgkmcnt(0)
    v_smfmac_f32_16x16x64_bf16 v[64:67], v[32:35], v[12:19], v10
    v_pk_add_f32 v[68:69], v[68:69], v[70:71]
    v_pk_add_f32 v[44:45], v[44:45], v[46:47]
    v_pk_add_f32 v[52:53], v[52:53], v[54:55]
    s_nop 0
    v_pk_add_f32 v[56:57], v[56:57], v[58:59]
    v_pk_mul_f32 v[68:69], v[68:69], v[60:61]
    v_pk_mul_f32 v[44:45], v[44:45], v[60:61]
    v_pk_mul_f32 v[52:53], v[52:53], v[60:61]
    v_pk_mul_f32 v[56:57], v[56:57], v[60:61]
    v_pk_add_f32 v[64:65], v[64:65], v[66:67]
    v_cvt_pk_bf16_f32 v40, v68, v69
    v_cvt_pk_bf16_f32 v36, v44, v45
    v_pk_mul_f32 v[64:65], v[64:65], v[60:61]
    buffer_store_dword v40, v8, s[4:7], s79 offen
    v_cvt_pk_bf16_f32 v37, v52, v53
    v_cvt_pk_bf16_f32 v38, v56, v57
    v_cvt_pk_bf16_f32 v39, v64, v65
    buffer_store_dwordx4 v[36:39], v7, s[4:7], s79 offen
    s_xor_b32 s79, s79, s92
    v_mov_b64 v[32:33], 0
    v_mov_b64 v[34:35], 0
    s_min_u32 s62, s0, s1
    s_max_u32 s68, s68, s62
    s_buffer_load_dword s0, s[4:7], s84 glc
    s_buffer_load_dword s1, s[4:7], s36 glc
L_sr_83:
    s_cmp_eq_u32 s72, 0
    s_cbranch_scc1 L_CH_NORED_11
    v_bfe_u32 v62, v1, 4, 1
    v_mov_b32 v63, 0x3f80
    v_lshlrev_b32 v62, 4, v62
    v_lshlrev_b32 v62, v62, v63
    v_cndmask_b32 v20, 0, v62, s[52:53]
    v_cndmask_b32 v21, 0, v62, s[54:55]
    v_cndmask_b32 v22, 0, v62, s[56:57]
    v_cndmask_b32 v23, 0, v62, s[58:59]
    s_sleep 1
    s_sleep 1
    s_sleep 1
    buffer_load_dwordx4 v[36:39], v1, s[4:7], s80 offen offset:0 sc1
    buffer_load_dwordx4 v[40:43], v1, s[4:7], s80 offen offset:1024 sc1
    buffer_load_dwordx4 v[44:47], v1, s[4:7], s80 offen offset:2048 sc1
    buffer_load_dwordx4 v[48:51], v1, s[4:7], s80 offen offset:3072 sc1
    s_sleep 1
    s_sleep 1
    buffer_load_dwordx4 v[52:55], v1, s[4:7], s80 offen offset:0 sc1
    buffer_load_dwordx4 v[56:59], v1, s[4:7], s80 offen offset:1024 sc1
    buffer_load_dwordx4 v[60:63], v1, s[4:7], s80 offen offset:2048 sc1
    buffer_load_dwordx4 v[64:67], v1, s[4:7], s80 offen offset:3072 sc1
L_CH_RED_11:
    s_waitcnt vmcnt(7)
    v_max3_u32 v76, v36, v37, v38
    v_max_u32 v76, v76, v39
    v_mfma_f32_16x16x32_bf16 v[68:71], v[36:39], v[20:23], 0
    s_waitcnt vmcnt(6)
    v_max3_u32 v76, v76, v40, v41
    v_max3_u32 v76, v76, v42, v43
    v_mfma_f32_16x16x32_bf16 v[68:71], v[40:43], v[20:23], v[68:71]
    s_waitcnt vmcnt(5)
    v_max3_u32 v76, v76, v44, v45
    v_max3_u32 v76, v76, v46, v47
    v_mfma_f32_16x16x32_bf16 v[68:71], v[44:47], v[20:23], v[68:71]
    s_waitcnt vmcnt(4)
    v_max3_u32 v76, v76, v48, v49
    v_max3_u32 v76, v76, v50, v51
    v_mfma_f32_16x16x32_bf16 v[68:71], v[48:51], v[20:23], v[68:71]
    v_cmp_eq_u32 vcc, -1, v76
    s_nop 0
    s_cbranch_vccz L_CH_REDOK_11
    buffer_load_dwordx4 v[36:39], v1, s[4:7], s80 offen offset:0 sc1
    buffer_load_dwordx4 v[40:43], v1, s[4:7], s80 offen offset:1024 sc1
    buffer_load_dwordx4 v[44:47], v1, s[4:7], s80 offen offset:2048 sc1
    buffer_load_dwordx4 v[48:51], v1, s[4:7], s80 offen offset:3072 sc1
    s_waitcnt vmcnt(7)
    v_max3_u32 v76, v52, v53, v54
    v_max_u32 v76, v76, v55
    v_mfma_f32_16x16x32_bf16 v[68:71], v[52:55], v[20:23], 0
    s_waitcnt vmcnt(6)
    v_max3_u32 v76, v76, v56, v57
    v_max3_u32 v76, v76, v58, v59
    v_mfma_f32_16x16x32_bf16 v[68:71], v[56:59], v[20:23], v[68:71]
    s_waitcnt vmcnt(5)
    v_max3_u32 v76, v76, v60, v61
    v_max3_u32 v76, v76, v62, v63
    v_mfma_f32_16x16x32_bf16 v[68:71], v[60:63], v[20:23], v[68:71]
    s_waitcnt vmcnt(4)
    v_max3_u32 v76, v76, v64, v65
    v_max3_u32 v76, v76, v66, v67
    v_mfma_f32_16x16x32_bf16 v[68:71], v[64:67], v[20:23], v[68:71]
    v_cmp_eq_u32 vcc, -1, v76
    s_nop 0
    s_cbranch_vccnz L_CH_REDX_11
L_CH_REDOK_11:
    s_nop 5
    v_permlane32_swap_b32 v68, v70
    v_permlane32_swap_b32 v69, v71
    v_pk_add_f32 v[68:69], v[68:69], v[70:71]
    v_cvt_pk_bf16_f32 v20, v68, v69
    s_mov_b64 exec, s[86:87]
    buffer_store_dword v20, v3, s[4:7], s63 offen
    buffer_store_dword v20, v3, s[4:7], s91 offen sc1
    s_mov_b64 exec, -1
    s_barrier
    s_xor_b32 s80, s80, s93
    s_mov_b32 s60, 0
    s_waitcnt vmcnt(2)
    ds_read_b128 v[56:59], v2 offset:32768
    ds_read_b128 v[60:63], v2 offset:33792
    ds_read_b128 v[64:67], v2 offset:49152
    ds_read_b128 v[68:71], v2 offset:50176
    ds_read_b128 v[48:51], v2 offset:34816
    ds_read_b128 v[52:55], v2 offset:35840
    v_mov_b64 v[12:13], 0
    v_mov_b64 v[14:15], 0
    v_mov_b64 v[16:17], 0
    v_mov_b64 v[18:19], 0
    v_mov_b64 v[20:21], 0
    v_mov_b64 v[22:23], 0
    v_mov_b64 v[24:25], 0
    v_mov_b64 v[26:27], 0
    v_mov_b64 v[28:29], 0
    v_mov_b64 v[30:31], 0
    v_mov_b64 v[36:37], -1
    v_mov_b64 v[38:39], -1
    s_sleep 1
    s_sleep 1
    s_sleep 1
    s_mov_b32 m0, s100
    s_add_u32 s64, s65, s99
    buffer_load_dwordx4 v1, s[4:7], s65 offen sc1 lds
    s_add_u32 m0, s100, s99
    s_mov_b64 exec, 0xffff
    buffer_load_dwordx4 v1, s[4:7], s64 offen sc1 lds
    s_mov_b64 exec, -1
    s_nop 11
    s_mov_b32 m0, s100
    s_add_u32 s64, s65, s99
    buffer_load_dwordx4 v1, s[4:7], s65 offen sc1 lds
    s_add_u32 m0, s100, s99
    s_mov_b64 exec, 0xffff
    buffer_load_dwordx4 v1, s[4:7], s64 offen sc1 lds
    s_mov_b64 exec, -1
    s_add_u32 s63, s101, s10
    buffer_store_dwordx4 v[36:39], v1, s[4:7], s101 offen
    s_mov_b64 exec, s[42:43]
    buffer_store_dwordx4 v[36:39], v1, s[4:7], s63 offen
    s_xor_b32 s101, s101, s40
    s_mov_b64 exec, -1
    s_waitcnt vmcnt(4)
    s_barrier
    ds_read_b128 v[36:39], v1 offset:0
    ds_read_b128 v[40:43], v1 offset:1024
    ds_read_b128 v[44:47], v1 offset:2048
    ds_read_b128 v[72:75], v1 offset:3072
    ds_read_b128 v[76:79], v1 offset:4096
    s_branch L_CH_A1_11
L_CH_NORED_11:
    v_mov_b64 v[12:13], 0
    v_mov_b64 v[14:15], 0
    v_mov_b64 v[16:17], 0
    v_mov_b64 v[18:19], 0
    v_mov_b64 v[20:21], 0
    v_mov_b64 v[22:23], 0
    v_mov_b64 v[24:25], 0
    v_mov_b64 v[26:27], 0
    v_mov_b64 v[28:29], 0
    v_mov_b64 v[30:31], 0
    ds_read_b128 v[56:59], v2 offset:32768
    ds_read_b128 v[60:63], v2 offset:33792
    ds_read_b128 v[64:67], v2 offset:49152
    ds_read_b128 v[68:71], v2 offset:50176
    ds_read_b128 v[48:51], v2 offset:34816
    ds_read_b128 v[52:55], v2 offset:35840
    s_barrier
    v_mov_b64 v[36:37], -1
    v_mov_b64 v[38:39], -1
    s_sleep 1
    s_sleep 1
    s_sleep 1
    s_sleep 1
    s_nop 11
    s_mov_b32 m0, s100
    s_add_u32 s64, s65, s99
    buffer_load_dwordx4 v1, s[4:7], s65 offen sc1 lds
    s_add_u32 m0, s100, s99
    s_mov_b64 exec, 0xffff
    buffer_load_dwordx4 v1, s[4:7], s64 offen sc1 lds
    s_mov_b64 exec, -1
    s_nop 11
    s_mov_b32 m0, s100
    s_add_u32 s64, s65, s99
    buffer_load_dwordx4 v1, s[4:7], s65 offen sc1 lds
    s_add_u32 m0, s100, s99
    s_mov_b64 exec, 0xffff
    buffer_load_dwordx4 v1, s[4:7], s64 offen sc1 lds
    s_mov_b64 exec, -1
    s_add_u32 s63, s101, s10
    buffer_store_dwordx4 v[36:39], v1, s[4:7], s101 offen
    s_mov_b64 exec, s[42:43]
    buffer_store_dwordx4 v[36:39], v1, s[4:7], s63 offen
    s_xor_b32 s101, s101, s40
    s_mov_b64 exec, -1
    s_waitcnt vmcnt(4)
    s_barrier
    ds_read_b128 v[36:39], v1 offset:0
    ds_read_b128 v[40:43], v1 offset:1024
    ds_read_b128 v[44:47], v1 offset:2048
    ds_read_b128 v[72:75], v1 offset:3072
    ds_read_b128 v[76:79], v1 offset:4096
    s_branch L_CH_A1_11
L_CH_LRETRY_11:
    s_add_u32 s60, s60, 1
    s_cmp_lg_u32 s60, 1
    s_cbranch_scc1 L_ln_84
    v_mov_b64 v[12:13], 0
    v_mov_b64 v[14:15], 0
    s_nop 0
    v_mov_b64 v[16:17], 0
    v_mov_b64 v[18:19], 0
    s_waitcnt vmcnt(0)
    s_branch L_CH_LOOP_11
L_ln_84:
    v_max3_u32 v9, v36, v37, v38
    v_max3_u32 v9, v9, v38, v39
    v_max3_u32 v9, v9, v40, v41
    v_max3_u32 v9, v9, v42, v43
    v_max3_u32 v9, v9, v44, v45
    v_max3_u32 v9, v9, v46, v47
    v_max3_u32 v9, v9, v72, v73
    v_max3_u32 v9, v9, v74, v75
    v_max3_u32 v9, v9, v76, v77
    v_max3_u32 v9, v9, v78, v79
    v_cmp_eq_u32 vcc, -1, v9
    s_nop 0
    s_cbranch_vccz L_CH_LGO_11
    s_cmp_ge_u32 s60, 0x100000
    s_movk_i32 s62, 15
    s_cbranch_scc1 L_ABORT
    s_sub_u32 s63, s65, s2
    s_mov_b32 m0, 131072
    s_add_u32 s64, s63, 4096
    buffer_load_dwordx4 v1, s[4:7], s63 offen offset:0 sc1 lds
    buffer_load_dwordx4 v1, s[4:7], s63 offen offset:1024 sc1 lds
    buffer_load_dwordx4 v1, s[4:7], s63 offen offset:2048 sc1 lds
    buffer_load_dwordx4 v1, s[4:7], s63 offen offset:3072 sc1 lds
    s_mov_b32 m0, 135168
    s_nop 0
    buffer_load_dwordx4 v1, s[4:7], s64 offen sc1 lds
    v_mov_b64 v[12:13], 0
    v_mov_b64 v[14:15], 0
    v_mov_b64 v[16:17], 0
    v_mov_b64 v[18:19], 0
    s_waitcnt vmcnt(0)
    s_branch L_CH_LOOP_11
L_CH_RETRY_11:
    s_mov_b32 s60, 0
    s_sleep 1
    s_sleep 1
    s_mov_b32 m0, s85
    s_add_u32 s64, s98, s99
    buffer_load_dwordx4 v1, s[4:7], s98 offen sc1 lds
    s_add_u32 m0, s85, s99
    s_mov_b64 exec, 0xffff
    buffer_load_dwordx4 v1, s[4:7], s64 offen sc1 lds
    s_mov_b64 exec, -1
    s_branch L_CH_RETRY2_11
L_CH_RETRY1_11:
    s_mov_b32 s63, s89
    s_mov_b32 m0, 136192
    s_add_u32 s64, s63, 4096
    buffer_load_dwordx4 v1, s[4:7], s63 offen offset:0 sc1 lds
    buffer_load_dwordx4 v1, s[4:7], s63 offen offset:1024 sc1 lds
    buffer_load_dwordx4 v1, s[4:7], s63 offen offset:2048 sc1 lds
    buffer_load_dwordx4 v1, s[4:7], s63 offen offset:3072 sc1 lds
    s_mov_b32 m0, 140288
    s_nop 0
    buffer_load_dwordx4 v1, s[4:7], s64 offen sc1 lds
L_CH_RETRY2_11:
    s_waitcnt vmcnt(0)
    ds_read_b128 v[64:67], v1 offset:5120
    ds_read_b128 v[68:71], v1 offset:6144
    ds_read_b128 v[48:51], v1 offset:7168
    ds_read_b128 v[56:59], v1 offset:8192
    ds_read_b128 v[60:63], v1 offset:9216
    s_waitcnt lgkmcnt(0)
L_CH_RETRY3_11:
    v_max3_u32 v9, v64, v65, v66
    v_max_u32 v9, v9, v67
    v_max3_u32 v9, v9, v68, v69
    v_max3_u32 v9, v9, v70, v71
    v_max3_u32 v9, v9, v48, v49
    v_max3_u32 v9, v9, v50, v51
    v_max3_u32 v9, v9, v56, v57
    v_max3_u32 v9, v9, v58, v59
    v_max3_u32 v9, v9, v60, v61
    v_max3_u32 v9, v9, v62, v63
    v_cmp_eq_u32 vcc, -1, v9
    s_nop 0
    s_cbranch_vccz L_CH_REDO_11
    s_add_u32 s60, s60, 1
    s_cmp_lt_u32 s60, 0x100000
    s_cbranch_scc1 L_CH_RETRY1_11
    s_movk_i32 s62, 13
    s_branch L_ABORT
L_CH_REDO_11:
    v_mov_b64 v[12:13], 0
    v_mov_b64 v[14:15], 0
    s_nop 1
    v_smfmac_f32_16x16x64_bf16 v[12:15], v[36:39], a[0:7], v10
    v_smfmac_f32_16x16x64_bf16 v[12:15], v[40:43], a[16:23], v10
    v_smfmac_f32_16x16x64_bf16 v[12:15], v[44:47], a[32:39], v10
    v_smfmac_f32_16x16x64_bf16 v[12:15], v[72:75], a[48:55], v10
    v_smfmac_f32_16x16x64_bf16 v[12:15], v[76:79], a[64:71], v10
    v_smfmac_f32_16x16x64_bf16 v[12:15], v[56:59], a[128:135], v10
    v_smfmac_f32_16x16x64_bf16 v[12:15], v[60:63], a[144:151], v10
    v_smfmac_f32_16x16x64_bf16 v[12:15], v[64:67], a[80:87], v10
    v_smfmac_f32_16x16x64_bf16 v[12:15], v[68:71], a[96:103], v10
    v_smfmac_f32_16x16x64_bf16 v[12:15], v[48:51], a[112:119], v10
    s_branch L_CH_C_11
L_CH_LAST_11:
    buffer_store_dwordx4 v[28:31], v1, s[4:7], s77 offen sc1
    s_add_u32 s77, s77, 131072
    s_waitcnt vmcnt(0)
    v_mov_b32 v62, 0
    v_mov_b32 v63, 64
    s_mov_b64 exec, 1
    buffer_store_dword v63, v62, s[4:7], s78 offen sc1
    s_mov_b64 exec, -1
    s_branch L_END2
L_CH_REDX_11:
    buffer_load_dwordx4 v[52:55], v1, s[4:7], s80 offen offset:0 sc1
    buffer_load_dwordx4 v[56:59], v1, s[4:7], s80 offen offset:1024 sc1
    buffer_load_dwordx4 v[60:63], v1, s[4:7], s80 offen offset:2048 sc1
    buffer_load_dwordx4 v[64:67], v1, s[4:7], s80 offen offset:3072 sc1
    s_add_u32 s60, s60, 1
    s_cmp_lt_u32 s60, 0x100000
    s_cbranch_scc1 L_CH_RED_11
    s_movk_i32 s62, 14
    s_branch L_ABORT
L_kv_81:
    v_bfe_u32 v52, v1, 4, 1
    v_lshlrev_b32 v52, 5, v52
    v_add_u32 v52, s46, v52
    v_add_u32 v52, 64, v52
    v_lshlrev_b32 v52, 6, v52
    s_mov_b32 s60, 0
L_pf_85:
    buffer_load_dword v53, v52, s[4:7], 0 offen sc1
    s_waitcnt vmcnt(0)
    v_cmp_gt_u32 vcc, s69, v53
    s_nop 0
    s_cbranch_vccz L_pfd_86
    s_sleep 1
    s_add_u32 s60, s60, 1
    s_cmp_lt_u32 s60, 0x100000
    s_cbranch_scc1 L_pf_85
    s_movk_i32 s62, 11
    s_branch L_ABORT
L_pfd_86:
    v_readlane_b32 s68, v53, 0
    v_readlane_b32 s62, v53, 1
    s_nop 0
    s_min_u32 s68, s68, s62
    s_branch L_kvr_82
L_kv_79:
    v_bfe_u32 v52, v1, 4, 1
    v_lshlrev_b32 v52, 5, v52
    v_add_u32 v52, s46, v52
    v_add_u32 v52, 64, v52
    v_lshlrev_b32 v52, 6, v52
    s_mov_b32 s60, 0
L_pf_87:
    buffer_load_dword v53, v52, s[4:7], 0 offen sc1
    s_waitcnt vmcnt(0)
    v_cmp_gt_u32 vcc, s69, v53
    s_nop 0
    s_cbranch_vccz L_pfd_88
    s_sleep 1
    s_add_u32 s60, s60, 1
    s_cmp_lt_u32 s60, 0x100000
    s_cbranch_scc1 L_pf_87
    s_movk_i32 s62, 11
    s_branch L_ABORT
L_pfd_88:
    v_readlane_b32 s68, v53, 0
    v_readlane_b32 s62, v53, 1
    s_nop 0
    s_min_u32 s68, s68, s62
    s_branch L_kvr_80
L_CH_FIRST_21:
    ds_read_b128 v[36:39], v1 offset:0
    ds_read_b128 v[40:43], v1 offset:1024
    ds_read_b128 v[44:47], v1 offset:2048
    ds_read_b128 v[72:75], v1 offset:3072
    ds_read_b128 v[76:79], v1 offset:4096
    s_waitcnt lgkmcnt(4)
    v_smfmac_f32_16x16x64_bf16 v[12:15], v[36:39], a[0:7], v10
    s_waitcnt lgkmcnt(3)
    v_smfmac_f32_16x16x64_bf16 v[12:15], v[40:43], a[16:23], v10
    s_waitcnt lgkmcnt(2)
    v_smfmac_f32_16x16x64_bf16 v[12:15], v[44:47], a[32:39], v10
    s_waitcnt lgkmcnt(1)
    v_smfmac_f32_16x16x64_bf16 v[12:15], v[72:75], a[48:55], v10
    s_waitcnt lgkmcnt(0)
    v_smfmac_f32_16x16x64_bf16 v[12:15], v[76:79], a[64:71], v10
    v_smfmac_f32_16x16x64_bf16 v[16:19], v[36:39], a[8:15], v10
    v_smfmac_f32_16x16x64_bf16 v[16:19], v[40:43], a[24:31], v10
    v_smfmac_f32_16x16x64_bf16 v[16:19], v[44:47], a[40:47], v10
    v_smfmac_f32_16x16x64_bf16 v[16:19], v[72:75], a[56:63], v10
    v_smfmac_f32_16x16x64_bf16 v[16:19], v[76:79], a[72:79], v10
    v_smfmac_f32_16x16x64_bf16 v[28:31], v[36:39], v[56:63], v10
    ds_read_b128 v[56:59], v2 offset:51200
    ds_read_b128 v[60:63], v2 offset:52224
    v_smfmac_f32_16x16x64_bf16 v[20:23], v[36:39], v[64:71], v10
    v_xor_b32 v2, 0x10000, v2
    ds_read_b128 v[64:67], v2 offset:0
    ds_read_b128 v[68:71], v2 offset:1024
    v_smfmac_f32_16x16x64_bf16 v[32:35], v[36:39], v[48:55], v10
    ds_read_b128 v[48:51], v2 offset:2048
    ds_read_b128 v[52:55], v2 offset:3072
    v_smfmac_f32_16x16x64_bf16 v[20:23], v[40:43], a[208:215], v10
    s_waitcnt lgkmcnt(4)
    v_smfmac_f32_16x16x64_bf16 v[24:27], v[36:39], v[56:63], v10
    ds_read_b128 v[56:59], v2 offset:16384
    ds_read_b128 v[60:63], v2 offset:17408
    v_smfmac_f32_16x16x64_bf16 v[24:27], v[40:43], a[216:223], v10
    s_waitcnt lgkmcnt(4)
    v_smfmac_f32_16x16x64_bf16 v[28:31], v[40:43], v[64:71], v10
    ds_read_b128 v[64:67], v2 offset:18432
    ds_read_b128 v[68:71], v2 offset:19456
    v_smfmac_f32_16x16x64_bf16 v[20:23], v[44:47], a[224:231], v10
    s_waitcnt lgkmcnt(4)
    v_smfmac_f32_16x16x64_bf16 v[32:35], v[40:43], v[48:55], v10
    ds_read_b128 v[48:51], v2 offset:32768
    ds_read_b128 v[52:55], v2 offset:33792
    v_smfmac_f32_16x16x64_bf16 v[24:27], v[44:47], a[232:239], v10
    s_waitcnt lgkmcnt(4)
    v_smfmac_f32_16x16x64_bf16 v[28:31], v[44:47], v[56:63], v10
    ds_read_b128 v[56:59], v2 offset:34816
    ds_read_b128 v[60:63], v2 offset:35840
    s_waitcnt lgkmcnt(4)
    v_smfmac_f32_16x16x64_bf16 v[32:35], v[44:47], v[64:71], v10
    ds_read_b128 v[64:67], v2 offset:49152
    ds_read_b128 v[68:71], v2 offset:50176
    s_waitcnt lgkmcnt(4)
    v_smfmac_f32_16x16x64_bf16 v[28:31], v[72:75], v[48:55], v10
    ds_read_b128 v[48:51], v2 offset:51200
    ds_read_b128 v[52:55], v2 offset:52224
    s_waitcnt lgkmcnt(4)
    v_smfmac_f32_16x16x64_bf16 v[32:35], v[72:75], v[56:63], v10
    s_barrier
    s_mov_b32 s69, 2
    ds_read_b128 v[56:59], v1 offset:8192
    ds_read_b128 v[60:63], v1 offset:9216
    s_waitcnt lgkmcnt(4)
    v_smfmac_f32_16x16x64_bf16 v[28:31], v[76:79], v[64:71], v10
    ds_read_b128 v[64:67], v1 offset:5120
    ds_read_b128 v[68:71], v1 offset:6144
    s_waitcnt lgkmcnt(4)
    v_smfmac_f32_16x16x64_bf16 v[32:35], v[76:79], v[48:55], v10
    ds_read_b128 v[48:51], v1 offset:7168
    v_smfmac_f32_16x16x64_bf16 v[20:23], v[72:75], v[144:151], v10
    s_waitcnt lgkmcnt(4)
    v_smfmac_f32_16x16x64_bf16 v[12:15], v[56:59], a[128:135], v10
    s_waitcnt lgkmcnt(3)
    v_smfmac_f32_16x16x64_bf16 v[12:15], v[60:63], a[144:151], v10
    s_waitcnt lgkmcnt(2)
    v_smfmac_f32_16x16x64_bf16 v[12:15], v[64:67], a[80:87], v10
    s_waitcnt lgkmcnt(1)
    v_smfmac_f32_16x16x64_bf16 v[12:15], v[68:71], a[96:103], v10
    s_waitcnt lgkmcnt(0)
    v_smfmac_f32_16x16x64_bf16 v[12:15], v[48:51], a[112:119], v10
    s_cmp_lt_u32 s68, s69
    s_cbranch_scc1 L_kv_89
L_kvr_90:
    v_smfmac_f32_16x16x64_bf16 v[24:27], v[72:75], v[152:159], v10
    v_smfmac_f32_16x16x64_bf16 v[20:23], v[76:79], v[160:167], v10
    v_smfmac_f32_16x16x64_bf16 v[24:27], v[76:79], v[168:175], v10
    s_branch L_CH_C_21
    .p2align 6
L_CH_B1_21:
    s_barrier
L_CH_LOOP_21:
    ds_read_b128 v[36:39], v1 offset:0
    ds_read_b128 v[40:43], v1 offset:1024
    ds_read_b128 v[44:47], v1 offset:2048
    ds_read_b128 v[72:75], v1 offset:3072
    ds_read_b128 v[76:79], v1 offset:4096
L_CH_A1_21:
    s_waitcnt lgkmcnt(4)
    v_smfmac_f32_16x16x64_bf16 v[12:15], v[36:39], a[0:7], v10
    s_waitcnt lgkmcnt(3)
    v_smfmac_f32_16x16x64_bf16 v[12:15], v[40:43], a[16:23], v10
    s_waitcnt lgkmcnt(2)
    v_smfmac_f32_16x16x64_bf16 v[12:15], v[44:47], a[32:39], v10
    s_waitcnt lgkmcnt(1)
    v_smfmac_f32_16x16x64_bf16 v[12:15], v[72:75], a[48:55], v10
    s_waitcnt lgkmcnt(0)
    v_smfmac_f32_16x16x64_bf16 v[12:15], v[76:79], a[64:71], v10
    v_smfmac_f32_16x16x64_bf16 v[16:19], v[36:39], a[8:15], v10
    v_smfmac_f32_16x16x64_bf16 v[16:19], v[40:43], a[24:31], v10
    s_add_u32 s69, s61, 2
    s_min_u32 s69, s69, 64
    s_mov_b32 m0, s85
    s_add_u32 s64, s98, s99
    s_nop 1
    v_cmp_u_f32 vcc, v12, v13
    v_cmp_u_f32 s[62:63], v14, v15
    v_smfmac_f32_16x16x64_bf16 v[16:19], v[44:47], a[40:47], v10
    s_or_b64 vcc, vcc, s[62:63]
    s_cbranch_scc1 L_CH_LRETRY_21
L_CH_LGO_21:
    buffer_load_dwordx4 v1, s[4:7], s98 offen sc1 lds
    s_add_u32 m0, s85, s99
    s_mov_b64 exec, 0xffff
    buffer_load_dwordx4 v1, s[4:7], s64 offen sc1 lds
    s_mov_b64 exec, -1
    v_smfmac_f32_16x16x64_bf16 v[16:19], v[72:75], a[56:63], v10
    v_smfmac_f32_16x16x64_bf16 v[16:19], v[76:79], a[72:79], v10
    v_smfmac_f32_16x16x64_bf16 v[28:31], v[36:39], v[56:63], v10
    ds_read_b128 v[56:59], v2 offset:51200
    ds_read_b128 v[60:63], v2 offset:52224
    v_smfmac_f32_16x16x64_bf16 v[20:23], v[36:39], v[64:71], v10
    v_xor_b32 v2, 0x10000, v2
    ds_read_b128 v[64:67], v2 offset:0
    ds_read_b128 v[68:71], v2 offset:1024
    v_smfmac_f32_16x16x64_bf16 v[32:35], v[36:39], v[48:55], v10
    ds_read_b128 v[48:51], v2 offset:2048
    ds_read_b128 v[52:55], v2 offset:3072
    v_smfmac_f32_16x16x64_bf16 v[20:23], v[40:43], a[208:215], v10
    v_mov_b32 v9, s61
    s_mov_b64 exec, 1
    buffer_store_dword v9, off, s[4:7], s78 sc1
    s_mov_b64 exec, -1
    s_waitcnt lgkmcnt(4)
    v_smfmac_f32_16x16x64_bf16 v[24:27], v[36:39], v[56:63], v10
    ds_read_b128 v[56:59], v2 offset:16384
    ds_read_b128 v[60:63], v2 offset:17408
    v_smfmac_f32_16x16x64_bf16 v[24:27], v[40:43], a[216:223], v10
    s_waitcnt lgkmcnt(4)
    v_smfmac_f32_16x16x64_bf16 v[28:31], v[40:43], v[64:71], v10
    ds_read_b128 v[64:67], v2 offset:18432
    ds_read_b128 v[68:71], v2 offset:19456
    v_smfmac_f32_16x16x64_bf16 v[20:23], v[44:47], a[224:231], v10
    s_waitcnt lgkmcnt(4)
    v_smfmac_f32_16x16x64_bf16 v[32:35], v[40:43], v[48:55], v10
    ds_read_b128 v[48:51], v2 offset:32768
    ds_read_b128 v[52:55], v2 offset:33792
    v_smfmac_f32_16x16x64_bf16 v[24:27], v[44:47], a[232:239], v10
    s_waitcnt lgkmcnt(4)
    v_smfmac_f32_16x16x64_bf16 v[28:31], v[44:47], v[56:63], v10
    ds_read_b128 v[56:59], v2 offset:34816
    ds_read_b128 v[60:63], v2 offset:35840
    s_waitcnt lgkmcnt(4)
    v_smfmac_f32_16x16x64_bf16 v[32:35], v[44:47], v[64:71], v10
    ds_read_b128 v[64:67], v2 offset:49152
    ds_read_b128 v[68:71], v2 offset:50176
    s_waitcnt lgkmcnt(4)
    v_smfmac_f32_16x16x64_bf16 v[28:31], v[72:75], v[48:55], v10
    ds_read_b128 v[48:51], v2 offset:51200
    ds_read_b128 v[52:55], v2 offset:52224
    s_waitcnt lgkmcnt(4)
    v_smfmac_f32_16x16x64_bf16 v[32:35], v[72:75], v[56:63], v10
    s_waitcnt vmcnt(1)
    s_barrier
    ds_read_b128 v[56:59], v1 offset:8192
    ds_read_b128 v[60:63], v1 offset:9216
    s_waitcnt lgkmcnt(4)
    v_smfmac_f32_16x16x64_bf16 v[28:31], v[76:79], v[64:71], v10
    ds_read_b128 v[64:67], v1 offset:5120
    ds_read_b128 v[68:71], v1 offset:6144
    s_waitcnt lgkmcnt(4)
    v_smfmac_f32_16x16x64_bf16 v[32:35], v[76:79], v[48:55], v10
    ds_read_b128 v[48:51], v1 offset:7168
    v_smfmac_f32_16x16x64_bf16 v[20:23], v[72:75], v[144:151], v10
    s_waitcnt lgkmcnt(4)
    v_smfmac_f32_16x16x64_bf16 v[12:15], v[56:59], a[128:135], v10
    s_waitcnt lgkmcnt(3)
    v_smfmac_f32_16x16x64_bf16 v[12:15], v[60:63], a[144:151], v10
    s_waitcnt lgkmcnt(2)
    v_smfmac_f32_16x16x64_bf16 v[12:15], v[64:67], a[80:87], v10
    s_waitcnt lgkmcnt(1)
    v_smfmac_f32_16x16x64_bf16 v[12:15], v[68:71], a[96:103], v10
    s_waitcnt lgkmcnt(0)
    v_smfmac_f32_16x16x64_bf16 v[12:15], v[48:51], a[112:119], v10
    s_cmp_lt_u32 s68, s69
    s_cbranch_scc1 L_kv_91
L_kvr_92:
    v_smfmac_f32_16x16x64_bf16 v[24:27], v[72:75], v[152:159], v10
    v_smfmac_f32_16x16x64_bf16 v[20:23], v[76:79], v[160:167], v10
    v_smfmac_f32_16x16x64_bf16 v[24:27], v[76:79], v[168:175], v10
    s_nop 2
    v_cmp_u_f32 vcc, v12, v13
    v_cmp_u_f32 s[62:63], v14, v15
    s_nop 0
    s_or_b64 vcc, vcc, s[62:63]
    s_cbranch_scc1 L_CH_RETRY_21
L_CH_C_21:
    v_smfmac_f32_16x16x64_bf16 v[16:19], v[64:67], a[88:95], v10
    buffer_load_dwordx4 v[72:75], v1, s[4:7], s76 offen sc1
    v_smfmac_f32_16x16x64_bf16 v[16:19], v[68:71], a[104:111], v10
    v_smfmac_f32_16x16x64_bf16 v[16:19], v[48:51], a[120:127], v10
    buffer_load_dwordx4 v[76:79], v1, s[4:7], s76 offen offset:1024 sc1
    s_add_u32 s76, s76, 262144
    v_smfmac_f32_16x16x64_bf16 v[16:19], v[56:59], a[136:143], v10
    v_pk_add_f32 v[12:13], v[12:13], v[14:15]
    v_smfmac_f32_16x16x64_bf16 v[16:19], v[60:63], a[152:159], v10
    ds_read_b128 v[36:39], v0 offset:0
    ds_read_b128 v[40:43], v0 offset:1024
    v_cvt_pk_bf16_f32 v14, v12, v13
    v_smfmac_f32_16x16x64_bf16 v[20:23], v[64:67], v[176:183], v10
    ds_read_b128 v[44:47], v0 offset:2048
    ds_read_b128 v[52:55], v0 offset:3072
    v_smfmac_f32_16x16x64_bf16 v[24:27], v[64:67], v[184:191], v10
    v_smfmac_f32_16x16x64_bf16 v[20:23], v[68:71], v[192:199], v10
    v_pk_add_f32 v[16:17], v[16:17], v[18:19]
    v_smfmac_f32_16x16x64_bf16 v[24:27], v[68:71], v[200:207], v10
    v_cvt_pk_bf16_f32 v18, v16, v17
    v_smfmac_f32_16x16x64_bf16 v[20:23], v[48:51], v[208:215], v10
    ds_write_b32 v4, v14 offset:0
    ds_write_b32 v4, v18 offset:528
    v_smfmac_f32_16x16x64_bf16 v[24:27], v[48:51], v[216:223], v10
    v_smfmac_f32_16x16x64_bf16 v[20:23], v[56:59], v[224:231], v10
    s_mov_b32 m0, s74
    s_xor_b32 s74, s74, s37
    buffer_load_dwordx4 v1, s[4:7], s73 offen sc1 lds
    v_smfmac_f32_16x16x64_bf16 v[24:27], v[56:59], v[232:239], v10
    v_smfmac_f32_16x16x64_bf16 v[20:23], v[60:63], v[240:247], v10
    buffer_load_dwordx4 v1, s[4:7], s73 offen offset:1024 sc1 lds
    s_add_u32 s73, s73, 262144
    v_smfmac_f32_16x16x64_bf16 v[24:27], v[60:63], v[248:255], v10
    s_waitcnt lgkmcnt(0)
    s_barrier
    ds_read_b64_tr_b16 v[12:13], v5 offset:0
    ds_read_b64_tr_b16 v[14:15], v5 offset:272
    v_smfmac_f32_16x16x64_bf16 v[28:31], v[64:67], v[80:87], v10
    ds_read_b64_tr_b16 v[16:17], v5 offset:1056
    ds_read_b64_tr_b16 v[18:19], v5 offset:1328
    v_pk_add_f32 v[20:21], v[20:21], v[22:23]
    v_smfmac_f32_16x16x64_bf16 v[32:35], v[64:67], v[88:95], v10
    ds_read_b64_tr_b16 v[64:65], v5 offset:2112
    ds_read_b64_tr_b16 v[66:67], v5 offset:2384
    v_pk_add_f32 v[24:25], v[24:25], v[26:27]
    v_cvt_pk_bf16_f32 v22, v20, v21
    v_smfmac_f32_16x16x64_bf16 v[28:31], v[68:71], v[96:103], v10
    v_cvt_pk_bf16_f32 v26, v24, v25
    ds_write_b32 v4, v22 offset:26624
    ds_write_b32 v4, v26 offset:27152
    v_smfmac_f32_16x16x64_bf16 v[32:35], v[68:71], v[104:111], v10
    ds_read_b64_tr_b16 v[68:69], v5 offset:3168
    ds_read_b64_tr_b16 v[70:71], v5 offset:3440
    v_smfmac_f32_16x16x64_bf16 v[28:31], v[48:51], v[112:119], v10
    v_smfmac_f32_16x16x64_bf16 v[32:35], v[48:51], v[120:127], v10
    ds_read_b128 v[48:51], v0 offset:4096
    v_smfmac_f32_16x16x64_bf16 v[28:31], v[56:59], v[128:135], v10
    v_smfmac_f32_16x16x64_bf16 v[32:35], v[56:59], v[136:143], v10
    ds_read_b128 v[56:59], v0 offset:5120
    v_smfmac_f32_16x16x64_bf16 v[28:31], v[60:63], a[240:247], v10
    v_smfmac_f32_16x16x64_bf16 v[32:35], v[60:63], a[248:255], v10
    s_waitcnt lgkmcnt(10)
    v_mfma_f32_16x16x32_bf16 v[60:63], v[36:39], v[12:15], 0
    ds_read_b128 v[36:39], v0 offset:6144
    s_waitcnt lgkmcnt(9)
    v_mfma_f32_16x16x32_bf16 v[60:63], v[40:43], v[16:19], v[60:63]
    ds_read_b128 v[40:43], v0 offset:7168
    s_waitcnt lgkmcnt(8)
    v_mfma_f32_16x16x32_bf16 v[60:63], v[44:47], v[64:67], v[60:63]
    v_cvt_pk_bf16_f32 v28, v28, v29
    v_cvt_pk_bf16_f32 v29, v30, v31
    s_waitcnt lgkmcnt(4)
    v_mfma_f32_16x16x32_bf16 v[60:63], v[52:55], v[68:71], v[60:63]
    v_cvt_pk_bf16_f32 v30, v32, v33
    v_cvt_pk_bf16_f32 v31, v34, v35
    s_cmp_eq_u32 s61, 63
    s_barrier
    s_cbranch_scc1 L_CH_LAST_21
    ds_read_b64_tr_b16 v[44:45], v5 offset:26624
    ds_read_b64_tr_b16 v[46:47], v5 offset:26896
    ds_read_b64_tr_b16 v[52:53], v5 offset:27680
    ds_read_b64_tr_b16 v[54:55], v5 offset:27952
    s_waitcnt lgkmcnt(7)
    v_mfma_f32_16x16x32_bf16 v[20:23], v[48:51], v[12:15], 0
    ds_read_b64_tr_b16 v[48:49], v5 offset:28736
    ds_read_b64_tr_b16 v[50:51], v5 offset:29008
    s_waitcnt lgkmcnt(8)
    v_mfma_f32_16x16x32_bf16 v[20:23], v[56:59], v[16:19], v[20:23]
    ds_read_b64_tr_b16 v[56:57], v5 offset:29792
    ds_read_b64_tr_b16 v[58:59], v5 offset:30064
    s_waitcnt lgkmcnt(9)
    v_mfma_f32_16x16x32_bf16 v[20:23], v[36:39], v[64:67], v[20:23]
    buffer_store_dwordx4 v[28:31], v1, s[4:7], s77 offen sc1
    s_waitcnt lgkmcnt(8)
    v_mfma_f32_16x16x32_bf16 v[20:23], v[40:43], v[68:71], v[20:23]
    v_xor_b32 v0, s75, v0
    s_waitcnt lgkmcnt(6)
    v_mfma_f32_16x16x32_bf16 v[24:27], v[44:47], v[12:15], 0
    v_max3_f32 v32, v60, v61, v62
    s_waitcnt lgkmcnt(4)
    v_mfma_f32_16x16x32_bf16 v[24:27], v[52:55], v[16:19], v[24:27]
    s_waitcnt lgkmcnt(2)
    v_mfma_f32_16x16x32_bf16 v[24:27], v[48:51], v[64:67], v[24:27]
    s_waitcnt lgkmcnt(0)
    v_mfma_f32_16x16x32_bf16 v[24:27], v[56:59], v[68:71], v[24:27]
    v_max3_f32 v32, v32, v63, v20
    v_max3_f32 v33, v21, v22, v23
    v_mov_b64 v[18:19], s[8:9]
    s_add_u32 s77, s77, 131072
    v_mov_b64 v[44:45], 0
    v_mov_b64 v[46:47], 0
    v_mov_b64 v[48:49], s[38:39]
    v_mov_b64 v[50:51], s[38:39]
    v_max_f32 v32, v32, v33
    v_max3_f32 v33, v32, v24, v25
    v_max3_f32 v32, v32, v24, v25
    v_mov_b64 v[56:57], 0
    v_mov_b64 v[58:59], 0
    v_permlane16_swap_b32 v32, v33
    v_max_f32 v34, v32, v33
    v_max_f32 v35, v32, v33
    v_mov_b64 v[64:65], 0
    v_mov_b64 v[66:67], 0
    v_permlane32_swap_b32 v34, v35
    v_max_f32 v32, v34, v35
    v_mul_f32 v32, s82, v32
    v_pk_fma_f32 v[60:61], v[60:61], s[82:83], v[32:33] op_sel_hi:[1,0,0] neg_lo:[0,0,1] neg_hi:[0,0,1]
    v_pk_fma_f32 v[62:63], v[62:63], s[82:83], v[32:33] op_sel_hi:[1,0,0] neg_lo:[0,0,1] neg_hi:[0,0,1]
    v_pk_fma_f32 v[20:21], v[20:21], s[82:83], v[32:33] op_sel_hi:[1,0,0] neg_lo:[0,0,1] neg_hi:[0,0,1]
    v_pk_fma_f32 v[22:23], v[22:23], s[82:83], v[32:33] op_sel_hi:[1,0,0] neg_lo:[0,0,1] neg_hi:[0,0,1]
    v_pk_fma_f32 v[24:25], v[24:25], s[82:83], v[32:33] op_sel_hi:[1,0,0] neg_lo:[0,0,1] neg_hi:[0,0,1]
    v_exp_f32 v60, v60
    v_exp_f32 v61, v61
    v_exp_f32 v62, v62
    v_cvt_pk_bf16_f32 v12, v60, v61
    v_exp_f32 v63, v63
    v_exp_f32 v20, v20
    v_cvt_pk_bf16_f32 v13, v62, v63
    v_exp_f32 v21, v21
    v_exp_f32 v22, v22
    v_cvt_pk_bf16_f32 v14, v20, v21
    v_exp_f32 v23, v23
    v_exp_f32 v24, v24
    v_cvt_pk_bf16_f32 v15, v22, v23
    v_exp_f32 v25, v25
    s_waitcnt vmcnt(3)
    v_mfma_f32_16x16x32_bf16 v[36:39], v[72:75], v[12:15], 0
    v_cvt_pk_bf16_f32 v16, v24, v25
    v_cvt_pk_bf16_f32 v17, v24, v25
    v_mfma_f32_16x16x32_bf16 v[40:43], v[76:79], v[12:15], 0
    s_add_u32 s81, s81, 16384
    s_and_b32 s81, s81, 0xffff
    s_add_u32 s61, s61, 1
    v_mfma_f32_16x16x16_bf16 v[36:39], v[28:29], v[16:17], v[36:39]
    v_mov_b64 v[68:69], 0
    v_mov_b64 v[70:71], 0
    v_mfma_f32_16x16x16_bf16 v[40:43], v[30:31], v[16:17], v[40:43]
    v_mfma_f32_16x16x32_bf16 v[24:27], v[12:15], v[48:51], 0
    v_xor_b32 v2, 0x10000, v2
    ds_read_b128 v[72:75], v2 offset:0
    ds_read_b128 v[76:79], v2 offset:1024
    v_mov_b64 v[52:53], 0
    v_mov_b64 v[54:55], 0
    s_mov_b64 exec, s[94:95]
    v_cvt_pk_bf16_f32 v36, v36, v37
    v_cvt_pk_bf16_f32 v37, v38, v39
    v_cvt_pk_bf16_f32 v38, v40, v41
    v_cvt_pk_bf16_f32 v39, v42, v43
    ds_write_b128 v6, v[36:39]
    s_mov_b64 exec, -1
    v_mfma_f32_16x16x16_bf16 v[24:27], v[16:17], v[18:19], v[24:27]
    ds_read_b128 v[12:15], v2 offset:2048
    ds_read_b128 v[16:19], v2 offset:3072
    s_add_u32 s63, s90, s81
    s_add_u32 s91, s91, 32768
    s_add_u32 s98, s98, 32768
    s_add_u32 s89, s89, 32768
    s_add_u32 s65, s88, s81
    s_mov_b32 s60, 0
    v_rcp_f32 v60, v24
    v_rcp_f32 v61, v25
    s_waitcnt lgkmcnt(2)
    s_barrier
    ds_read_b128 v[48:51], v1 offset:0
    ds_read_b128 v[32:35], v1 offset:1024
    s_waitcnt lgkmcnt(1)
    v_smfmac_f32_16x16x64_bf16 v[68:71], v[48:51], v[72:79], v10
    ds_read_b128 v[72:75], v2 offset:16384
    ds_read_b128 v[76:79], v2 offset:17408
    v_smfmac_f32_16x16x64_bf16 v[44:47], v[48:51], v[12:19], v10
    ds_read_b128 v[12:15], v2 offset:18432
    ds_read_b128 v[16:19], v2 offset:19456
    s_waitcnt lgkmcnt(4)
    v_smfmac_f32_16x16x64_bf16 v[68:71], v[32:35], a[200:207], v10
    v_smfmac_f32_16x16x64_bf16 v[44:47], v[32:35], a[176:183], v10
    v_smfmac_f32_16x16x64_bf16 v[52:55], v[48:51], a[160:167], v10
    v_smfmac_f32_16x16x64_bf16 v[52:55], v[32:35], a[184:191], v10
    v_smfmac_f32_16x16x64_bf16 v[56:59], v[48:51], a[168:175], v10
    v_smfmac_f32_16x16x64_bf16 v[56:59], v[32:35], a[192:199], v10
    s_waitcnt lgkmcnt(2)
    v_smfmac_f32_16x16x64_bf16 v[64:67], v[48:51], v[72:79], v10
    s_waitcnt lgkmcnt(0)
    v_smfmac_f32_16x16x64_bf16 v[64:67], v[32:35], v[12:19], v10
    v_pk_add_f32 v[68:69], v[68:69], v[70:71]
    v_pk_add_f32 v[44:45], v[44:45], v[46:47]
    v_pk_add_f32 v[52:53], v[52:53], v[54:55]
    s_nop 0
    v_pk_add_f32 v[56:57], v[56:57], v[58:59]
    v_pk_mul_f32 v[68:69], v[68:69], v[60:61]
    v_pk_mul_f32 v[44:45], v[44:45], v[60:61]
    v_pk_mul_f32 v[52:53], v[52:53], v[60:61]
    v_pk_mul_f32 v[56:57], v[56:57], v[60:61]
    v_pk_add_f32 v[64:65], v[64:65], v[66:67]
    v_cvt_pk_bf16_f32 v40, v68, v69
    v_cvt_pk_bf16_f32 v36, v44, v45
    v_pk_mul_f32 v[64:65], v[64:65], v[60:61]
    buffer_store_dword v40, v8, s[4:7], s79 offen
    v_cvt_pk_bf16_f32 v37, v52, v53
    v_cvt_pk_bf16_f32 v38, v56, v57
    v_cvt_pk_bf16_f32 v39, v64, v65
    buffer_store_dwordx4 v[36:39], v7, s[4:7], s79 offen
    s_xor_b32 s79, s79, s92
    v_mov_b64 v[32:33], 0
    v_mov_b64 v[34:35], 0
    v_mov_b64 v[12:13], 0
    v_mov_b64 v[14:15], 0
    v_mov_b64 v[16:17], 0
    v_mov_b64 v[18:19], 0
    v_mov_b64 v[20:21], 0
    v_mov_b64 v[22:23], 0
    v_mov_b64 v[24:25], 0
    v_mov_b64 v[26:27], 0
    v_mov_b64 v[28:29], 0
    v_mov_b64 v[30:31], 0
    s_min_u32 s62, s0, s1
    s_max_u32 s68, s68, s62
    s_buffer_load_dword s0, s[4:7], s84 glc
    s_buffer_load_dword s1, s[4:7], s36 glc
L_sr_93:
L_CH_NORED_21:
    ds_read_b128 v[56:59], v2 offset:32768
    ds_read_b128 v[60:63], v2 offset:33792
    ds_read_b128 v[64:67], v2 offset:49152
    ds_read_b128 v[68:71], v2 offset:50176
    ds_read_b128 v[48:51], v2 offset:34816
    ds_read_b128 v[52:55], v2 offset:35840
    s_barrier
    v_mov_b64 v[36:37], -1
    v_mov_b64 v[38:39], -1
    s_sleep 1
    s_sleep 1
    s_sleep 1
    s_sleep 1
    s_nop 11
    s_mov_b32 m0, s100
    s_add_u32 s64, s65, s99
    buffer_load_dwordx4 v1, s[4:7], s65 offen sc1 lds
    s_add_u32 m0, s100, s99
    s_mov_b64 exec, 0xffff
    buffer_load_dwordx4 v1, s[4:7], s64 offen sc1 lds
    s_mov_b64 exec, -1
    s_nop 11
    s_mov_b32 m0, s100
    s_add_u32 s64, s65, s99
    buffer_load_dwordx4 v1, s[4:7], s65 offen sc1 lds
    s_add_u32 m0, s100, s99
    s_mov_b64 exec, 0xffff
    buffer_load_dwordx4 v1, s[4:7], s64 offen sc1 lds
    s_mov_b64 exec, -1
    s_add_u32 s63, s101, s10
    buffer_store_dwordx4 v[36:39], v1, s[4:7], s101 offen
    s_mov_b64 exec, s[42:43]
    buffer_store_dwordx4 v[36:39], v1, s[4:7], s63 offen
    s_xor_b32 s101, s101, s40
    s_mov_b64 exec, -1
    s_waitcnt vmcnt(4)
    s_barrier
    ds_read_b128 v[36:39], v1 offset:0
    ds_read_b128 v[40:43], v1 offset:1024
    ds_read_b128 v[44:47], v1 offset:2048
    ds_read_b128 v[72:75], v1 offset:3072
    ds_read_b128 v[76:79], v1 offset:4096
    s_branch L_CH_A1_21
L_CH_LRETRY_21:
    s_add_u32 s60, s60, 1
    s_cmp_lg_u32 s60, 1
    s_cbranch_scc1 L_ln_94
    v_mov_b64 v[12:13], 0
    v_mov_b64 v[14:15], 0
    s_nop 0
    v_mov_b64 v[16:17], 0
    v_mov_b64 v[18:19], 0
    s_waitcnt vmcnt(0)
    s_branch L_CH_LOOP_21
L_ln_94:
    v_max3_u32 v9, v36, v37, v38
    v_max3_u32 v9, v9, v38, v39
    v_max3_u32 v9, v9, v40, v41
    v_max3_u32 v9, v9, v42, v43
    v_max3_u32 v9, v9, v44, v45
    v_max3_u32 v9, v9, v46, v47
    v_max3_u32 v9, v9, v72, v73
    v_max3_u32 v9, v9, v74, v75
    v_max3_u32 v9, v9, v76, v77
    v_max3_u32 v9, v9, v78, v79
    v_cmp_eq_u32 vcc, -1, v9
    s_nop 0
    s_cbranch_vccz L_CH_LGO_21
    s_cmp_ge_u32 s60, 0x100000
    s_movk_i32 s62, 15
    s_cbranch_scc1 L_ABORT
    s_sub_u32 s63, s65, s2
    s_mov_b32 m0, 131072
    s_add_u32 s64, s63, 4096
    buffer_load_dwordx4 v1, s[4:7], s63 offen offset:0 sc1 lds
    buffer_load_dwordx4 v1, s[4:7], s63 offen offset:1024 sc1 lds
    buffer_load_dwordx4 v1, s[4:7], s63 offen offset:2048 sc1 lds
    buffer_load_dwordx4 v1, s[4:7], s63 offen offset:3072 sc1 lds
    s_mov_b32 m0, 135168
    s_nop 0
    buffer_load_dwordx4 v1, s[4:7], s64 offen sc1 lds
    v_mov_b64 v[12:13], 0
    v_mov_b64 v[14:15], 0
    v_mov_b64 v[16:17], 0
    v_mov_b64 v[18:19], 0
    s_waitcnt vmcnt(0)
    s_branch L_CH_LOOP_21
L_CH_RETRY_21:
    s_mov_b32 s60, 0
    s_sleep 1
    s_sleep 1
    s_mov_b32 m0, s85
    s_add_u32 s64, s98, s99
    buffer_load_dwordx4 v1, s[4:7], s98 offen sc1 lds
    s_add_u32 m0, s85, s99
    s_mov_b64 exec, 0xffff
    buffer_load_dwordx4 v1, s[4:7], s64 offen sc1 lds
    s_mov_b64 exec, -1
    s_branch L_CH_RETRY2_21
L_CH_RETRY1_21:
    s_mov_b32 s63, s89
    s_mov_b32 m0, 136192
    s_add_u32 s64, s63, 4096
    buffer_load_dwordx4 v1, s[4:7], s63 offen offset:0 sc1 lds
    buffer_load_dwordx4 v1, s[4:7], s63 offen offset:1024 sc1 lds
    buffer_load_dwordx4 v1, s[4:7], s63 offen offset:2048 sc1 lds
    buffer_load_dwordx4 v1, s[4:7], s63 offen offset:3072 sc1 lds
    s_mov_b32 m0, 140288
    s_nop 0
    buffer_load_dwordx4 v1, s[4:7], s64 offen sc1 lds
L_CH_RETRY2_21:
    s_waitcnt vmcnt(0)
    ds_read_b128 v[64:67], v1 offset:5120
    ds_read_b128 v[68:71], v1 offset:6144
    ds_read_b128 v[48:51], v1 offset:7168
    ds_read_b128 v[56:59], v1 offset:8192
    ds_read_b128 v[60:63], v1 offset:9216
    s_waitcnt lgkmcnt(0)
L_CH_RETRY3_21:
    v_max3_u32 v9, v64, v65, v66
    v_max_u32 v9, v9, v67
    v_max3_u32 v9, v9, v68, v69
    v_max3_u32 v9, v9, v70, v71
    v_max3_u32 v9, v9, v48, v49
    v_max3_u32 v9, v9, v50, v51
    v_max3_u32 v9, v9, v56, v57
    v_max3_u32 v9, v9, v58, v59
    v_max3_u32 v9, v9, v60, v61
    v_max3_u32 v9, v9, v62, v63
    v_cmp_eq_u32 vcc, -1, v9
    s_nop 0
    s_cbranch_vccz L_CH_REDO_21
    s_add_u32 s60, s60, 1
    s_cmp_lt_u32 s60, 0x100000
    s_cbranch_scc1 L_CH_RETRY1_21
    s_movk_i32 s62, 13
    s_branch L_ABORT
L_CH_REDO_21:
    v_mov_b64 v[12:13], 0
    v_mov_b64 v[14:15], 0
    s_nop 1
    v_smfmac_f32_16x16x64_bf16 v[12:15], v[36:39], a[0:7], v10
    v_smfmac_f32_16x16x64_bf16 v[12:15], v[40:43], a[16:23], v10
    v_smfmac_f32_16x16x64_bf16 v[12:15], v[44:47], a[32:39], v10
    v_smfmac_f32_16x16x64_bf16 v[12:15], v[72:75], a[48:55], v10
    v_smfmac_f32_16x16x64_bf16 v[12:15], v[76:79], a[64:71], v10
    v_smfmac_f32_16x16x64_bf16 v[12:15], v[56:59], a[128:135], v10
    v_smfmac_f32_16x16x64_bf16 v[12:15], v[60:63], a[144:151], v10
    v_smfmac_f32_16x16x64_bf16 v[12:15], v[64:67], a[80:87], v10
    v_smfmac_f32_16x16x64_bf16 v[12:15], v[68:71], a[96:103], v10
    v_smfmac_f32_16x16x64_bf16 v[12:15], v[48:51], a[112:119], v10
    s_branch L_CH_C_21
L_CH_LAST_21:
    buffer_store_dwordx4 v[28:31], v1, s[4:7], s77 offen sc1
    s_add_u32 s77, s77, 131072
    s_waitcnt vmcnt(0)
    v_mov_b32 v62, 0
    v_mov_b32 v63, 64
    s_mov_b64 exec, 1
    buffer_store_dword v63, v62, s[4:7], s78 offen sc1
    s_mov_b64 exec, -1
    s_branch L_END2
L_kv_91:
    v_bfe_u32 v52, v1, 4, 1
    v_lshlrev_b32 v52, 5, v52
    v_add_u32 v52, s46, v52
    v_add_u32 v52, 64, v52
    v_lshlrev_b32 v52, 6, v52
    s_mov_b32 s60, 0
L_pf_95:
    buffer_load_dword v53, v52, s[4:7], 0 offen sc1
    s_waitcnt vmcnt(0)
    v_cmp_gt_u32 vcc, s69, v53
    s_nop 0
    s_cbranch_vccz L_pfd_96
    s_sleep 1
    s_add_u32 s60, s60, 1
    s_cmp_lt_u32 s60, 0x100000
    s_cbranch_scc1 L_pf_95
    s_movk_i32 s62, 11
    s_branch L_ABORT
L_pfd_96:
    v_readlane_b32 s68, v53, 0
    v_readlane_b32 s62, v53, 1
    s_nop 0
    s_min_u32 s68, s68, s62
    s_branch L_kvr_92
L_kv_89:
    v_bfe_u32 v52, v1, 4, 1
    v_lshlrev_b32 v52, 5, v52
    v_add_u32 v52, s46, v52
    v_add_u32 v52, 64, v52
    v_lshlrev_b32 v52, 6, v52
    s_mov_b32 s60, 0
L_pf_97:
    buffer_load_dword v53, v52, s[4:7], 0 offen sc1
    s_waitcnt vmcnt(0)
    v_cmp_gt_u32 vcc, s69, v53
    s_nop 0
    s_cbranch_vccz L_pfd_98
    s_sleep 1
    s_add_u32 s60, s60, 1
    s_cmp_lt_u32 s60, 0x100000
    s_cbranch_scc1 L_pf_97
    s_movk_i32 s62, 11
    s_branch L_ABORT
L_pfd_98:
    v_readlane_b32 s68, v53, 0
    v_readlane_b32 s62, v53, 1
    s_nop 0
    s_min_u32 s68, s68, s62
    s_branch L_kvr_90
L_CH_FIRST_31:
    ds_read_b128 v[36:39], v1 offset:0
    ds_read_b128 v[40:43], v1 offset:1024
    ds_read_b128 v[44:47], v1 offset:2048
    ds_read_b128 v[72:75], v1 offset:3072
    ds_read_b128 v[76:79], v1 offset:4096
    s_waitcnt lgkmcnt(4)
    v_smfmac_f32_16x16x64_bf16 v[12:15], v[36:39], a[0:7], v10
    s_waitcnt lgkmcnt(3)
    v_smfmac_f32_16x16x64_bf16 v[12:15], v[40:43], a[16:23], v10
    s_waitcnt lgkmcnt(2)
    v_smfmac_f32_16x16x64_bf16 v[12:15], v[44:47], a[32:39], v10
    s_waitcnt lgkmcnt(1)
    v_smfmac_f32_16x16x64_bf16 v[12:15], v[72:75], a[48:55], v10
    s_waitcnt lgkmcnt(0)
    v_smfmac_f32_16x16x64_bf16 v[12:15], v[76:79], a[64:71], v10
    v_smfmac_f32_16x16x64_bf16 v[16:19], v[36:39], a[8:15], v10
    v_smfmac_f32_16x16x64_bf16 v[16:19], v[40:43], a[24:31], v10
    v_smfmac_f32_16x16x64_bf16 v[16:19], v[44:47], a[40:47], v10
    v_smfmac_f32_16x16x64_bf16 v[16:19], v[72:75], a[56:63], v10
    v_smfmac_f32_16x16x64_bf16 v[16:19], v[76:79], a[72:79], v10
    v_smfmac_f32_16x16x64_bf16 v[28:31], v[36:39], v[56:63], v10
    ds_read_b128 v[56:59], v2 offset:51200
    ds_read_b128 v[60:63], v2 offset:52224
    v_smfmac_f32_16x16x64_bf16 v[20:23], v[36:39], v[64:71], v10
    v_xor_b32 v2, 0x10000, v2
    ds_read_b128 v[64:67], v2 offset:0
    ds_read_b128 v[68:71], v2 offset:1024
    v_smfmac_f32_16x16x64_bf16 v[32:35], v[36:39], v[48:55], v10
    ds_read_b128 v[48:51], v2 offset:2048
    ds_read_b128 v[52:55], v2 offset:3072
    v_smfmac_f32_16x16x64_bf16 v[20:23], v[40:43], a[208:215], v10
    s_waitcnt lgkmcnt(4)
    v_smfmac_f32_16x16x64_bf16 v[24:27], v[36:39], v[56:63], v10
    ds_read_b128 v[56:59], v2 offset:16384
    ds_read_b128 v[60:63], v2 offset:17408
    v_smfmac_f32_16x16x64_bf16 v[24:27], v[40:43], a[216:223], v10
    s_waitcnt lgkmcnt(4)
    v_smfmac_f32_16x16x64_bf16 v[28:31], v[40:43], v[64:71], v10
    ds_read_b128 v[64:67], v2 offset:18432
    ds_read_b128 v[68:71], v2 offset:19456
    v_smfmac_f32_16x16x64_bf16 v[20:23], v[44:47], a[224:231], v10
    s_waitcnt lgkmcnt(4)
    v_smfmac_f32_16x16x64_bf16 v[32:35], v[40:43], v[48:55], v10
    ds_read_b128 v[48:51], v2 offset:32768
    ds_read_b128 v[52:55], v2 offset:33792
    v_smfmac_f32_16x16x64_bf16 v[24:27], v[44:47], a[232:239], v10
    s_waitcnt lgkmcnt(4)
    v_smfmac_f32_16x16x64_bf16 v[28:31], v[44:47], v[56:63], v10
    ds_read_b128 v[56:59], v2 offset:34816
    ds_read_b128 v[60:63], v2 offset:35840
    s_waitcnt lgkmcnt(4)
    v_smfmac_f32_16x16x64_bf16 v[32:35], v[44:47], v[64:71], v10
    ds_read_b128 v[64:67], v2 offset:49152
    ds_read_b128 v[68:71], v2 offset:50176
    s_waitcnt lgkmcnt(4)
    v_smfmac_f32_16x16x64_bf16 v[28:31], v[72:75], v[48:55], v10
    ds_read_b128 v[48:51], v2 offset:51200
    ds_read_b128 v[52:55], v2 offset:52224
    s_waitcnt lgkmcnt(4)
    v_smfmac_f32_16x16x64_bf16 v[32:35], v[72:75], v[56:63], v10
    s_barrier
    s_mov_b32 s69, 2
    ds_read_b128 v[56:59], v1 offset:8192
    ds_read_b128 v[60:63], v1 offset:9216
    s_waitcnt lgkmcnt(4)
    v_smfmac_f32_16x16x64_bf16 v[28:31], v[76:79], v[64:71], v10
    ds_read_b128 v[64:67], v1 offset:5120
    ds_read_b128 v[68:71], v1 offset:6144
    s_waitcnt lgkmcnt(4)
    v_smfmac_f32_16x16x64_bf16 v[32:35], v[76:79], v[48:55], v10
    ds_read_b128 v[48:51], v1 offset:7168
    v_smfmac_f32_16x16x64_bf16 v[20:23], v[72:75], v[144:151], v10
    s_waitcnt lgkmcnt(4)
    v_smfmac_f32_16x16x64_bf16 v[12:15], v[56:59], a[128:135], v10
    s_waitcnt lgkmcnt(3)
    v_smfmac_f32_16x16x64_bf16 v[12:15], v[60:63], a[144:151], v10
    s_waitcnt lgkmcnt(2)
    v_smfmac_f32_16x16x64_bf16 v[12:15], v[64:67], a[80:87], v10
    s_waitcnt lgkmcnt(1)
    v_smfmac_f32_16x16x64_bf16 v[12:15], v[68:71], a[96:103], v10
    s_waitcnt lgkmcnt(0)
    v_smfmac_f32_16x16x64_bf16 v[12:15], v[48:51], a[112:119], v10
    s_cmp_lt_u32 s68, s69
    s_cbranch_scc1 L_kv_99
L_kvr_100:
    v_smfmac_f32_16x16x64_bf16 v[24:27], v[72:75], v[152:159], v10
    v_smfmac_f32_16x16x64_bf16 v[20:23], v[76:79], v[160:167], v10
    v_smfmac_f32_16x16x64_bf16 v[24:27], v[76:79], v[168:175], v10
    s_branch L_CH_C_31
    .p2align 6
L_CH_B1_31:
    s_barrier
L_CH_LOOP_31:
    ds_read_b128 v[36:39], v1 offset:0
    ds_read_b128 v[40:43], v1 offset:1024
    ds_read_b128 v[44:47], v1 offset:2048
    ds_read_b128 v[72:75], v1 offset:3072
    ds_read_b128 v[76:79], v1 offset:4096
L_CH_A1_31:
    s_waitcnt lgkmcnt(4)
    v_smfmac_f32_16x16x64_bf16 v[12:15], v[36:39], a[0:7], v10
    s_waitcnt lgkmcnt(3)
    v_smfmac_f32_16x16x64_bf16 v[12:15], v[40:43], a[16:23], v10
    s_waitcnt lgkmcnt(2)
    v_smfmac_f32_16x16x64_bf16 v[12:15], v[44:47], a[32:39], v10
    s_waitcnt lgkmcnt(1)
    v_smfmac_f32_16x16x64_bf16 v[12:15], v[72:75], a[48:55], v10
    s_waitcnt lgkmcnt(0)
    v_smfmac_f32_16x16x64_bf16 v[12:15], v[76:79], a[64:71], v10
    v_smfmac_f32_16x16x64_bf16 v[16:19], v[36:39], a[8:15], v10
    v_smfmac_f32_16x16x64_bf16 v[16:19], v[40:43], a[24:31], v10
    s_add_u32 s69, s61, 2
    s_min_u32 s69, s69, 64
    s_mov_b32 m0, s85
    s_add_u32 s64, s98, s99
    s_nop 1
    v_cmp_u_f32 vcc, v12, v13
    v_cmp_u_f32 s[62:63], v14, v15
    v_smfmac_f32_16x16x64_bf16 v[16:19], v[44:47], a[40:47], v10
    s_or_b64 vcc, vcc, s[62:63]
    s_cbranch_scc1 L_CH_LRETRY_31
L_CH_LGO_31:
    buffer_load_dwordx4 v1, s[4:7], s98 offen sc1 lds
    s_add_u32 m0, s85, s99
    s_mov_b64 exec, 0xffff
    buffer_load_dwordx4 v1, s[4:7], s64 offen sc1 lds
    s_mov_b64 exec, -1
    v_smfmac_f32_16x16x64_bf16 v[16:19], v[72:75], a[56:63], v10
    v_smfmac_f32_16x16x64_bf16 v[16:19], v[76:79], a[72:79], v10
    v_smfmac_f32_16x16x64_bf16 v[28:31], v[36:39], v[56:63], v10
    ds_read_b128 v[56:59], v2 offset:51200
    ds_read_b128 v[60:63], v2 offset:52224
    v_smfmac_f32_16x16x64_bf16 v[20:23], v[36:39], v[64:71], v10
    v_xor_b32 v2, 0x10000, v2
    ds_read_b128 v[64:67], v2 offset:0
    ds_read_b128 v[68:71], v2 offset:1024
    v_smfmac_f32_16x16x64_bf16 v[32:35], v[36:39], v[48:55], v10
    ds_read_b128 v[48:51], v2 offset:2048
    ds_read_b128 v[52:55], v2 offset:3072
    v_smfmac_f32_16x16x64_bf16 v[20:23], v[40:43], a[208:215], v10
    v_mov_b32 v9, s61
    s_mov_b64 exec, 1
    buffer_store_dword v9, off, s[4:7], s78 sc1
    s_mov_b64 exec, -1
    s_waitcnt lgkmcnt(4)
    v_smfmac_f32_16x16x64_bf16 v[24:27], v[36:39], v[56:63], v10
    ds_read_b128 v[56:59], v2 offset:16384
    ds_read_b128 v[60:63], v2 offset:17408
    v_smfmac_f32_16x16x64_bf16 v[24:27], v[40:43], a[216:223], v10
    s_waitcnt lgkmcnt(4)
    v_smfmac_f32_16x16x64_bf16 v[28:31], v[40:43], v[64:71], v10
    ds_read_b128 v[64:67], v2 offset:18432
    ds_read_b128 v[68:71], v2 offset:19456
    v_smfmac_f32_16x16x64_bf16 v[20:23], v[44:47], a[224:231], v10
    s_waitcnt lgkmcnt(4)
    v_smfmac_f32_16x16x64_bf16 v[32:35], v[40:43], v[48:55], v10
    ds_read_b128 v[48:51], v2 offset:32768
    ds_read_b128 v[52:55], v2 offset:33792
    v_smfmac_f32_16x16x64_bf16 v[24:27], v[44:47], a[232:239], v10
    s_waitcnt lgkmcnt(4)
    v_smfmac_f32_16x16x64_bf16 v[28:31], v[44:47], v[56:63], v10
    ds_read_b128 v[56:59], v2 offset:34816
    ds_read_b128 v[60:63], v2 offset:35840
    s_waitcnt lgkmcnt(4)
    v_smfmac_f32_16x16x64_bf16 v[32:35], v[44:47], v[64:71], v10
    ds_read_b128 v[64:67], v2 offset:49152
    ds_read_b128 v[68:71], v2 offset:50176
    s_waitcnt lgkmcnt(4)
    v_smfmac_f32_16x16x64_bf16 v[28:31], v[72:75], v[48:55], v10
    ds_read_b128 v[48:51], v2 offset:51200
    ds_read_b128 v[52:55], v2 offset:52224
    s_waitcnt lgkmcnt(4)
    v_smfmac_f32_16x16x64_bf16 v[32:35], v[72:75], v[56:63], v10
    s_waitcnt vmcnt(1)
    s_barrier
    ds_read_b128 v[56:59], v1 offset:8192
    ds_read_b128 v[60:63], v1 offset:9216
    s_waitcnt lgkmcnt(4)
    v_smfmac_f32_16x16x64_bf16 v[28:31], v[76:79], v[64:71], v10
    ds_read_b128 v[64:67], v1 offset:5120
    ds_read_b128 v[68:71], v1 offset:6144
    s_waitcnt lgkmcnt(4)
    v_smfmac_f32_16x16x64_bf16 v[32:35], v[76:79], v[48:55], v10
    ds_read_b128 v[48:51], v1 offset:7168
    v_smfmac_f32_16x16x64_bf16 v[20:23], v[72:75], v[144:151], v10
    s_waitcnt lgkmcnt(4)
    v_smfmac_f32_16x16x64_bf16 v[12:15], v[56:59], a[128:135], v10
    s_waitcnt lgkmcnt(3)
    v_smfmac_f32_16x16x64_bf16 v[12:15], v[60:63], a[144:151], v10
    s_waitcnt lgkmcnt(2)
    v_smfmac_f32_16x16x64_bf16 v[12:15], v[64:67], a[80:87], v10
    s_waitcnt lgkmcnt(1)
    v_smfmac_f32_16x16x64_bf16 v[12:15], v[68:71], a[96:103], v10
    s_waitcnt lgkmcnt(0)
    v_smfmac_f32_16x16x64_bf16 v[12:15], v[48:51], a[112:119], v10
    s_cmp_lt_u32 s68, s69
    s_cbranch_scc1 L_kv_101
L_kvr_102:
    v_smfmac_f32_16x16x64_bf16 v[24:27], v[72:75], v[152:159], v10
    v_smfmac_f32_16x16x64_bf16 v[20:23], v[76:79], v[160:167], v10
    v_smfmac_f32_16x16x64_bf16 v[24:27], v[76:79], v[168:175], v10
    s_nop 2
    v_cmp_u_f32 vcc, v12, v13
    v_cmp_u_f32 s[62:63], v14, v15
    s_nop 0
    s_or_b64 vcc, vcc, s[62:63]
    s_cbranch_scc1 L_CH_RETRY_31
L_CH_C_31:
    v_smfmac_f32_16x16x64_bf16 v[16:19], v[64:67], a[88:95], v10
    buffer_load_dwordx4 v[72:75], v1, s[4:7], s76 offen sc1
    v_smfmac_f32_16x16x64_bf16 v[16:19], v[68:71], a[104:111], v10
    v_smfmac_f32_16x16x64_bf16 v[16:19], v[48:51], a[120:127], v10
    buffer_load_dwordx4 v[76:79], v1, s[4:7], s76 offen offset:1024 sc1
    s_add_u32 s76, s76, 262144
    v_smfmac_f32_16x16x64_bf16 v[16:19], v[56:59], a[136:143], v10
    v_pk_add_f32 v[12:13], v[12:13], v[14:15]
    v_smfmac_f32_16x16x64_bf16 v[16:19], v[60:63], a[152:159], v10
    ds_read_b128 v[36:39], v0 offset:0
    ds_read_b128 v[40:43], v0 offset:1024
    v_cvt_pk_bf16_f32 v14, v12, v13
    v_smfmac_f32_16x16x64_bf16 v[20:23], v[64:67], v[176:183], v10
    ds_read_b128 v[44:47], v0 offset:2048
    ds_read_b128 v[52:55], v0 offset:3072
    v_smfmac_f32_16x16x64_bf16 v[24:27], v[64:67], v[184:191], v10
    v_smfmac_f32_16x16x64_bf16 v[20:23], v[68:71], v[192:199], v10
    v_pk_add_f32 v[16:17], v[16:17], v[18:19]
    v_smfmac_f32_16x16x64_bf16 v[24:27], v[68:71], v[200:207], v10
    v_cvt_pk_bf16_f32 v18, v16, v17
    v_smfmac_f32_16x16x64_bf16 v[20:23], v[48:51], v[208:215], v10
    ds_write_b32 v4, v14 offset:0
    ds_write_b32 v4, v18 offset:528
    v_smfmac_f32_16x16x64_bf16 v[24:27], v[48:51], v[216:223], v10
    v_smfmac_f32_16x16x64_bf16 v[20:23], v[56:59], v[224:231], v10
    s_mov_b32 m0, s74
    s_xor_b32 s74, s74, s37
    buffer_load_dwordx4 v1, s[4:7], s73 offen sc1 lds
    v_smfmac_f32_16x16x64_bf16 v[24:27], v[56:59], v[232:239], v10
    v_smfmac_f32_16x16x64_bf16 v[20:23], v[60:63], v[240:247], v10
    buffer_load_dwordx4 v1, s[4:7], s73 offen offset:1024 sc1 lds
    s_add_u32 s73, s73, 262144
    v_smfmac_f32_16x16x64_bf16 v[24:27], v[60:63], v[248:255], v10
    s_waitcnt lgkmcnt(0)
    s_barrier
    ds_read_b64_tr_b16 v[12:13], v5 offset:0
    ds_read_b64_tr_b16 v[14:15], v5 offset:272
    v_smfmac_f32_16x16x64_bf16 v[28:31], v[64:67], v[80:87], v10
    ds_read_b64_tr_b16 v[16:17], v5 offset:1056
    ds_read_b64_tr_b16 v[18:19], v5 offset:1328
    v_pk_add_f32 v[20:21], v[20:21], v[22:23]
    v_smfmac_f32_16x16x64_bf16 v[32:35], v[64:67], v[88:95], v10
    ds_read_b64_tr_b16 v[64:65], v5 offset:2112
    ds_read_b64_tr_b16 v[66:67], v5 offset:2384
    v_pk_add_f32 v[24:25], v[24:25], v[26:27]
    v_cvt_pk_bf16_f32 v22, v20, v21
    v_smfmac_f32_16x16x64_bf16 v[28:31], v[68:71], v[96:103], v10
    v_cvt_pk_bf16_f32 v26, v24, v25
    ds_write_b32 v4, v22 offset:26624
    ds_write_b32 v4, v26 offset:27152
    v_smfmac_f32_16x16x64_bf16 v[32:35], v[68:71], v[104:111], v10
    ds_read_b64_tr_b16 v[68:69], v5 offset:3168
    ds_read_b64_tr_b16 v[70:71], v5 offset:3440
    v_smfmac_f32_16x16x64_bf16 v[28:31], v[48:51], v[112:119], v10
    v_smfmac_f32_16x16x64_bf16 v[32:35], v[48:51], v[120:127], v10
    ds_read_b128 v[48:51], v0 offset:4096
    v_smfmac_f32_16x16x64_bf16 v[28:31], v[56:59], v[128:135], v10
    v_smfmac_f32_16x16x64_bf16 v[32:35], v[56:59], v[136:143], v10
    ds_read_b128 v[56:59], v0 offset:5120
    v_smfmac_f32_16x16x64_bf16 v[28:31], v[60:63], a[240:247], v10
    v_smfmac_f32_16x16x64_bf16 v[32:35], v[60:63], a[248:255], v10
    s_waitcnt lgkmcnt(10)
    v_mfma_f32_16x16x32_bf16 v[60:63], v[36:39], v[12:15], 0
    ds_read_b128 v[36:39], v0 offset:6144
    s_waitcnt lgkmcnt(9)
    v_mfma_f32_16x16x32_bf16 v[60:63], v[40:43], v[16:19], v[60:63]
    ds_read_b128 v[40:43], v0 offset:7168
    s_waitcnt lgkmcnt(8)
    v_mfma_f32_16x16x32_bf16 v[60:63], v[44:47], v[64:67], v[60:63]
    v_cvt_pk_bf16_f32 v28, v28, v29
    v_cvt_pk_bf16_f32 v29, v30, v31
    s_waitcnt lgkmcnt(4)
    v_mfma_f32_16x16x32_bf16 v[60:63], v[52:55], v[68:71], v[60:63]
    v_cvt_pk_bf16_f32 v30, v32, v33
    v_cvt_pk_bf16_f32 v31, v34, v35
    s_cmp_eq_u32 s61, 63
    s_barrier
    s_cbranch_scc1 L_CH_LAST_31
    ds_read_b64_tr_b16 v[44:45], v5 offset:26624
    ds_read_b64_tr_b16 v[46:47], v5 offset:26896
    ds_read_b64_tr_b16 v[52:53], v5 offset:27680
    ds_read_b64_tr_b16 v[54:55], v5 offset:27952
    s_waitcnt lgkmcnt(7)
    v_mfma_f32_16x16x32_bf16 v[20:23], v[48:51], v[12:15], 0
    ds_read_b64_tr_b16 v[48:49], v5 offset:28736
    ds_read_b64_tr_b16 v[50:51], v5 offset:29008
    s_waitcnt lgkmcnt(8)
    v_mfma_f32_16x16x32_bf16 v[20:23], v[56:59], v[16:19], v[20:23]
    ds_read_b64_tr_b16 v[56:57], v5 offset:29792
    ds_read_b64_tr_b16 v[58:59], v5 offset:30064
    s_waitcnt lgkmcnt(9)
    v_mfma_f32_16x16x32_bf16 v[20:23], v[36:39], v[64:67], v[20:23]
    buffer_store_dwordx4 v[28:31], v1, s[4:7], s77 offen sc1
    s_waitcnt lgkmcnt(8)
    v_mfma_f32_16x16x32_bf16 v[20:23], v[40:43], v[68:71], v[20:23]
    v_xor_b32 v0, s75, v0
    s_waitcnt lgkmcnt(6)
    v_mfma_f32_16x16x32_bf16 v[24:27], v[44:47], v[12:15], 0
    v_max3_f32 v32, v60, v61, v62
    s_waitcnt lgkmcnt(4)
    v_mfma_f32_16x16x32_bf16 v[24:27], v[52:55], v[16:19], v[24:27]
    s_waitcnt lgkmcnt(2)
    v_mfma_f32_16x16x32_bf16 v[24:27], v[48:51], v[64:67], v[24:27]
    s_waitcnt lgkmcnt(0)
    v_mfma_f32_16x16x32_bf16 v[24:27], v[56:59], v[68:71], v[24:27]
    v_max3_f32 v32, v32, v63, v20
    v_max3_f32 v33, v21, v22, v23
    v_mov_b64 v[18:19], s[8:9]
    s_add_u32 s77, s77, 131072
    v_mov_b64 v[44:45], 0
    v_mov_b64 v[46:47], 0
    v_mov_b64 v[48:49], s[38:39]
    v_mov_b64 v[50:51], s[38:39]
    v_max_f32 v32, v32, v33
    v_max3_f32 v33, v32, v24, v25
    v_max3_f32 v32, v32, v24, v25
    v_mov_b64 v[56:57], 0
    v_mov_b64 v[58:59], 0
    v_permlane16_swap_b32 v32, v33
    v_max_f32 v34, v32, v33
    v_max_f32 v35, v32, v33
    v_mov_b64 v[64:65], 0
    v_mov_b64 v[66:67], 0
    v_permlane32_swap_b32 v34, v35
    v_max_f32 v32, v34, v35
    v_mul_f32 v32, s82, v32
    v_pk_fma_f32 v[60:61], v[60:61], s[82:83], v[32:33] op_sel_hi:[1,0,0] neg_lo:[0,0,1] neg_hi:[0,0,1]
    v_pk_fma_f32 v[62:63], v[62:63], s[82:83], v[32:33] op_sel_hi:[1,0,0] neg_lo:[0,0,1] neg_hi:[0,0,1]
    v_pk_fma_f32 v[20:21], v[20:21], s[82:83], v[32:33] op_sel_hi:[1,0,0] neg_lo:[0,0,1] neg_hi:[0,0,1]
    v_pk_fma_f32 v[22:23], v[22:23], s[82:83], v[32:33] op_sel_hi:[1,0,0] neg_lo:[0,0,1] neg_hi:[0,0,1]
    v_pk_fma_f32 v[24:25], v[24:25], s[82:83], v[32:33] op_sel_hi:[1,0,0] neg_lo:[0,0,1] neg_hi:[0,0,1]
    v_exp_f32 v60, v60
    v_exp_f32 v61, v61
    v_exp_f32 v62, v62
    v_cvt_pk_bf16_f32 v12, v60, v61
    v_exp_f32 v63, v63
    v_exp_f32 v20, v20
    v_cvt_pk_bf16_f32 v13, v62, v63
    v_exp_f32 v21, v21
    v_exp_f32 v22, v22
    v_cvt_pk_bf16_f32 v14, v20, v21
    v_exp_f32 v23, v23
    v_exp_f32 v24, v24
    v_cvt_pk_bf16_f32 v15, v22, v23
    v_exp_f32 v25, v25
    s_waitcnt vmcnt(3)
    v_mfma_f32_16x16x32_bf16 v[36:39], v[72:75], v[12:15], 0
    v_cvt_pk_bf16_f32 v16, v24, v25
    v_cvt_pk_bf16_f32 v17, v24, v25
    v_mfma_f32_16x16x32_bf16 v[40:43], v[76:79], v[12:15], 0
    s_add_u32 s81, s81, 16384
    s_and_b32 s81, s81, 0xffff
    s_add_u32 s61, s61, 1
    v_mfma_f32_16x16x16_bf16 v[36:39], v[28:29], v[16:17], v[36:39]
    v_mov_b64 v[68:69], 0
    v_mov_b64 v[70:71], 0
    v_mfma_f32_16x16x16_bf16 v[40:43], v[30:31], v[16:17], v[40:43]
    v_mfma_f32_16x16x32_bf16 v[24:27], v[12:15], v[48:51], 0
    v_xor_b32 v2, 0x10000, v2
    ds_read_b128 v[72:75], v2 offset:0
    ds_read_b128 v[76:79], v2 offset:1024
    v_mov_b64 v[52:53], 0
    v_mov_b64 v[54:55], 0
    s_mov_b64 exec, s[94:95]
    v_cvt_pk_bf16_f32 v36, v36, v37
    v_cvt_pk_bf16_f32 v37, v38, v39
    v_cvt_pk_bf16_f32 v38, v40, v41
    v_cvt_pk_bf16_f32 v39, v42, v43
    ds_write_b128 v6, v[36:39]
    s_mov_b64 exec, -1
    v_mfma_f32_16x16x16_bf16 v[24:27], v[16:17], v[18:19], v[24:27]
    ds_read_b128 v[12:15], v2 offset:2048
    ds_read_b128 v[16:19], v2 offset:3072
    s_add_u32 s63, s90, s81
    s_add_u32 s91, s91, 32768
    s_add_u32 s98, s98, 32768
    s_add_u32 s89, s89, 32768
    s_add_u32 s65, s88, s81
    s_mov_b32 s60, 0
    v_rcp_f32 v60, v24
    v_rcp_f32 v61, v25
    s_waitcnt lgkmcnt(2)
    s_barrier
    ds_read_b128 v[48:51], v1 offset:0
    ds_read_b128 v[32:35], v1 offset:1024
    s_waitcnt lgkmcnt(1)
    v_smfmac_f32_16x16x64_bf16 v[68:71], v[48:51], v[72:79], v10
    ds_read_b128 v[72:75], v2 offset:16384
    ds_read_b128 v[76:79], v2 offset:17408
    v_smfmac_f32_16x16x64_bf16 v[44:47], v[48:51], v[12:19], v10
    ds_read_b128 v[12:15], v2 offset:18432
    ds_read_b128 v[16:19], v2 offset:19456
    s_waitcnt lgkmcnt(4)
    v_smfmac_f32_16x16x64_bf16 v[68:71], v[32:35], a[200:207], v10
    v_smfmac_f32_16x16x64_bf16 v[44:47], v[32:35], a[176:183], v10
    v_smfmac_f32_16x16x64_bf16 v[52:55], v[48:51], a[160:167], v10
    v_smfmac_f32_16x16x64_bf16 v[52:55], v[32:35], a[184:191], v10
    v_smfmac_f32_16x16x64_bf16 v[56:59], v[48:51], a[168:175], v10
    v_smfmac_f32_16x16x64_bf16 v[56:59], v[32:35], a[192:199], v10
    s_waitcnt lgkmcnt(2)
    v_smfmac_f32_16x16x64_bf16 v[64:67], v[48:51], v[72:79], v10
    s_waitcnt lgkmcnt(0)
    v_smfmac_f32_16x16x64_bf16 v[64:67], v[32:35], v[12:19], v10
    v_pk_add_f32 v[68:69], v[68:69], v[70:71]
    v_pk_add_f32 v[44:45], v[44:45], v[46:47]
    v_pk_add_f32 v[52:53], v[52:53], v[54:55]
    s_nop 0
    v_pk_add_f32 v[56:57], v[56:57], v[58:59]
    v_pk_mul_f32 v[68:69], v[68:69], v[60:61]
    v_pk_mul_f32 v[44:45], v[44:45], v[60:61]
    v_pk_mul_f32 v[52:53], v[52:53], v[60:61]
    v_pk_mul_f32 v[56:57], v[56:57], v[60:61]
    v_pk_add_f32 v[64:65], v[64:65], v[66:67]
    v_cvt_pk_bf16_f32 v40, v68, v69
    v_cvt_pk_bf16_f32 v36, v44, v45
    v_pk_mul_f32 v[64:65], v[64:65], v[60:61]
    buffer_store_dword v40, v8, s[4:7], s79 offen
    v_cvt_pk_bf16_f32 v37, v52, v53
    v_cvt_pk_bf16_f32 v38, v56, v57
    v_cvt_pk_bf16_f32 v39, v64, v65
    buffer_store_dwordx4 v[36:39], v7, s[4:7], s79 offen
    s_xor_b32 s79, s79, s92
    v_mov_b64 v[32:33], 0
    v_mov_b64 v[34:35], 0
    v_mov_b64 v[12:13], 0
    v_mov_b64 v[14:15], 0
    v_mov_b64 v[16:17], 0
    v_mov_b64 v[18:19], 0
    v_mov_b64 v[20:21], 0
    v_mov_b64 v[22:23], 0
    v_mov_b64 v[24:25], 0
    v_mov_b64 v[26:27], 0
    v_mov_b64 v[28:29], 0
    v_mov_b64 v[30:31], 0
    s_min_u32 s62, s0, s1
    s_max_u32 s68, s68, s62
    s_buffer_load_dword s0, s[4:7], s84 glc
    s_buffer_load_dword s1, s[4:7], s36 glc
L_sr_103:
L_CH_NORED_31:
    ds_read_b128 v[56:59], v2 offset:32768
    ds_read_b128 v[60:63], v2 offset:33792
    ds_read_b128 v[64:67], v2 offset:49152
    ds_read_b128 v[68:71], v2 offset:50176
    ds_read_b128 v[48:51], v2 offset:34816
    ds_read_b128 v[52:55], v2 offset:35840
    s_barrier
    v_mov_b64 v[36:37], -1
    v_mov_b64 v[38:39], -1
    s_sleep 1
    s_sleep 1
    s_sleep 1
    s_sleep 1
    s_nop 11
    s_mov_b32 m0, s100
    s_add_u32 s64, s65, s99
    buffer_load_dwordx4 v1, s[4:7], s65 offen sc1 lds
    s_add_u32 m0, s100, s99
    s_mov_b64 exec, 0xffff
    buffer_load_dwordx4 v1, s[4:7], s64 offen sc1 lds
    s_mov_b64 exec, -1
    s_nop 11
    s_mov_b32 m0, s100
    s_add_u32 s64, s65, s99
    buffer_load_dwordx4 v1, s[4:7], s65 offen sc1 lds
    s_add_u32 m0, s100, s99
    s_mov_b64 exec, 0xffff
    buffer_load_dwordx4 v1, s[4:7], s64 offen sc1 lds
    s_mov_b64 exec, -1
    s_add_u32 s63, s101, s10
    buffer_store_dwordx4 v[36:39], v1, s[4:7], s101 offen
    s_mov_b64 exec, s[42:43]
    buffer_store_dwordx4 v[36:39], v1, s[4:7], s63 offen
    s_xor_b32 s101, s101, s40
    s_mov_b64 exec, -1
    s_waitcnt vmcnt(4)
    s_barrier
    ds_read_b128 v[36:39], v1 offset:0
    ds_read_b128 v[40:43], v1 offset:1024
    ds_read_b128 v[44:47], v1 offset:2048
    ds_read_b128 v[72:75], v1 offset:3072
    ds_read_b128 v[76:79], v1 offset:4096
    s_branch L_CH_A1_31
L_CH_LRETRY_31:
    s_add_u32 s60, s60, 1
    s_cmp_lg_u32 s60, 1
    s_cbranch_scc1 L_ln_104
    v_mov_b64 v[12:13], 0
    v_mov_b64 v[14:15], 0
    s_nop 0
    v_mov_b64 v[16:17], 0
    v_mov_b64 v[18:19], 0
    s_waitcnt vmcnt(0)
    s_branch L_CH_LOOP_31
L_ln_104:
    v_max3_u32 v9, v36, v37, v38
    v_max3_u32 v9, v9, v38, v39
    v_max3_u32 v9, v9, v40, v41
    v_max3_u32 v9, v9, v42, v43
    v_max3_u32 v9, v9, v44, v45
    v_max3_u32 v9, v9, v46, v47
    v_max3_u32 v9, v9, v72, v73
    v_max3_u32 v9, v9, v74, v75
    v_max3_u32 v9, v9, v76, v77
    v_max3_u32 v9, v9, v78, v79
    v_cmp_eq_u32 vcc, -1, v9
    s_nop 0
    s_cbranch_vccz L_CH_LGO_31
    s_cmp_ge_u32 s60, 0x100000
    s_movk_i32 s62, 15
    s_cbranch_scc1 L_ABORT
    s_sub_u32 s63, s65, s2
    s_mov_b32 m0, 131072
    s_add_u32 s64, s63, 4096
    buffer_load_dwordx4 v1, s[4:7], s63 offen offset:0 sc1 lds
    buffer_load_dwordx4 v1, s[4:7], s63 offen offset:1024 sc1 lds
    buffer_load_dwordx4 v1, s[4:7], s63 offen offset:2048 sc1 lds
    buffer_load_dwordx4 v1, s[4:7], s63 offen offset:3072 sc1 lds
    s_mov_b32 m0, 135168
    s_nop 0
    buffer_load_dwordx4 v1, s[4:7], s64 offen sc1 lds
    v_mov_b64 v[12:13], 0
    v_mov_b64 v[14:15], 0
    v_mov_b64 v[16:17], 0
    v_mov_b64 v[18:19], 0
    s_waitcnt vmcnt(0)
    s_branch L_CH_LOOP_31
L_CH_RETRY_31:
    s_mov_b32 s60, 0
    s_sleep 1
    s_sleep 1
    s_mov_b32 m0, s85
    s_add_u32 s64, s98, s99
    buffer_load_dwordx4 v1, s[4:7], s98 offen sc1 lds
    s_add_u32 m0, s85, s99
    s_mov_b64 exec, 0xffff
    buffer_load_dwordx4 v1, s[4:7], s64 offen sc1 lds
    s_mov_b64 exec, -1
    s_branch L_CH_RETRY2_31
L_CH_RETRY1_31:
    s_mov_b32 s63, s89
    s_mov_b32 m0, 136192
    s_add_u32 s64, s63, 4096
    buffer_load_dwordx4 v1, s[4:7], s63 offen offset:0 sc1 lds
    buffer_load_dwordx4 v1, s[4:7], s63 offen offset:1024 sc1 lds
    buffer_load_dwordx4 v1, s[4:7], s63 offen offset:2048 sc1 lds
    buffer_load_dwordx4 v1, s[4:7], s63 offen offset:3072 sc1 lds
    s_mov_b32 m0, 140288
    s_nop 0
    buffer_load_dwordx4 v1, s[4:7], s64 offen sc1 lds
L_CH_RETRY2_31:
    s_waitcnt vmcnt(0)
    ds_read_b128 v[64:67], v1 offset:5120
    ds_read_b128 v[68:71], v1 offset:6144
    ds_read_b128 v[48:51], v1 offset:7168
    ds_read_b128 v[56:59], v1 offset:8192
    ds_read_b128 v[60:63], v1 offset:9216
    s_waitcnt lgkmcnt(0)
L_CH_RETRY3_31:
    v_max3_u32 v9, v64, v65, v66
    v_max_u32 v9, v9, v67
    v_max3_u32 v9, v9, v68, v69
    v_max3_u32 v9, v9, v70, v71
    v_max3_u32 v9, v9, v48, v49
    v_max3_u32 v9, v9, v50, v51
    v_max3_u32 v9, v9, v56, v57
    v_max3_u32 v9, v9, v58, v59
    v_max3_u32 v9, v9, v60, v61
    v_max3_u32 v9, v9, v62, v63
    v_cmp_eq_u32 vcc, -1, v9
    s_nop 0
    s_cbranch_vccz L_CH_REDO_31
    s_add_u32 s60, s60, 1
    s_cmp_lt_u32 s60, 0x100000
    s_cbranch_scc1 L_CH_RETRY1_31
    s_movk_i32 s62, 13
    s_branch L_ABORT
L_CH_REDO_31:
    v_mov_b64 v[12:13], 0
    v_mov_b64 v[14:15], 0
    s_nop 1
    v_smfmac_f32_16x16x64_bf16 v[12:15], v[36:39], a[0:7], v10
    v_smfmac_f32_16x16x64_bf16 v[12:15], v[40:43], a[16:23], v10
    v_smfmac_f32_16x16x64_bf16 v[12:15], v[44:47], a[32:39], v10
    v_smfmac_f32_16x16x64_bf16 v[12:15], v[72:75], a[48:55], v10
    v_smfmac_f32_16x16x64_bf16 v[12:15], v[76:79], a[64:71], v10
    v_smfmac_f32_16x16x64_bf16 v[12:15], v[56:59], a[128:135], v10
    v_smfmac_f32_16x16x64_bf16 v[12:15], v[60:63], a[144:151], v10
    v_smfmac_f32_16x16x64_bf16 v[12:15], v[64:67], a[80:87], v10
    v_smfmac_f32_16x16x64_bf16 v[12:15], v[68:71], a[96:103], v10
    v_smfmac_f32_16x16x64_bf16 v[12:15], v[48:51], a[112:119], v10
    s_branch L_CH_C_31
L_CH_LAST_31:
    buffer_store_dwordx4 v[28:31], v1, s[4:7], s77 offen sc1
    s_add_u32 s77, s77, 131072
    s_waitcnt vmcnt(0)
    v_mov_b32 v62, 0
    v_mov_b32 v63, 64
    s_mov_b64 exec, 1
    buffer_store_dword v63, v62, s[4:7], s78 offen sc1
    s_mov_b64 exec, -1
    s_branch L_END2
L_kv_101:
    v_bfe_u32 v52, v1, 4, 1
    v_lshlrev_b32 v52, 5, v52
    v_add_u32 v52, s46, v52
    v_add_u32 v52, 64, v52
    v_lshlrev_b32 v52, 6, v52
    s_mov_b32 s60, 0
L_pf_105:
    buffer_load_dword v53, v52, s[4:7], 0 offen sc1
    s_waitcnt vmcnt(0)
    v_cmp_gt_u32 vcc, s69, v53
    s_nop 0
    s_cbranch_vccz L_pfd_106
    s_sleep 1
    s_add_u32 s60, s60, 1
    s_cmp_lt_u32 s60, 0x100000
    s_cbranch_scc1 L_pf_105
    s_movk_i32 s62, 11
    s_branch L_ABORT
L_pfd_106:
    v_readlane_b32 s68, v53, 0
    v_readlane_b32 s62, v53, 1
    s_nop 0
    s_min_u32 s68, s68, s62
    s_branch L_kvr_102
L_kv_99:
    v_bfe_u32 v52, v1, 4, 1
    v_lshlrev_b32 v52, 5, v52
    v_add_u32 v52, s46, v52
    v_add_u32 v52, 64, v52
    v_lshlrev_b32 v52, 6, v52
    s_mov_b32 s60, 0
L_pf_107:
    buffer_load_dword v53, v52, s[4:7], 0 offen sc1
    s_waitcnt vmcnt(0)
    v_cmp_gt_u32 vcc, s69, v53
    s_nop 0
    s_cbranch_vccz L_pfd_108
    s_sleep 1
    s_add_u32 s60, s60, 1
    s_cmp_lt_u32 s60, 0x100000
    s_cbranch_scc1 L_pf_107
    s_movk_i32 s62, 11
    s_branch L_ABORT
L_pfd_108:
    v_readlane_b32 s68, v53, 0
    v_readlane_b32 s62, v53, 1
    s_nop 0
    s_min_u32 s68, s68, s62
    s_branch L_kvr_100
L_CH_FIRST_G:
    ds_read_b128 v[36:39], v1 offset:0
    ds_read_b128 v[40:43], v1 offset:1024
    ds_read_b128 v[44:47], v1 offset:2048
    ds_read_b128 v[72:75], v1 offset:3072
    ds_read_b128 v[76:79], v1 offset:4096
    s_waitcnt lgkmcnt(4)
    v_smfmac_f32_16x16x64_bf16 v[12:15], v[36:39], a[0:7], v10
    s_waitcnt lgkmcnt(3)
    v_smfmac_f32_16x16x64_bf16 v[12:15], v[40:43], a[16:23], v10
    s_waitcnt lgkmcnt(2)
    v_smfmac_f32_16x16x64_bf16 v[12:15], v[44:47], a[32:39], v10
    s_waitcnt lgkmcnt(1)
    v_smfmac_f32_16x16x64_bf16 v[12:15], v[72:75], a[48:55], v10
    s_waitcnt lgkmcnt(0)
    v_smfmac_f32_16x16x64_bf16 v[12:15], v[76:79], a[64:71], v10
    v_smfmac_f32_16x16x64_bf16 v[16:19], v[36:39], a[8:15], v10
    v_smfmac_f32_16x16x64_bf16 v[16:19], v[40:43], a[24:31], v10
    v_smfmac_f32_16x16x64_bf16 v[16:19], v[44:47], a[40:47], v10
    v_smfmac_f32_16x16x64_bf16 v[16:19], v[72:75], a[56:63], v10
    v_smfmac_f32_16x16x64_bf16 v[16:19], v[76:79], a[72:79], v10
    v_smfmac_f32_16x16x64_bf16 v[28:31], v[36:39], v[56:63], v10
    ds_read_b128 v[56:59], v2 offset:51200
    ds_read_b128 v[60:63], v2 offset:52224
    v_smfmac_f32_16x16x64_bf16 v[20:23], v[36:39], v[64:71], v10
    v_xor_b32 v2, 0x10000, v2
    ds_read_b128 v[64:67], v2 offset:0
    ds_read_b128 v[68:71], v2 offset:1024
    v_smfmac_f32_16x16x64_bf16 v[32:35], v[36:39], v[48:55], v10
    ds_read_b128 v[48:51], v2 offset:2048
    ds_read_b128 v[52:55], v2 offset:3072
    v_smfmac_f32_16x16x64_bf16 v[20:23], v[40:43], a[208:215], v10
    s_waitcnt lgkmcnt(4)
    v_smfmac_f32_16x16x64_bf16 v[24:27], v[36:39], v[56:63], v10
    ds_read_b128 v[56:59], v2 offset:16384
    ds_read_b128 v[60:63], v2 offset:17408
    v_smfmac_f32_16x16x64_bf16 v[24:27], v[40:43], a[216:223], v10
    s_waitcnt lgkmcnt(4)
    v_smfmac_f32_16x16x64_bf16 v[28:31], v[40:43], v[64:71], v10
    ds_read_b128 v[64:67], v2 offset:18432
    ds_read_b128 v[68:71], v2 offset:19456
    v_smfmac_f32_16x16x64_bf16 v[20:23], v[44:47], a[224:231], v10
    s_waitcnt lgkmcnt(4)
    v_smfmac_f32_16x16x64_bf16 v[32:35], v[40:43], v[48:55], v10
    ds_read_b128 v[48:51], v2 offset:32768
    ds_read_b128 v[52:55], v2 offset:33792
    v_smfmac_f32_16x16x64_bf16 v[24:27], v[44:47], a[232:239], v10
    s_waitcnt lgkmcnt(4)
    v_smfmac_f32_16x16x64_bf16 v[28:31], v[44:47], v[56:63], v10
    ds_read_b128 v[56:59], v2 offset:34816
    ds_read_b128 v[60:63], v2 offset:35840
    s_waitcnt lgkmcnt(4)
    v_smfmac_f32_16x16x64_bf16 v[32:35], v[44:47], v[64:71], v10
    ds_read_b128 v[64:67], v2 offset:49152
    ds_read_b128 v[68:71], v2 offset:50176
    s_waitcnt lgkmcnt(4)
    v_smfmac_f32_16x16x64_bf16 v[28:31], v[72:75], v[48:55], v10
    ds_read_b128 v[48:51], v2 offset:51200
    ds_read_b128 v[52:55], v2 offset:52224
    s_waitcnt lgkmcnt(4)
    v_smfmac_f32_16x16x64_bf16 v[32:35], v[72:75], v[56:63], v10
    s_barrier
    s_mov_b32 s69, 2
    ds_read_b128 v[56:59], v1 offset:8192
    ds_read_b128 v[60:63], v1 offset:9216
    s_waitcnt lgkmcnt(4)
    v_smfmac_f32_16x16x64_bf16 v[28:31], v[76:79], v[64:71], v10
    ds_read_b128 v[64:67], v1 offset:5120
    ds_read_b128 v[68:71], v1 offset:6144
    s_waitcnt lgkmcnt(4)
    v_smfmac_f32_16x16x64_bf16 v[32:35], v[76:79], v[48:55], v10
    ds_read_b128 v[48:51], v1 offset:7168
    v_smfmac_f32_16x16x64_bf16 v[20:23], v[72:75], v[144:151], v10
    s_waitcnt lgkmcnt(4)
    v_smfmac_f32_16x16x64_bf16 v[12:15], v[56:59], a[128:135], v10
    s_waitcnt lgkmcnt(3)
    v_smfmac_f32_16x16x64_bf16 v[12:15], v[60:63], a[144:151], v10
    s_waitcnt lgkmcnt(2)
    v_smfmac_f32_16x16x64_bf16 v[12:15], v[64:67], a[80:87], v10
    s_waitcnt lgkmcnt(1)
    v_smfmac_f32_16x16x64_bf16 v[12:15], v[68:71], a[96:103], v10
    s_waitcnt lgkmcnt(0)
    v_smfmac_f32_16x16x64_bf16 v[12:15], v[48:51], a[112:119], v10
    s_cmp_lt_u32 s68, s69
    s_cbranch_scc1 L_kv_109
L_kvr_110:
    v_smfmac_f32_16x16x64_bf16 v[24:27], v[72:75], v[152:159], v10
    v_smfmac_f32_16x16x64_bf16 v[20:23], v[76:79], v[160:167], v10
    v_smfmac_f32_16x16x64_bf16 v[24:27], v[76:79], v[168:175], v10
    s_branch L_CH_C_G
    .p2align 6
L_CH_B1_G:
    s_barrier
L_CH_LOOP_G:
    ds_read_b128 v[36:39], v1 offset:0
    ds_read_b128 v[40:43], v1 offset:1024
    ds_read_b128 v[44:47], v1 offset:2048
    ds_read_b128 v[72:75], v1 offset:3072
    ds_read_b128 v[76:79], v1 offset:4096
L_CH_A1_G:
    s_waitcnt lgkmcnt(4)
    v_smfmac_f32_16x16x64_bf16 v[12:15], v[36:39], a[0:7], v10
    s_waitcnt lgkmcnt(3)
    v_smfmac_f32_16x16x64_bf16 v[12:15], v[40:43], a[16:23], v10
    s_waitcnt lgkmcnt(2)
    v_smfmac_f32_16x16x64_bf16 v[12:15], v[44:47], a[32:39], v10
    s_waitcnt lgkmcnt(1)
    v_smfmac_f32_16x16x64_bf16 v[12:15], v[72:75], a[48:55], v10
    s_waitcnt lgkmcnt(0)
    v_smfmac_f32_16x16x64_bf16 v[12:15], v[76:79], a[64:71], v10
    v_smfmac_f32_16x16x64_bf16 v[16:19], v[36:39], a[8:15], v10
    v_smfmac_f32_16x16x64_bf16 v[16:19], v[40:43], a[24:31], v10
    s_add_u32 s69, s61, 2
    s_min_u32 s69, s69, 64
    s_mov_b32 m0, s85
    s_add_u32 s64, s98, s99
    s_nop 1
    v_cmp_u_f32 vcc, v12, v13
    v_cmp_u_f32 s[62:63], v14, v15
    v_smfmac_f32_16x16x64_bf16 v[16:19], v[44:47], a[40:47], v10
    s_or_b64 vcc, vcc, s[62:63]
    s_cbranch_scc1 L_CH_LRETRY_G
L_CH_LGO_G:
    buffer_load_dwordx4 v1, s[4:7], s98 offen sc1 lds
    s_add_u32 m0, s85, s99
    s_mov_b64 exec, 0xffff
    buffer_load_dwordx4 v1, s[4:7], s64 offen sc1 lds
    s_mov_b64 exec, -1
    v_smfmac_f32_16x16x64_bf16 v[16:19], v[72:75], a[56:63], v10
    v_smfmac_f32_16x16x64_bf16 v[16:19], v[76:79], a[72:79], v10
    v_smfmac_f32_16x16x64_bf16 v[28:31], v[36:39], v[56:63], v10
    ds_read_b128 v[56:59], v2 offset:51200
    ds_read_b128 v[60:63], v2 offset:52224
    v_smfmac_f32_16x16x64_bf16 v[20:23], v[36:39], v[64:71], v10
    v_xor_b32 v2, 0x10000, v2
    ds_read_b128 v[64:67], v2 offset:0
    ds_read_b128 v[68:71], v2 offset:1024
    v_smfmac_f32_16x16x64_bf16 v[32:35], v[36:39], v[48:55], v10
    ds_read_b128 v[48:51], v2 offset:2048
    ds_read_b128 v[52:55], v2 offset:3072
    v_smfmac_f32_16x16x64_bf16 v[20:23], v[40:43], a[208:215], v10
    v_mov_b32 v9, s61
    s_mov_b64 exec, 1
    buffer_store_dword v9, off, s[4:7], s78 sc1
    s_mov_b64 exec, -1
    s_waitcnt lgkmcnt(4)
    v_smfmac_f32_16x16x64_bf16 v[24:27], v[36:39], v[56:63], v10
    ds_read_b128 v[56:59], v2 offset:16384
    ds_read_b128 v[60:63], v2 offset:17408
    v_smfmac_f32_16x16x64_bf16 v[24:27], v[40:43], a[216:223], v10
    s_waitcnt lgkmcnt(4)
    v_smfmac_f32_16x16x64_bf16 v[28:31], v[40:43], v[64:71], v10
    ds_read_b128 v[64:67], v2 offset:18432
    ds_read_b128 v[68:71], v2 offset:19456
    v_smfmac_f32_16x16x64_bf16 v[20:23], v[44:47], a[224:231], v10
    s_waitcnt lgkmcnt(4)
    v_smfmac_f32_16x16x64_bf16 v[32:35], v[40:43], v[48:55], v10
    ds_read_b128 v[48:51], v2 offset:32768
    ds_read_b128 v[52:55], v2 offset:33792
    v_smfmac_f32_16x16x64_bf16 v[24:27], v[44:47], a[232:239], v10
    s_waitcnt lgkmcnt(4)
    v_smfmac_f32_16x16x64_bf16 v[28:31], v[44:47], v[56:63], v10
    ds_read_b128 v[56:59], v2 offset:34816
    ds_read_b128 v[60:63], v2 offset:35840
    s_waitcnt lgkmcnt(4)
    v_smfmac_f32_16x16x64_bf16 v[32:35], v[44:47], v[64:71], v10
    ds_read_b128 v[64:67], v2 offset:49152
    ds_read_b128 v[68:71], v2 offset:50176
    s_waitcnt lgkmcnt(4)
    v_smfmac_f32_16x16x64_bf16 v[28:31], v[72:75], v[48:55], v10
    ds_read_b128 v[48:51], v2 offset:51200
    ds_read_b128 v[52:55], v2 offset:52224
    s_waitcnt lgkmcnt(4)
    v_smfmac_f32_16x16x64_bf16 v[32:35], v[72:75], v[56:63], v10
    s_waitcnt vmcnt(1)
    s_barrier
    ds_read_b128 v[56:59], v1 offset:8192
    ds_read_b128 v[60:63], v1 offset:9216
    s_waitcnt lgkmcnt(4)
    v_smfmac_f32_16x16x64_bf16 v[28:31], v[76:79], v[64:71], v10
    ds_read_b128 v[64:67], v1 offset:5120
    ds_read_b128 v[68:71], v1 offset:6144
    s_waitcnt lgkmcnt(4)
    v_smfmac_f32_16x16x64_bf16 v[32:35], v[76:79], v[48:55], v10
    ds_read_b128 v[48:51], v1 offset:7168
    v_smfmac_f32_16x16x64_bf16 v[20:23], v[72:75], v[144:151], v10
    s_waitcnt lgkmcnt(4)
    v_smfmac_f32_16x16x64_bf16 v[12:15], v[56:59], a[128:135], v10
    s_waitcnt lgkmcnt(3)
    v_smfmac_f32_16x16x64_bf16 v[12:15], v[60:63], a[144:151], v10
    s_waitcnt lgkmcnt(2)
    v_smfmac_f32_16x16x64_bf16 v[12:15], v[64:67], a[80:87], v10
    s_waitcnt lgkmcnt(1)
    v_smfmac_f32_16x16x64_bf16 v[12:15], v[68:71], a[96:103], v10
    s_waitcnt lgkmcnt(0)
    v_smfmac_f32_16x16x64_bf16 v[12:15], v[48:51], a[112:119], v10
    s_cmp_lt_u32 s68, s69
    s_cbranch_scc1 L_kv_111
L_kvr_112:
    v_smfmac_f32_16x16x64_bf16 v[24:27], v[72:75], v[152:159], v10
    v_smfmac_f32_16x16x64_bf16 v[20:23], v[76:79], v[160:167], v10
    v_smfmac_f32_16x16x64_bf16 v[24:27], v[76:79], v[168:175], v10
    s_nop 2
    v_cmp_u_f32 vcc, v12, v13
    v_cmp_u_f32 s[62:63], v14, v15
    s_nop 0
    s_or_b64 vcc, vcc, s[62:63]
    s_cbranch_scc1 L_CH_RETRY_G
L_CH_C_G:
    v_smfmac_f32_16x16x64_bf16 v[16:19], v[64:67], a[88:95], v10
    buffer_load_dwordx4 v[72:75], v1, s[4:7], s76 offen sc1
    v_smfmac_f32_16x16x64_bf16 v[16:19], v[68:71], a[104:111], v10
    v_smfmac_f32_16x16x64_bf16 v[16:19], v[48:51], a[120:127], v10
    buffer_load_dwordx4 v[76:79], v1, s[4:7], s76 offen offset:1024 sc1
    s_add_u32 s76, s76, 262144
    v_smfmac_f32_16x16x64_bf16 v[16:19], v[56:59], a[136:143], v10
    v_pk_add_f32 v[12:13], v[12:13], v[14:15]
    v_smfmac_f32_16x16x64_bf16 v[16:19], v[60:63], a[152:159], v10
    ds_read_b128 v[36:39], v0 offset:0
    ds_read_b128 v[40:43], v0 offset:1024
    v_cvt_pk_bf16_f32 v14, v12, v13
    v_smfmac_f32_16x16x64_bf16 v[20:23], v[64:67], v[176:183], v10
    ds_read_b128 v[44:47], v0 offset:2048
    ds_read_b128 v[52:55], v0 offset:3072
    v_smfmac_f32_16x16x64_bf16 v[24:27], v[64:67], v[184:191], v10
    v_smfmac_f32_16x16x64_bf16 v[20:23], v[68:71], v[192:199], v10
    v_pk_add_f32 v[16:17], v[16:17], v[18:19]
    v_smfmac_f32_16x16x64_bf16 v[24:27], v[68:71], v[200:207], v10
    v_cvt_pk_bf16_f32 v18, v16, v17
    v_smfmac_f32_16x16x64_bf16 v[20:23], v[48:51], v[208:215], v10
    ds_write_b32 v4, v14 offset:0
    ds_write_b32 v4, v18 offset:528
    v_smfmac_f32_16x16x64_bf16 v[24:27], v[48:51], v[216:223], v10
    v_smfmac_f32_16x16x64_bf16 v[20:23], v[56:59], v[224:231], v10
    s_mov_b32 m0, s74
    s_xor_b32 s74, s74, s37
    buffer_load_dwordx4 v1, s[4:7], s73 offen sc1 lds
    v_smfmac_f32_16x16x64_bf16 v[24:27], v[56:59], v[232:239], v10
    v_smfmac_f32_16x16x64_bf16 v[20:23], v[60:63], v[240:247], v10
    buffer_load_dwordx4 v1, s[4:7], s73 offen offset:1024 sc1 lds
    s_add_u32 s73, s73, 262144
    v_smfmac_f32_16x16x64_bf16 v[24:27], v[60:63], v[248:255], v10
    s_waitcnt lgkmcnt(0)
    s_barrier
    ds_read_b64_tr_b16 v[12:13], v5 offset:0
    ds_read_b64_tr_b16 v[14:15], v5 offset:272
    v_smfmac_f32_16x16x64_bf16 v[28:31], v[64:67], v[80:87], v10
    ds_read_b64_tr_b16 v[16:17], v5 offset:1056
    ds_read_b64_tr_b16 v[18:19], v5 offset:1328
    v_pk_add_f32 v[20:21], v[20:21], v[22:23]
    v_smfmac_f32_16x16x64_bf16 v[32:35], v[64:67], v[88:95], v10
    ds_read_b64_tr_b16 v[64:65], v5 offset:2112
    ds_read_b64_tr_b16 v[66:67], v5 offset:2384
    v_pk_add_f32 v[24:25], v[24:25], v[26:27]
    v_cvt_pk_bf16_f32 v22, v20, v21
    v_smfmac_f32_16x16x64_bf16 v[28:31], v[68:71], v[96:103], v10
    v_cvt_pk_bf16_f32 v26, v24, v25
    ds_write_b32 v4, v22 offset:26624
    ds_write_b32 v4, v26 offset:27152
    v_smfmac_f32_16x16x64_bf16 v[32:35], v[68:71], v[104:111], v10
    ds_read_b64_tr_b16 v[68:69], v5 offset:3168
    ds_read_b64_tr_b16 v[70:71], v5 offset:3440
    v_smfmac_f32_16x16x64_bf16 v[28:31], v[48:51], v[112:119], v10
    v_smfmac_f32_16x16x64_bf16 v[32:35], v[48:51], v[120:127], v10
    ds_read_b128 v[48:51], v0 offset:4096
    v_smfmac_f32_16x16x64_bf16 v[28:31], v[56:59], v[128:135], v10
    v_smfmac_f32_16x16x64_bf16 v[32:35], v[56:59], v[136:143], v10
    ds_read_b128 v[56:59], v0 offset:5120
    v_smfmac_f32_16x16x64_bf16 v[28:31], v[60:63], a[240:247], v10
    v_smfmac_f32_16x16x64_bf16 v[32:35], v[60:63], a[248:255], v10
    s_waitcnt lgkmcnt(10)
    v_mfma_f32_16x16x32_bf16 v[60:63], v[36:39], v[12:15], 0
    ds_read_b128 v[36:39], v0 offset:6144
    s_waitcnt lgkmcnt(9)
    v_mfma_f32_16x16x32_bf16 v[60:63], v[40:43], v[16:19], v[60:63]
    ds_read_b128 v[40:43], v0 offset:7168
    s_waitcnt lgkmcnt(8)
    v_mfma_f32_16x16x32_bf16 v[60:63], v[44:47], v[64:67], v[60:63]
    v_cvt_pk_bf16_f32 v28, v28, v29
    v_cvt_pk_bf16_f32 v29, v30, v31
    s_waitcnt lgkmcnt(4)
    v_mfma_f32_16x16x32_bf16 v[60:63], v[52:55], v[68:71], v[60:63]
    v_cvt_pk_bf16_f32 v30, v32, v33
    v_cvt_pk_bf16_f32 v31, v34, v35
    s_cmp_eq_u32 s61, 63
    s_barrier
    s_cbranch_scc1 L_CH_LAST_G
    ds_read_b64_tr_b16 v[44:45], v5 offset:26624
    ds_read_b64_tr_b16 v[46:47], v5 offset:26896
    ds_read_b64_tr_b16 v[52:53], v5 offset:27680
    ds_read_b64_tr_b16 v[54:55], v5 offset:27952
    s_waitcnt lgkmcnt(7)
    v_mfma_f32_16x16x32_bf16 v[20:23], v[48:51], v[12:15], 0
    ds_read_b64_tr_b16 v[48:49], v5 offset:28736
    ds_read_b64_tr_b16 v[50:51], v5 offset:29008
    s_waitcnt lgkmcnt(8)
    v_mfma_f32_16x16x32_bf16 v[20:23], v[56:59], v[16:19], v[20:23]
    ds_read_b64_tr_b16 v[56:57], v5 offset:29792
    ds_read_b64_tr_b16 v[58:59], v5 offset:30064
    s_waitcnt lgkmcnt(9)
    v_mfma_f32_16x16x32_bf16 v[20:23], v[36:39], v[64:67], v[20:23]
    s_cmp_eq_u32 s3, 4
    s_cbranch_scc0 L_sk_113
    buffer_store_dwordx4 v[28:31], v1, s[4:7], s77 offen sc1
L_sk_113:
    s_waitcnt lgkmcnt(8)
    v_mfma_f32_16x16x32_bf16 v[20:23], v[40:43], v[68:71], v[20:23]
    v_xor_b32 v0, s75, v0
    s_waitcnt lgkmcnt(6)
    v_mfma_f32_16x16x32_bf16 v[24:27], v[44:47], v[12:15], 0
    v_max3_f32 v32, v60, v61, v62
    s_cmp_eq_u32 s3, 0
    s_cbranch_scc0 L_sk_114
    buffer_store_dwordx4 v[44:47], v1, s[4:7], s77 offen sc1
L_sk_114:
    s_waitcnt lgkmcnt(4)
    v_mfma_f32_16x16x32_bf16 v[24:27], v[52:55], v[16:19], v[24:27]
    s_cmp_eq_u32 s3, 1
    s_cbranch_scc0 L_sk_115
    buffer_store_dwordx4 v[52:55], v1, s[4:7], s77 offen sc1
L_sk_115:
    s_waitcnt lgkmcnt(2)
    v_mfma_f32_16x16x32_bf16 v[24:27], v[48:51], v[64:67], v[24:27]
    s_cmp_eq_u32 s3, 2
    s_cbranch_scc0 L_sk_116
    buffer_store_dwordx4 v[48:51], v1, s[4:7], s77 offen sc1
L_sk_116:
    s_waitcnt lgkmcnt(0)
    v_mfma_f32_16x16x32_bf16 v[24:27], v[56:59], v[68:71], v[24:27]
    s_cmp_eq_u32 s3, 3
    s_cbranch_scc0 L_sk_117
    buffer_store_dwordx4 v[56:59], v1, s[4:7], s77 offen sc1
L_sk_117:
    v_max3_f32 v32, v32, v63, v20
    v_max3_f32 v33, v21, v22, v23
    v_mov_b64 v[18:19], s[8:9]
    s_add_u32 s77, s77, 131072
    v_mov_b64 v[44:45], 0
    v_mov_b64 v[46:47], 0
    v_mov_b64 v[48:49], s[38:39]
    v_mov_b64 v[50:51], s[38:39]
    v_max_f32 v32, v32, v33
    v_max3_f32 v33, v32, v24, v25
    v_max3_f32 v32, v32, v24, v25
    v_mov_b64 v[56:57], 0
    v_mov_b64 v[58:59], 0
    v_permlane16_swap_b32 v32, v33
    v_max_f32 v34, v32, v33
    v_max_f32 v35, v32, v33
    v_mov_b64 v[64:65], 0
    v_mov_b64 v[66:67], 0
    v_permlane32_swap_b32 v34, v35
    v_max_f32 v32, v34, v35
    v_mul_f32 v32, s82, v32
    v_pk_fma_f32 v[60:61], v[60:61], s[82:83], v[32:33] op_sel_hi:[1,0,0] neg_lo:[0,0,1] neg_hi:[0,0,1]
    v_pk_fma_f32 v[62:63], v[62:63], s[82:83], v[32:33] op_sel_hi:[1,0,0] neg_lo:[0,0,1] neg_hi:[0,0,1]
    v_pk_fma_f32 v[20:21], v[20:21], s[82:83], v[32:33] op_sel_hi:[1,0,0] neg_lo:[0,0,1] neg_hi:[0,0,1]
    v_pk_fma_f32 v[22:23], v[22:23], s[82:83], v[32:33] op_sel_hi:[1,0,0] neg_lo:[0,0,1] neg_hi:[0,0,1]
    v_pk_fma_f32 v[24:25], v[24:25], s[82:83], v[32:33] op_sel_hi:[1,0,0] neg_lo:[0,0,1] neg_hi:[0,0,1]
    v_exp_f32 v60, v60
    v_exp_f32 v61, v61
    v_exp_f32 v62, v62
    v_cvt_pk_bf16_f32 v12, v60, v61
    v_exp_f32 v63, v63
    v_exp_f32 v20, v20
    v_cvt_pk_bf16_f32 v13, v62, v63
    v_exp_f32 v21, v21
    v_exp_f32 v22, v22
    v_cvt_pk_bf16_f32 v14, v20, v21
    v_exp_f32 v23, v23
    v_exp_f32 v24, v24
    v_cvt_pk_bf16_f32 v15, v22, v23
    v_exp_f32 v25, v25
    s_waitcnt vmcnt(3)
    v_mfma_f32_16x16x32_bf16 v[36:39], v[72:75], v[12:15], 0
    v_cvt_pk_bf16_f32 v16, v24, v25
    v_cvt_pk_bf16_f32 v17, v24, v25
    v_mfma_f32_16x16x32_bf16 v[40:43], v[76:79], v[12:15], 0
    s_add_u32 s81, s81, 16384
    s_and_b32 s81, s81, 0xffff
    s_add_u32 s61, s61, 1
    v_mfma_f32_16x16x16_bf16 v[36:39], v[28:29], v[16:17], v[36:39]
    v_mov_b64 v[68:69], 0
    v_mov_b64 v[70:71], 0
    v_mfma_f32_16x16x16_bf16 v[40:43], v[30:31], v[16:17], v[40:43]
    v_mfma_f32_16x16x32_bf16 v[24:27], v[12:15], v[48:51], 0
    v_xor_b32 v2, 0x10000, v2
    ds_read_b128 v[72:75], v2 offset:0
    ds_read_b128 v[76:79], v2 offset:1024
    v_mov_b64 v[52:53], 0
    v_mov_b64 v[54:55], 0
    s_mov_b64 exec, s[94:95]
    v_cvt_pk_bf16_f32 v36, v36, v37
    v_cvt_pk_bf16_f32 v37, v38, v39
    v_cvt_pk_bf16_f32 v38, v40, v41
    v_cvt_pk_bf16_f32 v39, v42, v43
    ds_write_b128 v6, v[36:39]
    s_mov_b64 exec, -1
    v_mfma_f32_16x16x16_bf16 v[24:27], v[16:17], v[18:19], v[24:27]
    ds_read_b128 v[12:15], v2 offset:2048
    ds_read_b128 v[16:19], v2 offset:3072
    s_add_u32 s63, s90, s81
    s_add_u32 s91, s91, 32768
    s_add_u32 s98, s98, 32768
    s_add_u32 s89, s89, 32768
    s_add_u32 s65, s88, s81
    s_mov_b32 s60, 0
    v_rcp_f32 v60, v24
    v_rcp_f32 v61, v25
    s_waitcnt lgkmcnt(2)
    s_barrier
    ds_read_b128 v[48:51], v1 offset:0
    ds_read_b128 v[32:35], v1 offset:1024
    s_waitcnt lgkmcnt(1)
    v_smfmac_f32_16x16x64_bf16 v[68:71], v[48:51], v[72:79], v10
    ds_read_b128 v[72:75], v2 offset:16384
    ds_read_b128 v[76:79], v2 offset:17408
    v_smfmac_f32_16x16x64_bf16 v[44:47], v[48:51], v[12:19], v10
    ds_read_b128 v[12:15], v2 offset:18432
    ds_read_b128 v[16:19], v2 offset:19456
    s_waitcnt lgkmcnt(4)
    v_smfmac_f32_16x16x64_bf16 v[68:71], v[32:35], a[200:207], v10
    v_smfmac_f32_16x16x64_bf16 v[44:47], v[32:35], a[176:183], v10
    v_smfmac_f32_16x16x64_bf16 v[52:55], v[48:51], a[160:167], v10
    v_smfmac_f32_16x16x64_bf16 v[52:55], v[32:35], a[184:191], v10
    v_smfmac_f32_16x16x64_bf16 v[56:59], v[48:51], a[168:175], v10
    v_smfmac_f32_16x16x64_bf16 v[56:59], v[32:35], a[192:199], v10
    s_waitcnt lgkmcnt(2)
    v_smfmac_f32_16x16x64_bf16 v[64:67], v[48:51], v[72:79], v10
    s_waitcnt lgkmcnt(0)
    v_smfmac_f32_16x16x64_bf16 v[64:67], v[32:35], v[12:19], v10
    v_pk_add_f32 v[68:69], v[68:69], v[70:71]
    v_pk_add_f32 v[44:45], v[44:45], v[46:47]
    v_pk_add_f32 v[52:53], v[52:53], v[54:55]
    s_nop 0
    v_pk_add_f32 v[56:57], v[56:57], v[58:59]
    v_pk_mul_f32 v[68:69], v[68:69], v[60:61]
    v_pk_mul_f32 v[44:45], v[44:45], v[60:61]
    v_pk_mul_f32 v[52:53], v[52:53], v[60:61]
    v_pk_mul_f32 v[56:57], v[56:57], v[60:61]
    v_pk_add_f32 v[64:65], v[64:65], v[66:67]
    v_cvt_pk_bf16_f32 v40, v68, v69
    v_cvt_pk_bf16_f32 v36, v44, v45
    v_pk_mul_f32 v[64:65], v[64:65], v[60:61]
    buffer_store_dword v40, v8, s[4:7], s79 offen sc1
    v_cvt_pk_bf16_f32 v37, v52, v53
    v_cvt_pk_bf16_f32 v38, v56, v57
    v_cvt_pk_bf16_f32 v39, v64, v65
    buffer_store_dwordx4 v[36:39], v7, s[4:7], s79 offen sc1
    s_xor_b32 s79, s79, s92
    v_mov_b64 v[32:33], 0
    v_mov_b64 v[34:35], 0
    s_min_u32 s62, s0, s1
    s_max_u32 s68, s68, s62
    s_buffer_load_dword s0, s[4:7], s84 glc
    s_buffer_load_dword s1, s[4:7], s36 glc
L_sr_118:
    s_cmp_eq_u32 s72, 0
    s_cbranch_scc1 L_CH_NORED_G
    v_bfe_u32 v62, v1, 4, 1
    v_mov_b32 v63, 0x3f80
    v_lshlrev_b32 v62, 4, v62
    v_lshlrev_b32 v62, v62, v63
    v_cndmask_b32 v20, 0, v62, s[52:53]
    v_cndmask_b32 v21, 0, v62, s[54:55]
    v_cndmask_b32 v22, 0, v62, s[56:57]
    v_cndmask_b32 v23, 0, v62, s[58:59]
    s_sleep 1
    s_sleep 1
    s_sleep 1
    buffer_load_dwordx4 v[36:39], v1, s[4:7], s80 offen offset:0 sc1
    buffer_load_dwordx4 v[40:43], v1, s[4:7], s80 offen offset:1024 sc1
    buffer_load_dwordx4 v[44:47], v1, s[4:7], s80 offen offset:2048 sc1
    buffer_load_dwordx4 v[48:51], v1, s[4:7], s80 offen offset:3072 sc1
    s_sleep 1
    s_sleep 1
    buffer_load_dwordx4 v[52:55], v1, s[4:7], s80 offen offset:0 sc1
    buffer_load_dwordx4 v[56:59], v1, s[4:7], s80 offen offset:1024 sc1
    buffer_load_dwordx4 v[60:63], v1, s[4:7], s80 offen offset:2048 sc1
    buffer_load_dwordx4 v[64:67], v1, s[4:7], s80 offen offset:3072 sc1
L_CH_RED_G:
    s_waitcnt vmcnt(7)
    v_max3_u32 v76, v36, v37, v38
    v_max_u32 v76, v76, v39
    v_mfma_f32_16x16x32_bf16 v[68:71], v[36:39], v[20:23], 0
    s_waitcnt vmcnt(6)
    v_max3_u32 v76, v76, v40, v41
    v_max3_u32 v76, v76, v42, v43
    v_mfma_f32_16x16x32_bf16 v[68:71], v[40:43], v[20:23], v[68:71]
    s_waitcnt vmcnt(5)
    v_max3_u32 v76, v76, v44, v45
    v_max3_u32 v76, v76, v46, v47
    v_mfma_f32_16x16x32_bf16 v[68:71], v[44:47], v[20:23], v[68:71]
    s_waitcnt vmcnt(4)
    v_max3_u32 v76, v76, v48, v49
    v_max3_u32 v76, v76, v50, v51
    v_mfma_f32_16x16x32_bf16 v[68:71], v[48:51], v[20:23], v[68:71]
    v_cmp_eq_u32 vcc, -1, v76
    s_nop 0
    s_cbranch_vccz L_CH_REDOK_G
    buffer_load_dwordx4 v[36:39], v1, s[4:7], s80 offen offset:0 sc1
    buffer_load_dwordx4 v[40:43], v1, s[4:7], s80 offen offset:1024 sc1
    buffer_load_dwordx4 v[44:47], v1, s[4:7], s80 offen offset:2048 sc1
    buffer_load_dwordx4 v[48:51], v1, s[4:7], s80 offen offset:3072 sc1
    s_waitcnt vmcnt(7)
    v_max3_u32 v76, v52, v53, v54
    v_max_u32 v76, v76, v55
    v_mfma_f32_16x16x32_bf16 v[68:71], v[52:55], v[20:23], 0
    s_waitcnt vmcnt(6)
    v_max3_u32 v76, v76, v56, v57
    v_max3_u32 v76, v76, v58, v59
    v_mfma_f32_16x16x32_bf16 v[68:71], v[56:59], v[20:23], v[68:71]
    s_waitcnt vmcnt(5)
    v_max3_u32 v76, v76, v60, v61
    v_max3_u32 v76, v76, v62, v63
    v_mfma_f32_16x16x32_bf16 v[68:71], v[60:63], v[20:23], v[68:71]
    s_waitcnt vmcnt(4)
    v_max3_u32 v76, v76, v64, v65
    v_max3_u32 v76, v76, v66, v67
    v_mfma_f32_16x16x32_bf16 v[68:71], v[64:67], v[20:23], v[68:71]
    v_cmp_eq_u32 vcc, -1, v76
    s_nop 0
    s_cbranch_vccnz L_CH_REDX_G
L_CH_REDOK_G:
    s_nop 5
    v_permlane32_swap_b32 v68, v70
    v_permlane32_swap_b32 v69, v71
    v_pk_add_f32 v[68:69], v[68:69], v[70:71]
    v_cvt_pk_bf16_f32 v20, v68, v69
    s_mov_b64 exec, s[86:87]
    buffer_store_dword v20, v3, s[4:7], s63 offen sc1
    buffer_store_dword v20, v3, s[4:7], s91 offen sc1
    s_mov_b64 exec, -1
    s_barrier
    s_xor_b32 s80, s80, s93
    s_mov_b32 s60, 0
    s_waitcnt vmcnt(2)
    ds_read_b128 v[56:59], v2 offset:32768
    ds_read_b128 v[60:63], v2 offset:33792
    ds_read_b128 v[64:67], v2 offset:49152
    ds_read_b128 v[68:71], v2 offset:50176
    ds_read_b128 v[48:51], v2 offset:34816
    ds_read_b128 v[52:55], v2 offset:35840
    v_mov_b64 v[12:13], 0
    v_mov_b64 v[14:15], 0
    v_mov_b64 v[16:17], 0
    v_mov_b64 v[18:19], 0
    v_mov_b64 v[20:21], 0
    v_mov_b64 v[22:23], 0
    v_mov_b64 v[24:25], 0
    v_mov_b64 v[26:27], 0
    v_mov_b64 v[28:29], 0
    v_mov_b64 v[30:31], 0
    v_mov_b64 v[36:37], -1
    v_mov_b64 v[38:39], -1
    s_sleep 1
    s_sleep 1
    s_sleep 1
    s_mov_b32 m0, s100
    s_add_u32 s64, s65, s99
    buffer_load_dwordx4 v1, s[4:7], s65 offen sc1 lds
    s_add_u32 m0, s100, s99
    s_mov_b64 exec, 0xffff
    buffer_load_dwordx4 v1, s[4:7], s64 offen sc1 lds
    s_mov_b64 exec, -1
    s_nop 11
    s_mov_b32 m0, s100
    s_add_u32 s64, s65, s99
    buffer_load_dwordx4 v1, s[4:7], s65 offen sc1 lds
    s_add_u32 m0, s100, s99
    s_mov_b64 exec, 0xffff
    buffer_load_dwordx4 v1, s[4:7], s64 offen sc1 lds
    s_mov_b64 exec, -1
    s_add_u32 s63, s101, s10
    buffer_store_dwordx4 v[36:39], v1, s[4:7], s101 offen sc1
    s_mov_b64 exec, s[42:43]
    buffer_store_dwordx4 v[36:39], v1, s[4:7], s63 offen sc1
    s_xor_b32 s101, s101, s40
    s_xor_b32 s62, s81, 0x8000
    s_add_u32 s62, s62, s41
    s_mov_b64 exec, s[66:67]
    buffer_store_dwordx4 v[36:39], v11, s[4:7], s62 offen sc1
    s_mov_b64 exec, -1
    s_waitcnt vmcnt(5)
    s_barrier
    ds_read_b128 v[36:39], v1 offset:0
    ds_read_b128 v[40:43], v1 offset:1024
    ds_read_b128 v[44:47], v1 offset:2048
    ds_read_b128 v[72:75], v1 offset:3072
    ds_read_b128 v[76:79], v1 offset:4096
    s_branch L_CH_A1_G
L_CH_NORED_G:
    v_mov_b64 v[12:13], 0
    v_mov_b64 v[14:15], 0
    v_mov_b64 v[16:17], 0
    v_mov_b64 v[18:19], 0
    v_mov_b64 v[20:21], 0
    v_mov_b64 v[22:23], 0
    v_mov_b64 v[24:25], 0
    v_mov_b64 v[26:27], 0
    v_mov_b64 v[28:29], 0
    v_mov_b64 v[30:31], 0
    ds_read_b128 v[56:59], v2 offset:32768
    ds_read_b128 v[60:63], v2 offset:33792
    ds_read_b128 v[64:67], v2 offset:49152
    ds_read_b128 v[68:71], v2 offset:50176
    ds_read_b128 v[48:51], v2 offset:34816
    ds_read_b128 v[52:55], v2 offset:35840
    s_barrier
    v_mov_b64 v[36:37], -1
    v_mov_b64 v[38:39], -1
    s_sleep 1
    s_sleep 1
    s_sleep 1
    s_sleep 1
    s_nop 11
    s_mov_b32 m0, s100
    s_add_u32 s64, s65, s99
    buffer_load_dwordx4 v1, s[4:7], s65 offen sc1 lds
    s_add_u32 m0, s100, s99
    s_mov_b64 exec, 0xffff
    buffer_load_dwordx4 v1, s[4:7], s64 offen sc1 lds
    s_mov_b64 exec, -1
    s_nop 11
    s_mov_b32 m0, s100
    s_add_u32 s64, s65, s99
    buffer_load_dwordx4 v1, s[4:7], s65 offen sc1 lds
    s_add_u32 m0, s100, s99
    s_mov_b64 exec, 0xffff
    buffer_load_dwordx4 v1, s[4:7], s64 offen sc1 lds
    s_mov_b64 exec, -1
    s_add_u32 s63, s101, s10
    buffer_store_dwordx4 v[36:39], v1, s[4:7], s101 offen sc1
    s_mov_b64 exec, s[42:43]
    buffer_store_dwordx4 v[36:39], v1, s[4:7], s63 offen sc1
    s_xor_b32 s101, s101, s40
    s_xor_b32 s62, s81, 0x8000
    s_add_u32 s62, s62, s41
    s_mov_b64 exec, s[66:67]
    buffer_store_dwordx4 v[36:39], v11, s[4:7], s62 offen sc1
    s_mov_b64 exec, -1
    s_waitcnt vmcnt(5)
    s_barrier
    ds_read_b128 v[36:39], v1 offset:0
    ds_read_b128 v[40:43], v1 offset:1024
    ds_read_b128 v[44:47], v1 offset:2048
    ds_read_b128 v[72:75], v1 offset:3072
    ds_read_b128 v[76:79], v1 offset:4096
    s_branch L_CH_A1_G
L_CH_LRETRY_G:
    s_add_u32 s60, s60, 1
    s_cmp_lg_u32 s60, 1
    s_cbranch_scc1 L_ln_119
    v_mov_b64 v[12:13], 0
    v_mov_b64 v[14:15], 0
    s_nop 0
    v_mov_b64 v[16:17], 0
    v_mov_b64 v[18:19], 0
    s_waitcnt vmcnt(0)
    s_branch L_CH_LOOP_G
L_ln_119:
    v_max3_u32 v9, v36, v37, v38
    v_max3_u32 v9, v9, v38, v39
    v_max3_u32 v9, v9, v40, v41
    v_max3_u32 v9, v9, v42, v43
    v_max3_u32 v9, v9, v44, v45
    v_max3_u32 v9, v9, v46, v47
    v_max3_u32 v9, v9, v72, v73
    v_max3_u32 v9, v9, v74, v75
    v_max3_u32 v9, v9, v76, v77
    v_max3_u32 v9, v9, v78, v79
    v_cmp_eq_u32 vcc, -1, v9
    s_nop 0
    s_cbranch_vccz L_CH_LGO_G
    s_cmp_ge_u32 s60, 0x100000
    s_movk_i32 s62, 15
    s_cbranch_scc1 L_ABORT
    s_sub_u32 s63, s65, s2
    s_mov_b32 m0, 131072
    s_add_u32 s64, s63, 4096
    buffer_load_dwordx4 v1, s[4:7], s63 offen offset:0 sc1 lds
    buffer_load_dwordx4 v1, s[4:7], s63 offen offset:1024 sc1 lds
    buffer_load_dwordx4 v1, s[4:7], s63 offen offset:2048 sc1 lds
    buffer_load_dwordx4 v1, s[4:7], s63 offen offset:3072 sc1 lds
    s_mov_b32 m0, 135168
    s_nop 0
    buffer_load_dwordx4 v1, s[4:7], s64 offen sc1 lds
    v_mov_b64 v[12:13], 0
    v_mov_b64 v[14:15], 0
    v_mov_b64 v[16:17], 0
    v_mov_b64 v[18:19], 0
    s_waitcnt vmcnt(0)
    s_branch L_CH_LOOP_G
L_CH_RETRY_G:
    s_mov_b32 s60, 0
    s_sleep 1
    s_sleep 1
    s_mov_b32 m0, s85
    s_add_u32 s64, s98, s99
    buffer_load_dwordx4 v1, s[4:7], s98 offen sc1 lds
    s_add_u32 m0, s85, s99
    s_mov_b64 exec, 0xffff
    buffer_load_dwordx4 v1, s[4:7], s64 offen sc1 lds
    s_mov_b64 exec, -1
    s_branch L_CH_RETRY2_G
L_CH_RETRY1_G:
    s_mov_b32 s63, s89
    s_mov_b32 m0, 136192
    s_add_u32 s64, s63, 4096
    buffer_load_dwordx4 v1, s[4:7], s63 offen offset:0 sc1 lds
    buffer_load_dwordx4 v1, s[4:7], s63 offen offset:1024 sc1 lds
    buffer_load_dwordx4 v1, s[4:7], s63 offen offset:2048 sc1 lds
    buffer_load_dwordx4 v1, s[4:7], s63 offen offset:3072 sc1 lds
    s_mov_b32 m0, 140288
    s_nop 0
    buffer_load_dwordx4 v1, s[4:7], s64 offen sc1 lds
L_CH_RETRY2_G:
    s_waitcnt vmcnt(0)
    ds_read_b128 v[64:67], v1 offset:5120
    ds_read_b128 v[68:71], v1 offset:6144
    ds_read_b128 v[48:51], v1 offset:7168
    ds_read_b128 v[56:59], v1 offset:8192
    ds_read_b128 v[60:63], v1 offset:9216
    s_waitcnt lgkmcnt(0)
L_CH_RETRY3_G:
    v_max3_u32 v9, v64, v65, v66
    v_max_u32 v9, v9, v67
    v_max3_u32 v9, v9, v68, v69
    v_max3_u32 v9, v9, v70, v71
    v_max3_u32 v9, v9, v48, v49
    v_max3_u32 v9, v9, v50, v51
    v_max3_u32 v9, v9, v56, v57
    v_max3_u32 v9, v9, v58, v59
    v_max3_u32 v9, v9, v60, v61
    v_max3_u32 v9, v9, v62, v63
    v_cmp_eq_u32 vcc, -1, v9
    s_nop 0
    s_cbranch_vccz L_CH_REDO_G
    s_add_u32 s60, s60, 1
    s_cmp_lt_u32 s60, 0x100000
    s_cbranch_scc1 L_CH_RETRY1_G
    s_movk_i32 s62, 13
    s_branch L_ABORT
L_CH_REDO_G:
    v_mov_b64 v[12:13], 0
    v_mov_b64 v[14:15], 0
    s_nop 1
    v_smfmac_f32_16x16x64_bf16 v[12:15], v[36:39], a[0:7], v10
    v_smfmac_f32_16x16x64_bf16 v[12:15], v[40:43], a[16:23], v10
    v_smfmac_f32_16x16x64_bf16 v[12:15], v[44:47], a[32:39], v10
    v_smfmac_f32_16x16x64_bf16 v[12:15], v[72:75], a[48:55], v10
    v_smfmac_f32_16x16x64_bf16 v[12:15], v[76:79], a[64:71], v10
    v_smfmac_f32_16x16x64_bf16 v[12:15], v[56:59], a[128:135], v10
    v_smfmac_f32_16x16x64_bf16 v[12:15], v[60:63], a[144:151], v10
    v_smfmac_f32_16x16x64_bf16 v[12:15], v[64:67], a[80:87], v10
    v_smfmac_f32_16x16x64_bf16 v[12:15], v[68:71], a[96:103], v10
    v_smfmac_f32_16x16x64_bf16 v[12:15], v[48:51], a[112:119], v10
    s_branch L_CH_C_G
L_CH_LAST_G:
    s_cmp_eq_u32 s70, 0
    s_cbranch_scc0 L_sk_120
    s_mul_i32 s62, s44, 1056
    v_add_u32 v9, s62, v5
    ds_read_b64_tr_b16 v[28:29], v9 offset:26624
    ds_read_b64_tr_b16 v[30:31], v9 offset:26896
    s_waitcnt lgkmcnt(0)
L_sk_120:
    buffer_store_dwordx4 v[28:31], v1, s[4:7], s77 offen sc1
    s_add_u32 s77, s77, 131072
    s_waitcnt vmcnt(0)
    v_mov_b32 v62, 0
    v_mov_b32 v63, 64
    s_mov_b64 exec, 1
    buffer_store_dword v63, v62, s[4:7], s78 offen sc1
    s_mov_b64 exec, -1
    s_branch L_END2
L_CH_REDX_G:
    buffer_load_dwordx4 v[52:55], v1, s[4:7], s80 offen offset:0 sc1
    buffer_load_dwordx4 v[56:59], v1, s[4:7], s80 offen offset:1024 sc1
    buffer_load_dwordx4 v[60:63], v1, s[4:7], s80 offen offset:2048 sc1
    buffer_load_dwordx4 v[64:67], v1, s[4:7], s80 offen offset:3072 sc1
    s_add_u32 s60, s60, 1
    s_cmp_lt_u32 s60, 0x100000
    s_cbranch_scc1 L_CH_RED_G
    s_movk_i32 s62, 14
    s_branch L_ABORT
L_kv_111:
    v_bfe_u32 v52, v1, 4, 1
    v_lshlrev_b32 v52, 5, v52
    v_add_u32 v52, s46, v52
    v_add_u32 v52, 64, v52
    v_lshlrev_b32 v52, 6, v52
    s_mov_b32 s60, 0
L_pf_121:
    buffer_load_dword v53, v52, s[4:7], 0 offen sc1
    s_waitcnt vmcnt(0)
    v_cmp_gt_u32 vcc, s69, v53
    s_nop 0
    s_cbranch_vccz L_pfd_122
    s_sleep 1
    s_add_u32 s60, s60, 1
    s_cmp_lt_u32 s60, 0x100000
    s_cbranch_scc1 L_pf_121
    s_movk_i32 s62, 11
    s_branch L_ABORT
L_pfd_122:
    v_readlane_b32 s68, v53, 0
    v_readlane_b32 s62, v53, 1
    s_nop 0
    s_min_u32 s68, s68, s62
    s_branch L_kvr_112
L_kv_109:
    v_bfe_u32 v52, v1, 4, 1
    v_lshlrev_b32 v52, 5, v52
    v_add_u32 v52, s46, v52
    v_add_u32 v52, 64, v52
    v_lshlrev_b32 v52, 6, v52
    s_mov_b32 s60, 0
L_pf_123:
    buffer_load_dword v53, v52, s[4:7], 0 offen sc1
    s_waitcnt vmcnt(0)
    v_cmp_gt_u32 vcc, s69, v53
    s_nop 0
    s_cbranch_vccz L_pfd_124
    s_sleep 1
    s_add_u32 s60, s60, 1
    s_cmp_lt_u32 s60, 0x100000
    s_cbranch_scc1 L_pf_123
    s_movk_i32 s62, 11
    s_branch L_ABORT
L_pfd_124:
    v_readlane_b32 s68, v53, 0
    v_readlane_b32 s62, v53, 1
    s_nop 0
    s_min_u32 s68, s68, s62
    s_branch L_kvr_110
L_KP:
    v_bfe_u32 v1, v0, 0, 6
    v_lshlrev_b32 v1, 4, v1
    s_mov_b32 s8, s22
    s_and_b32 s9, s23, 0xffff
    s_mov_b32 s10, 0x500000
    s_mov_b32 s11, 0x20000
    s_lshl_b32 s66, s46, 8
    v_bfe_u32 v4, v0, 0, 4
    v_lshlrev_b32 v4, 4, v4
    v_bfe_u32 v9, v0, 4, 2
    v_lshlrev_b32 v9, 6, v9
    v_xor_b32 v4, v4, v9
    v_bfe_u32 v9, v0, 4, 2
    v_lshlrev_b32 v9, 13, v9
    v_bfe_u32 v8, v0, 6, 2
    v_lshl_add_u32 v9, v8, 17, v9
    v_add_u32 v4, v4, v9
    v_bfe_u32 v6, v0, 1, 1
    v_lshlrev_b32 v6, 4, v6
    v_bfe_u32 v8, v0, 4, 1
    v_lshl_add_u32 v6, v8, 5, v6
    v_bfe_u32 v8, v0, 6, 2
    v_lshl_add_u32 v6, v8, 6, v6
    v_bfe_u32 v9, v0, 2, 2
    v_lshlrev_b32 v9, 6, v9
    v_xor_b32 v6, v6, v9
    v_bfe_u32 v9, v0, 0, 1
    v_lshlrev_b32 v9, 3, v9
    v_bfe_u32 v8, v0, 2, 2
    v_lshl_add_u32 v9, v8, 8, v9
    v_bfe_u32 v8, v0, 5, 1
    v_lshl_add_u32 v9, v8, 11, v9
    v_add_u32 v6, v6, v9
    v_add_u32 v7, 0x10000, v6
    s_lshl_b32 s67, s44, 12
    s_add_u32 s63, s66, 0x0
    s_add_u32 s64, s67, 0x0
    s_mov_b32 m0, s64
    s_nop 0
    buffer_load_dwordx4 v4, s[8:11], s63 offen lds
    s_add_u32 s63, s66, 0x8000
    s_add_u32 s64, s67, 0x400
    s_mov_b32 m0, s64
    s_nop 0
    buffer_load_dwordx4 v4, s[8:11], s63 offen lds
    s_add_u32 s63, s66, 0x10000
    s_add_u32 s64, s67, 0x800
    s_mov_b32 m0, s64
    s_nop 0
    buffer_load_dwordx4 v4, s[8:11], s63 offen lds
    s_add_u32 s63, s66, 0x18000
    s_add_u32 s64, s67, 0xc00
    s_mov_b32 m0, s64
    s_nop 0
    buffer_load_dwordx4 v4, s[8:11], s63 offen lds
    s_add_u32 s63, s66, 0x80000
    s_add_u32 s64, s67, 0x4000
    s_mov_b32 m0, s64
    s_nop 0
    buffer_load_dwordx4 v4, s[8:11], s63 offen lds
    s_add_u32 s63, s66, 0x88000
    s_add_u32 s64, s67, 0x4400
    s_mov_b32 m0, s64
    s_nop 0
    buffer_load_dwordx4 v4, s[8:11], s63 offen lds
    s_add_u32 s63, s66, 0x90000
    s_add_u32 s64, s67, 0x4800
    s_mov_b32 m0, s64
    s_nop 0
    buffer_load_dwordx4 v4, s[8:11], s63 offen lds
    s_add_u32 s63, s66, 0x98000
    s_add_u32 s64, s67, 0x4c00
    s_mov_b32 m0, s64
    s_nop 0
    buffer_load_dwordx4 v4, s[8:11], s63 offen lds
    s_add_u32 s63, s66, 0x100000
    s_add_u32 s64, s67, 0x8000
    s_mov_b32 m0, s64
    s_nop 0
    buffer_load_dwordx4 v4, s[8:11], s63 offen lds
    s_add_u32 s63, s66, 0x108000
    s_add_u32 s64, s67, 0x8400
    s_mov_b32 m0, s64
    s_nop 0
    buffer_load_dwordx4 v4, s[8:11], s63 offen lds
    s_add_u32 s63, s66, 0x110000
    s_add_u32 s64, s67, 0x8800
    s_mov_b32 m0, s64
    s_nop 0
    buffer_load_dwordx4 v4, s[8:11], s63 offen lds
    s_add_u32 s63, s66, 0x118000
    s_add_u32 s64, s67, 0x8c00
    s_mov_b32 m0, s64
    s_nop 0
    buffer_load_dwordx4 v4, s[8:11], s63 offen lds
    s_add_u32 s63, s66, 0x180000
    s_add_u32 s64, s67, 0xc000
    s_mov_b32 m0, s64
    s_nop 0
    buffer_load_dwordx4 v4, s[8:11], s63 offen lds
    s_add_u32 s63, s66, 0x188000
    s_add_u32 s64, s67, 0xc400
    s_mov_b32 m0, s64
    s_nop 0
    buffer_load_dwordx4 v4, s[8:11], s63 offen lds
    s_add_u32 s63, s66, 0x190000
    s_add_u32 s64, s67, 0xc800
    s_mov_b32 m0, s64
    s_nop 0
    buffer_load_dwordx4 v4, s[8:11], s63 offen lds
    s_add_u32 s63, s66, 0x198000
    s_add_u32 s64, s67, 0xcc00
    s_mov_b32 m0, s64
    s_nop 0
    buffer_load_dwordx4 v4, s[8:11], s63 offen lds
    s_add_u32 s63, s66, 0x200000
    s_add_u32 s64, s67, 0x10000
    s_mov_b32 m0, s64
    s_nop 0
    buffer_load_dwordx4 v4, s[8:11], s63 offen lds
    s_add_u32 s63, s66, 0x208000
    s_add_u32 s64, s67, 0x10400
    s_mov_b32 m0, s64
    s_nop 0
    buffer_load_dwordx4 v4, s[8:11], s63 offen lds
    s_add_u32 s63, s66, 0x210000
    s_add_u32 s64, s67, 0x10800
    s_mov_b32 m0, s64
    s_nop 0
    buffer_load_dwordx4 v4, s[8:11], s63 offen lds
    s_add_u32 s63, s66, 0x218000
    s_add_u32 s64, s67, 0x10c00
    s_mov_b32 m0, s64
    s_nop 0
    buffer_load_dwordx4 v4, s[8:11], s63 offen lds
    s_add_u32 s63, s66, 0x280000
    s_add_u32 s64, s67, 0x14000
    s_mov_b32 m0, s64
    s_nop 0
    buffer_load_dwordx4 v4, s[8:11], s63 offen lds
    s_add_u32 s63, s66, 0x288000
    s_add_u32 s64, s67, 0x14400
    s_mov_b32 m0, s64
    s_nop 0
    buffer_load_dwordx4 v4, s[8:11], s63 offen lds
    s_add_u32 s63, s66, 0x290000
    s_add_u32 s64, s67, 0x14800
    s_mov_b32 m0, s64
    s_nop 0
    buffer_load_dwordx4 v4, s[8:11], s63 offen lds
    s_add_u32 s63, s66, 0x298000
    s_add_u32 s64, s67, 0x14c00
    s_mov_b32 m0, s64
    s_nop 0
    buffer_load_dwordx4 v4, s[8:11], s63 offen lds
    s_add_u32 s63, s66, 0x300000
    s_add_u32 s64, s67, 0x18000
    s_mov_b32 m0, s64
    s_nop 0
    buffer_load_dwordx4 v4, s[8:11], s63 offen lds
    s_add_u32 s63, s66, 0x308000
    s_add_u32 s64, s67, 0x18400
    s_mov_b32 m0, s64
    s_nop 0
    buffer_load_dwordx4 v4, s[8:11], s63 offen lds
    s_add_u32 s63, s66, 0x310000
    s_add_u32 s64, s67, 0x18800
    s_mov_b32 m0, s64
    s_nop 0
    buffer_load_dwordx4 v4, s[8:11], s63 offen lds
    s_add_u32 s63, s66, 0x318000
    s_add_u32 s64, s67, 0x18c00
    s_mov_b32 m0, s64
    s_nop 0
    buffer_load_dwordx4 v4, s[8:11], s63 offen lds
    s_waitcnt vmcnt(24) lgkmcnt(0)
    s_barrier
    s_add_u32 s63, s66, 0x380000
    s_add_u32 s64, s67, 0x1c000
    s_mov_b32 m0, s64
    s_nop 0
    buffer_load_dwordx4 v4, s[8:11], s63 offen lds
    s_add_u32 s63, s66, 0x388000
    s_add_u32 s64, s67, 0x1c400
    s_mov_b32 m0, s64
    s_nop 0
    buffer_load_dwordx4 v4, s[8:11], s63 offen lds
    s_add_u32 s63, s66, 0x390000
    s_add_u32 s64, s67, 0x1c800
    s_mov_b32 m0, s64
    s_nop 0
    buffer_load_dwordx4 v4, s[8:11], s63 offen lds
    s_add_u32 s63, s66, 0x398000
    s_add_u32 s64, s67, 0x1cc00
    s_mov_b32 m0, s64
    s_nop 0
    buffer_load_dwordx4 v4, s[8:11], s63 offen lds
    ds_read_b64_tr_b16 a[0:1], v6 offset:0
    ds_read_b64_tr_b16 a[2:3], v6 offset:1024
    ds_read_b64_tr_b16 a[4:5], v6 offset:4096
    ds_read_b64_tr_b16 a[6:7], v6 offset:5120
    ds_read_b64_tr_b16 a[8:9], v6 offset:8192
    ds_read_b64_tr_b16 a[10:11], v6 offset:9216
    ds_read_b64_tr_b16 a[12:13], v6 offset:12288
    ds_read_b64_tr_b16 a[14:15], v6 offset:13312
    s_waitcnt vmcnt(24) lgkmcnt(0)
    s_barrier
    s_add_u32 s63, s66, 0x400000
    s_add_u32 s64, s67, 0x0
    s_mov_b32 m0, s64
    s_nop 0
    buffer_load_dwordx4 v4, s[8:11], s63 offen lds
    s_add_u32 s63, s66, 0x408000
    s_add_u32 s64, s67, 0x400
    s_mov_b32 m0, s64
    s_nop 0
    buffer_load_dwordx4 v4, s[8:11], s63 offen lds
    s_add_u32 s63, s66, 0x410000
    s_add_u32 s64, s67, 0x800
    s_mov_b32 m0, s64
    s_nop 0
    buffer_load_dwordx4 v4, s[8:11], s63 offen lds
    s_add_u32 s63, s66, 0x418000
    s_add_u32 s64, s67, 0xc00
    s_mov_b32 m0, s64
    s_nop 0
    buffer_load_dwordx4 v4, s[8:11], s63 offen lds
    ds_read_b64_tr_b16 a[16:17], v6 offset:16384
    ds_read_b64_tr_b16 a[18:19], v6 offset:17408
    ds_read_b64_tr_b16 a[20:21], v6 offset:20480
    ds_read_b64_tr_b16 a[22:23], v6 offset:21504
    ds_read_b64_tr_b16 a[24:25], v6 offset:24576
    ds_read_b64_tr_b16 a[26:27], v6 offset:25600
    ds_read_b64_tr_b16 a[28:29], v6 offset:28672
    ds_read_b64_tr_b16 a[30:31], v6 offset:29696
    s_waitcnt vmcnt(24) lgkmcnt(0)
    s_barrier
    s_add_u32 s63, s66, 0x480000
    s_add_u32 s64, s67, 0x4000
    s_mov_b32 m0, s64
    s_nop 0
    buffer_load_dwordx4 v4, s[8:11], s63 offen lds
    s_add_u32 s63, s66, 0x488000
    s_add_u32 s64, s67, 0x4400
    s_mov_b32 m0, s64
    s_nop 0
    buffer_load_dwordx4 v4, s[8:11], s63 offen lds
    s_add_u32 s63, s66, 0x490000
    s_add_u32 s64, s67, 0x4800
    s_mov_b32 m0, s64
    s_nop 0
    buffer_load_dwordx4 v4, s[8:11], s63 offen lds
    s_add_u32 s63, s66, 0x498000
    s_add_u32 s64, s67, 0x4c00
    s_mov_b32 m0, s64
    s_nop 0
    buffer_load_dwordx4 v4, s[8:11], s63 offen lds
    ds_read_b64_tr_b16 a[32:33], v6 offset:32768
    ds_read_b64_tr_b16 a[34:35], v6 offset:33792
    ds_read_b64_tr_b16 a[36:37], v6 offset:36864
    ds_read_b64_tr_b16 a[38:39], v6 offset:37888
    ds_read_b64_tr_b16 a[40:41], v6 offset:40960
    ds_read_b64_tr_b16 a[42:43], v6 offset:41984
    ds_read_b64_tr_b16 a[44:45], v6 offset:45056
    ds_read_b64_tr_b16 a[46:47], v6 offset:46080
    s_waitcnt vmcnt(24) lgkmcnt(0)
    s_barrier
    ds_read_b64_tr_b16 a[48:49], v6 offset:49152
    ds_read_b64_tr_b16 a[50:51], v6 offset:50176
    ds_read_b64_tr_b16 a[52:53], v6 offset:53248
    ds_read_b64_tr_b16 a[54:55], v6 offset:54272
    ds_read_b64_tr_b16 a[56:57], v6 offset:57344
    ds_read_b64_tr_b16 a[58:59], v6 offset:58368
    ds_read_b64_tr_b16 a[60:61], v6 offset:61440
    ds_read_b64_tr_b16 a[62:63], v6 offset:62464
    s_waitcnt vmcnt(20) lgkmcnt(0)
    s_barrier
    ds_read_b64_tr_b16 a[64:65], v7 offset:0
    ds_read_b64_tr_b16 a[66:67], v7 offset:1024
    ds_read_b64_tr_b16 a[68:69], v7 offset:4096
    ds_read_b64_tr_b16 a[70:71], v7 offset:5120
    ds_read_b64_tr_b16 a[72:73], v7 offset:8192
    ds_read_b64_tr_b16 a[74:75], v7 offset:9216
    ds_read_b64_tr_b16 a[76:77], v7 offset:12288
    ds_read_b64_tr_b16 a[78:79], v7 offset:13312
    s_waitcnt vmcnt(16) lgkmcnt(0)
    s_barrier
    ds_read_b64_tr_b16 a[80:81], v7 offset:16384
    ds_read_b64_tr_b16 a[82:83], v7 offset:17408
    ds_read_b64_tr_b16 a[84:85], v7 offset:20480
    ds_read_b64_tr_b16 a[86:87], v7 offset:21504
    ds_read_b64_tr_b16 a[88:89], v7 offset:24576
    ds_read_b64_tr_b16 a[90:91], v7 offset:25600
    ds_read_b64_tr_b16 a[92:93], v7 offset:28672
    ds_read_b64_tr_b16 a[94:95], v7 offset:29696
    s_waitcnt vmcnt(12) lgkmcnt(0)
    s_barrier
    ds_read_b64_tr_b16 a[96:97], v7 offset:32768
    ds_read_b64_tr_b16 a[98:99], v7 offset:33792
    ds_read_b64_tr_b16 a[100:101], v7 offset:36864
    ds_read_b64_tr_b16 a[102:103], v7 offset:37888
    ds_read_b64_tr_b16 a[104:105], v7 offset:40960
    ds_read_b64_tr_b16 a[106:107], v7 offset:41984
    ds_read_b64_tr_b16 a[108:109], v7 offset:45056
    ds_read_b64_tr_b16 a[110:111], v7 offset:46080
    s_waitcnt vmcnt(8) lgkmcnt(0)
    s_barrier
    ds_read_b64_tr_b16 a[112:113], v7 offset:49152
    ds_read_b64_tr_b16 a[114:115], v7 offset:50176
    ds_read_b64_tr_b16 a[116:117], v7 offset:53248
    ds_read_b64_tr_b16 a[118:119], v7 offset:54272
    ds_read_b64_tr_b16 a[120:121], v7 offset:57344
    ds_read_b64_tr_b16 a[122:123], v7 offset:58368
    ds_read_b64_tr_b16 a[124:125], v7 offset:61440
    ds_read_b64_tr_b16 a[126:127], v7 offset:62464
    s_waitcnt vmcnt(4) lgkmcnt(0)
    s_barrier
    ds_read_b64_tr_b16 a[128:129], v6 offset:0
    ds_read_b64_tr_b16 a[130:131], v6 offset:1024
    ds_read_b64_tr_b16 a[132:133], v6 offset:4096
    ds_read_b64_tr_b16 a[134:135], v6 offset:5120
    ds_read_b64_tr_b16 a[136:137], v6 offset:8192
    ds_read_b64_tr_b16 a[138:139], v6 offset:9216
    ds_read_b64_tr_b16 a[140:141], v6 offset:12288
    ds_read_b64_tr_b16 a[142:143], v6 offset:13312
    s_waitcnt vmcnt(0) lgkmcnt(0)
    s_barrier
    ds_read_b64_tr_b16 a[144:145], v6 offset:16384
    ds_read_b64_tr_b16 a[146:147], v6 offset:17408
    ds_read_b64_tr_b16 a[148:149], v6 offset:20480
    ds_read_b64_tr_b16 a[150:151], v6 offset:21504
    ds_read_b64_tr_b16 a[152:153], v6 offset:24576
    ds_read_b64_tr_b16 a[154:155], v6 offset:25600
    ds_read_b64_tr_b16 a[156:157], v6 offset:28672
    ds_read_b64_tr_b16 a[158:159], v6 offset:29696
    s_waitcnt lgkmcnt(0)
    s_barrier
    s_lshl_b32 s72, s46, 13
    s_add_u32 s72, s72, 0x400000
    v_bfe_u32 v3, v0, 0, 4
    v_lshlrev_b32 v3, 4, v3
    v_bfe_u32 v8, v0, 4, 1
    v_lshl_add_u32 v3, v8, 12, v3
    v_bfe_u32 v8, v0, 5, 1
    v_lshl_add_u32 v3, v8, 8, v3
    v_bfe_u32 v8, v0, 6, 2
    v_lshl_add_u32 v3, v8, 10, v3
    s_add_u32 s73, s46, 64
    s_lshl_b32 s73, s73, 6
    v_and_b32 v8, 7, v0
    v_lshlrev_b32 v8, 5, v8
    v_and_b32 v9, 8, v0
    v_lshl_add_u32 v8, v9, 1, v8
    s_mov_b32 s60, 0
L_tk_125:
    buffer_load_dword v9, v8, s[48:51], 0 offen sc1
    s_waitcnt vmcnt(0)
    v_readlane_b32 s62, v9, 8
    v_readlane_b32 s52, v9, 9
    s_nop 0
    s_add_u32 s62, s62, s52
    v_readlane_b32 s52, v9, 10
    s_nop 0
    s_add_u32 s62, s62, s52
    v_readlane_b32 s52, v9, 11
    s_nop 0
    s_add_u32 s62, s62, s52
    v_readlane_b32 s52, v9, 12
    s_nop 0
    s_add_u32 s62, s62, s52
    v_readlane_b32 s52, v9, 13
    s_nop 0
    s_add_u32 s62, s62, s52
    v_readlane_b32 s52, v9, 14
    s_nop 0
    s_add_u32 s62, s62, s52
    v_readlane_b32 s52, v9, 15
    s_nop 0
    s_add_u32 s62, s62, s52
    s_cmp_ge_u32 s62, 256
    s_cbranch_scc1 L_tkd_126
    s_sleep 2
    s_add_u32 s60, s60, 1
    s_cmp_lt_u32 s60, 0x100000
    s_cbranch_scc1 L_tk_125
    s_movk_i32 s62, 1
    s_branch L_ABORT
L_tkd_126:
    v_and_b32 v8, 63, v0
    v_lshlrev_b32 v8, 6, v8
    s_mov_b32 s60, 0
L_pf_127:
    buffer_load_dword v9, v8, s[4:7], 0 offen sc1
    s_waitcnt vmcnt(0)
    v_cmp_gt_u32 vcc, 1, v9
    s_nop 0
    s_cbranch_vccz L_pfd_128
    s_sleep 1
    s_add_u32 s60, s60, 1
    s_cmp_lt_u32 s60, 0x100000
    s_cbranch_scc1 L_pf_127
    s_movk_i32 s62, 4
    s_branch L_ABORT
L_pfd_128:
    s_mul_i32 s67, s44, 10240
    s_add_u32 s71, s67, 0x100000
    s_mov_b32 s70, 0
    s_mov_b32 s74, 0
    s_add_u32 s64, s70, s67
    s_add_u32 m0, s64, 0
    s_add_u32 s63, s71, 0
    buffer_load_dwordx4 v1, s[4:7], s63 offen offset:0 sc1 lds
    buffer_load_dwordx4 v1, s[4:7], s63 offen offset:1024 sc1 lds
    buffer_load_dwordx4 v1, s[4:7], s63 offen offset:2048 sc1 lds
    buffer_load_dwordx4 v1, s[4:7], s63 offen offset:3072 sc1 lds
    s_add_u32 m0, s64, 4096
    s_add_u32 s63, s71, 4096
    buffer_load_dwordx4 v1, s[4:7], s63 offen offset:0 sc1 lds
    buffer_load_dwordx4 v1, s[4:7], s63 offen offset:1024 sc1 lds
    buffer_load_dwordx4 v1, s[4:7], s63 offen offset:2048 sc1 lds
    buffer_load_dwordx4 v1, s[4:7], s63 offen offset:3072 sc1 lds
    s_add_u32 m0, s64, 8192
    s_add_u32 s63, s71, 8192
    buffer_load_dwordx4 v1, s[4:7], s63 offen offset:0 sc1 lds
    buffer_load_dwordx4 v1, s[4:7], s63 offen offset:1024 sc1 lds
    s_add_u32 s71, s71, 40960
    s_add_u32 s70, s70, 40960
    s_cmp_ge_u32 s70, 122880
    s_cselect_b32 s70, 0, s70
    s_add_u32 s64, s70, s67
    s_add_u32 m0, s64, 0
    s_add_u32 s63, s71, 0
    buffer_load_dwordx4 v1, s[4:7], s63 offen offset:0 sc1 lds
    buffer_load_dwordx4 v1, s[4:7], s63 offen offset:1024 sc1 lds
    buffer_load_dwordx4 v1, s[4:7], s63 offen offset:2048 sc1 lds
    buffer_load_dwordx4 v1, s[4:7], s63 offen offset:3072 sc1 lds
    s_add_u32 m0, s64, 4096
    s_add_u32 s63, s71, 4096
    buffer_load_dwordx4 v1, s[4:7], s63 offen offset:0 sc1 lds
    buffer_load_dwordx4 v1, s[4:7], s63 offen offset:1024 sc1 lds
    buffer_load_dwordx4 v1, s[4:7], s63 offen offset:2048 sc1 lds
    buffer_load_dwordx4 v1, s[4:7], s63 offen offset:3072 sc1 lds
    s_add_u32 m0, s64, 8192
    s_add_u32 s63, s71, 8192
    buffer_load_dwordx4 v1, s[4:7], s63 offen offset:0 sc1 lds
    buffer_load_dwordx4 v1, s[4:7], s63 offen offset:1024 sc1 lds
    s_add_u32 s71, s71, 40960
    s_add_u32 s70, s70, 40960
    s_cmp_ge_u32 s70, 122880
    s_cselect_b32 s70, 0, s70
    s_mov_b32 s61, 0
    s_waitcnt vmcnt(10)
L_KP_LOOP:
    s_barrier
    s_cmp_lg_u32 s44, 0
    s_cbranch_scc1 L_np_129
    s_cmp_lt_u32 s61, 2
    s_cbranch_scc1 L_np_129
    s_sub_u32 s62, s61, 1
    v_mov_b32 v8, 0
    v_mov_b32 v9, s62
    s_mov_b64 exec, 1
    buffer_store_dword v9, v8, s[4:7], s73 offen sc1
    s_mov_b64 exec, -1
L_np_129:
    v_add_u32 v2, s74, v1
    ds_read_b128 v[32:35], v2 offset:0
    ds_read_b128 v[36:39], v2 offset:1024
    ds_read_b128 v[40:43], v2 offset:2048
    ds_read_b128 v[44:47], v2 offset:3072
    s_waitcnt lgkmcnt(3)
    v_mfma_f32_32x32x16_bf16 v[16:31], a[0:3], v[32:35], 0
    ds_read_b128 v[32:35], v2 offset:4096
    s_waitcnt lgkmcnt(3)
    v_mfma_f32_32x32x16_bf16 v[16:31], a[4:7], v[36:39], v[16:31]
    ds_read_b128 v[36:39], v2 offset:5120
    s_add_u32 s64, s70, s67
    s_add_u32 m0, s64, 0
    s_add_u32 s63, s71, 0
    buffer_load_dwordx4 v1, s[4:7], s63 offen offset:0 sc1 lds
    s_waitcnt lgkmcnt(3)
    v_mfma_f32_32x32x16_bf16 v[16:31], a[8:11], v[40:43], v[16:31]
    ds_read_b128 v[40:43], v2 offset:6144
    s_waitcnt lgkmcnt(3)
    v_mfma_f32_32x32x16_bf16 v[16:31], a[12:15], v[44:47], v[16:31]
    ds_read_b128 v[44:47], v2 offset:7168
    s_waitcnt lgkmcnt(3)
    v_mfma_f32_32x32x16_bf16 v[16:31], a[16:19], v[32:35], v[16:31]
    ds_read_b128 v[32:35], v2 offset:8192
    s_waitcnt lgkmcnt(3)
    v_mfma_f32_32x32x16_bf16 v[16:31], a[20:23], v[36:39], v[16:31]
    ds_read_b128 v[36:39], v2 offset:9216
    buffer_load_dwordx4 v1, s[4:7], s63 offen offset:1024 sc1 lds
    s_waitcnt lgkmcnt(3)
    v_mfma_f32_32x32x16_bf16 v[16:31], a[24:27], v[40:43], v[16:31]
    ds_read_b128 v[40:43], v2 offset:10240
    s_waitcnt lgkmcnt(3)
    v_mfma_f32_32x32x16_bf16 v[16:31], a[28:31], v[44:47], v[16:31]
    ds_read_b128 v[44:47], v2 offset:11264
    s_waitcnt lgkmcnt(3)
    v_mfma_f32_32x32x16_bf16 v[16:31], a[32:35], v[32:35], v[16:31]
    ds_read_b128 v[32:35], v2 offset:12288
    s_waitcnt lgkmcnt(3)
    v_mfma_f32_32x32x16_bf16 v[16:31], a[36:39], v[36:39], v[16:31]
    ds_read_b128 v[36:39], v2 offset:13312
    buffer_load_dwordx4 v1, s[4:7], s63 offen offset:2048 sc1 lds
    s_waitcnt lgkmcnt(3)
    v_mfma_f32_32x32x16_bf16 v[16:31], a[40:43], v[40:43], v[16:31]
    ds_read_b128 v[40:43], v2 offset:14336
    s_waitcnt lgkmcnt(3)
    v_mfma_f32_32x32x16_bf16 v[16:31], a[44:47], v[44:47], v[16:31]
    ds_read_b128 v[44:47], v2 offset:15360
    s_waitcnt lgkmcnt(3)
    v_mfma_f32_32x32x16_bf16 v[16:31], a[48:51], v[32:35], v[16:31]
    ds_read_b128 v[32:35], v2 offset:16384
    s_waitcnt lgkmcnt(3)
    v_mfma_f32_32x32x16_bf16 v[16:31], a[52:55], v[36:39], v[16:31]
    ds_read_b128 v[36:39], v2 offset:17408
    buffer_load_dwordx4 v1, s[4:7], s63 offen offset:3072 sc1 lds
    s_waitcnt lgkmcnt(3)
    v_mfma_f32_32x32x16_bf16 v[16:31], a[56:59], v[40:43], v[16:31]
    ds_read_b128 v[40:43], v2 offset:18432
    s_waitcnt lgkmcnt(3)
    v_mfma_f32_32x32x16_bf16 v[16:31], a[60:63], v[44:47], v[16:31]
    ds_read_b128 v[44:47], v2 offset:19456
    s_waitcnt lgkmcnt(3)
    v_mfma_f32_32x32x16_bf16 v[16:31], a[64:67], v[32:35], v[16:31]
    ds_read_b128 v[32:35], v2 offset:20480
    s_waitcnt lgkmcnt(3)
    v_mfma_f32_32x32x16_bf16 v[16:31], a[68:71], v[36:39], v[16:31]
    ds_read_b128 v[36:39], v2 offset:21504
    s_add_u32 m0, s64, 4096
    s_add_u32 s63, s71, 4096
    buffer_load_dwordx4 v1, s[4:7], s63 offen offset:0 sc1 lds
    s_waitcnt lgkmcnt(3)
    v_mfma_f32_32x32x16_bf16 v[16:31], a[72:75], v[40:43], v[16:31]
    ds_read_b128 v[40:43], v2 offset:22528
    s_waitcnt lgkmcnt(3)
    v_mfma_f32_32x32x16_bf16 v[16:31], a[76:79], v[44:47], v[16:31]
    ds_read_b128 v[44:47], v2 offset:23552
    s_waitcnt lgkmcnt(3)
    v_mfma_f32_32x32x16_bf16 v[16:31], a[80:83], v[32:35], v[16:31]
    ds_read_b128 v[32:35], v2 offset:24576
    s_waitcnt lgkmcnt(3)
    v_mfma_f32_32x32x16_bf16 v[16:31], a[84:87], v[36:39], v[16:31]
    ds_read_b128 v[36:39], v2 offset:25600
    buffer_load_dwordx4 v1, s[4:7], s63 offen offset:1024 sc1 lds
    s_waitcnt lgkmcnt(3)
    v_mfma_f32_32x32x16_bf16 v[16:31], a[88:91], v[40:43], v[16:31]
    ds_read_b128 v[40:43], v2 offset:26624
    s_waitcnt lgkmcnt(3)
    v_mfma_f32_32x32x16_bf16 v[16:31], a[92:95], v[44:47], v[16:31]
    ds_read_b128 v[44:47], v2 offset:27648
    s_waitcnt lgkmcnt(3)
    v_mfma_f32_32x32x16_bf16 v[16:31], a[96:99], v[32:35], v[16:31]
    ds_read_b128 v[32:35], v2 offset:28672
    s_waitcnt lgkmcnt(3)
    v_mfma_f32_32x32x16_bf16 v[16:31], a[100:103], v[36:39], v[16:31]
    ds_read_b128 v[36:39], v2 offset:29696
    buffer_load_dwordx4 v1, s[4:7], s63 offen offset:2048 sc1 lds
    s_waitcnt lgkmcnt(3)
    v_mfma_f32_32x32x16_bf16 v[16:31], a[104:107], v[40:43], v[16:31]
    ds_read_b128 v[40:43], v2 offset:30720
    s_waitcnt lgkmcnt(3)
    v_mfma_f32_32x32x16_bf16 v[16:31], a[108:111], v[44:47], v[16:31]
    ds_read_b128 v[44:47], v2 offset:31744
    s_waitcnt lgkmcnt(3)
    v_mfma_f32_32x32x16_bf16 v[16:31], a[112:115], v[32:35], v[16:31]
    ds_read_b128 v[32:35], v2 offset:32768
    s_waitcnt lgkmcnt(3)
    v_mfma_f32_32x32x16_bf16 v[16:31], a[116:119], v[36:39], v[16:31]
    ds_read_b128 v[36:39], v2 offset:33792
    buffer_load_dwordx4 v1, s[4:7], s63 offen offset:3072 sc1 lds
    s_waitcnt lgkmcnt(3)
    v_mfma_f32_32x32x16_bf16 v[16:31], a[120:123], v[40:43], v[16:31]
    ds_read_b128 v[40:43], v2 offset:34816
    s_waitcnt lgkmcnt(3)
    v_mfma_f32_32x32x16_bf16 v[16:31], a[124:127], v[44:47], v[16:31]
    ds_read_b128 v[44:47], v2 offset:35840
    s_waitcnt lgkmcnt(3)
    v_mfma_f32_32x32x16_bf16 v[16:31], a[128:131], v[32:35], v[16:31]
    ds_read_b128 v[32:35], v2 offset:36864
    s_waitcnt lgkmcnt(3)
    v_mfma_f32_32x32x16_bf16 v[16:31], a[132:135], v[36:39], v[16:31]
    ds_read_b128 v[36:39], v2 offset:37888
    s_add_u32 m0, s64, 8192
    s_add_u32 s63, s71, 8192
    buffer_load_dwordx4 v1, s[4:7], s63 offen offset:0 sc1 lds
    s_waitcnt lgkmcnt(3)
    v_mfma_f32_32x32x16_bf16 v[16:31], a[136:139], v[40:43], v[16:31]
    ds_read_b128 v[40:43], v2 offset:38912
    s_waitcnt lgkmcnt(3)
    v_mfma_f32_32x32x16_bf16 v[16:31], a[140:143], v[44:47], v[16:31]
    ds_read_b128 v[44:47], v2 offset:39936
    s_waitcnt lgkmcnt(3)
    v_mfma_f32_32x32x16_bf16 v[16:31], a[144:147], v[32:35], v[16:31]
    s_waitcnt lgkmcnt(2)
    v_mfma_f32_32x32x16_bf16 v[16:31], a[148:151], v[36:39], v[16:31]
    buffer_load_dwordx4 v1, s[4:7], s63 offen offset:1024 sc1 lds
    s_add_u32 s71, s71, 40960
    s_add_u32 s70, s70, 40960
    s_cmp_ge_u32 s70, 122880
    s_cselect_b32 s70, 0, s70
    s_waitcnt lgkmcnt(1)
    v_mfma_f32_32x32x16_bf16 v[16:31], a[152:155], v[40:43], v[16:31]
    s_waitcnt lgkmcnt(0)
    v_mfma_f32_32x32x16_bf16 v[16:31], a[156:159], v[44:47], v[16:31]
    s_add_u32 s74, s74, 40960
    s_cmp_ge_u32 s74, 122880
    s_cselect_b32 s74, 0, s74
    s_nop 8
    v_cvt_pk_bf16_f32 v48, v16, v17
    v_cvt_pk_bf16_f32 v49, v18, v19
    v_cvt_pk_bf16_f32 v50, v20, v21
    v_cvt_pk_bf16_f32 v51, v22, v23
    buffer_store_dwordx4 v[48:51], v3, s[4:7], s72 offen offset:0 sc1
    v_cvt_pk_bf16_f32 v52, v24, v25
    v_cvt_pk_bf16_f32 v53, v26, v27
    v_cvt_pk_bf16_f32 v54, v28, v29
    v_cvt_pk_bf16_f32 v55, v30, v31
    buffer_store_dwordx4 v[52:55], v3, s[4:7], s72 offen offset:512 sc1
    s_add_u32 s72, s72, 262144
    s_add_u32 s61, s61, 1
    s_waitcnt vmcnt(12)
    s_cmp_lt_u32 s61, 64
    s_cbranch_scc1 L_KP_LOOP
    s_waitcnt vmcnt(0)
    s_barrier
    s_cmp_lg_u32 s44, 0
    s_cbranch_scc1 L_END
    v_mov_b32 v8, 0
    v_mov_b32 v9, 64
    s_mov_b64 exec, 1
    buffer_store_dword v9, v8, s[4:7], s73 offen sc1
    s_mov_b64 exec, -1
    s_branch L_END2
L_VP:
    v_bfe_u32 v1, v0, 0, 6
    v_lshlrev_b32 v1, 4, v1
    s_mov_b32 s8, s24
    s_and_b32 s9, s25, 0xffff
    s_mov_b32 s10, 0x500000
    s_mov_b32 s11, 0x20000
    s_lshl_b32 s66, s46, 8
    v_bfe_u32 v4, v0, 0, 4
    v_lshlrev_b32 v4, 4, v4
    v_bfe_u32 v9, v0, 4, 2
    v_lshlrev_b32 v9, 6, v9
    v_xor_b32 v4, v4, v9
    v_bfe_u32 v9, v0, 4, 2
    v_lshlrev_b32 v9, 13, v9
    v_bfe_u32 v8, v0, 6, 2
    v_lshl_add_u32 v9, v8, 17, v9
    v_add_u32 v4, v4, v9
    v_bfe_u32 v6, v0, 1, 1
    v_lshlrev_b32 v6, 4, v6
    v_bfe_u32 v8, v0, 4, 1
    v_lshl_add_u32 v6, v8, 5, v6
    v_bfe_u32 v8, v0, 6, 2
    v_lshl_add_u32 v6, v8, 6, v6
    v_bfe_u32 v9, v0, 2, 2
    v_lshlrev_b32 v9, 6, v9
    v_xor_b32 v6, v6, v9
    v_bfe_u32 v9, v0, 0, 1
    v_lshlrev_b32 v9, 3, v9
    v_bfe_u32 v8, v0, 2, 2
    v_lshl_add_u32 v9, v8, 8, v9
    v_bfe_u32 v8, v0, 5, 1
    v_lshl_add_u32 v9, v8, 11, v9
    v_add_u32 v6, v6, v9
    v_add_u32 v7, 0x10000, v6
    s_lshl_b32 s67, s44, 12
    s_add_u32 s63, s66, 0x0
    s_add_u32 s64, s67, 0x0
    s_mov_b32 m0, s64
    s_nop 0
    buffer_load_dwordx4 v4, s[8:11], s63 offen lds
    s_add_u32 s63, s66, 0x8000
    s_add_u32 s64, s67, 0x400
    s_mov_b32 m0, s64
    s_nop 0
    buffer_load_dwordx4 v4, s[8:11], s63 offen lds
    s_add_u32 s63, s66, 0x10000
    s_add_u32 s64, s67, 0x800
    s_mov_b32 m0, s64
    s_nop 0
    buffer_load_dwordx4 v4, s[8:11], s63 offen lds
    s_add_u32 s63, s66, 0x18000
    s_add_u32 s64, s67, 0xc00
    s_mov_b32 m0, s64
    s_nop 0
    buffer_load_dwordx4 v4, s[8:11], s63 offen lds
    s_add_u32 s63, s66, 0x80000
    s_add_u32 s64, s67, 0x4000
    s_mov_b32 m0, s64
    s_nop 0
    buffer_load_dwordx4 v4, s[8:11], s63 offen lds
    s_add_u32 s63, s66, 0x88000
    s_add_u32 s64, s67, 0x4400
    s_mov_b32 m0, s64
    s_nop 0
    buffer_load_dwordx4 v4, s[8:11], s63 offen lds
    s_add_u32 s63, s66, 0x90000
    s_add_u32 s64, s67, 0x4800
    s_mov_b32 m0, s64
    s_nop 0
    buffer_load_dwordx4 v4, s[8:11], s63 offen lds
    s_add_u32 s63, s66, 0x98000
    s_add_u32 s64, s67, 0x4c00
    s_mov_b32 m0, s64
    s_nop 0
    buffer_load_dwordx4 v4, s[8:11], s63 offen lds
    s_add_u32 s63, s66, 0x100000
    s_add_u32 s64, s67, 0x8000
    s_mov_b32 m0, s64
    s_nop 0
    buffer_load_dwordx4 v4, s[8:11], s63 offen lds
    s_add_u32 s63, s66, 0x108000
    s_add_u32 s64, s67, 0x8400
    s_mov_b32 m0, s64
    s_nop 0
    buffer_load_dwordx4 v4, s[8:11], s63 offen lds
    s_add_u32 s63, s66, 0x110000
    s_add_u32 s64, s67, 0x8800
    s_mov_b32 m0, s64
    s_nop 0
    buffer_load_dwordx4 v4, s[8:11], s63 offen lds
    s_add_u32 s63, s66, 0x118000
    s_add_u32 s64, s67, 0x8c00
    s_mov_b32 m0, s64
    s_nop 0
    buffer_load_dwordx4 v4, s[8:11], s63 offen lds
    s_add_u32 s63, s66, 0x180000
    s_add_u32 s64, s67, 0xc000
    s_mov_b32 m0, s64
    s_nop 0
    buffer_load_dwordx4 v4, s[8:11], s63 offen lds
    s_add_u32 s63, s66, 0x188000
    s_add_u32 s64, s67, 0xc400
    s_mov_b32 m0, s64
    s_nop 0
    buffer_load_dwordx4 v4, s[8:11], s63 offen lds
    s_add_u32 s63, s66, 0x190000
    s_add_u32 s64, s67, 0xc800
    s_mov_b32 m0, s64
    s_nop 0
    buffer_load_dwordx4 v4, s[8:11], s63 offen lds
    s_add_u32 s63, s66, 0x198000
    s_add_u32 s64, s67, 0xcc00
    s_mov_b32 m0, s64
    s_nop 0
    buffer_load_dwordx4 v4, s[8:11], s63 offen lds
    s_add_u32 s63, s66, 0x200000
    s_add_u32 s64, s67, 0x10000
    s_mov_b32 m0, s64
    s_nop 0
    buffer_load_dwordx4 v4, s[8:11], s63 offen lds
    s_add_u32 s63, s66, 0x208000
    s_add_u32 s64, s67, 0x10400
    s_mov_b32 m0, s64
    s_nop 0
    buffer_load_dwordx4 v4, s[8:11], s63 offen lds
    s_add_u32 s63, s66, 0x210000
    s_add_u32 s64, s67, 0x10800
    s_mov_b32 m0, s64
    s_nop 0
    buffer_load_dwordx4 v4, s[8:11], s63 offen lds
    s_add_u32 s63, s66, 0x218000
    s_add_u32 s64, s67, 0x10c00
    s_mov_b32 m0, s64
    s_nop 0
    buffer_load_dwordx4 v4, s[8:11], s63 offen lds
    s_add_u32 s63, s66, 0x280000
    s_add_u32 s64, s67, 0x14000
    s_mov_b32 m0, s64
    s_nop 0
    buffer_load_dwordx4 v4, s[8:11], s63 offen lds
    s_add_u32 s63, s66, 0x288000
    s_add_u32 s64, s67, 0x14400
    s_mov_b32 m0, s64
    s_nop 0
    buffer_load_dwordx4 v4, s[8:11], s63 offen lds
    s_add_u32 s63, s66, 0x290000
    s_add_u32 s64, s67, 0x14800
    s_mov_b32 m0, s64
    s_nop 0
    buffer_load_dwordx4 v4, s[8:11], s63 offen lds
    s_add_u32 s63, s66, 0x298000
    s_add_u32 s64, s67, 0x14c00
    s_mov_b32 m0, s64
    s_nop 0
    buffer_load_dwordx4 v4, s[8:11], s63 offen lds
    s_add_u32 s63, s66, 0x300000
    s_add_u32 s64, s67, 0x18000
    s_mov_b32 m0, s64
    s_nop 0
    buffer_load_dwordx4 v4, s[8:11], s63 offen lds
    s_add_u32 s63, s66, 0x308000
    s_add_u32 s64, s67, 0x18400
    s_mov_b32 m0, s64
    s_nop 0
    buffer_load_dwordx4 v4, s[8:11], s63 offen lds
    s_add_u32 s63, s66, 0x310000
    s_add_u32 s64, s67, 0x18800
    s_mov_b32 m0, s64
    s_nop 0
    buffer_load_dwordx4 v4, s[8:11], s63 offen lds
    s_add_u32 s63, s66, 0x318000
    s_add_u32 s64, s67, 0x18c00
    s_mov_b32 m0, s64
    s_nop 0
    buffer_load_dwordx4 v4, s[8:11], s63 offen lds
    s_waitcnt vmcnt(24) lgkmcnt(0)
    s_barrier
    s_add_u32 s63, s66, 0x380000
    s_add_u32 s64, s67, 0x1c000
    s_mov_b32 m0, s64
    s_nop 0
    buffer_load_dwordx4 v4, s[8:11], s63 offen lds
    s_add_u32 s63, s66, 0x388000
    s_add_u32 s64, s67, 0x1c400
    s_mov_b32 m0, s64
    s_nop 0
    buffer_load_dwordx4 v4, s[8:11], s63 offen lds
    s_add_u32 s63, s66, 0x390000
    s_add_u32 s64, s67, 0x1c800
    s_mov_b32 m0, s64
    s_nop 0
    buffer_load_dwordx4 v4, s[8:11], s63 offen lds
    s_add_u32 s63, s66, 0x398000
    s_add_u32 s64, s67, 0x1cc00
    s_mov_b32 m0, s64
    s_nop 0
    buffer_load_dwordx4 v4, s[8:11], s63 offen lds
    ds_read_b64_tr_b16 a[0:1], v6 offset:0
    ds_read_b64_tr_b16 a[2:3], v6 offset:1024
    ds_read_b64_tr_b16 a[4:5], v6 offset:4096
    ds_read_b64_tr_b16 a[6:7], v6 offset:5120
    ds_read_b64_tr_b16 a[8:9], v6 offset:8192
    ds_read_b64_tr_b16 a[10:11], v6 offset:9216
    ds_read_b64_tr_b16 a[12:13], v6 offset:12288
    ds_read_b64_tr_b16 a[14:15], v6 offset:13312
    s_waitcnt vmcnt(24) lgkmcnt(0)
    s_barrier
    s_add_u32 s63, s66, 0x400000
    s_add_u32 s64, s67, 0x0
    s_mov_b32 m0, s64
    s_nop 0
    buffer_load_dwordx4 v4, s[8:11], s63 offen lds
    s_add_u32 s63, s66, 0x408000
    s_add_u32 s64, s67, 0x400
    s_mov_b32 m0, s64
    s_nop 0
    buffer_load_dwordx4 v4, s[8:11], s63 offen lds
    s_add_u32 s63, s66, 0x410000
    s_add_u32 s64, s67, 0x800
    s_mov_b32 m0, s64
    s_nop 0
    buffer_load_dwordx4 v4, s[8:11], s63 offen lds
    s_add_u32 s63, s66, 0x418000
    s_add_u32 s64, s67, 0xc00
    s_mov_b32 m0, s64
    s_nop 0
    buffer_load_dwordx4 v4, s[8:11], s63 offen lds
    ds_read_b64_tr_b16 a[16:17], v6 offset:16384
    ds_read_b64_tr_b16 a[18:19], v6 offset:17408
    ds_read_b64_tr_b16 a[20:21], v6 offset:20480
    ds_read_b64_tr_b16 a[22:23], v6 offset:21504
    ds_read_b64_tr_b16 a[24:25], v6 offset:24576
    ds_read_b64_tr_b16 a[26:27], v6 offset:25600
    ds_read_b64_tr_b16 a[28:29], v6 offset:28672
    ds_read_b64_tr_b16 a[30:31], v6 offset:29696
    s_waitcnt vmcnt(24) lgkmcnt(0)
    s_barrier
    s_add_u32 s63, s66, 0x480000
    s_add_u32 s64, s67, 0x4000
    s_mov_b32 m0, s64
    s_nop 0
    buffer_load_dwordx4 v4, s[8:11], s63 offen lds
    s_add_u32 s63, s66, 0x488000
    s_add_u32 s64, s67, 0x4400
    s_mov_b32 m0, s64
    s_nop 0
    buffer_load_dwordx4 v4, s[8:11], s63 offen lds
    s_add_u32 s63, s66, 0x490000
    s_add_u32 s64, s67, 0x4800
    s_mov_b32 m0, s64
    s_nop 0
    buffer_load_dwordx4 v4, s[8:11], s63 offen lds
    s_add_u32 s63, s66, 0x498000
    s_add_u32 s64, s67, 0x4c00
    s_mov_b32 m0, s64
    s_nop 0
    buffer_load_dwordx4 v4, s[8:11], s63 offen lds
    ds_read_b64_tr_b16 a[32:33], v6 offset:32768
    ds_read_b64_tr_b16 a[34:35], v6 offset:33792
    ds_read_b64_tr_b16 a[36:37], v6 offset:36864
    ds_read_b64_tr_b16 a[38:39], v6 offset:37888
    ds_read_b64_tr_b16 a[40:41], v6 offset:40960
    ds_read_b64_tr_b16 a[42:43], v6 offset:41984
    ds_read_b64_tr_b16 a[44:45], v6 offset:45056
    ds_read_b64_tr_b16 a[46:47], v6 offset:46080
    s_waitcnt vmcnt(24) lgkmcnt(0)
    s_barrier
    ds_read_b64_tr_b16 a[48:49], v6 offset:49152
    ds_read_b64_tr_b16 a[50:51], v6 offset:50176
    ds_read_b64_tr_b16 a[52:53], v6 offset:53248
    ds_read_b64_tr_b16 a[54:55], v6 offset:54272
    ds_read_b64_tr_b16 a[56:57], v6 offset:57344
    ds_read_b64_tr_b16 a[58:59], v6 offset:58368
    ds_read_b64_tr_b16 a[60:61], v6 offset:61440
    ds_read_b64_tr_b16 a[62:63], v6 offset:62464
    s_waitcnt vmcnt(20) lgkmcnt(0)
    s_barrier
    ds_read_b64_tr_b16 a[64:65], v7 offset:0
    ds_read_b64_tr_b16 a[66:67], v7 offset:1024
    ds_read_b64_tr_b16 a[68:69], v7 offset:4096
    ds_read_b64_tr_b16 a[70:71], v7 offset:5120
    ds_read_b64_tr_b16 a[72:73], v7 offset:8192
    ds_read_b64_tr_b16 a[74:75], v7 offset:9216
    ds_read_b64_tr_b16 a[76:77], v7 offset:12288
    ds_read_b64_tr_b16 a[78:79], v7 offset:13312
    s_waitcnt vmcnt(16) lgkmcnt(0)
    s_barrier
    ds_read_b64_tr_b16 a[80:81], v7 offset:16384
    ds_read_b64_tr_b16 a[82:83], v7 offset:17408
    ds_read_b64_tr_b16 a[84:85], v7 offset:20480
    ds_read_b64_tr_b16 a[86:87], v7 offset:21504
    ds_read_b64_tr_b16 a[88:89], v7 offset:24576
    ds_read_b64_tr_b16 a[90:91], v7 offset:25600
    ds_read_b64_tr_b16 a[92:93], v7 offset:28672
    ds_read_b64_tr_b16 a[94:95], v7 offset:29696
    s_waitcnt vmcnt(12) lgkmcnt(0)
    s_barrier
    ds_read_b64_tr_b16 a[96:97], v7 offset:32768
    ds_read_b64_tr_b16 a[98:99], v7 offset:33792
    ds_read_b64_tr_b16 a[100:101], v7 offset:36864
    ds_read_b64_tr_b16 a[102:103], v7 offset:37888
    ds_read_b64_tr_b16 a[104:105], v7 offset:40960
    ds_read_b64_tr_b16 a[106:107], v7 offset:41984
    ds_read_b64_tr_b16 a[108:109], v7 offset:45056
    ds_read_b64_tr_b16 a[110:111], v7 offset:46080
    s_waitcnt vmcnt(8) lgkmcnt(0)
    s_barrier
    ds_read_b64_tr_b16 a[112:113], v7 offset:49152
    ds_read_b64_tr_b16 a[114:115], v7 offset:50176
    ds_read_b64_tr_b16 a[116:117], v7 offset:53248
    ds_read_b64_tr_b16 a[118:119], v7 offset:54272
    ds_read_b64_tr_b16 a[120:121], v7 offset:57344
    ds_read_b64_tr_b16 a[122:123], v7 offset:58368
    ds_read_b64_tr_b16 a[124:125], v7 offset:61440
    ds_read_b64_tr_b16 a[126:127], v7 offset:62464
    s_waitcnt vmcnt(4) lgkmcnt(0)
    s_barrier
    ds_read_b64_tr_b16 a[128:129], v6 offset:0
    ds_read_b64_tr_b16 a[130:131], v6 offset:1024
    ds_read_b64_tr_b16 a[132:133], v6 offset:4096
    ds_read_b64_tr_b16 a[134:135], v6 offset:5120
    ds_read_b64_tr_b16 a[136:137], v6 offset:8192
    ds_read_b64_tr_b16 a[138:139], v6 offset:9216
    ds_read_b64_tr_b16 a[140:141], v6 offset:12288
    ds_read_b64_tr_b16 a[142:143], v6 offset:13312
    s_waitcnt vmcnt(0) lgkmcnt(0)
    s_barrier
    ds_read_b64_tr_b16 a[144:145], v6 offset:16384
    ds_read_b64_tr_b16 a[146:147], v6 offset:17408
    ds_read_b64_tr_b16 a[148:149], v6 offset:20480
    ds_read_b64_tr_b16 a[150:151], v6 offset:21504
    ds_read_b64_tr_b16 a[152:153], v6 offset:24576
    ds_read_b64_tr_b16 a[154:155], v6 offset:25600
    ds_read_b64_tr_b16 a[156:157], v6 offset:28672
    ds_read_b64_tr_b16 a[158:159], v6 offset:29696
    s_waitcnt lgkmcnt(0)
    s_barrier
    s_lshl_b32 s72, s46, 13
    s_add_u32 s72, s72, 0x1400000
    v_bfe_u32 v3, v0, 0, 4
    v_lshlrev_b32 v3, 4, v3
    v_bfe_u32 v8, v0, 4, 1
    v_lshl_add_u32 v3, v8, 10, v3
    v_bfe_u32 v8, v0, 5, 1
    v_lshl_add_u32 v3, v8, 8, v3
    v_bfe_u32 v8, v0, 6, 2
    v_lshl_add_u32 v3, v8, 11, v3
    s_add_u32 s73, s46, 96
    s_lshl_b32 s73, s73, 6
    v_and_b32 v8, 7, v0
    v_lshlrev_b32 v8, 5, v8
    v_and_b32 v9, 8, v0
    v_lshl_add_u32 v8, v9, 1, v8
    s_mov_b32 s60, 0
L_tk_130:
    buffer_load_dword v9, v8, s[48:51], 0 offen sc1
    s_waitcnt vmcnt(0)
    v_readlane_b32 s62, v9, 8
    v_readlane_b32 s52, v9, 9
    s_nop 0
    s_add_u32 s62, s62, s52
    v_readlane_b32 s52, v9, 10
    s_nop 0
    s_add_u32 s62, s62, s52
    v_readlane_b32 s52, v9, 11
    s_nop 0
    s_add_u32 s62, s62, s52
    v_readlane_b32 s52, v9, 12
    s_nop 0
    s_add_u32 s62, s62, s52
    v_readlane_b32 s52, v9, 13
    s_nop 0
    s_add_u32 s62, s62, s52
    v_readlane_b32 s52, v9, 14
    s_nop 0
    s_add_u32 s62, s62, s52
    v_readlane_b32 s52, v9, 15
    s_nop 0
    s_add_u32 s62, s62, s52
    s_cmp_ge_u32 s62, 256
    s_cbranch_scc1 L_tkd_131
    s_sleep 2
    s_add_u32 s60, s60, 1
    s_cmp_lt_u32 s60, 0x100000
    s_cbranch_scc1 L_tk_130
    s_movk_i32 s62, 1
    s_branch L_ABORT
L_tkd_131:
    v_and_b32 v8, 63, v0
    v_lshlrev_b32 v8, 6, v8
    s_mov_b32 s60, 0
L_pf_132:
    buffer_load_dword v9, v8, s[4:7], 0 offen sc1
    s_waitcnt vmcnt(0)
    v_cmp_gt_u32 vcc, 1, v9
    s_nop 0
    s_cbranch_vccz L_pfd_133
    s_sleep 1
    s_add_u32 s60, s60, 1
    s_cmp_lt_u32 s60, 0x100000
    s_cbranch_scc1 L_pf_132
    s_movk_i32 s62, 4
    s_branch L_ABORT
L_pfd_133:
    s_mul_i32 s67, s44, 10240
    s_add_u32 s71, s67, 0x100000
    s_mov_b32 s70, 0
    s_mov_b32 s74, 0
    s_add_u32 s64, s70, s67
    s_add_u32 m0, s64, 0
    s_add_u32 s63, s71, 0
    buffer_load_dwordx4 v1, s[4:7], s63 offen offset:0 sc1 lds
    buffer_load_dwordx4 v1, s[4:7], s63 offen offset:1024 sc1 lds
    buffer_load_dwordx4 v1, s[4:7], s63 offen offset:2048 sc1 lds
    buffer_load_dwordx4 v1, s[4:7], s63 offen offset:3072 sc1 lds
    s_add_u32 m0, s64, 4096
    s_add_u32 s63, s71, 4096
    buffer_load_dwordx4 v1, s[4:7], s63 offen offset:0 sc1 lds
    buffer_load_dwordx4 v1, s[4:7], s63 offen offset:1024 sc1 lds
    buffer_load_dwordx4 v1, s[4:7], s63 offen offset:2048 sc1 lds
    buffer_load_dwordx4 v1, s[4:7], s63 offen offset:3072 sc1 lds
    s_add_u32 m0, s64, 8192
    s_add_u32 s63, s71, 8192
    buffer_load_dwordx4 v1, s[4:7], s63 offen offset:0 sc1 lds
    buffer_load_dwordx4 v1, s[4:7], s63 offen offset:1024 sc1 lds
    s_add_u32 s71, s71, 40960
    s_add_u32 s70, s70, 40960
    s_cmp_ge_u32 s70, 122880
    s_cselect_b32 s70, 0, s70
    s_add_u32 s64, s70, s67
    s_add_u32 m0, s64, 0
    s_add_u32 s63, s71, 0
    buffer_load_dwordx4 v1, s[4:7], s63 offen offset:0 sc1 lds
    buffer_load_dwordx4 v1, s[4:7], s63 offen offset:1024 sc1 lds
    buffer_load_dwordx4 v1, s[4:7], s63 offen offset:2048 sc1 lds
    buffer_load_dwordx4 v1, s[4:7], s63 offen offset:3072 sc1 lds
    s_add_u32 m0, s64, 4096
    s_add_u32 s63, s71, 4096
    buffer_load_dwordx4 v1, s[4:7], s63 offen offset:0 sc1 lds
    buffer_load_dwordx4 v1, s[4:7], s63 offen offset:1024 sc1 lds
    buffer_load_dwordx4 v1, s[4:7], s63 offen offset:2048 sc1 lds
    buffer_load_dwordx4 v1, s[4:7], s63 offen offset:3072 sc1 lds
    s_add_u32 m0, s64, 8192
    s_add_u32 s63, s71, 8192
    buffer_load_dwordx4 v1, s[4:7], s63 offen offset:0 sc1 lds
    buffer_load_dwordx4 v1, s[4:7], s63 offen offset:1024 sc1 lds
    s_add_u32 s71, s71, 40960
    s_add_u32 s70, s70, 40960
    s_cmp_ge_u32 s70, 122880
    s_cselect_b32 s70, 0, s70
    s_mov_b32 s61, 0
    s_waitcnt vmcnt(10)
L_VP_LOOP:
    s_barrier
    s_cmp_lg_u32 s44, 0
    s_cbranch_scc1 L_np_134
    s_cmp_lt_u32 s61, 2
    s_cbranch_scc1 L_np_134
    s_sub_u32 s62, s61, 1
    v_mov_b32 v8, 0
    v_mov_b32 v9, s62
    s_mov_b64 exec, 1
    buffer_store_dword v9, v8, s[4:7], s73 offen sc1
    s_mov_b64 exec, -1
L_np_134:
    v_add_u32 v2, s74, v1
    ds_read_b128 v[32:35], v2 offset:0
    ds_read_b128 v[36:39], v2 offset:1024
    ds_read_b128 v[40:43], v2 offset:2048
    ds_read_b128 v[44:47], v2 offset:3072
    s_waitcnt lgkmcnt(3)
    v_mfma_f32_32x32x16_bf16 v[16:31], v[32:35], a[0:3], 0
    ds_read_b128 v[32:35], v2 offset:4096
    s_waitcnt lgkmcnt(3)
    v_mfma_f32_32x32x16_bf16 v[16:31], v[36:39], a[4:7], v[16:31]
    ds_read_b128 v[36:39], v2 offset:5120
    s_add_u32 s64, s70, s67
    s_add_u32 m0, s64, 0
    s_add_u32 s63, s71, 0
    buffer_load_dwordx4 v1, s[4:7], s63 offen offset:0 sc1 lds
    s_waitcnt lgkmcnt(3)
    v_mfma_f32_32x32x16_bf16 v[16:31], v[40:43], a[8:11], v[16:31]
    ds_read_b128 v[40:43], v2 offset:6144
    s_waitcnt lgkmcnt(3)
    v_mfma_f32_32x32x16_bf16 v[16:31], v[44:47], a[12:15], v[16:31]
    ds_read_b128 v[44:47], v2 offset:7168
    s_waitcnt lgkmcnt(3)
    v_mfma_f32_32x32x16_bf16 v[16:31], v[32:35], a[16:19], v[16:31]
    ds_read_b128 v[32:35], v2 offset:8192
    s_waitcnt lgkmcnt(3)
    v_mfma_f32_32x32x16_bf16 v[16:31], v[36:39], a[20:23], v[16:31]
    ds_read_b128 v[36:39], v2 offset:9216
    buffer_load_dwordx4 v1, s[4:7], s63 offen offset:1024 sc1 lds
    s_waitcnt lgkmcnt(3)
    v_mfma_f32_32x32x16_bf16 v[16:31], v[40:43], a[24:27], v[16:31]
    ds_read_b128 v[40:43], v2 offset:10240
    s_waitcnt lgkmcnt(3)
    v_mfma_f32_32x32x16_bf16 v[16:31], v[44:47], a[28:31], v[16:31]
    ds_read_b128 v[44:47], v2 offset:11264
    s_waitcnt lgkmcnt(3)
    v_mfma_f32_32x32x16_bf16 v[16:31], v[32:35], a[32:35], v[16:31]
    ds_read_b128 v[32:35], v2 offset:12288
    s_waitcnt lgkmcnt(3)
    v_mfma_f32_32x32x16_bf16 v[16:31], v[36:39], a[36:39], v[16:31]
    ds_read_b128 v[36:39], v2 offset:13312
    buffer_load_dwordx4 v1, s[4:7], s63 offen offset:2048 sc1 lds
    s_waitcnt lgkmcnt(3)
    v_mfma_f32_32x32x16_bf16 v[16:31], v[40:43], a[40:43], v[16:31]
    ds_read_b128 v[40:43], v2 offset:14336
    s_waitcnt lgkmcnt(3)
    v_mfma_f32_32x32x16_bf16 v[16:31], v[44:47], a[44:47], v[16:31]
    ds_read_b128 v[44:47], v2 offset:15360
    s_waitcnt lgkmcnt(3)
    v_mfma_f32_32x32x16_bf16 v[16:31], v[32:35], a[48:51], v[16:31]
    ds_read_b128 v[32:35], v2 offset:16384
    s_waitcnt lgkmcnt(3)
    v_mfma_f32_32x32x16_bf16 v[16:31], v[36:39], a[52:55], v[16:31]
    ds_read_b128 v[36:39], v2 offset:17408
    buffer_load_dwordx4 v1, s[4:7], s63 offen offset:3072 sc1 lds
    s_waitcnt lgkmcnt(3)
    v_mfma_f32_32x32x16_bf16 v[16:31], v[40:43], a[56:59], v[16:31]
    ds_read_b128 v[40:43], v2 offset:18432
    s_waitcnt lgkmcnt(3)
    v_mfma_f32_32x32x16_bf16 v[16:31], v[44:47], a[60:63], v[16:31]
    ds_read_b128 v[44:47], v2 offset:19456
    s_waitcnt lgkmcnt(3)
    v_mfma_f32_32x32x16_bf16 v[16:31], v[32:35], a[64:67], v[16:31]
    ds_read_b128 v[32:35], v2 offset:20480
    s_waitcnt lgkmcnt(3)
    v_mfma_f32_32x32x16_bf16 v[16:31], v[36:39], a[68:71], v[16:31]
    ds_read_b128 v[36:39], v2 offset:21504
    s_add_u32 m0, s64, 4096
    s_add_u32 s63, s71, 4096
    buffer_load_dwordx4 v1, s[4:7], s63 offen offset:0 sc1 lds
    s_waitcnt lgkmcnt(3)
    v_mfma_f32_32x32x16_bf16 v[16:31], v[40:43], a[72:75], v[16:31]
    ds_read_b128 v[40:43], v2 offset:22528
    s_waitcnt lgkmcnt(3)
    v_mfma_f32_32x32x16_bf16 v[16:31], v[44:47], a[76:79], v[16:31]
    ds_read_b128 v[44:47], v2 offset:23552
    s_waitcnt lgkmcnt(3)
    v_mfma_f32_32x32x16_bf16 v[16:31], v[32:35], a[80:83], v[16:31]
    ds_read_b128 v[32:35], v2 offset:24576
    s_waitcnt lgkmcnt(3)
    v_mfma_f32_32x32x16_bf16 v[16:31], v[36:39], a[84:87], v[16:31]
    ds_read_b128 v[36:39], v2 offset:25600
    buffer_load_dwordx4 v1, s[4:7], s63 offen offset:1024 sc1 lds
    s_waitcnt lgkmcnt(3)
    v_mfma_f32_32x32x16_bf16 v[16:31], v[40:43], a[88:91], v[16:31]
    ds_read_b128 v[40:43], v2 offset:26624
    s_waitcnt lgkmcnt(3)
    v_mfma_f32_32x32x16_bf16 v[16:31], v[44:47], a[92:95], v[16:31]
    ds_read_b128 v[44:47], v2 offset:27648
    s_waitcnt lgkmcnt(3)
    v_mfma_f32_32x32x16_bf16 v[16:31], v[32:35], a[96:99], v[16:31]
    ds_read_b128 v[32:35], v2 offset:28672
    s_waitcnt lgkmcnt(3)
    v_mfma_f32_32x32x16_bf16 v[16:31], v[36:39], a[100:103], v[16:31]
    ds_read_b128 v[36:39], v2 offset:29696
    buffer_load_dwordx4 v1, s[4:7], s63 offen offset:2048 sc1 lds
    s_waitcnt lgkmcnt(3)
    v_mfma_f32_32x32x16_bf16 v[16:31], v[40:43], a[104:107], v[16:31]
    ds_read_b128 v[40:43], v2 offset:30720
    s_waitcnt lgkmcnt(3)
    v_mfma_f32_32x32x16_bf16 v[16:31], v[44:47], a[108:111], v[16:31]
    ds_read_b128 v[44:47], v2 offset:31744
    s_waitcnt lgkmcnt(3)
    v_mfma_f32_32x32x16_bf16 v[16:31], v[32:35], a[112:115], v[16:31]
    ds_read_b128 v[32:35], v2 offset:32768
    s_waitcnt lgkmcnt(3)
    v_mfma_f32_32x32x16_bf16 v[16:31], v[36:39], a[116:119], v[16:31]
    ds_read_b128 v[36:39], v2 offset:33792
    buffer_load_dwordx4 v1, s[4:7], s63 offen offset:3072 sc1 lds
    s_waitcnt lgkmcnt(3)
    v_mfma_f32_32x32x16_bf16 v[16:31], v[40:43], a[120:123], v[16:31]
    ds_read_b128 v[40:43], v2 offset:34816
    s_waitcnt lgkmcnt(3)
    v_mfma_f32_32x32x16_bf16 v[16:31], v[44:47], a[124:127], v[16:31]
    ds_read_b128 v[44:47], v2 offset:35840
    s_waitcnt lgkmcnt(3)
    v_mfma_f32_32x32x16_bf16 v[16:31], v[32:35], a[128:131], v[16:31]
    ds_read_b128 v[32:35], v2 offset:36864
    s_waitcnt lgkmcnt(3)
    v_mfma_f32_32x32x16_bf16 v[16:31], v[36:39], a[132:135], v[16:31]
    ds_read_b128 v[36:39], v2 offset:37888
    s_add_u32 m0, s64, 8192
    s_add_u32 s63, s71, 8192
    buffer_load_dwordx4 v1, s[4:7], s63 offen offset:0 sc1 lds
    s_waitcnt lgkmcnt(3)
    v_mfma_f32_32x32x16_bf16 v[16:31], v[40:43], a[136:139], v[16:31]
    ds_read_b128 v[40:43], v2 offset:38912
    s_waitcnt lgkmcnt(3)
    v_mfma_f32_32x32x16_bf16 v[16:31], v[44:47], a[140:143], v[16:31]
    ds_read_b128 v[44:47], v2 offset:39936
    s_waitcnt lgkmcnt(3)
    v_mfma_f32_32x32x16_bf16 v[16:31], v[32:35], a[144:147], v[16:31]
    s_waitcnt lgkmcnt(2)
    v_mfma_f32_32x32x16_bf16 v[16:31], v[36:39], a[148:151], v[16:31]
    buffer_load_dwordx4 v1, s[4:7], s63 offen offset:1024 sc1 lds
    s_add_u32 s71, s71, 40960
    s_add_u32 s70, s70, 40960
    s_cmp_ge_u32 s70, 122880
    s_cselect_b32 s70, 0, s70
    s_waitcnt lgkmcnt(1)
    v_mfma_f32_32x32x16_bf16 v[16:31], v[40:43], a[152:155], v[16:31]
    s_waitcnt lgkmcnt(0)
    v_mfma_f32_32x32x16_bf16 v[16:31], v[44:47], a[156:159], v[16:31]
    s_add_u32 s74, s74, 40960
    s_cmp_ge_u32 s74, 122880
    s_cselect_b32 s74, 0, s74
    s_nop 8
    v_cvt_pk_bf16_f32 v48, v16, v17
    v_cvt_pk_bf16_f32 v49, v18, v19
    v_cvt_pk_bf16_f32 v50, v24, v25
    v_cvt_pk_bf16_f32 v51, v26, v27
    buffer_store_dwordx4 v[48:51], v3, s[4:7], s72 offen offset:0 sc1
    v_cvt_pk_bf16_f32 v52, v20, v21
    v_cvt_pk_bf16_f32 v53, v22, v23
    v_cvt_pk_bf16_f32 v54, v28, v29
    v_cvt_pk_bf16_f32 v55, v30, v31
    buffer_store_dwordx4 v[52:55], v3, s[4:7], s72 offen offset:512 sc1
    s_add_u32 s72, s72, 262144
    s_add_u32 s61, s61, 1
    s_waitcnt vmcnt(12)
    s_cmp_lt_u32 s61, 64
    s_cbranch_scc1 L_VP_LOOP
    s_waitcnt vmcnt(0)
    s_barrier
    s_cmp_lg_u32 s44, 0
    s_cbranch_scc1 L_END
    v_mov_b32 v8, 0
    v_mov_b32 v9, 64
    s_mov_b64 exec, 1
    buffer_store_dword v9, v8, s[4:7], s73 offen sc1
    s_mov_b64 exec, -1
    s_branch L_END2
L_GU:
    v_bfe_u32 v1, v0, 0, 6
    v_lshlrev_b32 v1, 4, v1
    s_lshl_b32 s62, s44, 5
    s_add_u32 s62, s62, s46
    s_cmp_lg_u32 s62, 27
    s_cbranch_scc1 L_pr_135
    s_mov_b32 s75, -1
    s_mov_b32 s76, -1
    s_mov_b64 exec, 0xff
    v_mov_b32 v4, -1
    v_mov_b32 v5, -1
    v_mov_b32 v6, -1
    v_mov_b32 v7, -1
    s_mov_b32 s82, 0
L_prl_136:
    s_and_b32 s63, s82, 0x780
    s_add_u32 s63, s63, 0x7201800
    s_memtime s[78:79]
    s_waitcnt lgkmcnt(0)
    buffer_store_dwordx4 v[4:7], v1, s[4:7], s63 offen sc1
    s_waitcnt vmcnt(0)
    s_memtime s[80:81]
    s_waitcnt lgkmcnt(0)
    s_sub_u32 s80, s80, s78
    s_min_u32 s75, s75, s80
    s_and_b32 s63, s82, 0x780
    s_add_u32 s63, s63, 0x7203800
    s_memtime s[78:79]
    s_waitcnt lgkmcnt(0)
    buffer_store_dwordx4 v[4:7], v1, s[4:7], s63 offen sc1
    s_waitcnt vmcnt(0)
    s_memtime s[80:81]
    s_waitcnt lgkmcnt(0)
    s_sub_u32 s80, s80, s78
    s_min_u32 s76, s76, s80
    s_add_u32 s82, s82, 128
    s_cmp_lt_u32 s82, 1792
    s_cbranch_scc1 L_prl_136
    s_mov_b64 exec, -1
    s_cmp_le_u32 s75, s76
    s_cselect_b32 s77, 1, 2
    v_and_b32 v8, 7, v0
    v_lshlrev_b32 v8, 5, v8
    v_and_b32 v9, 8, v0
    v_lshl_add_u32 v8, v9, 1, v8
    s_mov_b32 s60, 0
L_tk_137:
    buffer_load_dword v9, v8, s[48:51], 0 offen sc1
    s_waitcnt vmcnt(0)
    v_readlane_b32 s62, v9, 8
    v_readlane_b32 s52, v9, 9
    s_nop 0
    s_add_u32 s62, s62, s52
    v_readlane_b32 s52, v9, 10
    s_nop 0
    s_add_u32 s62, s62, s52
    v_readlane_b32 s52, v9, 11
    s_nop 0
    s_add_u32 s62, s62, s52
    v_readlane_b32 s52, v9, 12
    s_nop 0
    s_add_u32 s62, s62, s52
    v_readlane_b32 s52, v9, 13
    s_nop 0
    s_add_u32 s62, s62, s52
    v_readlane_b32 s52, v9, 14
    s_nop 0
    s_add_u32 s62, s62, s52
    v_readlane_b32 s52, v9, 15
    s_nop 0
    s_add_u32 s62, s62, s52
    s_cmp_ge_u32 s62, 256
    s_cbranch_scc1 L_tkd_138
    s_sleep 2
    s_add_u32 s60, s60, 1
    s_cmp_lt_u32 s60, 0x100000
    s_cbranch_scc1 L_tk_137
    s_movk_i32 s62, 1
    s_branch L_ABORT
L_tkd_138:
    s_mov_b32 s63, 17024
    v_mov_b32 v8, 0
    v_mov_b32 v9, s77
    s_mov_b64 exec, 1
    buffer_store_dword v9, v8, s[4:7], s63 offen sc1
    s_mov_b64 exec, -1
L_pr_135:
    s_cmp_ge_u32 s46, 27
    s_cbranch_scc1 L_END
    v_and_b32 v8, 7, v0
    v_lshlrev_b32 v8, 5, v8
    v_and_b32 v9, 8, v0
    v_lshl_add_u32 v8, v9, 1, v8
    s_mov_b32 s60, 0
L_tk_139:
    buffer_load_dword v9, v8, s[48:51], 0 offen sc1
    s_waitcnt vmcnt(0)
    v_readlane_b32 s62, v9, 8
    v_readlane_b32 s52, v9, 9
    s_nop 0
    s_add_u32 s62, s62, s52
    v_readlane_b32 s52, v9, 10
    s_nop 0
    s_add_u32 s62, s62, s52
    v_readlane_b32 s52, v9, 11
    s_nop 0
    s_add_u32 s62, s62, s52
    v_readlane_b32 s52, v9, 12
    s_nop 0
    s_add_u32 s62, s62, s52
    v_readlane_b32 s52, v9, 13
    s_nop 0
    s_add_u32 s62, s62, s52
    v_readlane_b32 s52, v9, 14
    s_nop 0
    s_add_u32 s62, s62, s52
    v_readlane_b32 s52, v9, 15
    s_nop 0
    s_add_u32 s62, s62, s52
    s_cmp_ge_u32 s62, 256
    s_cbranch_scc1 L_tkd_140
    s_sleep 2
    s_add_u32 s60, s60, 1
    s_cmp_lt_u32 s60, 0x100000
    s_cbranch_scc1 L_tk_139
    s_movk_i32 s62, 1
    s_branch L_ABORT
L_tkd_140:
    v_and_b32 v8, 63, v0
    v_lshlrev_b32 v8, 6, v8
    s_mov_b32 s60, 0
L_pf_141:
    buffer_load_dword v9, v8, s[4:7], 0 offen sc1
    s_waitcnt vmcnt(0)
    v_cmp_gt_u32 vcc, 1, v9
    s_nop 0
    s_cbranch_vccz L_pfd_142
    s_sleep 1
    s_add_u32 s60, s60, 1
    s_cmp_lt_u32 s60, 0x100000
    s_cbranch_scc1 L_pf_141
    s_movk_i32 s62, 4
    s_branch L_ABORT
L_pfd_142:
    s_mov_b32 s8, s32
    s_and_b32 s9, s33, 0xffff
    s_mov_b32 s10, 0x21c000
    s_mov_b32 s11, 0x20000
    s_mov_b32 s12, s34
    s_and_b32 s13, s35, 0xffff
    s_mov_b32 s14, 0x21c000
    s_mov_b32 s15, 0x20000
    s_lshl_b32 s66, s46, 7
    v_bfe_u32 v4, v0, 0, 3
    v_lshlrev_b32 v4, 4, v4
    v_bfe_u32 v9, v0, 4, 1
    v_lshlrev_b32 v9, 5, v9
    v_xor_b32 v4, v4, v9
    v_bfe_u32 v9, v0, 3, 3
    v_mul_u32_u24 v9, 0xd80, v9
    v_bfe_u32 v8, v0, 6, 2
    v_mul_u32_u24 v8, 0xd800, v8
    v_add_u32 v9, v8, v9
    v_add_u32 v4, v4, v9
    v_bfe_u32 v5, v0, 0, 3
    v_lshlrev_b32 v5, 4, v5
    v_bfe_u32 v9, v0, 4, 1
    v_lshlrev_b32 v9, 5, v9
    v_add_u32 v9, 0x40, v9
    v_xor_b32 v5, v5, v9
    v_bfe_u32 v9, v0, 3, 3
    v_mul_u32_u24 v9, 0xd80, v9
    v_bfe_u32 v8, v0, 6, 2
    v_mul_u32_u24 v8, 0xd800, v8
    v_add_u32 v9, v8, v9
    v_add_u32 v5, v5, v9
    v_bfe_u32 v6, v0, 1, 1
    v_lshlrev_b32 v6, 4, v6
    v_bfe_u32 v8, v0, 6, 2
    v_lshl_add_u32 v6, v8, 5, v6
    v_bfe_u32 v9, v0, 3, 2
    v_lshlrev_b32 v9, 5, v9
    v_xor_b32 v6, v6, v9
    v_bfe_u32 v9, v0, 0, 1
    v_lshlrev_b32 v9, 3, v9
    v_bfe_u32 v8, v0, 2, 2
    v_lshl_add_u32 v9, v8, 7, v9
    v_bfe_u32 v8, v0, 4, 1
    v_lshl_add_u32 v9, v8, 13, v9
    v_bfe_u32 v8, v0, 5, 1
    v_lshl_add_u32 v9, v8, 10, v9
    v_add_u32 v6, v6, v9
    v_add_u32 v7, 0x10000, v6
    s_lshl_b32 s67, s44, 11
    s_add_u32 s63, s66, 0x0
    s_add_u32 s64, s67, 0x0
    s_mov_b32 m0, s64
    s_nop 0
    buffer_load_dwordx4 v4, s[8:11], s63 offen lds
    s_add_u32 s63, s66, 0x6c00
    s_add_u32 s64, s67, 0x400
    s_mov_b32 m0, s64
    s_nop 0
    buffer_load_dwordx4 v4, s[8:11], s63 offen lds
    s_add_u32 s63, s66, 0x0
    s_add_u32 s64, s67, 0x2000
    s_mov_b32 m0, s64
    s_nop 0
    buffer_load_dwordx4 v5, s[12:15], s63 offen lds
    s_add_u32 s63, s66, 0x6c00
    s_add_u32 s64, s67, 0x2400
    s_mov_b32 m0, s64
    s_nop 0
    buffer_load_dwordx4 v5, s[12:15], s63 offen lds
    s_add_u32 s63, s66, 0x36000
    s_add_u32 s64, s67, 0x4000
    s_mov_b32 m0, s64
    s_nop 0
    buffer_load_dwordx4 v4, s[8:11], s63 offen lds
    s_add_u32 s63, s66, 0x3cc00
    s_add_u32 s64, s67, 0x4400
    s_mov_b32 m0, s64
    s_nop 0
    buffer_load_dwordx4 v4, s[8:11], s63 offen lds
    s_add_u32 s63, s66, 0x36000
    s_add_u32 s64, s67, 0x6000
    s_mov_b32 m0, s64
    s_nop 0
    buffer_load_dwordx4 v5, s[12:15], s63 offen lds
    s_add_u32 s63, s66, 0x3cc00
    s_add_u32 s64, s67, 0x6400
    s_mov_b32 m0, s64
    s_nop 0
    buffer_load_dwordx4 v5, s[12:15], s63 offen lds
    s_add_u32 s63, s66, 0x6c000
    s_add_u32 s64, s67, 0x8000
    s_mov_b32 m0, s64
    s_nop 0
    buffer_load_dwordx4 v4, s[8:11], s63 offen lds
    s_add_u32 s63, s66, 0x72c00
    s_add_u32 s64, s67, 0x8400
    s_mov_b32 m0, s64
    s_nop 0
    buffer_load_dwordx4 v4, s[8:11], s63 offen lds
    s_add_u32 s63, s66, 0x6c000
    s_add_u32 s64, s67, 0xa000
    s_mov_b32 m0, s64
    s_nop 0
    buffer_load_dwordx4 v5, s[12:15], s63 offen lds
    s_add_u32 s63, s66, 0x72c00
    s_add_u32 s64, s67, 0xa400
    s_mov_b32 m0, s64
    s_nop 0
    buffer_load_dwordx4 v5, s[12:15], s63 offen lds
    s_add_u32 s63, s66, 0xa2000
    s_add_u32 s64, s67, 0xc000
    s_mov_b32 m0, s64
    s_nop 0
    buffer_load_dwordx4 v4, s[8:11], s63 offen lds
    s_add_u32 s63, s66, 0xa8c00
    s_add_u32 s64, s67, 0xc400
    s_mov_b32 m0, s64
    s_nop 0
    buffer_load_dwordx4 v4, s[8:11], s63 offen lds
    s_add_u32 s63, s66, 0xa2000
    s_add_u32 s64, s67, 0xe000
    s_mov_b32 m0, s64
    s_nop 0
    buffer_load_dwordx4 v5, s[12:15], s63 offen lds
    s_add_u32 s63, s66, 0xa8c00
    s_add_u32 s64, s67, 0xe400
    s_mov_b32 m0, s64
    s_nop 0
    buffer_load_dwordx4 v5, s[12:15], s63 offen lds
    s_add_u32 s63, s66, 0xd8000
    s_add_u32 s64, s67, 0x10000
    s_mov_b32 m0, s64
    s_nop 0
    buffer_load_dwordx4 v4, s[8:11], s63 offen lds
    s_add_u32 s63, s66, 0xdec00
    s_add_u32 s64, s67, 0x10400
    s_mov_b32 m0, s64
    s_nop 0
    buffer_load_dwordx4 v4, s[8:11], s63 offen lds
    s_add_u32 s63, s66, 0xd8000
    s_add_u32 s64, s67, 0x12000
    s_mov_b32 m0, s64
    s_nop 0
    buffer_load_dwordx4 v5, s[12:15], s63 offen lds
    s_add_u32 s63, s66, 0xdec00
    s_add_u32 s64, s67, 0x12400
    s_mov_b32 m0, s64
    s_nop 0
    buffer_load_dwordx4 v5, s[12:15], s63 offen lds
    s_add_u32 s63, s66, 0x10e000
    s_add_u32 s64, s67, 0x14000
    s_mov_b32 m0, s64
    s_nop 0
    buffer_load_dwordx4 v4, s[8:11], s63 offen lds
    s_add_u32 s63, s66, 0x114c00
    s_add_u32 s64, s67, 0x14400
    s_mov_b32 m0, s64
    s_nop 0
    buffer_load_dwordx4 v4, s[8:11], s63 offen lds
    s_add_u32 s63, s66, 0x10e000
    s_add_u32 s64, s67, 0x16000
    s_mov_b32 m0, s64
    s_nop 0
    buffer_load_dwordx4 v5, s[12:15], s63 offen lds
    s_add_u32 s63, s66, 0x114c00
    s_add_u32 s64, s67, 0x16400
    s_mov_b32 m0, s64
    s_nop 0
    buffer_load_dwordx4 v5, s[12:15], s63 offen lds
    s_add_u32 s63, s66, 0x144000
    s_add_u32 s64, s67, 0x18000
    s_mov_b32 m0, s64
    s_nop 0
    buffer_load_dwordx4 v4, s[8:11], s63 offen lds
    s_add_u32 s63, s66, 0x14ac00
    s_add_u32 s64, s67, 0x18400
    s_mov_b32 m0, s64
    s_nop 0
    buffer_load_dwordx4 v4, s[8:11], s63 offen lds
    s_add_u32 s63, s66, 0x144000
    s_add_u32 s64, s67, 0x1a000
    s_mov_b32 m0, s64
    s_nop 0
    buffer_load_dwordx4 v5, s[12:15], s63 offen lds
    s_add_u32 s63, s66, 0x14ac00
    s_add_u32 s64, s67, 0x1a400
    s_mov_b32 m0, s64
    s_nop 0
    buffer_load_dwordx4 v5, s[12:15], s63 offen lds
    s_waitcnt vmcnt(24) lgkmcnt(0)
    s_barrier
    s_add_u32 s63, s66, 0x17a000
    s_add_u32 s64, s67, 0x1c000
    s_mov_b32 m0, s64
    s_nop 0
    buffer_load_dwordx4 v4, s[8:11], s63 offen lds
    s_add_u32 s63, s66, 0x180c00
    s_add_u32 s64, s67, 0x1c400
    s_mov_b32 m0, s64
    s_nop 0
    buffer_load_dwordx4 v4, s[8:11], s63 offen lds
    s_add_u32 s63, s66, 0x17a000
    s_add_u32 s64, s67, 0x1e000
    s_mov_b32 m0, s64
    s_nop 0
    buffer_load_dwordx4 v5, s[12:15], s63 offen lds
    s_add_u32 s63, s66, 0x180c00
    s_add_u32 s64, s67, 0x1e400
    s_mov_b32 m0, s64
    s_nop 0
    buffer_load_dwordx4 v5, s[12:15], s63 offen lds
    ds_read_b64_tr_b16 a[0:1], v6 offset:0
    ds_read_b64_tr_b16 a[2:3], v6 offset:512
    ds_read_b64_tr_b16 a[4:5], v6 offset:2048
    ds_read_b64_tr_b16 a[6:7], v6 offset:2560
    ds_read_b64_tr_b16 a[8:9], v6 offset:4096
    ds_read_b64_tr_b16 a[10:11], v6 offset:4608
    ds_read_b64_tr_b16 a[12:13], v6 offset:6144
    ds_read_b64_tr_b16 a[14:15], v6 offset:6656
    s_waitcnt vmcnt(24) lgkmcnt(0)
    s_barrier
    s_add_u32 s63, s66, 0x1b0000
    s_add_u32 s64, s67, 0x0
    s_mov_b32 m0, s64
    s_nop 0
    buffer_load_dwordx4 v4, s[8:11], s63 offen lds
    s_add_u32 s63, s66, 0x1b6c00
    s_add_u32 s64, s67, 0x400
    s_mov_b32 m0, s64
    s_nop 0
    buffer_load_dwordx4 v4, s[8:11], s63 offen lds
    s_add_u32 s63, s66, 0x1b0000
    s_add_u32 s64, s67, 0x2000
    s_mov_b32 m0, s64
    s_nop 0
    buffer_load_dwordx4 v5, s[12:15], s63 offen lds
    s_add_u32 s63, s66, 0x1b6c00
    s_add_u32 s64, s67, 0x2400
    s_mov_b32 m0, s64
    s_nop 0
    buffer_load_dwordx4 v5, s[12:15], s63 offen lds
    ds_read_b64_tr_b16 a[16:17], v6 offset:16384
    ds_read_b64_tr_b16 a[18:19], v6 offset:16896
    ds_read_b64_tr_b16 a[20:21], v6 offset:18432
    ds_read_b64_tr_b16 a[22:23], v6 offset:18944
    ds_read_b64_tr_b16 a[24:25], v6 offset:20480
    ds_read_b64_tr_b16 a[26:27], v6 offset:20992
    ds_read_b64_tr_b16 a[28:29], v6 offset:22528
    ds_read_b64_tr_b16 a[30:31], v6 offset:23040
    s_waitcnt vmcnt(24) lgkmcnt(0)
    s_barrier
    s_add_u32 s63, s66, 0x1e6000
    s_add_u32 s64, s67, 0x4000
    s_mov_b32 m0, s64
    s_nop 0
    buffer_load_dwordx4 v4, s[8:11], s63 offen lds
    s_add_u32 s63, s66, 0x1ecc00
    s_add_u32 s64, s67, 0x4400
    s_mov_b32 m0, s64
    s_nop 0
    buffer_load_dwordx4 v4, s[8:11], s63 offen lds
    s_add_u32 s63, s66, 0x1e6000
    s_add_u32 s64, s67, 0x6000
    s_mov_b32 m0, s64
    s_nop 0
    buffer_load_dwordx4 v5, s[12:15], s63 offen lds
    s_add_u32 s63, s66, 0x1ecc00
    s_add_u32 s64, s67, 0x6400
    s_mov_b32 m0, s64
    s_nop 0
    buffer_load_dwordx4 v5, s[12:15], s63 offen lds
    ds_read_b64_tr_b16 a[32:33], v6 offset:32768
    ds_read_b64_tr_b16 a[34:35], v6 offset:33280
    ds_read_b64_tr_b16 a[36:37], v6 offset:34816
    ds_read_b64_tr_b16 a[38:39], v6 offset:35328
    ds_read_b64_tr_b16 a[40:41], v6 offset:36864
    ds_read_b64_tr_b16 a[42:43], v6 offset:37376
    ds_read_b64_tr_b16 a[44:45], v6 offset:38912
    ds_read_b64_tr_b16 a[46:47], v6 offset:39424
    s_waitcnt vmcnt(24) lgkmcnt(0)
    s_barrier
    ds_read_b64_tr_b16 a[48:49], v6 offset:49152
    ds_read_b64_tr_b16 a[50:51], v6 offset:49664
    ds_read_b64_tr_b16 a[52:53], v6 offset:51200
    ds_read_b64_tr_b16 a[54:55], v6 offset:51712
    ds_read_b64_tr_b16 a[56:57], v6 offset:53248
    ds_read_b64_tr_b16 a[58:59], v6 offset:53760
    ds_read_b64_tr_b16 a[60:61], v6 offset:55296
    ds_read_b64_tr_b16 a[62:63], v6 offset:55808
    s_waitcnt vmcnt(20) lgkmcnt(0)
    s_barrier
    ds_read_b64_tr_b16 a[64:65], v7 offset:0
    ds_read_b64_tr_b16 a[66:67], v7 offset:512
    ds_read_b64_tr_b16 a[68:69], v7 offset:2048
    ds_read_b64_tr_b16 a[70:71], v7 offset:2560
    ds_read_b64_tr_b16 a[72:73], v7 offset:4096
    ds_read_b64_tr_b16 a[74:75], v7 offset:4608
    ds_read_b64_tr_b16 a[76:77], v7 offset:6144
    ds_read_b64_tr_b16 a[78:79], v7 offset:6656
    s_waitcnt vmcnt(16) lgkmcnt(0)
    s_barrier
    ds_read_b64_tr_b16 a[80:81], v7 offset:16384
    ds_read_b64_tr_b16 a[82:83], v7 offset:16896
    ds_read_b64_tr_b16 a[84:85], v7 offset:18432
    ds_read_b64_tr_b16 a[86:87], v7 offset:18944
    ds_read_b64_tr_b16 a[88:89], v7 offset:20480
    ds_read_b64_tr_b16 a[90:91], v7 offset:20992
    ds_read_b64_tr_b16 a[92:93], v7 offset:22528
    ds_read_b64_tr_b16 a[94:95], v7 offset:23040
    s_waitcnt vmcnt(12) lgkmcnt(0)
    s_barrier
    ds_read_b64_tr_b16 a[96:97], v7 offset:32768
    ds_read_b64_tr_b16 a[98:99], v7 offset:33280
    ds_read_b64_tr_b16 a[100:101], v7 offset:34816
    ds_read_b64_tr_b16 a[102:103], v7 offset:35328
    ds_read_b64_tr_b16 a[104:105], v7 offset:36864
    ds_read_b64_tr_b16 a[106:107], v7 offset:37376
    ds_read_b64_tr_b16 a[108:109], v7 offset:38912
    ds_read_b64_tr_b16 a[110:111], v7 offset:39424
    s_waitcnt vmcnt(8) lgkmcnt(0)
    s_barrier
    ds_read_b64_tr_b16 a[112:113], v7 offset:49152
    ds_read_b64_tr_b16 a[114:115], v7 offset:49664
    ds_read_b64_tr_b16 a[116:117], v7 offset:51200
    ds_read_b64_tr_b16 a[118:119], v7 offset:51712
    ds_read_b64_tr_b16 a[120:121], v7 offset:53248
    ds_read_b64_tr_b16 a[122:123], v7 offset:53760
    ds_read_b64_tr_b16 a[124:125], v7 offset:55296
    ds_read_b64_tr_b16 a[126:127], v7 offset:55808
    s_waitcnt vmcnt(4) lgkmcnt(0)
    s_barrier
    ds_read_b64_tr_b16 a[128:129], v6 offset:0
    ds_read_b64_tr_b16 a[130:131], v6 offset:512
    ds_read_b64_tr_b16 a[132:133], v6 offset:2048
    ds_read_b64_tr_b16 a[134:135], v6 offset:2560
    ds_read_b64_tr_b16 a[136:137], v6 offset:4096
    ds_read_b64_tr_b16 a[138:139], v6 offset:4608
    ds_read_b64_tr_b16 a[140:141], v6 offset:6144
    ds_read_b64_tr_b16 a[142:143], v6 offset:6656
    s_waitcnt vmcnt(0) lgkmcnt(0)
    s_barrier
    ds_read_b64_tr_b16 a[144:145], v6 offset:16384
    ds_read_b64_tr_b16 a[146:147], v6 offset:16896
    ds_read_b64_tr_b16 a[148:149], v6 offset:18432
    ds_read_b64_tr_b16 a[150:151], v6 offset:18944
    ds_read_b64_tr_b16 a[152:153], v6 offset:20480
    ds_read_b64_tr_b16 a[154:155], v6 offset:20992
    ds_read_b64_tr_b16 a[156:157], v6 offset:22528
    ds_read_b64_tr_b16 a[158:159], v6 offset:23040
    s_waitcnt lgkmcnt(0)
    s_barrier
    s_lshl_b32 s72, s46, 2
    s_add_u32 s72, s72, s44
    s_lshl_b32 s72, s72, 10
    s_add_u32 s72, s72, 0x2400000
    v_mov_b32 v3, v1
    s_add_u32 s73, s46, 128
    s_lshl_b32 s73, s73, 6
    s_mul_i32 s67, s44, 10240
    s_add_u32 s71, s67, 0x100000
    s_mov_b32 s70, 0
    s_mov_b32 s74, 0
    s_add_u32 s64, s70, s67
    s_add_u32 m0, s64, 0
    s_add_u32 s63, s71, 0
    buffer_load_dwordx4 v1, s[4:7], s63 offen offset:0 sc1 lds
    buffer_load_dwordx4 v1, s[4:7], s63 offen offset:1024 sc1 lds
    buffer_load_dwordx4 v1, s[4:7], s63 offen offset:2048 sc1 lds
    buffer_load_dwordx4 v1, s[4:7], s63 offen offset:3072 sc1 lds
    s_add_u32 m0, s64, 4096
    s_add_u32 s63, s71, 4096
    buffer_load_dwordx4 v1, s[4:7], s63 offen offset:0 sc1 lds
    buffer_load_dwordx4 v1, s[4:7], s63 offen offset:1024 sc1 lds
    buffer_load_dwordx4 v1, s[4:7], s63 offen offset:2048 sc1 lds
    buffer_load_dwordx4 v1, s[4:7], s63 offen offset:3072 sc1 lds
    s_add_u32 m0, s64, 8192
    s_add_u32 s63, s71, 8192
    buffer_load_dwordx4 v1, s[4:7], s63 offen offset:0 sc1 lds
    buffer_load_dwordx4 v1, s[4:7], s63 offen offset:1024 sc1 lds
    s_add_u32 s71, s71, 40960
    s_add_u32 s70, s70, 40960
    s_cmp_ge_u32 s70, 122880
    s_cselect_b32 s70, 0, s70
    s_add_u32 s64, s70, s67
    s_add_u32 m0, s64, 0
    s_add_u32 s63, s71, 0
    buffer_load_dwordx4 v1, s[4:7], s63 offen offset:0 sc1 lds
    buffer_load_dwordx4 v1, s[4:7], s63 offen offset:1024 sc1 lds
    buffer_load_dwordx4 v1, s[4:7], s63 offen offset:2048 sc1 lds
    buffer_load_dwordx4 v1, s[4:7], s63 offen offset:3072 sc1 lds
    s_add_u32 m0, s64, 4096
    s_add_u32 s63, s71, 4096
    buffer_load_dwordx4 v1, s[4:7], s63 offen offset:0 sc1 lds
    buffer_load_dwordx4 v1, s[4:7], s63 offen offset:1024 sc1 lds
    buffer_load_dwordx4 v1, s[4:7], s63 offen offset:2048 sc1 lds
    buffer_load_dwordx4 v1, s[4:7], s63 offen offset:3072 sc1 lds
    s_add_u32 m0, s64, 8192
    s_add_u32 s63, s71, 8192
    buffer_load_dwordx4 v1, s[4:7], s63 offen offset:0 sc1 lds
    buffer_load_dwordx4 v1, s[4:7], s63 offen offset:1024 sc1 lds
    s_add_u32 s71, s71, 40960
    s_add_u32 s70, s70, 40960
    s_cmp_ge_u32 s70, 122880
    s_cselect_b32 s70, 0, s70
    s_mov_b32 s61, 0
    s_waitcnt vmcnt(10)
L_GU_LOOP:
    s_barrier
    s_cmp_lg_u32 s44, 0
    s_cbranch_scc1 L_np_143
    s_cmp_lt_u32 s61, 2
    s_cbranch_scc1 L_np_143
    s_sub_u32 s62, s61, 1
    v_mov_b32 v8, 0
    v_mov_b32 v9, s62
    s_mov_b64 exec, 1
    buffer_store_dword v9, v8, s[4:7], s73 offen sc1
    s_mov_b64 exec, -1
L_np_143:
    v_add_u32 v2, s74, v1
    ds_read_b128 v[32:35], v2 offset:0
    ds_read_b128 v[36:39], v2 offset:1024
    ds_read_b128 v[40:43], v2 offset:2048
    ds_read_b128 v[44:47], v2 offset:3072
    s_waitcnt lgkmcnt(3)
    v_mfma_f32_32x32x16_bf16 v[16:31], a[0:3], v[32:35], 0
    ds_read_b128 v[32:35], v2 offset:4096
    s_waitcnt lgkmcnt(3)
    v_mfma_f32_32x32x16_bf16 v[16:31], a[4:7], v[36:39], v[16:31]
    ds_read_b128 v[36:39], v2 offset:5120
    s_add_u32 s64, s70, s67
    s_add_u32 m0, s64, 0
    s_add_u32 s63, s71, 0
    buffer_load_dwordx4 v1, s[4:7], s63 offen offset:0 sc1 lds
    s_waitcnt lgkmcnt(3)
    v_mfma_f32_32x32x16_bf16 v[16:31], a[8:11], v[40:43], v[16:31]
    ds_read_b128 v[40:43], v2 offset:6144
    s_waitcnt lgkmcnt(3)
    v_mfma_f32_32x32x16_bf16 v[16:31], a[12:15], v[44:47], v[16:31]
    ds_read_b128 v[44:47], v2 offset:7168
    s_waitcnt lgkmcnt(3)
    v_mfma_f32_32x32x16_bf16 v[16:31], a[16:19], v[32:35], v[16:31]
    ds_read_b128 v[32:35], v2 offset:8192
    s_waitcnt lgkmcnt(3)
    v_mfma_f32_32x32x16_bf16 v[16:31], a[20:23], v[36:39], v[16:31]
    ds_read_b128 v[36:39], v2 offset:9216
    buffer_load_dwordx4 v1, s[4:7], s63 offen offset:1024 sc1 lds
    s_waitcnt lgkmcnt(3)
    v_mfma_f32_32x32x16_bf16 v[16:31], a[24:27], v[40:43], v[16:31]
    ds_read_b128 v[40:43], v2 offset:10240
    s_waitcnt lgkmcnt(3)
    v_mfma_f32_32x32x16_bf16 v[16:31], a[28:31], v[44:47], v[16:31]
    ds_read_b128 v[44:47], v2 offset:11264
    s_waitcnt lgkmcnt(3)
    v_mfma_f32_32x32x16_bf16 v[16:31], a[32:35], v[32:35], v[16:31]
    ds_read_b128 v[32:35], v2 offset:12288
    s_waitcnt lgkmcnt(3)
    v_mfma_f32_32x32x16_bf16 v[16:31], a[36:39], v[36:39], v[16:31]
    ds_read_b128 v[36:39], v2 offset:13312
    buffer_load_dwordx4 v1, s[4:7], s63 offen offset:2048 sc1 lds
    s_waitcnt lgkmcnt(3)
    v_mfma_f32_32x32x16_bf16 v[16:31], a[40:43], v[40:43], v[16:31]
    ds_read_b128 v[40:43], v2 offset:14336
    s_waitcnt lgkmcnt(3)
    v_mfma_f32_32x32x16_bf16 v[16:31], a[44:47], v[44:47], v[16:31]
    ds_read_b128 v[44:47], v2 offset:15360
    s_waitcnt lgkmcnt(3)
    v_mfma_f32_32x32x16_bf16 v[16:31], a[48:51], v[32:35], v[16:31]
    ds_read_b128 v[32:35], v2 offset:16384
    s_waitcnt lgkmcnt(3)
    v_mfma_f32_32x32x16_bf16 v[16:31], a[52:55], v[36:39], v[16:31]
    ds_read_b128 v[36:39], v2 offset:17408
    buffer_load_dwordx4 v1, s[4:7], s63 offen offset:3072 sc1 lds
    s_waitcnt lgkmcnt(3)
    v_mfma_f32_32x32x16_bf16 v[16:31], a[56:59], v[40:43], v[16:31]
    ds_read_b128 v[40:43], v2 offset:18432
    s_waitcnt lgkmcnt(3)
    v_mfma_f32_32x32x16_bf16 v[16:31], a[60:63], v[44:47], v[16:31]
    ds_read_b128 v[44:47], v2 offset:19456
    s_waitcnt lgkmcnt(3)
    v_mfma_f32_32x32x16_bf16 v[16:31], a[64:67], v[32:35], v[16:31]
    ds_read_b128 v[32:35], v2 offset:20480
    s_waitcnt lgkmcnt(3)
    v_mfma_f32_32x32x16_bf16 v[16:31], a[68:71], v[36:39], v[16:31]
    ds_read_b128 v[36:39], v2 offset:21504
    s_add_u32 m0, s64, 4096
    s_add_u32 s63, s71, 4096
    buffer_load_dwordx4 v1, s[4:7], s63 offen offset:0 sc1 lds
    s_waitcnt lgkmcnt(3)
    v_mfma_f32_32x32x16_bf16 v[16:31], a[72:75], v[40:43], v[16:31]
    ds_read_b128 v[40:43], v2 offset:22528
    s_waitcnt lgkmcnt(3)
    v_mfma_f32_32x32x16_bf16 v[16:31], a[76:79], v[44:47], v[16:31]
    ds_read_b128 v[44:47], v2 offset:23552
    s_waitcnt lgkmcnt(3)
    v_mfma_f32_32x32x16_bf16 v[16:31], a[80:83], v[32:35], v[16:31]
    ds_read_b128 v[32:35], v2 offset:24576
    s_waitcnt lgkmcnt(3)
    v_mfma_f32_32x32x16_bf16 v[16:31], a[84:87], v[36:39], v[16:31]
    ds_read_b128 v[36:39], v2 offset:25600
    buffer_load_dwordx4 v1, s[4:7], s63 offen offset:1024 sc1 lds
    s_waitcnt lgkmcnt(3)
    v_mfma_f32_32x32x16_bf16 v[16:31], a[88:91], v[40:43], v[16:31]
    ds_read_b128 v[40:43], v2 offset:26624
    s_waitcnt lgkmcnt(3)
    v_mfma_f32_32x32x16_bf16 v[16:31], a[92:95], v[44:47], v[16:31]
    ds_read_b128 v[44:47], v2 offset:27648
    s_waitcnt lgkmcnt(3)
    v_mfma_f32_32x32x16_bf16 v[16:31], a[96:99], v[32:35], v[16:31]
    ds_read_b128 v[32:35], v2 offset:28672
    s_waitcnt lgkmcnt(3)
    v_mfma_f32_32x32x16_bf16 v[16:31], a[100:103], v[36:39], v[16:31]
    ds_read_b128 v[36:39], v2 offset:29696
    buffer_load_dwordx4 v1, s[4:7], s63 offen offset:2048 sc1 lds
    s_waitcnt lgkmcnt(3)
    v_mfma_f32_32x32x16_bf16 v[16:31], a[104:107], v[40:43], v[16:31]
    ds_read_b128 v[40:43], v2 offset:30720
    s_waitcnt lgkmcnt(3)
    v_mfma_f32_32x32x16_bf16 v[16:31], a[108:111], v[44:47], v[16:31]
    ds_read_b128 v[44:47], v2 offset:31744
    s_waitcnt lgkmcnt(3)
    v_mfma_f32_32x32x16_bf16 v[16:31], a[112:115], v[32:35], v[16:31]
    ds_read_b128 v[32:35], v2 offset:32768
    s_waitcnt lgkmcnt(3)
    v_mfma_f32_32x32x16_bf16 v[16:31], a[116:119], v[36:39], v[16:31]
    ds_read_b128 v[36:39], v2 offset:33792
    buffer_load_dwordx4 v1, s[4:7], s63 offen offset:3072 sc1 lds
    s_waitcnt lgkmcnt(3)
    v_mfma_f32_32x32x16_bf16 v[16:31], a[120:123], v[40:43], v[16:31]
    ds_read_b128 v[40:43], v2 offset:34816
    s_waitcnt lgkmcnt(3)
    v_mfma_f32_32x32x16_bf16 v[16:31], a[124:127], v[44:47], v[16:31]
    ds_read_b128 v[44:47], v2 offset:35840
    s_waitcnt lgkmcnt(3)
    v_mfma_f32_32x32x16_bf16 v[16:31], a[128:131], v[32:35], v[16:31]
    ds_read_b128 v[32:35], v2 offset:36864
    s_waitcnt lgkmcnt(3)
    v_mfma_f32_32x32x16_bf16 v[16:31], a[132:135], v[36:39], v[16:31]
    ds_read_b128 v[36:39], v2 offset:37888
    s_add_u32 m0, s64, 8192
    s_add_u32 s63, s71, 8192
    buffer_load_dwordx4 v1, s[4:7], s63 offen offset:0 sc1 lds
    s_waitcnt lgkmcnt(3)
    v_mfma_f32_32x32x16_bf16 v[16:31], a[136:139], v[40:43], v[16:31]
    ds_read_b128 v[40:43], v2 offset:38912
    s_waitcnt lgkmcnt(3)
    v_mfma_f32_32x32x16_bf16 v[16:31], a[140:143], v[44:47], v[16:31]
    ds_read_b128 v[44:47], v2 offset:39936
    s_waitcnt lgkmcnt(3)
    v_mfma_f32_32x32x16_bf16 v[16:31], a[144:147], v[32:35], v[16:31]
    s_waitcnt lgkmcnt(2)
    v_mfma_f32_32x32x16_bf16 v[16:31], a[148:151], v[36:39], v[16:31]
    buffer_load_dwordx4 v1, s[4:7], s63 offen offset:1024 sc1 lds
    s_add_u32 s71, s71, 40960
    s_add_u32 s70, s70, 40960
    s_cmp_ge_u32 s70, 122880
    s_cselect_b32 s70, 0, s70
    s_waitcnt lgkmcnt(1)
    v_mfma_f32_32x32x16_bf16 v[16:31], a[152:155], v[40:43], v[16:31]
    s_waitcnt lgkmcnt(0)
    v_mfma_f32_32x32x16_bf16 v[16:31], a[156:159], v[44:47], v[16:31]
    s_add_u32 s74, s74, 40960
    s_cmp_ge_u32 s74, 122880
    s_cselect_b32 s74, 0, s74
    s_nop 8
    v_cvt_pk_bf16_f32 v72, v16, v17
    v_cvt_pk_bf16_f32 v76, v24, v25
    v_cvt_pk_bf16_f32 v73, v18, v19
    v_cvt_pk_bf16_f32 v77, v26, v27
    v_cvt_pk_bf16_f32 v74, v20, v21
    v_cvt_pk_bf16_f32 v78, v28, v29
    v_cvt_pk_bf16_f32 v75, v22, v23
    v_cvt_pk_bf16_f32 v79, v30, v31
    v_lshlrev_b32 v56, 16, v72
    v_and_b32 v57, 0xffff0000, v72
    v_lshlrev_b32 v64, 16, v76
    v_and_b32 v65, 0xffff0000, v76
    v_lshlrev_b32 v58, 16, v73
    v_and_b32 v59, 0xffff0000, v73
    v_lshlrev_b32 v66, 16, v77
    v_and_b32 v67, 0xffff0000, v77
    v_lshlrev_b32 v60, 16, v74
    v_and_b32 v61, 0xffff0000, v74
    v_lshlrev_b32 v68, 16, v78
    v_and_b32 v69, 0xffff0000, v78
    v_lshlrev_b32 v62, 16, v75
    v_and_b32 v63, 0xffff0000, v75
    v_lshlrev_b32 v70, 16, v79
    v_and_b32 v71, 0xffff0000, v79
    s_mov_b32 s62, 0xbdd2d3e8
    v_mov_b32 v8, 0xc0135761
    v_mul_f32 v72, v56, v56
    v_mul_f32 v73, v57, v57
    v_mul_f32 v74, v58, v58
    v_mul_f32 v75, v59, v59
    v_mul_f32 v76, v60, v60
    v_mul_f32 v77, v61, v61
    v_mul_f32 v78, v62, v62
    v_mul_f32 v79, v63, v63
    v_fma_f32 v72, v72, s62, v8
    v_fma_f32 v73, v73, s62, v8
    v_fma_f32 v74, v74, s62, v8
    v_fma_f32 v75, v75, s62, v8
    v_fma_f32 v76, v76, s62, v8
    v_fma_f32 v77, v77, s62, v8
    v_fma_f32 v78, v78, s62, v8
    v_fma_f32 v79, v79, s62, v8
    v_mul_f32 v72, v72, v56
    v_mul_f32 v73, v73, v57
    v_mul_f32 v74, v74, v58
    v_mul_f32 v75, v75, v59
    v_mul_f32 v76, v76, v60
    v_mul_f32 v77, v77, v61
    v_mul_f32 v78, v78, v62
    v_mul_f32 v79, v79, v63
    v_exp_f32 v72, v72
    v_exp_f32 v73, v73
    v_exp_f32 v74, v74
    v_exp_f32 v75, v75
    v_exp_f32 v76, v76
    v_exp_f32 v77, v77
    v_exp_f32 v78, v78
    v_exp_f32 v79, v79
    v_add_f32 v72, 1.0, v72
    v_add_f32 v73, 1.0, v73
    v_add_f32 v74, 1.0, v74
    v_add_f32 v75, 1.0, v75
    v_add_f32 v76, 1.0, v76
    v_add_f32 v77, 1.0, v77
    v_add_f32 v78, 1.0, v78
    v_add_f32 v79, 1.0, v79
    v_rcp_f32 v72, v72
    v_rcp_f32 v73, v73
    v_rcp_f32 v74, v74
    v_rcp_f32 v75, v75
    v_rcp_f32 v76, v76
    v_rcp_f32 v77, v77
    v_rcp_f32 v78, v78
    v_rcp_f32 v79, v79
    v_mul_f32 v56, v56, v72
    v_mul_f32 v57, v57, v73
    v_mul_f32 v58, v58, v74
    v_mul_f32 v59, v59, v75
    v_mul_f32 v60, v60, v76
    v_mul_f32 v61, v61, v77
    v_mul_f32 v62, v62, v78
    v_mul_f32 v63, v63, v79
    v_cvt_pk_bf16_f32 v72, v56, v57
    v_cvt_pk_bf16_f32 v73, v58, v59
    v_cvt_pk_bf16_f32 v74, v60, v61
    v_cvt_pk_bf16_f32 v75, v62, v63
    v_lshlrev_b32 v56, 16, v72
    v_and_b32 v57, 0xffff0000, v72
    v_lshlrev_b32 v58, 16, v73
    v_and_b32 v59, 0xffff0000, v73
    v_lshlrev_b32 v60, 16, v74
    v_and_b32 v61, 0xffff0000, v74
    v_lshlrev_b32 v62, 16, v75
    v_and_b32 v63, 0xffff0000, v75
    v_mul_f32 v56, v56, v64
    v_mul_f32 v57, v57, v65
    v_mul_f32 v58, v58, v66
    v_mul_f32 v59, v59, v67
    v_mul_f32 v60, v60, v68
    v_mul_f32 v61, v61, v69
    v_mul_f32 v62, v62, v70
    v_mul_f32 v63, v63, v71
    v_cvt_pk_bf16_f32 v48, v56, v57
    v_cvt_pk_bf16_f32 v49, v58, v59
    v_cvt_pk_bf16_f32 v50, v60, v61
    v_cvt_pk_bf16_f32 v51, v62, v63
    buffer_store_dwordx4 v[48:51], v3, s[4:7], s72 offen sc1
    s_add_u32 s72, s72, 110592
    s_add_u32 s61, s61, 1
    s_waitcnt vmcnt(11)
    s_cmp_lt_u32 s61, 64
    s_cbranch_scc1 L_GU_LOOP
    s_waitcnt vmcnt(0)
    s_barrier
    s_cmp_lg_u32 s44, 0
    s_cbranch_scc1 L_END
    v_mov_b32 v8, 0
    v_mov_b32 v9, 64
    s_mov_b64 exec, 1
    buffer_store_dword v9, v8, s[4:7], s73 offen sc1
    s_mov_b64 exec, -1
    s_branch L_END2
L_QA:
    v_bfe_u32 v1, v0, 0, 6
    v_lshlrev_b32 v1, 4, v1
    v_and_b32 v8, 7, v0
    v_lshlrev_b32 v8, 5, v8
    v_and_b32 v9, 8, v0
    v_lshl_add_u32 v8, v9, 1, v8
    s_mov_b32 s60, 0
L_tk_144:
    buffer_load_dword v9, v8, s[48:51], 0 offen sc1
    s_waitcnt vmcnt(0)
    v_readlane_b32 s62, v9, 8
    v_readlane_b32 s52, v9, 9
    s_nop 0
    s_add_u32 s62, s62, s52
    v_readlane_b32 s52, v9, 10
    s_nop 0
    s_add_u32 s62, s62, s52
    v_readlane_b32 s52, v9, 11
    s_nop 0
    s_add_u32 s62, s62, s52
    v_readlane_b32 s52, v9, 12
    s_nop 0
    s_add_u32 s62, s62, s52
    v_readlane_b32 s52, v9, 13
    s_nop 0
    s_add_u32 s62, s62, s52
    v_readlane_b32 s52, v9, 14
    s_nop 0
    s_add_u32 s62, s62, s52
    v_readlane_b32 s52, v9, 15
    s_nop 0
    s_add_u32 s62, s62, s52
    s_cmp_ge_u32 s62, 256
    s_cbranch_scc1 L_tkd_145
    s_sleep 2
    s_add_u32 s60, s60, 1
    s_cmp_lt_u32 s60, 0x100000
    s_cbranch_scc1 L_tk_144
    s_movk_i32 s62, 1
    s_branch L_ABORT
L_tkd_145:
    v_and_b32 v8, 63, v0
    v_lshlrev_b32 v8, 6, v8
    s_mov_b32 s60, 0
L_pf_146:
    buffer_load_dword v9, v8, s[4:7], 0 offen sc1
    s_waitcnt vmcnt(0)
    v_cmp_gt_u32 vcc, 1, v9
    s_nop 0
    s_cbranch_vccz L_pfd_147
    s_sleep 1
    s_add_u32 s60, s60, 1
    s_cmp_lt_u32 s60, 0x100000
    s_cbranch_scc1 L_pf_146
    s_movk_i32 s62, 4
    s_branch L_ABORT
L_pfd_147:
    s_mov_b32 s8, s20
    s_and_b32 s9, s21, 0xffff
    s_mov_b32 s10, 0x500000
    s_mov_b32 s11, 0x20000
    s_lshl_b32 s66, s46, 8
    v_bfe_u32 v4, v0, 0, 4
    v_lshlrev_b32 v4, 4, v4
    v_bfe_u32 v9, v0, 4, 2
    v_lshlrev_b32 v9, 6, v9
    v_xor_b32 v4, v4, v9
    v_bfe_u32 v9, v0, 4, 2
    v_lshlrev_b32 v9, 13, v9
    v_bfe_u32 v8, v0, 6, 2
    v_lshl_add_u32 v9, v8, 17, v9
    v_add_u32 v4, v4, v9
    v_bfe_u32 v6, v0, 1, 1
    v_lshlrev_b32 v6, 4, v6
    v_bfe_u32 v8, v0, 4, 1
    v_lshl_add_u32 v6, v8, 5, v6
    v_bfe_u32 v8, v0, 6, 2
    v_lshl_add_u32 v6, v8, 6, v6
    v_bfe_u32 v9, v0, 2, 2
    v_lshlrev_b32 v9, 6, v9
    v_xor_b32 v6, v6, v9
    v_bfe_u32 v9, v0, 0, 1
    v_lshlrev_b32 v9, 3, v9
    v_bfe_u32 v8, v0, 2, 2
    v_lshl_add_u32 v9, v8, 8, v9
    v_bfe_u32 v8, v0, 5, 1
    v_lshl_add_u32 v9, v8, 11, v9
    v_add_u32 v6, v6, v9
    v_add_u32 v7, 0x10000, v6
    s_lshl_b32 s67, s44, 12
    s_add_u32 s63, s66, 0x0
    s_add_u32 s64, s67, 0x0
    s_mov_b32 m0, s64
    s_nop 0
    buffer_load_dwordx4 v4, s[8:11], s63 offen lds
    s_add_u32 s63, s66, 0x8000
    s_add_u32 s64, s67, 0x400
    s_mov_b32 m0, s64
    s_nop 0
    buffer_load_dwordx4 v4, s[8:11], s63 offen lds
    s_add_u32 s63, s66, 0x10000
    s_add_u32 s64, s67, 0x800
    s_mov_b32 m0, s64
    s_nop 0
    buffer_load_dwordx4 v4, s[8:11], s63 offen lds
    s_add_u32 s63, s66, 0x18000
    s_add_u32 s64, s67, 0xc00
    s_mov_b32 m0, s64
    s_nop 0
    buffer_load_dwordx4 v4, s[8:11], s63 offen lds
    s_add_u32 s63, s66, 0x80000
    s_add_u32 s64, s67, 0x4000
    s_mov_b32 m0, s64
    s_nop 0
    buffer_load_dwordx4 v4, s[8:11], s63 offen lds
    s_add_u32 s63, s66, 0x88000
    s_add_u32 s64, s67, 0x4400
    s_mov_b32 m0, s64
    s_nop 0
    buffer_load_dwordx4 v4, s[8:11], s63 offen lds
    s_add_u32 s63, s66, 0x90000
    s_add_u32 s64, s67, 0x4800
    s_mov_b32 m0, s64
    s_nop 0
    buffer_load_dwordx4 v4, s[8:11], s63 offen lds
    s_add_u32 s63, s66, 0x98000
    s_add_u32 s64, s67, 0x4c00
    s_mov_b32 m0, s64
    s_nop 0
    buffer_load_dwordx4 v4, s[8:11], s63 offen lds
    s_add_u32 s63, s66, 0x100000
    s_add_u32 s64, s67, 0x8000
    s_mov_b32 m0, s64
    s_nop 0
    buffer_load_dwordx4 v4, s[8:11], s63 offen lds
    s_add_u32 s63, s66, 0x108000
    s_add_u32 s64, s67, 0x8400
    s_mov_b32 m0, s64
    s_nop 0
    buffer_load_dwordx4 v4, s[8:11], s63 offen lds
    s_add_u32 s63, s66, 0x110000
    s_add_u32 s64, s67, 0x8800
    s_mov_b32 m0, s64
    s_nop 0
    buffer_load_dwordx4 v4, s[8:11], s63 offen lds
    s_add_u32 s63, s66, 0x118000
    s_add_u32 s64, s67, 0x8c00
    s_mov_b32 m0, s64
    s_nop 0
    buffer_load_dwordx4 v4, s[8:11], s63 offen lds
    s_add_u32 s63, s66, 0x180000
    s_add_u32 s64, s67, 0xc000
    s_mov_b32 m0, s64
    s_nop 0
    buffer_load_dwordx4 v4, s[8:11], s63 offen lds
    s_add_u32 s63, s66, 0x188000
    s_add_u32 s64, s67, 0xc400
    s_mov_b32 m0, s64
    s_nop 0
    buffer_load_dwordx4 v4, s[8:11], s63 offen lds
    s_add_u32 s63, s66, 0x190000
    s_add_u32 s64, s67, 0xc800
    s_mov_b32 m0, s64
    s_nop 0
    buffer_load_dwordx4 v4, s[8:11], s63 offen lds
    s_add_u32 s63, s66, 0x198000
    s_add_u32 s64, s67, 0xcc00
    s_mov_b32 m0, s64
    s_nop 0
    buffer_load_dwordx4 v4, s[8:11], s63 offen lds
    s_add_u32 s63, s66, 0x200000
    s_add_u32 s64, s67, 0x10000
    s_mov_b32 m0, s64
    s_nop 0
    buffer_load_dwordx4 v4, s[8:11], s63 offen lds
    s_add_u32 s63, s66, 0x208000
    s_add_u32 s64, s67, 0x10400
    s_mov_b32 m0, s64
    s_nop 0
    buffer_load_dwordx4 v4, s[8:11], s63 offen lds
    s_add_u32 s63, s66, 0x210000
    s_add_u32 s64, s67, 0x10800
    s_mov_b32 m0, s64
    s_nop 0
    buffer_load_dwordx4 v4, s[8:11], s63 offen lds
    s_add_u32 s63, s66, 0x218000
    s_add_u32 s64, s67, 0x10c00
    s_mov_b32 m0, s64
    s_nop 0
    buffer_load_dwordx4 v4, s[8:11], s63 offen lds
    s_add_u32 s63, s66, 0x280000
    s_add_u32 s64, s67, 0x14000
    s_mov_b32 m0, s64
    s_nop 0
    buffer_load_dwordx4 v4, s[8:11], s63 offen lds
    s_add_u32 s63, s66, 0x288000
    s_add_u32 s64, s67, 0x14400
    s_mov_b32 m0, s64
    s_nop 0
    buffer_load_dwordx4 v4, s[8:11], s63 offen lds
    s_add_u32 s63, s66, 0x290000
    s_add_u32 s64, s67, 0x14800
    s_mov_b32 m0, s64
    s_nop 0
    buffer_load_dwordx4 v4, s[8:11], s63 offen lds
    s_add_u32 s63, s66, 0x298000
    s_add_u32 s64, s67, 0x14c00
    s_mov_b32 m0, s64
    s_nop 0
    buffer_load_dwordx4 v4, s[8:11], s63 offen lds
    s_add_u32 s63, s66, 0x300000
    s_add_u32 s64, s67, 0x18000
    s_mov_b32 m0, s64
    s_nop 0
    buffer_load_dwordx4 v4, s[8:11], s63 offen lds
    s_add_u32 s63, s66, 0x308000
    s_add_u32 s64, s67, 0x18400
    s_mov_b32 m0, s64
    s_nop 0
    buffer_load_dwordx4 v4, s[8:11], s63 offen lds
    s_add_u32 s63, s66, 0x310000
    s_add_u32 s64, s67, 0x18800
    s_mov_b32 m0, s64
    s_nop 0
    buffer_load_dwordx4 v4, s[8:11], s63 offen lds
    s_add_u32 s63, s66, 0x318000
    s_add_u32 s64, s67, 0x18c00
    s_mov_b32 m0, s64
    s_nop 0
    buffer_load_dwordx4 v4, s[8:11], s63 offen lds
    s_waitcnt vmcnt(24) lgkmcnt(0)
    s_barrier
    s_add_u32 s63, s66, 0x380000
    s_add_u32 s64, s67, 0x1c000
    s_mov_b32 m0, s64
    s_nop 0
    buffer_load_dwordx4 v4, s[8:11], s63 offen lds
    s_add_u32 s63, s66, 0x388000
    s_add_u32 s64, s67, 0x1c400
    s_mov_b32 m0, s64
    s_nop 0
    buffer_load_dwordx4 v4, s[8:11], s63 offen lds
    s_add_u32 s63, s66, 0x390000
    s_add_u32 s64, s67, 0x1c800
    s_mov_b32 m0, s64
    s_nop 0
    buffer_load_dwordx4 v4, s[8:11], s63 offen lds
    s_add_u32 s63, s66, 0x398000
    s_add_u32 s64, s67, 0x1cc00
    s_mov_b32 m0, s64
    s_nop 0
    buffer_load_dwordx4 v4, s[8:11], s63 offen lds
    ds_read_b64_tr_b16 a[0:1], v6 offset:0
    ds_read_b64_tr_b16 a[2:3], v6 offset:1024
    ds_read_b64_tr_b16 a[4:5], v6 offset:4096
    ds_read_b64_tr_b16 a[6:7], v6 offset:5120
    ds_read_b64_tr_b16 a[8:9], v6 offset:8192
    ds_read_b64_tr_b16 a[10:11], v6 offset:9216
    ds_read_b64_tr_b16 a[12:13], v6 offset:12288
    ds_read_b64_tr_b16 a[14:15], v6 offset:13312
    s_waitcnt vmcnt(24) lgkmcnt(0)
    s_barrier
    s_add_u32 s63, s66, 0x400000
    s_add_u32 s64, s67, 0x0
    s_mov_b32 m0, s64
    s_nop 0
    buffer_load_dwordx4 v4, s[8:11], s63 offen lds
    s_add_u32 s63, s66, 0x408000
    s_add_u32 s64, s67, 0x400
    s_mov_b32 m0, s64
    s_nop 0
    buffer_load_dwordx4 v4, s[8:11], s63 offen lds
    s_add_u32 s63, s66, 0x410000
    s_add_u32 s64, s67, 0x800
    s_mov_b32 m0, s64
    s_nop 0
    buffer_load_dwordx4 v4, s[8:11], s63 offen lds
    s_add_u32 s63, s66, 0x418000
    s_add_u32 s64, s67, 0xc00
    s_mov_b32 m0, s64
    s_nop 0
    buffer_load_dwordx4 v4, s[8:11], s63 offen lds
    ds_read_b64_tr_b16 a[16:17], v6 offset:16384
    ds_read_b64_tr_b16 a[18:19], v6 offset:17408
    ds_read_b64_tr_b16 a[20:21], v6 offset:20480
    ds_read_b64_tr_b16 a[22:23], v6 offset:21504
    ds_read_b64_tr_b16 a[24:25], v6 offset:24576
    ds_read_b64_tr_b16 a[26:27], v6 offset:25600
    ds_read_b64_tr_b16 a[28:29], v6 offset:28672
    ds_read_b64_tr_b16 a[30:31], v6 offset:29696
    s_waitcnt vmcnt(24) lgkmcnt(0)
    s_barrier
    s_add_u32 s63, s66, 0x480000
    s_add_u32 s64, s67, 0x4000
    s_mov_b32 m0, s64
    s_nop 0
    buffer_load_dwordx4 v4, s[8:11], s63 offen lds
    s_add_u32 s63, s66, 0x488000
    s_add_u32 s64, s67, 0x4400
    s_mov_b32 m0, s64
    s_nop 0
    buffer_load_dwordx4 v4, s[8:11], s63 offen lds
    s_add_u32 s63, s66, 0x490000
    s_add_u32 s64, s67, 0x4800
    s_mov_b32 m0, s64
    s_nop 0
    buffer_load_dwordx4 v4, s[8:11], s63 offen lds
    s_add_u32 s63, s66, 0x498000
    s_add_u32 s64, s67, 0x4c00
    s_mov_b32 m0, s64
    s_nop 0
    buffer_load_dwordx4 v4, s[8:11], s63 offen lds
    ds_read_b64_tr_b16 a[32:33], v6 offset:32768
    ds_read_b64_tr_b16 a[34:35], v6 offset:33792
    ds_read_b64_tr_b16 a[36:37], v6 offset:36864
    ds_read_b64_tr_b16 a[38:39], v6 offset:37888
    ds_read_b64_tr_b16 a[40:41], v6 offset:40960
    ds_read_b64_tr_b16 a[42:43], v6 offset:41984
    ds_read_b64_tr_b16 a[44:45], v6 offset:45056
    ds_read_b64_tr_b16 a[46:47], v6 offset:46080
    s_waitcnt vmcnt(24) lgkmcnt(0)
    s_barrier
    ds_read_b64_tr_b16 a[48:49], v6 offset:49152
    ds_read_b64_tr_b16 a[50:51], v6 offset:50176
    ds_read_b64_tr_b16 a[52:53], v6 offset:53248
    ds_read_b64_tr_b16 a[54:55], v6 offset:54272
    ds_read_b64_tr_b16 a[56:57], v6 offset:57344
    ds_read_b64_tr_b16 a[58:59], v6 offset:58368
    ds_read_b64_tr_b16 a[60:61], v6 offset:61440
    ds_read_b64_tr_b16 a[62:63], v6 offset:62464
    s_waitcnt vmcnt(20) lgkmcnt(0)
    s_barrier
    ds_read_b64_tr_b16 a[64:65], v7 offset:0
    ds_read_b64_tr_b16 a[66:67], v7 offset:1024
    ds_read_b64_tr_b16 a[68:69], v7 offset:4096
    ds_read_b64_tr_b16 a[70:71], v7 offset:5120
    ds_read_b64_tr_b16 a[72:73], v7 offset:8192
    ds_read_b64_tr_b16 a[74:75], v7 offset:9216
    ds_read_b64_tr_b16 a[76:77], v7 offset:12288
    ds_read_b64_tr_b16 a[78:79], v7 offset:13312
    s_waitcnt vmcnt(16) lgkmcnt(0)
    s_barrier
    ds_read_b64_tr_b16 a[80:81], v7 offset:16384
    ds_read_b64_tr_b16 a[82:83], v7 offset:17408
    ds_read_b64_tr_b16 a[84:85], v7 offset:20480
    ds_read_b64_tr_b16 a[86:87], v7 offset:21504
    ds_read_b64_tr_b16 a[88:89], v7 offset:24576
    ds_read_b64_tr_b16 a[90:91], v7 offset:25600
    ds_read_b64_tr_b16 a[92:93], v7 offset:28672
    ds_read_b64_tr_b16 a[94:95], v7 offset:29696
    s_waitcnt vmcnt(12) lgkmcnt(0)
    s_barrier
    ds_read_b64_tr_b16 a[96:97], v7 offset:32768
    ds_read_b64_tr_b16 a[98:99], v7 offset:33792
    ds_read_b64_tr_b16 a[100:101], v7 offset:36864
    ds_read_b64_tr_b16 a[102:103], v7 offset:37888
    ds_read_b64_tr_b16 a[104:105], v7 offset:40960
    ds_read_b64_tr_b16 a[106:107], v7 offset:41984
    ds_read_b64_tr_b16 a[108:109], v7 offset:45056
    ds_read_b64_tr_b16 a[110:111], v7 offset:46080
    s_waitcnt vmcnt(8) lgkmcnt(0)
    s_barrier
    ds_read_b64_tr_b16 a[112:113], v7 offset:49152
    ds_read_b64_tr_b16 a[114:115], v7 offset:50176
    ds_read_b64_tr_b16 a[116:117], v7 offset:53248
    ds_read_b64_tr_b16 a[118:119], v7 offset:54272
    ds_read_b64_tr_b16 a[120:121], v7 offset:57344
    ds_read_b64_tr_b16 a[122:123], v7 offset:58368
    ds_read_b64_tr_b16 a[124:125], v7 offset:61440
    ds_read_b64_tr_b16 a[126:127], v7 offset:62464
    s_waitcnt vmcnt(4) lgkmcnt(0)
    s_barrier
    ds_read_b64_tr_b16 a[128:129], v6 offset:0
    ds_read_b64_tr_b16 a[130:131], v6 offset:1024
    ds_read_b64_tr_b16 a[132:133], v6 offset:4096
    ds_read_b64_tr_b16 a[134:135], v6 offset:5120
    ds_read_b64_tr_b16 a[136:137], v6 offset:8192
    ds_read_b64_tr_b16 a[138:139], v6 offset:9216
    ds_read_b64_tr_b16 a[140:141], v6 offset:12288
    ds_read_b64_tr_b16 a[142:143], v6 offset:13312
    s_waitcnt vmcnt(0) lgkmcnt(0)
    s_barrier
    ds_read_b64_tr_b16 a[144:145], v6 offset:16384
    ds_read_b64_tr_b16 a[146:147], v6 offset:17408
    ds_read_b64_tr_b16 a[148:149], v6 offset:20480
    ds_read_b64_tr_b16 a[150:151], v6 offset:21504
    ds_read_b64_tr_b16 a[152:153], v6 offset:24576
    ds_read_b64_tr_b16 a[154:155], v6 offset:25600
    ds_read_b64_tr_b16 a[156:157], v6 offset:28672
    ds_read_b64_tr_b16 a[158:159], v6 offset:29696
    s_waitcnt lgkmcnt(0)
    s_barrier
    v_bfe_u32 v3, v0, 0, 4
    v_lshlrev_b32 v3, 4, v3
    v_bfe_u32 v8, v0, 4, 1
    v_lshl_add_u32 v3, v8, 12, v3
    v_bfe_u32 v8, v0, 5, 1
    v_lshl_add_u32 v3, v8, 8, v3
    v_bfe_u32 v8, v0, 6, 2
    v_lshl_add_u32 v3, v8, 10, v3
    v_add_u32 v3, 0x14000, v3
    v_bfe_u32 v4, v0, 0, 6
    v_lshlrev_b32 v4, 4, v4
    v_bfe_u32 v8, v0, 6, 1
    v_lshl_add_u32 v4, v8, 12, v4
    v_add_u32 v4, 0x14000, v4
    v_bfe_u32 v5, v0, 0, 6
    v_lshlrev_b32 v5, 4, v5
    v_add_u32 v5, 0x16000, v5
    v_bfe_u32 v6, v0, 0, 6
    v_lshlrev_b32 v6, 4, v6
    v_bfe_u32 v8, v0, 7, 1
    v_lshl_add_u32 v6, v8, 12, v6
    v_add_u32 v6, 0x18000, v6
    v_bfe_u32 v7, v0, 0, 6
    v_lshlrev_b32 v7, 4, v7
    v_bfe_u32 v8, v0, 7, 1
    v_lshl_add_u32 v7, v8, 11, v7
    v_add_u32 v7, 0x1f000, v7
    v_bfe_u32 v12, v0, 0, 4
    v_lshlrev_b32 v12, 4, v12
    v_bfe_u32 v8, v0, 4, 2
    v_lshl_add_u32 v12, v8, 9, v12
    v_bfe_u32 v8, v0, 6, 1
    v_lshl_add_u32 v12, v8, 8, v12
    v_bfe_u32 v8, v0, 7, 1
    v_lshl_add_u32 v12, v8, 12, v12
    v_and_b32 v10, 1, v0
    v_lshlrev_b32 v10, 5, v10
    v_add_u32 v10, s46, v10
    v_add_u32 v10, 64, v10
    v_lshlrev_b32 v10, 6, v10
    v_bfe_u32 v11, v0, 0, 2
    v_lshlrev_b32 v11, 2, v11
    v_bfe_u32 v8, v0, 2, 1
    v_lshl_add_u32 v11, v8, 6, v11
    v_add_u32 v11, 0x5000, v11
    s_lshl_b32 s62, s46, 7
    v_add_u32 v11, s62, v11
    v_bfe_u32 v8, v0, 0, 4
    v_bfe_u32 v9, v0, 4, 2
    v_lshlrev_b32 v9, 2, v9
    v_cmp_le_u32 s[80:81], v9, v8
    v_add_u32 v9, 1, v9
    v_cmp_le_u32 s[82:83], v9, v8
    v_add_u32 v9, 1, v9
    v_cmp_le_u32 s[84:85], v9, v8
    v_add_u32 v9, 1, v9
    v_cmp_le_u32 s[86:87], v9, v8
    v_add_u32 v9, 1, v9
    s_mov_b32 s78, 0x3e0293ee
    s_add_u32 s73, s46, 160
    s_lshl_b32 s73, s73, 6
    s_lshl_b32 s56, s44, 11
    s_lshl_b32 s57, s44, 10
    s_lshl_b32 s75, s46, 13
    s_add_u32 s72, s75, 0x2c00000
    s_add_u32 s75, s75, 0x400000
    s_add_u32 s75, s75, s56
    s_lshl_b32 s76, s46, 12
    s_add_u32 s76, s76, s57
    s_add_u32 s77, s76, 0x5e00000
    s_add_u32 s76, s76, 0x6900000
    v_mov_b32 v13, 0xce6e6b28
    s_mul_i32 s67, s44, 10240
    s_add_u32 s71, s67, 0x100000
    s_mov_b32 s70, 0
    s_mov_b32 s74, 0
    s_add_u32 s64, s70, s67
    s_add_u32 m0, s64, 0
    s_add_u32 s63, s71, 0
    buffer_load_dwordx4 v1, s[4:7], s63 offen offset:0 sc1 lds
    buffer_load_dwordx4 v1, s[4:7], s63 offen offset:1024 sc1 lds
    buffer_load_dwordx4 v1, s[4:7], s63 offen offset:2048 sc1 lds
    buffer_load_dwordx4 v1, s[4:7], s63 offen offset:3072 sc1 lds
    s_add_u32 m0, s64, 4096
    s_add_u32 s63, s71, 4096
    buffer_load_dwordx4 v1, s[4:7], s63 offen offset:0 sc1 lds
    buffer_load_dwordx4 v1, s[4:7], s63 offen offset:1024 sc1 lds
    buffer_load_dwordx4 v1, s[4:7], s63 offen offset:2048 sc1 lds
    buffer_load_dwordx4 v1, s[4:7], s63 offen offset:3072 sc1 lds
    s_add_u32 m0, s64, 8192
    s_add_u32 s63, s71, 8192
    buffer_load_dwordx4 v1, s[4:7], s63 offen offset:0 sc1 lds
    buffer_load_dwordx4 v1, s[4:7], s63 offen offset:1024 sc1 lds
    s_add_u32 s71, s71, 40960
    s_add_u32 s70, s70, 40960
    s_cmp_ge_u32 s70, 81920
    s_cselect_b32 s70, 0, s70
    s_add_u32 s64, s70, s67
    s_add_u32 m0, s64, 0
    s_add_u32 s63, s71, 0
    buffer_load_dwordx4 v1, s[4:7], s63 offen offset:0 sc1 lds
    buffer_load_dwordx4 v1, s[4:7], s63 offen offset:1024 sc1 lds
    buffer_load_dwordx4 v1, s[4:7], s63 offen offset:2048 sc1 lds
    buffer_load_dwordx4 v1, s[4:7], s63 offen offset:3072 sc1 lds
    s_add_u32 m0, s64, 4096
    s_add_u32 s63, s71, 4096
    buffer_load_dwordx4 v1, s[4:7], s63 offen offset:0 sc1 lds
    buffer_load_dwordx4 v1, s[4:7], s63 offen offset:1024 sc1 lds
    buffer_load_dwordx4 v1, s[4:7], s63 offen offset:2048 sc1 lds
    buffer_load_dwordx4 v1, s[4:7], s63 offen offset:3072 sc1 lds
    s_add_u32 m0, s64, 8192
    s_add_u32 s63, s71, 8192
    buffer_load_dwordx4 v1, s[4:7], s63 offen offset:0 sc1 lds
    buffer_load_dwordx4 v1, s[4:7], s63 offen offset:1024 sc1 lds
    s_add_u32 s71, s71, 40960
    s_add_u32 s70, s70, 40960
    s_cmp_ge_u32 s70, 81920
    s_cselect_b32 s70, 0, s70
    s_mov_b32 s68, 0
    s_mov_b32 s79, 0
    s_mov_b32 s61, 0
    s_waitcnt vmcnt(10)
    s_barrier
    v_add_u32 v2, s74, v1
    ds_read_b128 v[32:35], v2 offset:0
    ds_read_b128 v[36:39], v2 offset:1024
    ds_read_b128 v[40:43], v2 offset:2048
    ds_read_b128 v[44:47], v2 offset:3072
    s_waitcnt lgkmcnt(3)
    v_mfma_f32_32x32x16_bf16 v[16:31], a[0:3], v[32:35], 0
    ds_read_b128 v[32:35], v2 offset:4096
    s_waitcnt lgkmcnt(3)
    v_mfma_f32_32x32x16_bf16 v[16:31], a[4:7], v[36:39], v[16:31]
    ds_read_b128 v[36:39], v2 offset:5120
    s_waitcnt lgkmcnt(3)
    v_mfma_f32_32x32x16_bf16 v[16:31], a[8:11], v[40:43], v[16:31]
    ds_read_b128 v[40:43], v2 offset:6144
    s_waitcnt lgkmcnt(3)
    v_mfma_f32_32x32x16_bf16 v[16:31], a[12:15], v[44:47], v[16:31]
    ds_read_b128 v[44:47], v2 offset:7168
    s_waitcnt lgkmcnt(3)
    v_mfma_f32_32x32x16_bf16 v[16:31], a[16:19], v[32:35], v[16:31]
    ds_read_b128 v[32:35], v2 offset:8192
    s_waitcnt lgkmcnt(3)
    v_mfma_f32_32x32x16_bf16 v[16:31], a[20:23], v[36:39], v[16:31]
    ds_read_b128 v[36:39], v2 offset:9216
    s_waitcnt lgkmcnt(3)
    v_mfma_f32_32x32x16_bf16 v[16:31], a[24:27], v[40:43], v[16:31]
    ds_read_b128 v[40:43], v2 offset:10240
    s_waitcnt lgkmcnt(3)
    v_mfma_f32_32x32x16_bf16 v[16:31], a[28:31], v[44:47], v[16:31]
    ds_read_b128 v[44:47], v2 offset:11264
    s_waitcnt lgkmcnt(3)
    v_mfma_f32_32x32x16_bf16 v[16:31], a[32:35], v[32:35], v[16:31]
    ds_read_b128 v[32:35], v2 offset:12288
    s_waitcnt lgkmcnt(3)
    v_mfma_f32_32x32x16_bf16 v[16:31], a[36:39], v[36:39], v[16:31]
    ds_read_b128 v[36:39], v2 offset:13312
    s_waitcnt lgkmcnt(3)
    v_mfma_f32_32x32x16_bf16 v[16:31], a[40:43], v[40:43], v[16:31]
    ds_read_b128 v[40:43], v2 offset:14336
    s_waitcnt lgkmcnt(3)
    v_mfma_f32_32x32x16_bf16 v[16:31], a[44:47], v[44:47], v[16:31]
    ds_read_b128 v[44:47], v2 offset:15360
    s_waitcnt lgkmcnt(3)
    v_mfma_f32_32x32x16_bf16 v[16:31], a[48:51], v[32:35], v[16:31]
    ds_read_b128 v[32:35], v2 offset:16384
    s_waitcnt lgkmcnt(3)
    v_mfma_f32_32x32x16_bf16 v[16:31], a[52:55], v[36:39], v[16:31]
    ds_read_b128 v[36:39], v2 offset:17408
    s_waitcnt lgkmcnt(3)
    v_mfma_f32_32x32x16_bf16 v[16:31], a[56:59], v[40:43], v[16:31]
    ds_read_b128 v[40:43], v2 offset:18432
    s_waitcnt lgkmcnt(3)
    v_mfma_f32_32x32x16_bf16 v[16:31], a[60:63], v[44:47], v[16:31]
    ds_read_b128 v[44:47], v2 offset:19456
    s_waitcnt lgkmcnt(3)
    v_mfma_f32_32x32x16_bf16 v[16:31], a[64:67], v[32:35], v[16:31]
    ds_read_b128 v[32:35], v2 offset:20480
    s_waitcnt lgkmcnt(3)
    v_mfma_f32_32x32x16_bf16 v[16:31], a[68:71], v[36:39], v[16:31]
    ds_read_b128 v[36:39], v2 offset:21504
    s_waitcnt lgkmcnt(3)
    v_mfma_f32_32x32x16_bf16 v[16:31], a[72:75], v[40:43], v[16:31]
    ds_read_b128 v[40:43], v2 offset:22528
    s_waitcnt lgkmcnt(3)
    v_mfma_f32_32x32x16_bf16 v[16:31], a[76:79], v[44:47], v[16:31]
    ds_read_b128 v[44:47], v2 offset:23552
    s_waitcnt lgkmcnt(3)
    v_mfma_f32_32x32x16_bf16 v[16:31], a[80:83], v[32:35], v[16:31]
    ds_read_b128 v[32:35], v2 offset:24576
    s_waitcnt lgkmcnt(3)
    v_mfma_f32_32x32x16_bf16 v[16:31], a[84:87], v[36:39], v[16:31]
    ds_read_b128 v[36:39], v2 offset:25600
    s_waitcnt lgkmcnt(3)
    v_mfma_f32_32x32x16_bf16 v[16:31], a[88:91], v[40:43], v[16:31]
    ds_read_b128 v[40:43], v2 offset:26624
    s_waitcnt lgkmcnt(3)
    v_mfma_f32_32x32x16_bf16 v[16:31], a[92:95], v[44:47], v[16:31]
    ds_read_b128 v[44:47], v2 offset:27648
    s_waitcnt lgkmcnt(3)
    v_mfma_f32_32x32x16_bf16 v[16:31], a[96:99], v[32:35], v[16:31]
    ds_read_b128 v[32:35], v2 offset:28672
    s_waitcnt lgkmcnt(3)
    v_mfma_f32_32x32x16_bf16 v[16:31], a[100:103], v[36:39], v[16:31]
    ds_read_b128 v[36:39], v2 offset:29696
    s_waitcnt lgkmcnt(3)
    v_mfma_f32_32x32x16_bf16 v[16:31], a[104:107], v[40:43], v[16:31]
    ds_read_b128 v[40:43], v2 offset:30720
    s_waitcnt lgkmcnt(3)
    v_mfma_f32_32x32x16_bf16 v[16:31], a[108:111], v[44:47], v[16:31]
    ds_read_b128 v[44:47], v2 offset:31744
    s_waitcnt lgkmcnt(3)
    v_mfma_f32_32x32x16_bf16 v[16:31], a[112:115], v[32:35], v[16:31]
    ds_read_b128 v[32:35], v2 offset:32768
    s_waitcnt lgkmcnt(3)
    v_mfma_f32_32x32x16_bf16 v[16:31], a[116:119], v[36:39], v[16:31]
    ds_read_b128 v[36:39], v2 offset:33792
    s_waitcnt lgkmcnt(3)
    v_mfma_f32_32x32x16_bf16 v[16:31], a[120:123], v[40:43], v[16:31]
    ds_read_b128 v[40:43], v2 offset:34816
    s_waitcnt lgkmcnt(3)
    v_mfma_f32_32x32x16_bf16 v[16:31], a[124:127], v[44:47], v[16:31]
    ds_read_b128 v[44:47], v2 offset:35840
    s_waitcnt lgkmcnt(3)
    v_mfma_f32_32x32x16_bf16 v[16:31], a[128:131], v[32:35], v[16:31]
    ds_read_b128 v[32:35], v2 offset:36864
    s_waitcnt lgkmcnt(3)
    v_mfma_f32_32x32x16_bf16 v[16:31], a[132:135], v[36:39], v[16:31]
    ds_read_b128 v[36:39], v2 offset:37888
    s_waitcnt lgkmcnt(3)
    v_mfma_f32_32x32x16_bf16 v[16:31], a[136:139], v[40:43], v[16:31]
    ds_read_b128 v[40:43], v2 offset:38912
    s_waitcnt lgkmcnt(3)
    v_mfma_f32_32x32x16_bf16 v[16:31], a[140:143], v[44:47], v[16:31]
    ds_read_b128 v[44:47], v2 offset:39936
    s_waitcnt lgkmcnt(3)
    v_mfma_f32_32x32x16_bf16 v[16:31], a[144:147], v[32:35], v[16:31]
    s_waitcnt lgkmcnt(2)
    v_mfma_f32_32x32x16_bf16 v[16:31], a[148:151], v[36:39], v[16:31]
    s_waitcnt lgkmcnt(1)
    v_mfma_f32_32x32x16_bf16 v[16:31], a[152:155], v[40:43], v[16:31]
    s_waitcnt lgkmcnt(0)
    v_mfma_f32_32x32x16_bf16 v[16:31], a[156:159], v[44:47], v[16:31]
    s_add_u32 s74, s74, 40960
    s_cmp_ge_u32 s74, 81920
    s_cselect_b32 s74, 0, s74
    s_nop 8
    v_cvt_pk_bf16_f32 v164, v16, v17
    v_cvt_pk_bf16_f32 v165, v18, v19
    v_cvt_pk_bf16_f32 v166, v20, v21
    v_cvt_pk_bf16_f32 v167, v22, v23
    ds_write_b128 v3, v[164:167] offset:0
    v_cvt_pk_bf16_f32 v168, v24, v25
    v_cvt_pk_bf16_f32 v169, v26, v27
    v_cvt_pk_bf16_f32 v170, v28, v29
    v_cvt_pk_bf16_f32 v171, v30, v31
    ds_write_b128 v3, v[168:171] offset:512
    s_waitcnt lgkmcnt(0)
    s_waitcnt vmcnt(0)
    s_barrier
    ds_read_b128 v[48:51], v4 offset:0
    ds_read_b128 v[52:55], v4 offset:1024
    ds_read_b128 v[56:59], v4 offset:2048
    ds_read_b128 v[60:63], v4 offset:3072
    s_cmp_ge_u32 s68, 1
    s_cbranch_scc1 L_hv_148
    s_mov_b32 s60, 0
L_pf_149:
    buffer_load_dword v9, v10, s[4:7], 0 offen sc1
    s_waitcnt vmcnt(0)
    v_cmp_gt_u32 vcc, 1, v9
    s_nop 0
    s_cbranch_vccz L_pfd_150
    s_sleep 1
    s_add_u32 s60, s60, 1
    s_cmp_lt_u32 s60, 0x100000
    s_cbranch_scc1 L_pf_149
    s_movk_i32 s62, 18
    s_branch L_ABORT
L_pfd_150:
    v_readlane_b32 s68, v9, 0
    v_readlane_b32 s62, v9, 1
    s_nop 0
    s_min_u32 s68, s68, s62
L_hv_148:
    s_waitcnt lgkmcnt(0)
    s_barrier
    v_add_u32 v2, s74, v1
    ds_read_b128 v[32:35], v2 offset:0
    ds_read_b128 v[36:39], v2 offset:1024
    ds_read_b128 v[40:43], v2 offset:2048
    ds_read_b128 v[44:47], v2 offset:3072
    s_waitcnt lgkmcnt(3)
    v_mfma_f32_32x32x16_bf16 v[16:31], a[0:3], v[32:35], 0
    ds_read_b128 v[32:35], v2 offset:4096
    s_waitcnt lgkmcnt(3)
    v_mfma_f32_32x32x16_bf16 v[16:31], a[4:7], v[36:39], v[16:31]
    ds_read_b128 v[36:39], v2 offset:5120
    s_add_u32 m0, s56, 90112
    s_add_u32 s66, s75, 0x1000000
    buffer_load_dwordx4 v1, s[4:7], s75 offen offset:0 sc1 lds
    s_waitcnt lgkmcnt(3)
    v_mfma_f32_32x32x16_bf16 v[16:31], a[8:11], v[40:43], v[16:31]
    ds_read_b128 v[40:43], v2 offset:6144
    s_waitcnt lgkmcnt(3)
    v_mfma_f32_32x32x16_bf16 v[16:31], a[12:15], v[44:47], v[16:31]
    ds_read_b128 v[44:47], v2 offset:7168
    buffer_load_dwordx4 v1, s[4:7], s75 offen offset:1024 sc1 lds
    s_waitcnt lgkmcnt(3)
    v_mfma_f32_32x32x16_bf16 v[16:31], a[16:19], v[32:35], v[16:31]
    ds_read_b128 v[32:35], v2 offset:8192
    s_waitcnt lgkmcnt(3)
    v_mfma_f32_32x32x16_bf16 v[16:31], a[20:23], v[36:39], v[16:31]
    ds_read_b128 v[36:39], v2 offset:9216
    s_add_u32 m0, s56, 98304
    s_add_u32 s75, s75, 262144
    buffer_load_dwordx4 v1, s[4:7], s66 offen offset:0 sc1 lds
    s_waitcnt lgkmcnt(3)
    v_mfma_f32_32x32x16_bf16 v[16:31], a[24:27], v[40:43], v[16:31]
    ds_read_b128 v[40:43], v2 offset:10240
    s_waitcnt lgkmcnt(3)
    v_mfma_f32_32x32x16_bf16 v[16:31], a[28:31], v[44:47], v[16:31]
    ds_read_b128 v[44:47], v2 offset:11264
    buffer_load_dwordx4 v1, s[4:7], s66 offen offset:1024 sc1 lds
    s_waitcnt lgkmcnt(3)
    v_mfma_f32_32x32x16_bf16 v[16:31], a[32:35], v[32:35], v[16:31]
    ds_read_b128 v[32:35], v2 offset:12288
    s_waitcnt lgkmcnt(3)
    v_mfma_f32_32x32x16_bf16 v[16:31], a[36:39], v[36:39], v[16:31]
    ds_read_b128 v[36:39], v2 offset:13312
    s_add_u32 s64, s70, s67
    s_add_u32 m0, s64, 0
    s_add_u32 s63, s71, 0
    buffer_load_dwordx4 v1, s[4:7], s63 offen offset:0 sc1 lds
    s_waitcnt lgkmcnt(3)
    v_mfma_f32_32x32x16_bf16 v[16:31], a[40:43], v[40:43], v[16:31]
    ds_read_b128 v[40:43], v2 offset:14336
    s_waitcnt lgkmcnt(3)
    v_mfma_f32_32x32x16_bf16 v[16:31], a[44:47], v[44:47], v[16:31]
    ds_read_b128 v[44:47], v2 offset:15360
    buffer_load_dwordx4 v1, s[4:7], s63 offen offset:1024 sc1 lds
    s_waitcnt lgkmcnt(3)
    v_mfma_f32_32x32x16_bf16 v[16:31], a[48:51], v[32:35], v[16:31]
    ds_read_b128 v[32:35], v2 offset:16384
    s_waitcnt lgkmcnt(3)
    v_mfma_f32_32x32x16_bf16 v[16:31], a[52:55], v[36:39], v[16:31]
    ds_read_b128 v[36:39], v2 offset:17408
    buffer_load_dwordx4 v1, s[4:7], s63 offen offset:2048 sc1 lds
    s_waitcnt lgkmcnt(3)
    v_mfma_f32_32x32x16_bf16 v[16:31], a[56:59], v[40:43], v[16:31]
    ds_read_b128 v[40:43], v2 offset:18432
    s_waitcnt lgkmcnt(3)
    v_mfma_f32_32x32x16_bf16 v[16:31], a[60:63], v[44:47], v[16:31]
    ds_read_b128 v[44:47], v2 offset:19456
    buffer_load_dwordx4 v1, s[4:7], s63 offen offset:3072 sc1 lds
    s_waitcnt lgkmcnt(3)
    v_mfma_f32_32x32x16_bf16 v[16:31], a[64:67], v[32:35], v[16:31]
    ds_read_b128 v[32:35], v2 offset:20480
    s_waitcnt lgkmcnt(3)
    v_mfma_f32_32x32x16_bf16 v[16:31], a[68:71], v[36:39], v[16:31]
    ds_read_b128 v[36:39], v2 offset:21504
    s_add_u32 m0, s64, 4096
    s_add_u32 s63, s71, 4096
    buffer_load_dwordx4 v1, s[4:7], s63 offen offset:0 sc1 lds
    s_waitcnt lgkmcnt(3)
    v_mfma_f32_32x32x16_bf16 v[16:31], a[72:75], v[40:43], v[16:31]
    ds_read_b128 v[40:43], v2 offset:22528
    s_waitcnt lgkmcnt(3)
    v_mfma_f32_32x32x16_bf16 v[16:31], a[76:79], v[44:47], v[16:31]
    ds_read_b128 v[44:47], v2 offset:23552
    buffer_load_dwordx4 v1, s[4:7], s63 offen offset:1024 sc1 lds
    s_waitcnt lgkmcnt(3)
    v_mfma_f32_32x32x16_bf16 v[16:31], a[80:83], v[32:35], v[16:31]
    ds_read_b128 v[32:35], v2 offset:24576
    s_waitcnt lgkmcnt(3)
    v_mfma_f32_32x32x16_bf16 v[16:31], a[84:87], v[36:39], v[16:31]
    ds_read_b128 v[36:39], v2 offset:25600
    buffer_load_dwordx4 v1, s[4:7], s63 offen offset:2048 sc1 lds
    s_waitcnt lgkmcnt(3)
    v_mfma_f32_32x32x16_bf16 v[16:31], a[88:91], v[40:43], v[16:31]
    ds_read_b128 v[40:43], v2 offset:26624
    s_waitcnt lgkmcnt(3)
    v_mfma_f32_32x32x16_bf16 v[16:31], a[92:95], v[44:47], v[16:31]
    ds_read_b128 v[44:47], v2 offset:27648
    buffer_load_dwordx4 v1, s[4:7], s63 offen offset:3072 sc1 lds
    s_waitcnt lgkmcnt(3)
    v_mfma_f32_32x32x16_bf16 v[16:31], a[96:99], v[32:35], v[16:31]
    ds_read_b128 v[32:35], v2 offset:28672
    s_waitcnt lgkmcnt(3)
    v_mfma_f32_32x32x16_bf16 v[16:31], a[100:103], v[36:39], v[16:31]
    ds_read_b128 v[36:39], v2 offset:29696
    s_add_u32 m0, s64, 8192
    s_add_u32 s63, s71, 8192
    buffer_load_dwordx4 v1, s[4:7], s63 offen offset:0 sc1 lds
    s_waitcnt lgkmcnt(3)
    v_mfma_f32_32x32x16_bf16 v[16:31], a[104:107], v[40:43], v[16:31]
    ds_read_b128 v[40:43], v2 offset:30720
    s_waitcnt lgkmcnt(3)
    v_mfma_f32_32x32x16_bf16 v[16:31], a[108:111], v[44:47], v[16:31]
    ds_read_b128 v[44:47], v2 offset:31744
    buffer_load_dwordx4 v1, s[4:7], s63 offen offset:1024 sc1 lds
    s_add_u32 s71, s71, 40960
    s_add_u32 s70, s70, 40960
    s_cmp_ge_u32 s70, 81920
    s_cselect_b32 s70, 0, s70
    s_waitcnt lgkmcnt(3)
    v_mfma_f32_32x32x16_bf16 v[16:31], a[112:115], v[32:35], v[16:31]
    ds_read_b128 v[32:35], v2 offset:32768
    s_waitcnt lgkmcnt(3)
    v_mfma_f32_32x32x16_bf16 v[16:31], a[116:119], v[36:39], v[16:31]
    ds_read_b128 v[36:39], v2 offset:33792
    s_waitcnt lgkmcnt(3)
    v_mfma_f32_32x32x16_bf16 v[16:31], a[120:123], v[40:43], v[16:31]
    ds_read_b128 v[40:43], v2 offset:34816
    s_waitcnt lgkmcnt(3)
    v_mfma_f32_32x32x16_bf16 v[16:31], a[124:127], v[44:47], v[16:31]
    ds_read_b128 v[44:47], v2 offset:35840
    s_waitcnt lgkmcnt(3)
    v_mfma_f32_32x32x16_bf16 v[16:31], a[128:131], v[32:35], v[16:31]
    ds_read_b128 v[32:35], v2 offset:36864
    s_waitcnt lgkmcnt(3)
    v_mfma_f32_32x32x16_bf16 v[16:31], a[132:135], v[36:39], v[16:31]
    ds_read_b128 v[36:39], v2 offset:37888
    s_waitcnt lgkmcnt(3)
    v_mfma_f32_32x32x16_bf16 v[16:31], a[136:139], v[40:43], v[16:31]
    ds_read_b128 v[40:43], v2 offset:38912
    s_waitcnt lgkmcnt(3)
    v_mfma_f32_32x32x16_bf16 v[16:31], a[140:143], v[44:47], v[16:31]
    ds_read_b128 v[44:47], v2 offset:39936
    s_waitcnt lgkmcnt(3)
    v_mfma_f32_32x32x16_bf16 v[16:31], a[144:147], v[32:35], v[16:31]
    s_waitcnt lgkmcnt(2)
    v_mfma_f32_32x32x16_bf16 v[16:31], a[148:151], v[36:39], v[16:31]
    s_waitcnt lgkmcnt(1)
    v_mfma_f32_32x32x16_bf16 v[16:31], a[152:155], v[40:43], v[16:31]
    s_waitcnt lgkmcnt(0)
    v_mfma_f32_32x32x16_bf16 v[16:31], a[156:159], v[44:47], v[16:31]
    s_add_u32 s74, s74, 40960
    s_cmp_ge_u32 s74, 81920
    s_cselect_b32 s74, 0, s74
    s_nop 8
    v_cvt_pk_bf16_f32 v164, v16, v17
    v_cvt_pk_bf16_f32 v165, v18, v19
    v_cvt_pk_bf16_f32 v166, v20, v21
    v_cvt_pk_bf16_f32 v167, v22, v23
    ds_write_b128 v3, v[164:167] offset:0
    v_cvt_pk_bf16_f32 v168, v24, v25
    v_cvt_pk_bf16_f32 v169, v26, v27
    v_cvt_pk_bf16_f32 v170, v28, v29
    v_cvt_pk_bf16_f32 v171, v30, v31
    ds_write_b128 v3, v[168:171] offset:512
    s_waitcnt lgkmcnt(0)
    s_waitcnt vmcnt(10)
    s_barrier
L_QA_LOOP:
    ds_read_b128 v[64:67], v5 offset:0
    ds_read_b128 v[68:71], v5 offset:1024
    ds_read_b128 v[72:75], v5 offset:2048
    ds_read_b128 v[76:79], v5 offset:3072
    ds_read_b128 v[80:83], v5 offset:4096
    ds_read_b128 v[84:87], v5 offset:5120
    ds_read_b128 v[88:91], v5 offset:6144
    ds_read_b128 v[92:95], v5 offset:7168
    ds_read_b128 v[96:99], v6 offset:0
    ds_read_b128 v[100:103], v6 offset:1024
    ds_read_b128 v[104:107], v6 offset:2048
    ds_read_b128 v[108:111], v6 offset:3072
    s_waitcnt lgkmcnt(11)
    v_mfma_f32_16x16x32_bf16 v[136:139], v[64:67], v[48:51], 0
    s_waitcnt lgkmcnt(10)
    v_mfma_f32_16x16x32_bf16 v[136:139], v[68:71], v[52:55], v[136:139]
    s_waitcnt lgkmcnt(9)
    v_mfma_f32_16x16x32_bf16 v[136:139], v[72:75], v[56:59], v[136:139]
    s_waitcnt lgkmcnt(8)
    v_mfma_f32_16x16x32_bf16 v[136:139], v[76:79], v[60:63], v[136:139]
    s_waitcnt lgkmcnt(7)
    v_mfma_f32_16x16x32_bf16 v[140:143], v[80:83], v[48:51], 0
    s_waitcnt lgkmcnt(6)
    v_mfma_f32_16x16x32_bf16 v[140:143], v[84:87], v[52:55], v[140:143]
    s_waitcnt lgkmcnt(5)
    v_mfma_f32_16x16x32_bf16 v[140:143], v[88:91], v[56:59], v[140:143]
    s_waitcnt lgkmcnt(4)
    v_mfma_f32_16x16x32_bf16 v[140:143], v[92:95], v[60:63], v[140:143]
    ds_read_b128 v[176:179], v4 offset:0
    ds_read_b128 v[180:183], v4 offset:1024
    ds_read_b128 v[184:187], v4 offset:2048
    ds_read_b128 v[188:191], v4 offset:3072
    s_add_u32 s65, s61, 2
    s_cmp_ge_u32 s68, s65
    s_cbranch_scc1 L_hv_151
    s_mov_b32 s60, 0
L_pf_152:
    buffer_load_dword v9, v10, s[4:7], 0 offen sc1
    s_waitcnt vmcnt(0)
    v_cmp_gt_u32 vcc, s65, v9
    s_nop 0
    s_cbranch_vccz L_pfd_153
    s_sleep 1
    s_add_u32 s60, s60, 1
    s_cmp_lt_u32 s60, 0x100000
    s_cbranch_scc1 L_pf_152
    s_movk_i32 s62, 9
    s_branch L_ABORT
L_pfd_153:
    v_readlane_b32 s68, v9, 0
    v_readlane_b32 s62, v9, 1
    s_nop 0
    s_min_u32 s68, s68, s62
L_hv_151:
    s_add_u32 s69, s61, 1
    s_cmp_ge_u32 s79, s69
    s_cbranch_scc1 L_hm_154
    s_mov_b32 s60, 0
L_pf_155:
    buffer_load_dword v9, v11, s[4:7], 0 offen sc1
    s_waitcnt vmcnt(0)
    v_cmp_gt_u32 vcc, s69, v9
    s_nop 0
    s_cbranch_vccz L_pfd_156
    s_sleep 1
    s_add_u32 s60, s60, 1
    s_cmp_lt_u32 s60, 0x100000
    s_cbranch_scc1 L_pf_155
    s_movk_i32 s62, 10
    s_branch L_ABORT
L_pfd_156:
    v_readlane_b32 s79, v9, 0
    v_readlane_b32 s62, v9, 1
    s_nop 0
    s_min_u32 s79, s79, s62
    v_readlane_b32 s62, v9, 2
    s_nop 0
    s_min_u32 s79, s79, s62
    v_readlane_b32 s62, v9, 3
    s_nop 0
    s_min_u32 s79, s79, s62
    v_readlane_b32 s62, v9, 4
    s_nop 0
    s_min_u32 s79, s79, s62
    v_readlane_b32 s62, v9, 5
    s_nop 0
    s_min_u32 s79, s79, s62
    v_readlane_b32 s62, v9, 6
    s_nop 0
    s_min_u32 s79, s79, s62
    v_readlane_b32 s62, v9, 7
    s_nop 0
    s_min_u32 s79, s79, s62
L_hm_154:
    s_add_u32 m0, s57, 122880
    s_nop 0
    buffer_load_dwordx4 v1, s[4:7], s76 offen offset:0 sc1 lds
    s_add_u32 m0, s57, 126976
    s_nop 0
    buffer_load_dwordx4 v1, s[4:7], s77 offen offset:0 sc1 lds
    s_add_u32 s76, s76, 131072
    s_add_u32 s77, s77, 131072
    s_bitcmp1_b32 s44, 0
    s_cbranch_scc1 L_m1_157
    v_cndmask_b32 v136, v13, v136, s[80:81]
    v_mov_b32 v140, v13
    v_cndmask_b32 v137, v13, v137, s[82:83]
    v_mov_b32 v141, v13
    v_cndmask_b32 v138, v13, v138, s[84:85]
    v_mov_b32 v142, v13
    v_cndmask_b32 v139, v13, v139, s[86:87]
    v_mov_b32 v143, v13
    s_branch L_me_158
L_m1_157:
    v_cndmask_b32 v140, v13, v140, s[80:81]
    v_cndmask_b32 v141, v13, v141, s[82:83]
    v_cndmask_b32 v142, v13, v142, s[84:85]
    v_cndmask_b32 v143, v13, v143, s[86:87]
L_me_158:
    s_waitcnt vmcnt(2) lgkmcnt(0)
    s_barrier
    s_cmp_lg_u32 s44, 0
    s_cbranch_scc1 L_np_159
    v_mov_b32 v9, s61
    s_mov_b64 exec, 1
    buffer_store_dword v9, off, s[4:7], s73 sc1
    s_mov_b64 exec, -1
L_np_159:
    v_add_u32 v2, s74, v1
    ds_read_b128 v[32:35], v2 offset:0
    ds_read_b128 v[36:39], v2 offset:1024
    ds_read_b128 v[40:43], v2 offset:2048
    ds_read_b128 v[44:47], v2 offset:3072
    s_waitcnt lgkmcnt(3)
    v_mfma_f32_32x32x16_bf16 v[16:31], a[0:3], v[32:35], 0
    ds_read_b128 v[32:35], v2 offset:4096
    s_waitcnt lgkmcnt(3)
    v_mfma_f32_32x32x16_bf16 v[16:31], a[4:7], v[36:39], v[16:31]
    ds_read_b128 v[36:39], v2 offset:5120
    s_add_u32 m0, s56, 106496
    s_add_u32 s66, s75, 0x1000000
    buffer_load_dwordx4 v1, s[4:7], s75 offen offset:0 sc1 lds
    s_waitcnt lgkmcnt(3)
    v_mfma_f32_32x32x16_bf16 v[16:31], a[8:11], v[40:43], v[16:31]
    ds_read_b128 v[40:43], v2 offset:6144
    s_waitcnt lgkmcnt(3)
    v_mfma_f32_32x32x16_bf16 v[16:31], a[12:15], v[44:47], v[16:31]
    ds_read_b128 v[44:47], v2 offset:7168
    buffer_load_dwordx4 v1, s[4:7], s75 offen offset:1024 sc1 lds
    s_waitcnt lgkmcnt(3)
    v_mfma_f32_32x32x16_bf16 v[16:31], a[16:19], v[32:35], v[16:31]
    ds_read_b128 v[32:35], v2 offset:8192
    s_waitcnt lgkmcnt(3)
    v_mfma_f32_32x32x16_bf16 v[16:31], a[20:23], v[36:39], v[16:31]
    ds_read_b128 v[36:39], v2 offset:9216
    s_add_u32 m0, s56, 114688
    s_add_u32 s75, s75, 262144
    buffer_load_dwordx4 v1, s[4:7], s66 offen offset:0 sc1 lds
    s_waitcnt lgkmcnt(3)
    v_mfma_f32_32x32x16_bf16 v[16:31], a[24:27], v[40:43], v[16:31]
    ds_read_b128 v[40:43], v2 offset:10240
    s_waitcnt lgkmcnt(3)
    v_mfma_f32_32x32x16_bf16 v[16:31], a[28:31], v[44:47], v[16:31]
    ds_read_b128 v[44:47], v2 offset:11264
    buffer_load_dwordx4 v1, s[4:7], s66 offen offset:1024 sc1 lds
    s_waitcnt lgkmcnt(3)
    v_mfma_f32_32x32x16_bf16 v[16:31], a[32:35], v[32:35], v[16:31]
    ds_read_b128 v[32:35], v2 offset:12288
    s_waitcnt lgkmcnt(3)
    v_mfma_f32_32x32x16_bf16 v[16:31], a[36:39], v[36:39], v[16:31]
    ds_read_b128 v[36:39], v2 offset:13312
    s_add_u32 s64, s70, s67
    s_add_u32 m0, s64, 0
    s_add_u32 s63, s71, 0
    buffer_load_dwordx4 v1, s[4:7], s63 offen offset:0 sc1 lds
    s_waitcnt lgkmcnt(3)
    v_mfma_f32_32x32x16_bf16 v[16:31], a[40:43], v[40:43], v[16:31]
    ds_read_b128 v[40:43], v2 offset:14336
    s_waitcnt lgkmcnt(3)
    v_mfma_f32_32x32x16_bf16 v[16:31], a[44:47], v[44:47], v[16:31]
    ds_read_b128 v[44:47], v2 offset:15360
    buffer_load_dwordx4 v1, s[4:7], s63 offen offset:1024 sc1 lds
    s_waitcnt lgkmcnt(3)
    v_mfma_f32_32x32x16_bf16 v[16:31], a[48:51], v[32:35], v[16:31]
    ds_read_b128 v[32:35], v2 offset:16384
    s_waitcnt lgkmcnt(3)
    v_mfma_f32_32x32x16_bf16 v[16:31], a[52:55], v[36:39], v[16:31]
    ds_read_b128 v[36:39], v2 offset:17408
    buffer_load_dwordx4 v1, s[4:7], s63 offen offset:2048 sc1 lds
    s_waitcnt lgkmcnt(3)
    v_mfma_f32_32x32x16_bf16 v[16:31], a[56:59], v[40:43], v[16:31]
    ds_read_b128 v[40:43], v2 offset:18432
    s_waitcnt lgkmcnt(3)
    v_mfma_f32_32x32x16_bf16 v[16:31], a[60:63], v[44:47], v[16:31]
    ds_read_b128 v[44:47], v2 offset:19456
    buffer_load_dwordx4 v1, s[4:7], s63 offen offset:3072 sc1 lds
    s_waitcnt lgkmcnt(3)
    v_mfma_f32_32x32x16_bf16 v[16:31], a[64:67], v[32:35], v[16:31]
    ds_read_b128 v[32:35], v2 offset:20480
    s_waitcnt lgkmcnt(3)
    v_mfma_f32_32x32x16_bf16 v[16:31], a[68:71], v[36:39], v[16:31]
    ds_read_b128 v[36:39], v2 offset:21504
    s_add_u32 m0, s64, 4096
    s_add_u32 s63, s71, 4096
    buffer_load_dwordx4 v1, s[4:7], s63 offen offset:0 sc1 lds
    s_waitcnt lgkmcnt(3)
    v_mfma_f32_32x32x16_bf16 v[16:31], a[72:75], v[40:43], v[16:31]
    ds_read_b128 v[40:43], v2 offset:22528
    s_waitcnt lgkmcnt(3)
    v_mfma_f32_32x32x16_bf16 v[16:31], a[76:79], v[44:47], v[16:31]
    ds_read_b128 v[44:47], v2 offset:23552
    buffer_load_dwordx4 v1, s[4:7], s63 offen offset:1024 sc1 lds
    s_waitcnt lgkmcnt(3)
    v_mfma_f32_32x32x16_bf16 v[16:31], a[80:83], v[32:35], v[16:31]
    ds_read_b128 v[32:35], v2 offset:24576
    s_waitcnt lgkmcnt(3)
    v_mfma_f32_32x32x16_bf16 v[16:31], a[84:87], v[36:39], v[16:31]
    ds_read_b128 v[36:39], v2 offset:25600
    buffer_load_dwordx4 v1, s[4:7], s63 offen offset:2048 sc1 lds
    s_waitcnt lgkmcnt(3)
    v_mfma_f32_32x32x16_bf16 v[16:31], a[88:91], v[40:43], v[16:31]
    ds_read_b128 v[40:43], v2 offset:26624
    s_waitcnt lgkmcnt(3)
    v_mfma_f32_32x32x16_bf16 v[16:31], a[92:95], v[44:47], v[16:31]
    ds_read_b128 v[44:47], v2 offset:27648
    buffer_load_dwordx4 v1, s[4:7], s63 offen offset:3072 sc1 lds
    s_waitcnt lgkmcnt(3)
    v_mfma_f32_32x32x16_bf16 v[16:31], a[96:99], v[32:35], v[16:31]
    ds_read_b128 v[32:35], v2 offset:28672
    s_waitcnt lgkmcnt(3)
    v_mfma_f32_32x32x16_bf16 v[16:31], a[100:103], v[36:39], v[16:31]
    ds_read_b128 v[36:39], v2 offset:29696
    s_add_u32 m0, s64, 8192
    s_add_u32 s63, s71, 8192
    buffer_load_dwordx4 v1, s[4:7], s63 offen offset:0 sc1 lds
    s_waitcnt lgkmcnt(3)
    v_mfma_f32_32x32x16_bf16 v[16:31], a[104:107], v[40:43], v[16:31]
    ds_read_b128 v[40:43], v2 offset:30720
    s_waitcnt lgkmcnt(3)
    v_mfma_f32_32x32x16_bf16 v[16:31], a[108:111], v[44:47], v[16:31]
    ds_read_b128 v[44:47], v2 offset:31744
    buffer_load_dwordx4 v1, s[4:7], s63 offen offset:1024 sc1 lds
    s_add_u32 s71, s71, 40960
    s_add_u32 s70, s70, 40960
    s_cmp_ge_u32 s70, 81920
    s_cselect_b32 s70, 0, s70
    s_waitcnt lgkmcnt(3)
    v_mfma_f32_32x32x16_bf16 v[16:31], a[112:115], v[32:35], v[16:31]
    ds_read_b128 v[32:35], v2 offset:32768
    s_waitcnt lgkmcnt(3)
    v_mfma_f32_32x32x16_bf16 v[16:31], a[116:119], v[36:39], v[16:31]
    ds_read_b128 v[36:39], v2 offset:33792
    s_waitcnt lgkmcnt(3)
    v_mfma_f32_32x32x16_bf16 v[16:31], a[120:123], v[40:43], v[16:31]
    ds_read_b128 v[40:43], v2 offset:34816
    s_waitcnt lgkmcnt(3)
    v_mfma_f32_32x32x16_bf16 v[16:31], a[124:127], v[44:47], v[16:31]
    ds_read_b128 v[44:47], v2 offset:35840
    s_waitcnt lgkmcnt(3)
    v_mfma_f32_32x32x16_bf16 v[16:31], a[128:131], v[32:35], v[16:31]
    ds_read_b128 v[32:35], v2 offset:36864
    s_waitcnt lgkmcnt(3)
    v_mfma_f32_32x32x16_bf16 v[16:31], a[132:135], v[36:39], v[16:31]
    ds_read_b128 v[36:39], v2 offset:37888
    s_waitcnt lgkmcnt(3)
    v_mfma_f32_32x32x16_bf16 v[16:31], a[136:139], v[40:43], v[16:31]
    ds_read_b128 v[40:43], v2 offset:38912
    s_waitcnt lgkmcnt(3)
    v_mfma_f32_32x32x16_bf16 v[16:31], a[140:143], v[44:47], v[16:31]
    ds_read_b128 v[44:47], v2 offset:39936
    s_waitcnt lgkmcnt(3)
    v_mfma_f32_32x32x16_bf16 v[16:31], a[144:147], v[32:35], v[16:31]
    s_waitcnt lgkmcnt(2)
    v_mfma_f32_32x32x16_bf16 v[16:31], a[148:151], v[36:39], v[16:31]
    s_waitcnt lgkmcnt(1)
    v_mfma_f32_32x32x16_bf16 v[16:31], a[152:155], v[40:43], v[16:31]
    s_waitcnt lgkmcnt(0)
    v_mfma_f32_32x32x16_bf16 v[16:31], a[156:159], v[44:47], v[16:31]
    s_add_u32 s74, s74, 40960
    s_cmp_ge_u32 s74, 81920
    s_cselect_b32 s74, 0, s74
    s_nop 8
    v_cvt_pk_bf16_f32 v164, v16, v17
    v_cvt_pk_bf16_f32 v165, v18, v19
    v_cvt_pk_bf16_f32 v166, v20, v21
    v_cvt_pk_bf16_f32 v167, v22, v23
    ds_write_b128 v3, v[164:167] offset:0
    v_cvt_pk_bf16_f32 v168, v24, v25
    v_cvt_pk_bf16_f32 v169, v26, v27
    v_cvt_pk_bf16_f32 v170, v28, v29
    v_cvt_pk_bf16_f32 v171, v30, v31
    ds_write_b128 v3, v[168:171] offset:512
    s_waitcnt lgkmcnt(0)
    s_waitcnt vmcnt(10)
    s_barrier
    ds_read_b128 v[112:115], v5 offset:32768
    ds_read_b128 v[116:119], v5 offset:33792
    ds_read_b128 v[120:123], v5 offset:34816
    ds_read_b128 v[124:127], v5 offset:35840
    ds_read_b128 v[128:131], v7 offset:0
    ds_read_b128 v[132:135], v7 offset:1024
    s_waitcnt lgkmcnt(5)
    v_mfma_f32_16x16x32_bf16 v[144:147], v[112:115], v[48:51], 0
    s_waitcnt lgkmcnt(4)
    v_mfma_f32_16x16x32_bf16 v[144:147], v[116:119], v[52:55], v[144:147]
    s_waitcnt lgkmcnt(3)
    v_mfma_f32_16x16x32_bf16 v[144:147], v[120:123], v[56:59], v[144:147]
    s_waitcnt lgkmcnt(2)
    v_mfma_f32_16x16x32_bf16 v[144:147], v[124:127], v[60:63], v[144:147]
    v_max3_f32 v172, v136, v137, v138
    v_max3_f32 v173, v139, v140, v141
    v_max3_f32 v172, v172, v142, v143
    s_nop 4
    v_max3_f32 v173, v173, v144, v145
    v_max_f32 v172, v172, v173
    v_mov_b32 v173, v172
    s_nop 1
    v_permlane16_swap_b32 v172, v173
    v_max_f32 v172, v172, v173
    v_mov_b32 v173, v172
    s_nop 1
    v_permlane32_swap_b32 v172, v173
    v_max_f32 v172, v172, v173
    v_mul_f32 v172, s78, v172
    v_fma_f32 v136, v136, s78, -v172
    v_fma_f32 v137, v137, s78, -v172
    v_fma_f32 v138, v138, s78, -v172
    v_fma_f32 v139, v139, s78, -v172
    v_fma_f32 v140, v140, s78, -v172
    v_fma_f32 v141, v141, s78, -v172
    v_fma_f32 v142, v142, s78, -v172
    v_fma_f32 v143, v143, s78, -v172
    v_fma_f32 v144, v144, s78, -v172
    v_fma_f32 v145, v145, s78, -v172
    v_exp_f32 v136, v136
    v_exp_f32 v137, v137
    v_exp_f32 v138, v138
    v_exp_f32 v139, v139
    v_cvt_pk_bf16_f32 v164, v136, v137
    v_exp_f32 v140, v140
    v_exp_f32 v141, v141
    v_cvt_pk_bf16_f32 v165, v138, v139
    v_exp_f32 v142, v142
    v_exp_f32 v143, v143
    v_cvt_pk_bf16_f32 v166, v140, v141
    v_exp_f32 v144, v144
    v_exp_f32 v145, v145
    v_cvt_pk_bf16_f32 v167, v142, v143
    v_cvt_pk_bf16_f32 v168, v144, v145
    v_cvt_pk_bf16_f32 v169, v144, v145
    s_waitcnt lgkmcnt(0)
    v_mfma_f32_16x16x32_bf16 v[148:151], v[96:99], v[164:167], 0
    v_mfma_f32_16x16x32_bf16 v[152:155], v[100:103], v[164:167], 0
    v_mfma_f32_16x16x32_bf16 v[156:159], v[104:107], v[164:167], 0
    v_mfma_f32_16x16x32_bf16 v[160:163], v[108:111], v[164:167], 0
    s_nop 2
    v_mfma_f32_16x16x16_bf16 v[148:151], v[128:129], v[168:169], v[148:151]
    s_nop 2
    v_mfma_f32_16x16x16_bf16 v[152:155], v[130:131], v[168:169], v[152:155]
    s_nop 2
    v_mfma_f32_16x16x16_bf16 v[156:159], v[132:133], v[168:169], v[156:159]
    s_nop 2
    v_mfma_f32_16x16x16_bf16 v[160:163], v[134:135], v[168:169], v[160:163]
    v_pk_add_f32 v[136:137], v[136:137], v[138:139]
    v_pk_add_f32 v[140:141], v[140:141], v[142:143]
    v_pk_add_f32 v[136:137], v[136:137], v[144:145]
    v_pk_add_f32 v[136:137], v[136:137], v[140:141]
    v_add_f32 v172, v136, v137
    v_mov_b32 v173, v172
    s_nop 1
    v_permlane16_swap_b32 v172, v173
    v_add_f32 v172, v172, v173
    v_mov_b32 v173, v172
    s_nop 1
    v_permlane32_swap_b32 v172, v173
    v_add_f32 v172, v172, v173
    v_rcp_f32 v172, v172
    s_nop 0
    v_pk_mul_f32 v[148:149], v[148:149], v[172:173] op_sel_hi:[1,0]
    v_pk_mul_f32 v[150:151], v[150:151], v[172:173] op_sel_hi:[1,0]
    v_pk_mul_f32 v[152:153], v[152:153], v[172:173] op_sel_hi:[1,0]
    v_pk_mul_f32 v[154:155], v[154:155], v[172:173] op_sel_hi:[1,0]
    v_pk_mul_f32 v[156:157], v[156:157], v[172:173] op_sel_hi:[1,0]
    v_pk_mul_f32 v[158:159], v[158:159], v[172:173] op_sel_hi:[1,0]
    v_pk_mul_f32 v[160:161], v[160:161], v[172:173] op_sel_hi:[1,0]
    v_pk_mul_f32 v[162:163], v[162:163], v[172:173] op_sel_hi:[1,0]
    v_cvt_pk_bf16_f32 v136, v148, v149
    v_cvt_pk_bf16_f32 v137, v150, v151
    v_cvt_pk_bf16_f32 v138, v152, v153
    v_cvt_pk_bf16_f32 v139, v154, v155
    buffer_store_dwordx4 v[136:139], v12, s[4:7], s72 offen offset:0 sc1
    v_cvt_pk_bf16_f32 v140, v156, v157
    v_cvt_pk_bf16_f32 v141, v158, v159
    v_cvt_pk_bf16_f32 v142, v160, v161
    v_cvt_pk_bf16_f32 v143, v162, v163
    buffer_store_dwordx4 v[140:143], v12, s[4:7], s72 offen offset:2048 sc1
    s_add_u32 s72, s72, 262144
    s_add_u32 s61, s61, 1
    ds_read_b128 v[64:67], v5 offset:16384
    ds_read_b128 v[68:71], v5 offset:17408
    ds_read_b128 v[72:75], v5 offset:18432
    ds_read_b128 v[76:79], v5 offset:19456
    ds_read_b128 v[80:83], v5 offset:20480
    ds_read_b128 v[84:87], v5 offset:21504
    ds_read_b128 v[88:91], v5 offset:22528
    ds_read_b128 v[92:95], v5 offset:23552
    ds_read_b128 v[96:99], v6 offset:16384
    ds_read_b128 v[100:103], v6 offset:17408
    ds_read_b128 v[104:107], v6 offset:18432
    ds_read_b128 v[108:111], v6 offset:19456
    s_waitcnt lgkmcnt(11)
    v_mfma_f32_16x16x32_bf16 v[136:139], v[64:67], v[176:179], 0
    s_waitcnt lgkmcnt(10)
    v_mfma_f32_16x16x32_bf16 v[136:139], v[68:71], v[180:183], v[136:139]
    s_waitcnt lgkmcnt(9)
    v_mfma_f32_16x16x32_bf16 v[136:139], v[72:75], v[184:187], v[136:139]
    s_waitcnt lgkmcnt(8)
    v_mfma_f32_16x16x32_bf16 v[136:139], v[76:79], v[188:191], v[136:139]
    s_waitcnt lgkmcnt(7)
    v_mfma_f32_16x16x32_bf16 v[140:143], v[80:83], v[176:179], 0
    s_waitcnt lgkmcnt(6)
    v_mfma_f32_16x16x32_bf16 v[140:143], v[84:87], v[180:183], v[140:143]
    s_waitcnt lgkmcnt(5)
    v_mfma_f32_16x16x32_bf16 v[140:143], v[88:91], v[184:187], v[140:143]
    s_waitcnt lgkmcnt(4)
    v_mfma_f32_16x16x32_bf16 v[140:143], v[92:95], v[188:191], v[140:143]
    ds_read_b128 v[48:51], v4 offset:0
    ds_read_b128 v[52:55], v4 offset:1024
    ds_read_b128 v[56:59], v4 offset:2048
    ds_read_b128 v[60:63], v4 offset:3072
    s_add_u32 s65, s61, 2
    s_cmp_ge_u32 s68, s65
    s_cbranch_scc1 L_hv_160
    s_mov_b32 s60, 0
L_pf_161:
    buffer_load_dword v9, v10, s[4:7], 0 offen sc1
    s_waitcnt vmcnt(0)
    v_cmp_gt_u32 vcc, s65, v9
    s_nop 0
    s_cbranch_vccz L_pfd_162
    s_sleep 1
    s_add_u32 s60, s60, 1
    s_cmp_lt_u32 s60, 0x100000
    s_cbranch_scc1 L_pf_161
    s_movk_i32 s62, 9
    s_branch L_ABORT
L_pfd_162:
    v_readlane_b32 s68, v9, 0
    v_readlane_b32 s62, v9, 1
    s_nop 0
    s_min_u32 s68, s68, s62
L_hv_160:
    s_add_u32 s69, s61, 1
    s_cmp_ge_u32 s79, s69
    s_cbranch_scc1 L_hm_163
    s_mov_b32 s60, 0
L_pf_164:
    buffer_load_dword v9, v11, s[4:7], 0 offen sc1
    s_waitcnt vmcnt(0)
    v_cmp_gt_u32 vcc, s69, v9
    s_nop 0
    s_cbranch_vccz L_pfd_165
    s_sleep 1
    s_add_u32 s60, s60, 1
    s_cmp_lt_u32 s60, 0x100000
    s_cbranch_scc1 L_pf_164
    s_movk_i32 s62, 10
    s_branch L_ABORT
L_pfd_165:
    v_readlane_b32 s79, v9, 0
    v_readlane_b32 s62, v9, 1
    s_nop 0
    s_min_u32 s79, s79, s62
    v_readlane_b32 s62, v9, 2
    s_nop 0
    s_min_u32 s79, s79, s62
    v_readlane_b32 s62, v9, 3
    s_nop 0
    s_min_u32 s79, s79, s62
    v_readlane_b32 s62, v9, 4
    s_nop 0
    s_min_u32 s79, s79, s62
    v_readlane_b32 s62, v9, 5
    s_nop 0
    s_min_u32 s79, s79, s62
    v_readlane_b32 s62, v9, 6
    s_nop 0
    s_min_u32 s79, s79, s62
    v_readlane_b32 s62, v9, 7
    s_nop 0
    s_min_u32 s79, s79, s62
L_hm_163:
    s_add_u32 m0, s57, 131072
    s_nop 0
    buffer_load_dwordx4 v1, s[4:7], s76 offen offset:0 sc1 lds
    s_add_u32 m0, s57, 135168
    s_nop 0
    buffer_load_dwordx4 v1, s[4:7], s77 offen offset:0 sc1 lds
    s_add_u32 s76, s76, 131072
    s_add_u32 s77, s77, 131072
    s_bitcmp1_b32 s44, 0
    s_cbranch_scc1 L_m1_166
    v_cndmask_b32 v136, v13, v136, s[80:81]
    v_mov_b32 v140, v13
    v_cndmask_b32 v137, v13, v137, s[82:83]
    v_mov_b32 v141, v13
    v_cndmask_b32 v138, v13, v138, s[84:85]
    v_mov_b32 v142, v13
    v_cndmask_b32 v139, v13, v139, s[86:87]
    v_mov_b32 v143, v13
    s_branch L_me_167
L_m1_166:
    v_cndmask_b32 v140, v13, v140, s[80:81]
    v_cndmask_b32 v141, v13, v141, s[82:83]
    v_cndmask_b32 v142, v13, v142, s[84:85]
    v_cndmask_b32 v143, v13, v143, s[86:87]
L_me_167:
    s_waitcnt vmcnt(2) lgkmcnt(0)
    s_barrier
    s_cmp_lg_u32 s44, 0
    s_cbranch_scc1 L_np_168
    v_mov_b32 v9, s61
    s_mov_b64 exec, 1
    buffer_store_dword v9, off, s[4:7], s73 sc1
    s_mov_b64 exec, -1
L_np_168:
    v_add_u32 v2, s74, v1
    ds_read_b128 v[32:35], v2 offset:0
    ds_read_b128 v[36:39], v2 offset:1024
    ds_read_b128 v[40:43], v2 offset:2048
    ds_read_b128 v[44:47], v2 offset:3072
    s_waitcnt lgkmcnt(3)
    v_mfma_f32_32x32x16_bf16 v[16:31], a[0:3], v[32:35], 0
    ds_read_b128 v[32:35], v2 offset:4096
    s_waitcnt lgkmcnt(3)
    v_mfma_f32_32x32x16_bf16 v[16:31], a[4:7], v[36:39], v[16:31]
    ds_read_b128 v[36:39], v2 offset:5120
    s_add_u32 m0, s56, 90112
    s_add_u32 s66, s75, 0x1000000
    buffer_load_dwordx4 v1, s[4:7], s75 offen offset:0 sc1 lds
    s_waitcnt lgkmcnt(3)
    v_mfma_f32_32x32x16_bf16 v[16:31], a[8:11], v[40:43], v[16:31]
    ds_read_b128 v[40:43], v2 offset:6144
    s_waitcnt lgkmcnt(3)
    v_mfma_f32_32x32x16_bf16 v[16:31], a[12:15], v[44:47], v[16:31]
    ds_read_b128 v[44:47], v2 offset:7168
    buffer_load_dwordx4 v1, s[4:7], s75 offen offset:1024 sc1 lds
    s_waitcnt lgkmcnt(3)
    v_mfma_f32_32x32x16_bf16 v[16:31], a[16:19], v[32:35], v[16:31]
    ds_read_b128 v[32:35], v2 offset:8192
    s_waitcnt lgkmcnt(3)
    v_mfma_f32_32x32x16_bf16 v[16:31], a[20:23], v[36:39], v[16:31]
    ds_read_b128 v[36:39], v2 offset:9216
    s_add_u32 m0, s56, 98304
    s_add_u32 s75, s75, 262144
    buffer_load_dwordx4 v1, s[4:7], s66 offen offset:0 sc1 lds
    s_waitcnt lgkmcnt(3)
    v_mfma_f32_32x32x16_bf16 v[16:31], a[24:27], v[40:43], v[16:31]
    ds_read_b128 v[40:43], v2 offset:10240
    s_waitcnt lgkmcnt(3)
    v_mfma_f32_32x32x16_bf16 v[16:31], a[28:31], v[44:47], v[16:31]
    ds_read_b128 v[44:47], v2 offset:11264
    buffer_load_dwordx4 v1, s[4:7], s66 offen offset:1024 sc1 lds
    s_waitcnt lgkmcnt(3)
    v_mfma_f32_32x32x16_bf16 v[16:31], a[32:35], v[32:35], v[16:31]
    ds_read_b128 v[32:35], v2 offset:12288
    s_waitcnt lgkmcnt(3)
    v_mfma_f32_32x32x16_bf16 v[16:31], a[36:39], v[36:39], v[16:31]
    ds_read_b128 v[36:39], v2 offset:13312
    s_add_u32 s64, s70, s67
    s_add_u32 m0, s64, 0
    s_add_u32 s63, s71, 0
    buffer_load_dwordx4 v1, s[4:7], s63 offen offset:0 sc1 lds
    s_waitcnt lgkmcnt(3)
    v_mfma_f32_32x32x16_bf16 v[16:31], a[40:43], v[40:43], v[16:31]
    ds_read_b128 v[40:43], v2 offset:14336
    s_waitcnt lgkmcnt(3)
    v_mfma_f32_32x32x16_bf16 v[16:31], a[44:47], v[44:47], v[16:31]
    ds_read_b128 v[44:47], v2 offset:15360
    buffer_load_dwordx4 v1, s[4:7], s63 offen offset:1024 sc1 lds
    s_waitcnt lgkmcnt(3)
    v_mfma_f32_32x32x16_bf16 v[16:31], a[48:51], v[32:35], v[16:31]
    ds_read_b128 v[32:35], v2 offset:16384
    s_waitcnt lgkmcnt(3)
    v_mfma_f32_32x32x16_bf16 v[16:31], a[52:55], v[36:39], v[16:31]
    ds_read_b128 v[36:39], v2 offset:17408
    buffer_load_dwordx4 v1, s[4:7], s63 offen offset:2048 sc1 lds
    s_waitcnt lgkmcnt(3)
    v_mfma_f32_32x32x16_bf16 v[16:31], a[56:59], v[40:43], v[16:31]
    ds_read_b128 v[40:43], v2 offset:18432
    s_waitcnt lgkmcnt(3)
    v_mfma_f32_32x32x16_bf16 v[16:31], a[60:63], v[44:47], v[16:31]
    ds_read_b128 v[44:47], v2 offset:19456
    buffer_load_dwordx4 v1, s[4:7], s63 offen offset:3072 sc1 lds
    s_waitcnt lgkmcnt(3)
    v_mfma_f32_32x32x16_bf16 v[16:31], a[64:67], v[32:35], v[16:31]
    ds_read_b128 v[32:35], v2 offset:20480
    s_waitcnt lgkmcnt(3)
    v_mfma_f32_32x32x16_bf16 v[16:31], a[68:71], v[36:39], v[16:31]
    ds_read_b128 v[36:39], v2 offset:21504
    s_add_u32 m0, s64, 4096
    s_add_u32 s63, s71, 4096
    buffer_load_dwordx4 v1, s[4:7], s63 offen offset:0 sc1 lds
    s_waitcnt lgkmcnt(3)
    v_mfma_f32_32x32x16_bf16 v[16:31], a[72:75], v[40:43], v[16:31]
    ds_read_b128 v[40:43], v2 offset:22528
    s_waitcnt lgkmcnt(3)
    v_mfma_f32_32x32x16_bf16 v[16:31], a[76:79], v[44:47], v[16:31]
    ds_read_b128 v[44:47], v2 offset:23552
    buffer_load_dwordx4 v1, s[4:7], s63 offen offset:1024 sc1 lds
    s_waitcnt lgkmcnt(3)
    v_mfma_f32_32x32x16_bf16 v[16:31], a[80:83], v[32:35], v[16:31]
    ds_read_b128 v[32:35], v2 offset:24576
    s_waitcnt lgkmcnt(3)
    v_mfma_f32_32x32x16_bf16 v[16:31], a[84:87], v[36:39], v[16:31]
    ds_read_b128 v[36:39], v2 offset:25600
    buffer_load_dwordx4 v1, s[4:7], s63 offen offset:2048 sc1 lds
    s_waitcnt lgkmcnt(3)
    v_mfma_f32_32x32x16_bf16 v[16:31], a[88:91], v[40:43], v[16:31]
    ds_read_b128 v[40:43], v2 offset:26624
    s_waitcnt lgkmcnt(3)
    v_mfma_f32_32x32x16_bf16 v[16:31], a[92:95], v[44:47], v[16:31]
    ds_read_b128 v[44:47], v2 offset:27648
    buffer_load_dwordx4 v1, s[4:7], s63 offen offset:3072 sc1 lds
    s_waitcnt lgkmcnt(3)
    v_mfma_f32_32x32x16_bf16 v[16:31], a[96:99], v[32:35], v[16:31]
    ds_read_b128 v[32:35], v2 offset:28672
    s_waitcnt lgkmcnt(3)
    v_mfma_f32_32x32x16_bf16 v[16:31], a[100:103], v[36:39], v[16:31]
    ds_read_b128 v[36:39], v2 offset:29696
    s_add_u32 m0, s64, 8192
    s_add_u32 s63, s71, 8192
    buffer_load_dwordx4 v1, s[4:7], s63 offen offset:0 sc1 lds
    s_waitcnt lgkmcnt(3)
    v_mfma_f32_32x32x16_bf16 v[16:31], a[104:107], v[40:43], v[16:31]
    ds_read_b128 v[40:43], v2 offset:30720
    s_waitcnt lgkmcnt(3)
    v_mfma_f32_32x32x16_bf16 v[16:31], a[108:111], v[44:47], v[16:31]
    ds_read_b128 v[44:47], v2 offset:31744
    buffer_load_dwordx4 v1, s[4:7], s63 offen offset:1024 sc1 lds
    s_add_u32 s71, s71, 40960
    s_add_u32 s70, s70, 40960
    s_cmp_ge_u32 s70, 81920
    s_cselect_b32 s70, 0, s70
    s_waitcnt lgkmcnt(3)
    v_mfma_f32_32x32x16_bf16 v[16:31], a[112:115], v[32:35], v[16:31]
    ds_read_b128 v[32:35], v2 offset:32768
    s_waitcnt lgkmcnt(3)
    v_mfma_f32_32x32x16_bf16 v[16:31], a[116:119], v[36:39], v[16:31]
    ds_read_b128 v[36:39], v2 offset:33792
    s_waitcnt lgkmcnt(3)
    v_mfma_f32_32x32x16_bf16 v[16:31], a[120:123], v[40:43], v[16:31]
    ds_read_b128 v[40:43], v2 offset:34816
    s_waitcnt lgkmcnt(3)
    v_mfma_f32_32x32x16_bf16 v[16:31], a[124:127], v[44:47], v[16:31]
    ds_read_b128 v[44:47], v2 offset:35840
    s_waitcnt lgkmcnt(3)
    v_mfma_f32_32x32x16_bf16 v[16:31], a[128:131], v[32:35], v[16:31]
    ds_read_b128 v[32:35], v2 offset:36864
    s_waitcnt lgkmcnt(3)
    v_mfma_f32_32x32x16_bf16 v[16:31], a[132:135], v[36:39], v[16:31]
    ds_read_b128 v[36:39], v2 offset:37888
    s_waitcnt lgkmcnt(3)
    v_mfma_f32_32x32x16_bf16 v[16:31], a[136:139], v[40:43], v[16:31]
    ds_read_b128 v[40:43], v2 offset:38912
    s_waitcnt lgkmcnt(3)
    v_mfma_f32_32x32x16_bf16 v[16:31], a[140:143], v[44:47], v[16:31]
    ds_read_b128 v[44:47], v2 offset:39936
    s_waitcnt lgkmcnt(3)
    v_mfma_f32_32x32x16_bf16 v[16:31], a[144:147], v[32:35], v[16:31]
    s_waitcnt lgkmcnt(2)
    v_mfma_f32_32x32x16_bf16 v[16:31], a[148:151], v[36:39], v[16:31]
    s_waitcnt lgkmcnt(1)
    v_mfma_f32_32x32x16_bf16 v[16:31], a[152:155], v[40:43], v[16:31]
    s_waitcnt lgkmcnt(0)
    v_mfma_f32_32x32x16_bf16 v[16:31], a[156:159], v[44:47], v[16:31]
    s_add_u32 s74, s74, 40960
    s_cmp_ge_u32 s74, 81920
    s_cselect_b32 s74, 0, s74
    s_nop 8
    v_cvt_pk_bf16_f32 v164, v16, v17
    v_cvt_pk_bf16_f32 v165, v18, v19
    v_cvt_pk_bf16_f32 v166, v20, v21
    v_cvt_pk_bf16_f32 v167, v22, v23
    ds_write_b128 v3, v[164:167] offset:0
    v_cvt_pk_bf16_f32 v168, v24, v25
    v_cvt_pk_bf16_f32 v169, v26, v27
    v_cvt_pk_bf16_f32 v170, v28, v29
    v_cvt_pk_bf16_f32 v171, v30, v31
    ds_write_b128 v3, v[168:171] offset:512
    s_waitcnt lgkmcnt(0)
    s_waitcnt vmcnt(10)
    s_barrier
    ds_read_b128 v[112:115], v5 offset:40960
    ds_read_b128 v[116:119], v5 offset:41984
    ds_read_b128 v[120:123], v5 offset:43008
    ds_read_b128 v[124:127], v5 offset:44032
    ds_read_b128 v[128:131], v7 offset:8192
    ds_read_b128 v[132:135], v7 offset:9216
    s_waitcnt lgkmcnt(5)
    v_mfma_f32_16x16x32_bf16 v[144:147], v[112:115], v[176:179], 0
    s_waitcnt lgkmcnt(4)
    v_mfma_f32_16x16x32_bf16 v[144:147], v[116:119], v[180:183], v[144:147]
    s_waitcnt lgkmcnt(3)
    v_mfma_f32_16x16x32_bf16 v[144:147], v[120:123], v[184:187], v[144:147]
    s_waitcnt lgkmcnt(2)
    v_mfma_f32_16x16x32_bf16 v[144:147], v[124:127], v[188:191], v[144:147]
    v_max3_f32 v172, v136, v137, v138
    v_max3_f32 v173, v139, v140, v141
    v_max3_f32 v172, v172, v142, v143
    s_nop 4
    v_max3_f32 v173, v173, v144, v145
    v_max_f32 v172, v172, v173
    v_mov_b32 v173, v172
    s_nop 1
    v_permlane16_swap_b32 v172, v173
    v_max_f32 v172, v172, v173
    v_mov_b32 v173, v172
    s_nop 1
    v_permlane32_swap_b32 v172, v173
    v_max_f32 v172, v172, v173
    v_mul_f32 v172, s78, v172
    v_fma_f32 v136, v136, s78, -v172
    v_fma_f32 v137, v137, s78, -v172
    v_fma_f32 v138, v138, s78, -v172
    v_fma_f32 v139, v139, s78, -v172
    v_fma_f32 v140, v140, s78, -v172
    v_fma_f32 v141, v141, s78, -v172
    v_fma_f32 v142, v142, s78, -v172
    v_fma_f32 v143, v143, s78, -v172
    v_fma_f32 v144, v144, s78, -v172
    v_fma_f32 v145, v145, s78, -v172
    v_exp_f32 v136, v136
    v_exp_f32 v137, v137
    v_exp_f32 v138, v138
    v_exp_f32 v139, v139
    v_cvt_pk_bf16_f32 v164, v136, v137
    v_exp_f32 v140, v140
    v_exp_f32 v141, v141
    v_cvt_pk_bf16_f32 v165, v138, v139
    v_exp_f32 v142, v142
    v_exp_f32 v143, v143
    v_cvt_pk_bf16_f32 v166, v140, v141
    v_exp_f32 v144, v144
    v_exp_f32 v145, v145
    v_cvt_pk_bf16_f32 v167, v142, v143
    v_cvt_pk_bf16_f32 v168, v144, v145
    v_cvt_pk_bf16_f32 v169, v144, v145
    s_waitcnt lgkmcnt(0)
    v_mfma_f32_16x16x32_bf16 v[148:151], v[96:99], v[164:167], 0
    v_mfma_f32_16x16x32_bf16 v[152:155], v[100:103], v[164:167], 0
    v_mfma_f32_16x16x32_bf16 v[156:159], v[104:107], v[164:167], 0
    v_mfma_f32_16x16x32_bf16 v[160:163], v[108:111], v[164:167], 0
    s_nop 2
    v_mfma_f32_16x16x16_bf16 v[148:151], v[128:129], v[168:169], v[148:151]
    s_nop 2
    v_mfma_f32_16x16x16_bf16 v[152:155], v[130:131], v[168:169], v[152:155]
    s_nop 2
    v_mfma_f32_16x16x16_bf16 v[156:159], v[132:133], v[168:169], v[156:159]
    s_nop 2
    v_mfma_f32_16x16x16_bf16 v[160:163], v[134:135], v[168:169], v[160:163]
    v_pk_add_f32 v[136:137], v[136:137], v[138:139]
    v_pk_add_f32 v[140:141], v[140:141], v[142:143]
    v_pk_add_f32 v[136:137], v[136:137], v[144:145]
    v_pk_add_f32 v[136:137], v[136:137], v[140:141]
    v_add_f32 v172, v136, v137
    v_mov_b32 v173, v172
    s_nop 1
    v_permlane16_swap_b32 v172, v173
    v_add_f32 v172, v172, v173
    v_mov_b32 v173, v172
    s_nop 1
    v_permlane32_swap_b32 v172, v173
    v_add_f32 v172, v172, v173
    v_rcp_f32 v172, v172
    s_nop 0
    v_pk_mul_f32 v[148:149], v[148:149], v[172:173] op_sel_hi:[1,0]
    v_pk_mul_f32 v[150:151], v[150:151], v[172:173] op_sel_hi:[1,0]
    v_pk_mul_f32 v[152:153], v[152:153], v[172:173] op_sel_hi:[1,0]
    v_pk_mul_f32 v[154:155], v[154:155], v[172:173] op_sel_hi:[1,0]
    v_pk_mul_f32 v[156:157], v[156:157], v[172:173] op_sel_hi:[1,0]
    v_pk_mul_f32 v[158:159], v[158:159], v[172:173] op_sel_hi:[1,0]
    v_pk_mul_f32 v[160:161], v[160:161], v[172:173] op_sel_hi:[1,0]
    v_pk_mul_f32 v[162:163], v[162:163], v[172:173] op_sel_hi:[1,0]
    v_cvt_pk_bf16_f32 v136, v148, v149
    v_cvt_pk_bf16_f32 v137, v150, v151
    v_cvt_pk_bf16_f32 v138, v152, v153
    v_cvt_pk_bf16_f32 v139, v154, v155
    buffer_store_dwordx4 v[136:139], v12, s[4:7], s72 offen offset:0 sc1
    v_cvt_pk_bf16_f32 v140, v156, v157
    v_cvt_pk_bf16_f32 v141, v158, v159
    v_cvt_pk_bf16_f32 v142, v160, v161
    v_cvt_pk_bf16_f32 v143, v162, v163
    buffer_store_dwordx4 v[140:143], v12, s[4:7], s72 offen offset:2048 sc1
    s_add_u32 s72, s72, 262144
    s_add_u32 s61, s61, 1
    s_cmp_lt_u32 s61, 62
    s_cbranch_scc1 L_QA_LOOP
    ds_read_b128 v[64:67], v5 offset:0
    ds_read_b128 v[68:71], v5 offset:1024
    ds_read_b128 v[72:75], v5 offset:2048
    ds_read_b128 v[76:79], v5 offset:3072
    ds_read_b128 v[80:83], v5 offset:4096
    ds_read_b128 v[84:87], v5 offset:5120
    ds_read_b128 v[88:91], v5 offset:6144
    ds_read_b128 v[92:95], v5 offset:7168
    ds_read_b128 v[96:99], v6 offset:0
    ds_read_b128 v[100:103], v6 offset:1024
    ds_read_b128 v[104:107], v6 offset:2048
    ds_read_b128 v[108:111], v6 offset:3072
    s_waitcnt lgkmcnt(11)
    v_mfma_f32_16x16x32_bf16 v[136:139], v[64:67], v[48:51], 0
    s_waitcnt lgkmcnt(10)
    v_mfma_f32_16x16x32_bf16 v[136:139], v[68:71], v[52:55], v[136:139]
    s_waitcnt lgkmcnt(9)
    v_mfma_f32_16x16x32_bf16 v[136:139], v[72:75], v[56:59], v[136:139]
    s_waitcnt lgkmcnt(8)
    v_mfma_f32_16x16x32_bf16 v[136:139], v[76:79], v[60:63], v[136:139]
    s_waitcnt lgkmcnt(7)
    v_mfma_f32_16x16x32_bf16 v[140:143], v[80:83], v[48:51], 0
    s_waitcnt lgkmcnt(6)
    v_mfma_f32_16x16x32_bf16 v[140:143], v[84:87], v[52:55], v[140:143]
    s_waitcnt lgkmcnt(5)
    v_mfma_f32_16x16x32_bf16 v[140:143], v[88:91], v[56:59], v[140:143]
    s_waitcnt lgkmcnt(4)
    v_mfma_f32_16x16x32_bf16 v[140:143], v[92:95], v[60:63], v[140:143]
    ds_read_b128 v[176:179], v4 offset:0
    ds_read_b128 v[180:183], v4 offset:1024
    ds_read_b128 v[184:187], v4 offset:2048
    ds_read_b128 v[188:191], v4 offset:3072
    s_add_u32 s65, s61, 2
    s_cmp_ge_u32 s68, s65
    s_cbranch_scc1 L_hv_169
    s_mov_b32 s60, 0
L_pf_170:
    buffer_load_dword v9, v10, s[4:7], 0 offen sc1
    s_waitcnt vmcnt(0)
    v_cmp_gt_u32 vcc, s65, v9
    s_nop 0
    s_cbranch_vccz L_pfd_171
    s_sleep 1
    s_add_u32 s60, s60, 1
    s_cmp_lt_u32 s60, 0x100000
    s_cbranch_scc1 L_pf_170
    s_movk_i32 s62, 9
    s_branch L_ABORT
L_pfd_171:
    v_readlane_b32 s68, v9, 0
    v_readlane_b32 s62, v9, 1
    s_nop 0
    s_min_u32 s68, s68, s62
L_hv_169:
    s_add_u32 s69, s61, 1
    s_cmp_ge_u32 s79, s69
    s_cbranch_scc1 L_hm_172
    s_mov_b32 s60, 0
L_pf_173:
    buffer_load_dword v9, v11, s[4:7], 0 offen sc1
    s_waitcnt vmcnt(0)
    v_cmp_gt_u32 vcc, s69, v9
    s_nop 0
    s_cbranch_vccz L_pfd_174
    s_sleep 1
    s_add_u32 s60, s60, 1
    s_cmp_lt_u32 s60, 0x100000
    s_cbranch_scc1 L_pf_173
    s_movk_i32 s62, 10
    s_branch L_ABORT
L_pfd_174:
    v_readlane_b32 s79, v9, 0
    v_readlane_b32 s62, v9, 1
    s_nop 0
    s_min_u32 s79, s79, s62
    v_readlane_b32 s62, v9, 2
    s_nop 0
    s_min_u32 s79, s79, s62
    v_readlane_b32 s62, v9, 3
    s_nop 0
    s_min_u32 s79, s79, s62
    v_readlane_b32 s62, v9, 4
    s_nop 0
    s_min_u32 s79, s79, s62
    v_readlane_b32 s62, v9, 5
    s_nop 0
    s_min_u32 s79, s79, s62
    v_readlane_b32 s62, v9, 6
    s_nop 0
    s_min_u32 s79, s79, s62
    v_readlane_b32 s62, v9, 7
    s_nop 0
    s_min_u32 s79, s79, s62
L_hm_172:
    s_add_u32 m0, s57, 122880
    s_nop 0
    buffer_load_dwordx4 v1, s[4:7], s76 offen offset:0 sc1 lds
    s_add_u32 m0, s57, 126976
    s_nop 0
    buffer_load_dwordx4 v1, s[4:7], s77 offen offset:0 sc1 lds
    s_add_u32 s76, s76, 131072
    s_add_u32 s77, s77, 131072
    s_bitcmp1_b32 s44, 0
    s_cbranch_scc1 L_m1_175
    v_cndmask_b32 v136, v13, v136, s[80:81]
    v_mov_b32 v140, v13
    v_cndmask_b32 v137, v13, v137, s[82:83]
    v_mov_b32 v141, v13
    v_cndmask_b32 v138, v13, v138, s[84:85]
    v_mov_b32 v142, v13
    v_cndmask_b32 v139, v13, v139, s[86:87]
    v_mov_b32 v143, v13
    s_branch L_me_176
L_m1_175:
    v_cndmask_b32 v140, v13, v140, s[80:81]
    v_cndmask_b32 v141, v13, v141, s[82:83]
    v_cndmask_b32 v142, v13, v142, s[84:85]
    v_cndmask_b32 v143, v13, v143, s[86:87]
L_me_176:
    s_waitcnt vmcnt(0) lgkmcnt(0)
    s_barrier
    s_cmp_lg_u32 s44, 0
    s_cbranch_scc1 L_np_177
    v_mov_b32 v9, s61
    s_mov_b64 exec, 1
    buffer_store_dword v9, off, s[4:7], s73 sc1
    s_mov_b64 exec, -1
L_np_177:
    s_add_u32 m0, s56, 106496
    s_add_u32 s66, s75, 0x1000000
    buffer_load_dwordx4 v1, s[4:7], s75 offen offset:0 sc1 lds
    buffer_load_dwordx4 v1, s[4:7], s75 offen offset:1024 sc1 lds
    s_add_u32 m0, s56, 114688
    s_add_u32 s75, s75, 262144
    buffer_load_dwordx4 v1, s[4:7], s66 offen offset:0 sc1 lds
    buffer_load_dwordx4 v1, s[4:7], s66 offen offset:1024 sc1 lds
    ds_read_b128 v[112:115], v5 offset:32768
    ds_read_b128 v[116:119], v5 offset:33792
    ds_read_b128 v[120:123], v5 offset:34816
    ds_read_b128 v[124:127], v5 offset:35840
    ds_read_b128 v[128:131], v7 offset:0
    ds_read_b128 v[132:135], v7 offset:1024
    s_waitcnt lgkmcnt(5)
    v_mfma_f32_16x16x32_bf16 v[144:147], v[112:115], v[48:51], 0
    s_waitcnt lgkmcnt(4)
    v_mfma_f32_16x16x32_bf16 v[144:147], v[116:119], v[52:55], v[144:147]
    s_waitcnt lgkmcnt(3)
    v_mfma_f32_16x16x32_bf16 v[144:147], v[120:123], v[56:59], v[144:147]
    s_waitcnt lgkmcnt(2)
    v_mfma_f32_16x16x32_bf16 v[144:147], v[124:127], v[60:63], v[144:147]
    v_max3_f32 v172, v136, v137, v138
    v_max3_f32 v173, v139, v140, v141
    v_max3_f32 v172, v172, v142, v143
    s_nop 4
    v_max3_f32 v173, v173, v144, v145
    v_max_f32 v172, v172, v173
    v_mov_b32 v173, v172
    s_nop 1
    v_permlane16_swap_b32 v172, v173
    v_max_f32 v172, v172, v173
    v_mov_b32 v173, v172
    s_nop 1
    v_permlane32_swap_b32 v172, v173
    v_max_f32 v172, v172, v173
    v_mul_f32 v172, s78, v172
    v_fma_f32 v136, v136, s78, -v172
    v_fma_f32 v137, v137, s78, -v172
    v_fma_f32 v138, v138, s78, -v172
    v_fma_f32 v139, v139, s78, -v172
    v_fma_f32 v140, v140, s78, -v172
    v_fma_f32 v141, v141, s78, -v172
    v_fma_f32 v142, v142, s78, -v172
    v_fma_f32 v143, v143, s78, -v172
    v_fma_f32 v144, v144, s78, -v172
    v_fma_f32 v145, v145, s78, -v172
    v_exp_f32 v136, v136
    v_exp_f32 v137, v137
    v_exp_f32 v138, v138
    v_exp_f32 v139, v139
    v_cvt_pk_bf16_f32 v164, v136, v137
    v_exp_f32 v140, v140
    v_exp_f32 v141, v141
    v_cvt_pk_bf16_f32 v165, v138, v139
    v_exp_f32 v142, v142
    v_exp_f32 v143, v143
    v_cvt_pk_bf16_f32 v166, v140, v141
    v_exp_f32 v144, v144
    v_exp_f32 v145, v145
    v_cvt_pk_bf16_f32 v167, v142, v143
    v_cvt_pk_bf16_f32 v168, v144, v145
    v_cvt_pk_bf16_f32 v169, v144, v145
    s_waitcnt lgkmcnt(0)
    v_mfma_f32_16x16x32_bf16 v[148:151], v[96:99], v[164:167], 0
    v_mfma_f32_16x16x32_bf16 v[152:155], v[100:103], v[164:167], 0
    v_mfma_f32_16x16x32_bf16 v[156:159], v[104:107], v[164:167], 0
    v_mfma_f32_16x16x32_bf16 v[160:163], v[108:111], v[164:167], 0
    s_nop 2
    v_mfma_f32_16x16x16_bf16 v[148:151], v[128:129], v[168:169], v[148:151]
    s_nop 2
    v_mfma_f32_16x16x16_bf16 v[152:155], v[130:131], v[168:169], v[152:155]
    s_nop 2
    v_mfma_f32_16x16x16_bf16 v[156:159], v[132:133], v[168:169], v[156:159]
    s_nop 2
    v_mfma_f32_16x16x16_bf16 v[160:163], v[134:135], v[168:169], v[160:163]
    v_pk_add_f32 v[136:137], v[136:137], v[138:139]
    v_pk_add_f32 v[140:141], v[140:141], v[142:143]
    v_pk_add_f32 v[136:137], v[136:137], v[144:145]
    v_pk_add_f32 v[136:137], v[136:137], v[140:141]
    v_add_f32 v172, v136, v137
    v_mov_b32 v173, v172
    s_nop 1
    v_permlane16_swap_b32 v172, v173
    v_add_f32 v172, v172, v173
    v_mov_b32 v173, v172
    s_nop 1
    v_permlane32_swap_b32 v172, v173
    v_add_f32 v172, v172, v173
    v_rcp_f32 v172, v172
    s_waitcnt vmcnt(0)
    v_pk_mul_f32 v[148:149], v[148:149], v[172:173] op_sel_hi:[1,0]
    v_pk_mul_f32 v[150:151], v[150:151], v[172:173] op_sel_hi:[1,0]
    v_pk_mul_f32 v[152:153], v[152:153], v[172:173] op_sel_hi:[1,0]
    v_pk_mul_f32 v[154:155], v[154:155], v[172:173] op_sel_hi:[1,0]
    v_pk_mul_f32 v[156:157], v[156:157], v[172:173] op_sel_hi:[1,0]
    v_pk_mul_f32 v[158:159], v[158:159], v[172:173] op_sel_hi:[1,0]
    v_pk_mul_f32 v[160:161], v[160:161], v[172:173] op_sel_hi:[1,0]
    v_pk_mul_f32 v[162:163], v[162:163], v[172:173] op_sel_hi:[1,0]
    v_cvt_pk_bf16_f32 v136, v148, v149
    v_cvt_pk_bf16_f32 v137, v150, v151
    v_cvt_pk_bf16_f32 v138, v152, v153
    v_cvt_pk_bf16_f32 v139, v154, v155
    buffer_store_dwordx4 v[136:139], v12, s[4:7], s72 offen offset:0 sc1
    v_cvt_pk_bf16_f32 v140, v156, v157
    v_cvt_pk_bf16_f32 v141, v158, v159
    v_cvt_pk_bf16_f32 v142, v160, v161
    v_cvt_pk_bf16_f32 v143, v162, v163
    buffer_store_dwordx4 v[140:143], v12, s[4:7], s72 offen offset:2048 sc1
    s_add_u32 s72, s72, 262144
    s_add_u32 s61, s61, 1
    s_barrier
    ds_read_b128 v[64:67], v5 offset:16384
    ds_read_b128 v[68:71], v5 offset:17408
    ds_read_b128 v[72:75], v5 offset:18432
    ds_read_b128 v[76:79], v5 offset:19456
    ds_read_b128 v[80:83], v5 offset:20480
    ds_read_b128 v[84:87], v5 offset:21504
    ds_read_b128 v[88:91], v5 offset:22528
    ds_read_b128 v[92:95], v5 offset:23552
    ds_read_b128 v[96:99], v6 offset:16384
    ds_read_b128 v[100:103], v6 offset:17408
    ds_read_b128 v[104:107], v6 offset:18432
    ds_read_b128 v[108:111], v6 offset:19456
    s_waitcnt lgkmcnt(11)
    v_mfma_f32_16x16x32_bf16 v[136:139], v[64:67], v[176:179], 0
    s_waitcnt lgkmcnt(10)
    v_mfma_f32_16x16x32_bf16 v[136:139], v[68:71], v[180:183], v[136:139]
    s_waitcnt lgkmcnt(9)
    v_mfma_f32_16x16x32_bf16 v[136:139], v[72:75], v[184:187], v[136:139]
    s_waitcnt lgkmcnt(8)
    v_mfma_f32_16x16x32_bf16 v[136:139], v[76:79], v[188:191], v[136:139]
    s_waitcnt lgkmcnt(7)
    v_mfma_f32_16x16x32_bf16 v[140:143], v[80:83], v[176:179], 0
    s_waitcnt lgkmcnt(6)
    v_mfma_f32_16x16x32_bf16 v[140:143], v[84:87], v[180:183], v[140:143]
    s_waitcnt lgkmcnt(5)
    v_mfma_f32_16x16x32_bf16 v[140:143], v[88:91], v[184:187], v[140:143]
    s_waitcnt lgkmcnt(4)
    v_mfma_f32_16x16x32_bf16 v[140:143], v[92:95], v[188:191], v[140:143]
    s_add_u32 s69, s61, 1
    s_cmp_ge_u32 s79, s69
    s_cbranch_scc1 L_hm_178
    s_mov_b32 s60, 0
L_pf_179:
    buffer_load_dword v9, v11, s[4:7], 0 offen sc1
    s_waitcnt vmcnt(0)
    v_cmp_gt_u32 vcc, s69, v9
    s_nop 0
    s_cbranch_vccz L_pfd_180
    s_sleep 1
    s_add_u32 s60, s60, 1
    s_cmp_lt_u32 s60, 0x100000
    s_cbranch_scc1 L_pf_179
    s_movk_i32 s62, 10
    s_branch L_ABORT
L_pfd_180:
    v_readlane_b32 s79, v9, 0
    v_readlane_b32 s62, v9, 1
    s_nop 0
    s_min_u32 s79, s79, s62
    v_readlane_b32 s62, v9, 2
    s_nop 0
    s_min_u32 s79, s79, s62
    v_readlane_b32 s62, v9, 3
    s_nop 0
    s_min_u32 s79, s79, s62
    v_readlane_b32 s62, v9, 4
    s_nop 0
    s_min_u32 s79, s79, s62
    v_readlane_b32 s62, v9, 5
    s_nop 0
    s_min_u32 s79, s79, s62
    v_readlane_b32 s62, v9, 6
    s_nop 0
    s_min_u32 s79, s79, s62
    v_readlane_b32 s62, v9, 7
    s_nop 0
    s_min_u32 s79, s79, s62
L_hm_178:
    s_add_u32 m0, s57, 131072
    s_nop 0
    buffer_load_dwordx4 v1, s[4:7], s76 offen offset:0 sc1 lds
    s_add_u32 m0, s57, 135168
    s_nop 0
    buffer_load_dwordx4 v1, s[4:7], s77 offen offset:0 sc1 lds
    s_add_u32 s76, s76, 131072
    s_add_u32 s77, s77, 131072
    s_bitcmp1_b32 s44, 0
    s_cbranch_scc1 L_m1_181
    v_cndmask_b32 v136, v13, v136, s[80:81]
    v_mov_b32 v140, v13
    v_cndmask_b32 v137, v13, v137, s[82:83]
    v_mov_b32 v141, v13
    v_cndmask_b32 v138, v13, v138, s[84:85]
    v_mov_b32 v142, v13
    v_cndmask_b32 v139, v13, v139, s[86:87]
    v_mov_b32 v143, v13
    s_branch L_me_182
L_m1_181:
    v_cndmask_b32 v140, v13, v140, s[80:81]
    v_cndmask_b32 v141, v13, v141, s[82:83]
    v_cndmask_b32 v142, v13, v142, s[84:85]
    v_cndmask_b32 v143, v13, v143, s[86:87]
L_me_182:
    s_waitcnt vmcnt(0) lgkmcnt(0)
    s_barrier
    s_cmp_lg_u32 s44, 0
    s_cbranch_scc1 L_np_183
    v_mov_b32 v9, s61
    s_mov_b64 exec, 1
    buffer_store_dword v9, off, s[4:7], s73 sc1
    s_mov_b64 exec, -1
L_np_183:
    ds_read_b128 v[112:115], v5 offset:40960
    ds_read_b128 v[116:119], v5 offset:41984
    ds_read_b128 v[120:123], v5 offset:43008
    ds_read_b128 v[124:127], v5 offset:44032
    ds_read_b128 v[128:131], v7 offset:8192
    ds_read_b128 v[132:135], v7 offset:9216
    s_waitcnt lgkmcnt(5)
    v_mfma_f32_16x16x32_bf16 v[144:147], v[112:115], v[176:179], 0
    s_waitcnt lgkmcnt(4)
    v_mfma_f32_16x16x32_bf16 v[144:147], v[116:119], v[180:183], v[144:147]
    s_waitcnt lgkmcnt(3)
    v_mfma_f32_16x16x32_bf16 v[144:147], v[120:123], v[184:187], v[144:147]
    s_waitcnt lgkmcnt(2)
    v_mfma_f32_16x16x32_bf16 v[144:147], v[124:127], v[188:191], v[144:147]
    v_max3_f32 v172, v136, v137, v138
    v_max3_f32 v173, v139, v140, v141
    v_max3_f32 v172, v172, v142, v143
    s_nop 4
    v_max3_f32 v173, v173, v144, v145
    v_max_f32 v172, v172, v173
    v_mov_b32 v173, v172
    s_nop 1
    v_permlane16_swap_b32 v172, v173
    v_max_f32 v172, v172, v173
    v_mov_b32 v173, v172
    s_nop 1
    v_permlane32_swap_b32 v172, v173
    v_max_f32 v172, v172, v173
    v_mul_f32 v172, s78, v172
    v_fma_f32 v136, v136, s78, -v172
    v_fma_f32 v137, v137, s78, -v172
    v_fma_f32 v138, v138, s78, -v172
    v_fma_f32 v139, v139, s78, -v172
    v_fma_f32 v140, v140, s78, -v172
    v_fma_f32 v141, v141, s78, -v172
    v_fma_f32 v142, v142, s78, -v172
    v_fma_f32 v143, v143, s78, -v172
    v_fma_f32 v144, v144, s78, -v172
    v_fma_f32 v145, v145, s78, -v172
    v_exp_f32 v136, v136
    v_exp_f32 v137, v137
    v_exp_f32 v138, v138
    v_exp_f32 v139, v139
    v_cvt_pk_bf16_f32 v164, v136, v137
    v_exp_f32 v140, v140
    v_exp_f32 v141, v141
    v_cvt_pk_bf16_f32 v165, v138, v139
    v_exp_f32 v142, v142
    v_exp_f32 v143, v143
    v_cvt_pk_bf16_f32 v166, v140, v141
    v_exp_f32 v144, v144
    v_exp_f32 v145, v145
    v_cvt_pk_bf16_f32 v167, v142, v143
    v_cvt_pk_bf16_f32 v168, v144, v145
    v_cvt_pk_bf16_f32 v169, v144, v145
    s_waitcnt lgkmcnt(0)
    v_mfma_f32_16x16x32_bf16 v[148:151], v[96:99], v[164:167], 0
    v_mfma_f32_16x16x32_bf16 v[152:155], v[100:103], v[164:167], 0
    v_mfma_f32_16x16x32_bf16 v[156:159], v[104:107], v[164:167], 0
    v_mfma_f32_16x16x32_bf16 v[160:163], v[108:111], v[164:167], 0
    s_nop 2
    v_mfma_f32_16x16x16_bf16 v[148:151], v[128:129], v[168:169], v[148:151]
    s_nop 2
    v_mfma_f32_16x16x16_bf16 v[152:155], v[130:131], v[168:169], v[152:155]
    s_nop 2
    v_mfma_f32_16x16x16_bf16 v[156:159], v[132:133], v[168:169], v[156:159]
    s_nop 2
    v_mfma_f32_16x16x16_bf16 v[160:163], v[134:135], v[168:169], v[160:163]
    v_pk_add_f32 v[136:137], v[136:137], v[138:139]
    v_pk_add_f32 v[140:141], v[140:141], v[142:143]
    v_pk_add_f32 v[136:137], v[136:137], v[144:145]
    v_pk_add_f32 v[136:137], v[136:137], v[140:141]
    v_add_f32 v172, v136, v137
    v_mov_b32 v173, v172
    s_nop 1
    v_permlane16_swap_b32 v172, v173
    v_add_f32 v172, v172, v173
    v_mov_b32 v173, v172
    s_nop 1
    v_permlane32_swap_b32 v172, v173
    v_add_f32 v172, v172, v173
    v_rcp_f32 v172, v172
    s_nop 0
    v_pk_mul_f32 v[148:149], v[148:149], v[172:173] op_sel_hi:[1,0]
    v_pk_mul_f32 v[150:151], v[150:151], v[172:173] op_sel_hi:[1,0]
    v_pk_mul_f32 v[152:153], v[152:153], v[172:173] op_sel_hi:[1,0]
    v_pk_mul_f32 v[154:155], v[154:155], v[172:173] op_sel_hi:[1,0]
    v_pk_mul_f32 v[156:157], v[156:157], v[172:173] op_sel_hi:[1,0]
    v_pk_mul_f32 v[158:159], v[158:159], v[172:173] op_sel_hi:[1,0]
    v_pk_mul_f32 v[160:161], v[160:161], v[172:173] op_sel_hi:[1,0]
    v_pk_mul_f32 v[162:163], v[162:163], v[172:173] op_sel_hi:[1,0]
    v_cvt_pk_bf16_f32 v136, v148, v149
    v_cvt_pk_bf16_f32 v137, v150, v151
    v_cvt_pk_bf16_f32 v138, v152, v153
    v_cvt_pk_bf16_f32 v139, v154, v155
    buffer_store_dwordx4 v[136:139], v12, s[4:7], s72 offen offset:0 sc1
    v_cvt_pk_bf16_f32 v140, v156, v157
    v_cvt_pk_bf16_f32 v141, v158, v159
    v_cvt_pk_bf16_f32 v142, v160, v161
    v_cvt_pk_bf16_f32 v143, v162, v163
    buffer_store_dwordx4 v[140:143], v12, s[4:7], s72 offen offset:2048 sc1
    s_add_u32 s72, s72, 262144
    s_add_u32 s61, s61, 1
    s_waitcnt vmcnt(0)
    s_barrier
    s_cmp_lg_u32 s44, 0
    s_cbranch_scc1 L_np_184
    v_mov_b32 v9, s61
    s_mov_b64 exec, 1
    buffer_store_dword v9, off, s[4:7], s73 sc1
    s_mov_b64 exec, -1
L_np_184:
    s_branch L_END2
L_OP:
    v_bfe_u32 v1, v0, 0, 6
    v_lshlrev_b32 v1, 4, v1
    s_mul_i32 s75, s46, 52
    s_lshr_b32 s75, s75, 8
    s_mul_i32 s76, s75, 5
    s_sub_u32 s76, s46, s76
    s_sub_u32 s61, s45, 6
    s_mul_i32 s73, s61, 20
    s_add_u32 s73, s73, s46
    s_add_u32 s73, s73, 192
    s_lshl_b32 s73, s73, 6
    s_mov_b32 s8, s26
    s_and_b32 s9, s27, 0xffff
    s_mov_b32 s10, 0x500000
    s_mov_b32 s11, 0x20000
    s_mul_i32 s66, s75, 1310720
    s_lshl_b32 s62, s76, 8
    s_add_u32 s66, s66, s62
    v_bfe_u32 v4, v0, 0, 4
    v_lshlrev_b32 v4, 4, v4
    v_bfe_u32 v9, v0, 4, 2
    v_lshlrev_b32 v9, 6, v9
    v_xor_b32 v4, v4, v9
    v_bfe_u32 v9, v0, 4, 2
    v_mul_u32_u24 v9, 0x500, v9
    v_bfe_u32 v8, v0, 6, 2
    v_mul_u32_u24 v8, 0x5000, v8
    v_add_u32 v9, v8, v9
    v_add_u32 v4, v4, v9
    v_bfe_u32 v6, v0, 1, 1
    v_lshlrev_b32 v6, 4, v6
    v_bfe_u32 v8, v0, 4, 1
    v_lshl_add_u32 v6, v8, 5, v6
    v_bfe_u32 v8, v0, 6, 2
    v_lshl_add_u32 v6, v8, 6, v6
    v_bfe_u32 v9, v0, 2, 2
    v_lshlrev_b32 v9, 6, v9
    v_xor_b32 v6, v6, v9
    v_bfe_u32 v9, v0, 0, 1
    v_lshlrev_b32 v9, 3, v9
    v_bfe_u32 v8, v0, 2, 2
    v_lshl_add_u32 v9, v8, 8, v9
    v_bfe_u32 v8, v0, 5, 1
    v_lshl_add_u32 v9, v8, 10, v9
    v_add_u32 v6, v6, v9
    v_add_u32 v7, 0x10000, v6
    s_lshl_b32 s67, s44, 12
    s_add_u32 s63, s66, 0x0
    s_add_u32 s64, s67, 0x0
    s_mov_b32 m0, s64
    s_nop 0
    buffer_load_dwordx4 v4, s[8:11], s63 offen lds
    s_add_u32 s63, s66, 0x1400
    s_add_u32 s64, s67, 0x400
    s_mov_b32 m0, s64
    s_nop 0
    buffer_load_dwordx4 v4, s[8:11], s63 offen lds
    s_add_u32 s63, s66, 0x2800
    s_add_u32 s64, s67, 0x800
    s_mov_b32 m0, s64
    s_nop 0
    buffer_load_dwordx4 v4, s[8:11], s63 offen lds
    s_add_u32 s63, s66, 0x3c00
    s_add_u32 s64, s67, 0xc00
    s_mov_b32 m0, s64
    s_nop 0
    buffer_load_dwordx4 v4, s[8:11], s63 offen lds
    s_add_u32 s63, s66, 0x14000
    s_add_u32 s64, s67, 0x4000
    s_mov_b32 m0, s64
    s_nop 0
    buffer_load_dwordx4 v4, s[8:11], s63 offen lds
    s_add_u32 s63, s66, 0x15400
    s_add_u32 s64, s67, 0x4400
    s_mov_b32 m0, s64
    s_nop 0
    buffer_load_dwordx4 v4, s[8:11], s63 offen lds
    s_add_u32 s63, s66, 0x16800
    s_add_u32 s64, s67, 0x4800
    s_mov_b32 m0, s64
    s_nop 0
    buffer_load_dwordx4 v4, s[8:11], s63 offen lds
    s_add_u32 s63, s66, 0x17c00
    s_add_u32 s64, s67, 0x4c00
    s_mov_b32 m0, s64
    s_nop 0
    buffer_load_dwordx4 v4, s[8:11], s63 offen lds
    s_add_u32 s63, s66, 0x28000
    s_add_u32 s64, s67, 0x8000
    s_mov_b32 m0, s64
    s_nop 0
    buffer_load_dwordx4 v4, s[8:11], s63 offen lds
    s_add_u32 s63, s66, 0x29400
    s_add_u32 s64, s67, 0x8400
    s_mov_b32 m0, s64
    s_nop 0
    buffer_load_dwordx4 v4, s[8:11], s63 offen lds
    s_add_u32 s63, s66, 0x2a800
    s_add_u32 s64, s67, 0x8800
    s_mov_b32 m0, s64
    s_nop 0
    buffer_load_dwordx4 v4, s[8:11], s63 offen lds
    s_add_u32 s63, s66, 0x2bc00
    s_add_u32 s64, s67, 0x8c00
    s_mov_b32 m0, s64
    s_nop 0
    buffer_load_dwordx4 v4, s[8:11], s63 offen lds
    s_add_u32 s63, s66, 0x3c000
    s_add_u32 s64, s67, 0xc000
    s_mov_b32 m0, s64
    s_nop 0
    buffer_load_dwordx4 v4, s[8:11], s63 offen lds
    s_add_u32 s63, s66, 0x3d400
    s_add_u32 s64, s67, 0xc400
    s_mov_b32 m0, s64
    s_nop 0
    buffer_load_dwordx4 v4, s[8:11], s63 offen lds
    s_add_u32 s63, s66, 0x3e800
    s_add_u32 s64, s67, 0xc800
    s_mov_b32 m0, s64
    s_nop 0
    buffer_load_dwordx4 v4, s[8:11], s63 offen lds
    s_add_u32 s63, s66, 0x3fc00
    s_add_u32 s64, s67, 0xcc00
    s_mov_b32 m0, s64
    s_nop 0
    buffer_load_dwordx4 v4, s[8:11], s63 offen lds
    s_add_u32 s63, s66, 0x50000
    s_add_u32 s64, s67, 0x10000
    s_mov_b32 m0, s64
    s_nop 0
    buffer_load_dwordx4 v4, s[8:11], s63 offen lds
    s_add_u32 s63, s66, 0x51400
    s_add_u32 s64, s67, 0x10400
    s_mov_b32 m0, s64
    s_nop 0
    buffer_load_dwordx4 v4, s[8:11], s63 offen lds
    s_add_u32 s63, s66, 0x52800
    s_add_u32 s64, s67, 0x10800
    s_mov_b32 m0, s64
    s_nop 0
    buffer_load_dwordx4 v4, s[8:11], s63 offen lds
    s_add_u32 s63, s66, 0x53c00
    s_add_u32 s64, s67, 0x10c00
    s_mov_b32 m0, s64
    s_nop 0
    buffer_load_dwordx4 v4, s[8:11], s63 offen lds
    s_add_u32 s63, s66, 0x64000
    s_add_u32 s64, s67, 0x14000
    s_mov_b32 m0, s64
    s_nop 0
    buffer_load_dwordx4 v4, s[8:11], s63 offen lds
    s_add_u32 s63, s66, 0x65400
    s_add_u32 s64, s67, 0x14400
    s_mov_b32 m0, s64
    s_nop 0
    buffer_load_dwordx4 v4, s[8:11], s63 offen lds
    s_add_u32 s63, s66, 0x66800
    s_add_u32 s64, s67, 0x14800
    s_mov_b32 m0, s64
    s_nop 0
    buffer_load_dwordx4 v4, s[8:11], s63 offen lds
    s_add_u32 s63, s66, 0x67c00
    s_add_u32 s64, s67, 0x14c00
    s_mov_b32 m0, s64
    s_nop 0
    buffer_load_dwordx4 v4, s[8:11], s63 offen lds
    s_add_u32 s63, s66, 0x78000
    s_add_u32 s64, s67, 0x18000
    s_mov_b32 m0, s64
    s_nop 0
    buffer_load_dwordx4 v4, s[8:11], s63 offen lds
    s_add_u32 s63, s66, 0x79400
    s_add_u32 s64, s67, 0x18400
    s_mov_b32 m0, s64
    s_nop 0
    buffer_load_dwordx4 v4, s[8:11], s63 offen lds
    s_add_u32 s63, s66, 0x7a800
    s_add_u32 s64, s67, 0x18800
    s_mov_b32 m0, s64
    s_nop 0
    buffer_load_dwordx4 v4, s[8:11], s63 offen lds
    s_add_u32 s63, s66, 0x7bc00
    s_add_u32 s64, s67, 0x18c00
    s_mov_b32 m0, s64
    s_nop 0
    buffer_load_dwordx4 v4, s[8:11], s63 offen lds
    s_waitcnt vmcnt(24) lgkmcnt(0)
    s_barrier
    s_add_u32 s63, s66, 0x8c000
    s_add_u32 s64, s67, 0x1c000
    s_mov_b32 m0, s64
    s_nop 0
    buffer_load_dwordx4 v4, s[8:11], s63 offen lds
    s_add_u32 s63, s66, 0x8d400
    s_add_u32 s64, s67, 0x1c400
    s_mov_b32 m0, s64
    s_nop 0
    buffer_load_dwordx4 v4, s[8:11], s63 offen lds
    s_add_u32 s63, s66, 0x8e800
    s_add_u32 s64, s67, 0x1c800
    s_mov_b32 m0, s64
    s_nop 0
    buffer_load_dwordx4 v4, s[8:11], s63 offen lds
    s_add_u32 s63, s66, 0x8fc00
    s_add_u32 s64, s67, 0x1cc00
    s_mov_b32 m0, s64
    s_nop 0
    buffer_load_dwordx4 v4, s[8:11], s63 offen lds
    ds_read_b64_tr_b16 a[0:1], v6 offset:0
    ds_read_b64_tr_b16 a[2:3], v6 offset:4096
    ds_read_b64_tr_b16 a[4:5], v6 offset:2048
    ds_read_b64_tr_b16 a[6:7], v6 offset:6144
    ds_read_b64_tr_b16 a[8:9], v6 offset:8192
    ds_read_b64_tr_b16 a[10:11], v6 offset:12288
    ds_read_b64_tr_b16 a[12:13], v6 offset:10240
    ds_read_b64_tr_b16 a[14:15], v6 offset:14336
    s_waitcnt vmcnt(24) lgkmcnt(0)
    s_barrier
    s_add_u32 s63, s66, 0xa0000
    s_add_u32 s64, s67, 0x0
    s_mov_b32 m0, s64
    s_nop 0
    buffer_load_dwordx4 v4, s[8:11], s63 offen lds
    s_add_u32 s63, s66, 0xa1400
    s_add_u32 s64, s67, 0x400
    s_mov_b32 m0, s64
    s_nop 0
    buffer_load_dwordx4 v4, s[8:11], s63 offen lds
    s_add_u32 s63, s66, 0xa2800
    s_add_u32 s64, s67, 0x800
    s_mov_b32 m0, s64
    s_nop 0
    buffer_load_dwordx4 v4, s[8:11], s63 offen lds
    s_add_u32 s63, s66, 0xa3c00
    s_add_u32 s64, s67, 0xc00
    s_mov_b32 m0, s64
    s_nop 0
    buffer_load_dwordx4 v4, s[8:11], s63 offen lds
    ds_read_b64_tr_b16 a[16:17], v6 offset:16384
    ds_read_b64_tr_b16 a[18:19], v6 offset:20480
    ds_read_b64_tr_b16 a[20:21], v6 offset:18432
    ds_read_b64_tr_b16 a[22:23], v6 offset:22528
    ds_read_b64_tr_b16 a[24:25], v6 offset:24576
    ds_read_b64_tr_b16 a[26:27], v6 offset:28672
    ds_read_b64_tr_b16 a[28:29], v6 offset:26624
    ds_read_b64_tr_b16 a[30:31], v6 offset:30720
    s_waitcnt vmcnt(24) lgkmcnt(0)
    s_barrier
    s_add_u32 s63, s66, 0xb4000
    s_add_u32 s64, s67, 0x4000
    s_mov_b32 m0, s64
    s_nop 0
    buffer_load_dwordx4 v4, s[8:11], s63 offen lds
    s_add_u32 s63, s66, 0xb5400
    s_add_u32 s64, s67, 0x4400
    s_mov_b32 m0, s64
    s_nop 0
    buffer_load_dwordx4 v4, s[8:11], s63 offen lds
    s_add_u32 s63, s66, 0xb6800
    s_add_u32 s64, s67, 0x4800
    s_mov_b32 m0, s64
    s_nop 0
    buffer_load_dwordx4 v4, s[8:11], s63 offen lds
    s_add_u32 s63, s66, 0xb7c00
    s_add_u32 s64, s67, 0x4c00
    s_mov_b32 m0, s64
    s_nop 0
    buffer_load_dwordx4 v4, s[8:11], s63 offen lds
    ds_read_b64_tr_b16 a[32:33], v6 offset:32768
    ds_read_b64_tr_b16 a[34:35], v6 offset:36864
    ds_read_b64_tr_b16 a[36:37], v6 offset:34816
    ds_read_b64_tr_b16 a[38:39], v6 offset:38912
    ds_read_b64_tr_b16 a[40:41], v6 offset:40960
    ds_read_b64_tr_b16 a[42:43], v6 offset:45056
    ds_read_b64_tr_b16 a[44:45], v6 offset:43008
    ds_read_b64_tr_b16 a[46:47], v6 offset:47104
    s_waitcnt vmcnt(24) lgkmcnt(0)
    s_barrier
    s_add_u32 s63, s66, 0xc8000
    s_add_u32 s64, s67, 0x8000
    s_mov_b32 m0, s64
    s_nop 0
    buffer_load_dwordx4 v4, s[8:11], s63 offen lds
    s_add_u32 s63, s66, 0xc9400
    s_add_u32 s64, s67, 0x8400
    s_mov_b32 m0, s64
    s_nop 0
    buffer_load_dwordx4 v4, s[8:11], s63 offen lds
    s_add_u32 s63, s66, 0xca800
    s_add_u32 s64, s67, 0x8800
    s_mov_b32 m0, s64
    s_nop 0
    buffer_load_dwordx4 v4, s[8:11], s63 offen lds
    s_add_u32 s63, s66, 0xcbc00
    s_add_u32 s64, s67, 0x8c00
    s_mov_b32 m0, s64
    s_nop 0
    buffer_load_dwordx4 v4, s[8:11], s63 offen lds
    ds_read_b64_tr_b16 a[48:49], v6 offset:49152
    ds_read_b64_tr_b16 a[50:51], v6 offset:53248
    ds_read_b64_tr_b16 a[52:53], v6 offset:51200
    ds_read_b64_tr_b16 a[54:55], v6 offset:55296
    ds_read_b64_tr_b16 a[56:57], v6 offset:57344
    ds_read_b64_tr_b16 a[58:59], v6 offset:61440
    ds_read_b64_tr_b16 a[60:61], v6 offset:59392
    ds_read_b64_tr_b16 a[62:63], v6 offset:63488
    s_waitcnt vmcnt(24) lgkmcnt(0)
    s_barrier
    s_add_u32 s63, s66, 0xdc000
    s_add_u32 s64, s67, 0xc000
    s_mov_b32 m0, s64
    s_nop 0
    buffer_load_dwordx4 v4, s[8:11], s63 offen lds
    s_add_u32 s63, s66, 0xdd400
    s_add_u32 s64, s67, 0xc400
    s_mov_b32 m0, s64
    s_nop 0
    buffer_load_dwordx4 v4, s[8:11], s63 offen lds
    s_add_u32 s63, s66, 0xde800
    s_add_u32 s64, s67, 0xc800
    s_mov_b32 m0, s64
    s_nop 0
    buffer_load_dwordx4 v4, s[8:11], s63 offen lds
    s_add_u32 s63, s66, 0xdfc00
    s_add_u32 s64, s67, 0xcc00
    s_mov_b32 m0, s64
    s_nop 0
    buffer_load_dwordx4 v4, s[8:11], s63 offen lds
    ds_read_b64_tr_b16 a[64:65], v7 offset:0
    ds_read_b64_tr_b16 a[66:67], v7 offset:4096
    ds_read_b64_tr_b16 a[68:69], v7 offset:2048
    ds_read_b64_tr_b16 a[70:71], v7 offset:6144
    ds_read_b64_tr_b16 a[72:73], v7 offset:8192
    ds_read_b64_tr_b16 a[74:75], v7 offset:12288
    ds_read_b64_tr_b16 a[76:77], v7 offset:10240
    ds_read_b64_tr_b16 a[78:79], v7 offset:14336
    s_waitcnt vmcnt(24) lgkmcnt(0)
    s_barrier
    s_add_u32 s63, s66, 0xf0000
    s_add_u32 s64, s67, 0x10000
    s_mov_b32 m0, s64
    s_nop 0
    buffer_load_dwordx4 v4, s[8:11], s63 offen lds
    s_add_u32 s63, s66, 0xf1400
    s_add_u32 s64, s67, 0x10400
    s_mov_b32 m0, s64
    s_nop 0
    buffer_load_dwordx4 v4, s[8:11], s63 offen lds
    s_add_u32 s63, s66, 0xf2800
    s_add_u32 s64, s67, 0x10800
    s_mov_b32 m0, s64
    s_nop 0
    buffer_load_dwordx4 v4, s[8:11], s63 offen lds
    s_add_u32 s63, s66, 0xf3c00
    s_add_u32 s64, s67, 0x10c00
    s_mov_b32 m0, s64
    s_nop 0
    buffer_load_dwordx4 v4, s[8:11], s63 offen lds
    ds_read_b64_tr_b16 a[80:81], v7 offset:16384
    ds_read_b64_tr_b16 a[82:83], v7 offset:20480
    ds_read_b64_tr_b16 a[84:85], v7 offset:18432
    ds_read_b64_tr_b16 a[86:87], v7 offset:22528
    ds_read_b64_tr_b16 a[88:89], v7 offset:24576
    ds_read_b64_tr_b16 a[90:91], v7 offset:28672
    ds_read_b64_tr_b16 a[92:93], v7 offset:26624
    ds_read_b64_tr_b16 a[94:95], v7 offset:30720
    s_waitcnt vmcnt(24) lgkmcnt(0)
    s_barrier
    s_add_u32 s63, s66, 0x104000
    s_add_u32 s64, s67, 0x14000
    s_mov_b32 m0, s64
    s_nop 0
    buffer_load_dwordx4 v4, s[8:11], s63 offen lds
    s_add_u32 s63, s66, 0x105400
    s_add_u32 s64, s67, 0x14400
    s_mov_b32 m0, s64
    s_nop 0
    buffer_load_dwordx4 v4, s[8:11], s63 offen lds
    s_add_u32 s63, s66, 0x106800
    s_add_u32 s64, s67, 0x14800
    s_mov_b32 m0, s64
    s_nop 0
    buffer_load_dwordx4 v4, s[8:11], s63 offen lds
    s_add_u32 s63, s66, 0x107c00
    s_add_u32 s64, s67, 0x14c00
    s_mov_b32 m0, s64
    s_nop 0
    buffer_load_dwordx4 v4, s[8:11], s63 offen lds
    ds_read_b64_tr_b16 a[96:97], v7 offset:32768
    ds_read_b64_tr_b16 a[98:99], v7 offset:36864
    ds_read_b64_tr_b16 a[100:101], v7 offset:34816
    ds_read_b64_tr_b16 a[102:103], v7 offset:38912
    ds_read_b64_tr_b16 a[104:105], v7 offset:40960
    ds_read_b64_tr_b16 a[106:107], v7 offset:45056
    ds_read_b64_tr_b16 a[108:109], v7 offset:43008
    ds_read_b64_tr_b16 a[110:111], v7 offset:47104
    s_waitcnt vmcnt(24) lgkmcnt(0)
    s_barrier
    s_add_u32 s63, s66, 0x118000
    s_add_u32 s64, s67, 0x18000
    s_mov_b32 m0, s64
    s_nop 0
    buffer_load_dwordx4 v4, s[8:11], s63 offen lds
    s_add_u32 s63, s66, 0x119400
    s_add_u32 s64, s67, 0x18400
    s_mov_b32 m0, s64
    s_nop 0
    buffer_load_dwordx4 v4, s[8:11], s63 offen lds
    s_add_u32 s63, s66, 0x11a800
    s_add_u32 s64, s67, 0x18800
    s_mov_b32 m0, s64
    s_nop 0
    buffer_load_dwordx4 v4, s[8:11], s63 offen lds
    s_add_u32 s63, s66, 0x11bc00
    s_add_u32 s64, s67, 0x18c00
    s_mov_b32 m0, s64
    s_nop 0
    buffer_load_dwordx4 v4, s[8:11], s63 offen lds
    ds_read_b64_tr_b16 a[112:113], v7 offset:49152
    ds_read_b64_tr_b16 a[114:115], v7 offset:53248
    ds_read_b64_tr_b16 a[116:117], v7 offset:51200
    ds_read_b64_tr_b16 a[118:119], v7 offset:55296
    ds_read_b64_tr_b16 a[120:121], v7 offset:57344
    ds_read_b64_tr_b16 a[122:123], v7 offset:61440
    ds_read_b64_tr_b16 a[124:125], v7 offset:59392
    ds_read_b64_tr_b16 a[126:127], v7 offset:63488
    s_waitcnt vmcnt(24) lgkmcnt(0)
    s_barrier
    s_add_u32 s63, s66, 0x12c000
    s_add_u32 s64, s67, 0x1c000
    s_mov_b32 m0, s64
    s_nop 0
    buffer_load_dwordx4 v4, s[8:11], s63 offen lds
    s_add_u32 s63, s66, 0x12d400
    s_add_u32 s64, s67, 0x1c400
    s_mov_b32 m0, s64
    s_nop 0
    buffer_load_dwordx4 v4, s[8:11], s63 offen lds
    s_add_u32 s63, s66, 0x12e800
    s_add_u32 s64, s67, 0x1c800
    s_mov_b32 m0, s64
    s_nop 0
    buffer_load_dwordx4 v4, s[8:11], s63 offen lds
    s_add_u32 s63, s66, 0x12fc00
    s_add_u32 s64, s67, 0x1cc00
    s_mov_b32 m0, s64
    s_nop 0
    buffer_load_dwordx4 v4, s[8:11], s63 offen lds
    ds_read_b64_tr_b16 a[128:129], v6 offset:0
    ds_read_b64_tr_b16 a[130:131], v6 offset:4096
    ds_read_b64_tr_b16 a[132:133], v6 offset:2048
    ds_read_b64_tr_b16 a[134:135], v6 offset:6144
    ds_read_b64_tr_b16 a[136:137], v6 offset:8192
    ds_read_b64_tr_b16 a[138:139], v6 offset:12288
    ds_read_b64_tr_b16 a[140:141], v6 offset:10240
    ds_read_b64_tr_b16 a[142:143], v6 offset:14336
    s_waitcnt vmcnt(24) lgkmcnt(0)
    s_barrier
    ds_read_b64_tr_b16 a[144:145], v6 offset:16384
    ds_read_b64_tr_b16 a[146:147], v6 offset:20480
    ds_read_b64_tr_b16 a[148:149], v6 offset:18432
    ds_read_b64_tr_b16 a[150:151], v6 offset:22528
    ds_read_b64_tr_b16 a[152:153], v6 offset:24576
    ds_read_b64_tr_b16 a[154:155], v6 offset:28672
    ds_read_b64_tr_b16 a[156:157], v6 offset:26624
    ds_read_b64_tr_b16 a[158:159], v6 offset:30720
    s_waitcnt vmcnt(20) lgkmcnt(0)
    s_barrier
    ds_read_b64_tr_b16 a[160:161], v6 offset:32768
    ds_read_b64_tr_b16 a[162:163], v6 offset:36864
    ds_read_b64_tr_b16 a[164:165], v6 offset:34816
    ds_read_b64_tr_b16 a[166:167], v6 offset:38912
    ds_read_b64_tr_b16 a[168:169], v6 offset:40960
    ds_read_b64_tr_b16 a[170:171], v6 offset:45056
    ds_read_b64_tr_b16 a[172:173], v6 offset:43008
    ds_read_b64_tr_b16 a[174:175], v6 offset:47104
    s_waitcnt vmcnt(16) lgkmcnt(0)
    s_barrier
    ds_read_b64_tr_b16 a[176:177], v6 offset:49152
    ds_read_b64_tr_b16 a[178:179], v6 offset:53248
    ds_read_b64_tr_b16 a[180:181], v6 offset:51200
    ds_read_b64_tr_b16 a[182:183], v6 offset:55296
    ds_read_b64_tr_b16 a[184:185], v6 offset:57344
    ds_read_b64_tr_b16 a[186:187], v6 offset:61440
    ds_read_b64_tr_b16 a[188:189], v6 offset:59392
    ds_read_b64_tr_b16 a[190:191], v6 offset:63488
    s_waitcnt vmcnt(12) lgkmcnt(0)
    s_barrier
    ds_read_b64_tr_b16 a[192:193], v7 offset:0
    ds_read_b64_tr_b16 a[194:195], v7 offset:4096
    ds_read_b64_tr_b16 a[196:197], v7 offset:2048
    ds_read_b64_tr_b16 a[198:199], v7 offset:6144
    ds_read_b64_tr_b16 a[200:201], v7 offset:8192
    ds_read_b64_tr_b16 a[202:203], v7 offset:12288
    ds_read_b64_tr_b16 a[204:205], v7 offset:10240
    ds_read_b64_tr_b16 a[206:207], v7 offset:14336
    s_waitcnt vmcnt(8) lgkmcnt(0)
    s_barrier
    ds_read_b64_tr_b16 a[208:209], v7 offset:16384
    ds_read_b64_tr_b16 a[210:211], v7 offset:20480
    ds_read_b64_tr_b16 a[212:213], v7 offset:18432
    ds_read_b64_tr_b16 a[214:215], v7 offset:22528
    ds_read_b64_tr_b16 a[216:217], v7 offset:24576
    ds_read_b64_tr_b16 a[218:219], v7 offset:28672
    ds_read_b64_tr_b16 a[220:221], v7 offset:26624
    ds_read_b64_tr_b16 a[222:223], v7 offset:30720
    s_waitcnt vmcnt(4) lgkmcnt(0)
    s_barrier
    ds_read_b64_tr_b16 a[224:225], v7 offset:32768
    ds_read_b64_tr_b16 a[226:227], v7 offset:36864
    ds_read_b64_tr_b16 a[228:229], v7 offset:34816
    ds_read_b64_tr_b16 a[230:231], v7 offset:38912
    ds_read_b64_tr_b16 a[232:233], v7 offset:40960
    ds_read_b64_tr_b16 a[234:235], v7 offset:45056
    ds_read_b64_tr_b16 a[236:237], v7 offset:43008
    ds_read_b64_tr_b16 a[238:239], v7 offset:47104
    s_waitcnt vmcnt(0) lgkmcnt(0)
    s_barrier
    ds_read_b64_tr_b16 a[240:241], v7 offset:49152
    ds_read_b64_tr_b16 a[242:243], v7 offset:53248
    ds_read_b64_tr_b16 a[244:245], v7 offset:51200
    ds_read_b64_tr_b16 a[246:247], v7 offset:55296
    ds_read_b64_tr_b16 a[248:249], v7 offset:57344
    ds_read_b64_tr_b16 a[250:251], v7 offset:61440
    ds_read_b64_tr_b16 a[252:253], v7 offset:59392
    ds_read_b64_tr_b16 a[254:255], v7 offset:63488
    s_waitcnt lgkmcnt(0)
    s_barrier
    s_lshl_b32 s72, s61, 2
    s_add_u32 s72, s72, s75
    s_mul_i32 s72, s72, 20
    s_lshl_b32 s62, s76, 2
    s_add_u32 s72, s72, s62
    s_add_u32 s72, s72, s44
    s_lshl_b32 s72, s72, 12
    s_add_u32 s72, s72, 0x3c00000
    v_and_b32 v10, 7, v0
    s_lshl_b32 s62, s75, 3
    s_add_u32 s62, s62, 160
    v_add_u32 v10, s62, v10
    v_lshlrev_b32 v10, 6, v10
    s_lshl_b32 s67, s44, 12
    s_lshl_b32 s71, s61, 2
    s_add_u32 s71, s71, s75
    s_lshl_b32 s71, s71, 16
    s_add_u32 s71, s71, s67
    s_add_u32 s71, s71, 0x2c00000
    v_mov_b32 v2, v1
L_OP_LOOP:
    s_add_u32 s69, s61, 1
    s_mov_b32 s60, 0
L_pf_185:
    buffer_load_dword v9, v10, s[4:7], 0 offen sc1
    s_waitcnt vmcnt(0)
    v_cmp_gt_u32 vcc, s69, v9
    s_nop 0
    s_cbranch_vccz L_pfd_186
    s_sleep 1
    s_add_u32 s60, s60, 1
    s_cmp_lt_u32 s60, 0x100000
    s_cbranch_scc1 L_pf_185
    s_movk_i32 s62, 7
    s_branch L_ABORT
L_pfd_186:
    s_add_u32 s65, s71, 0
    s_add_u32 s64, s67, 0
    s_add_u32 m0, s64, 0
    s_add_u32 s63, s65, 0
    buffer_load_dwordx4 v1, s[4:7], s63 offen offset:0 sc1 lds
    buffer_load_dwordx4 v1, s[4:7], s63 offen offset:1024 sc1 lds
    buffer_load_dwordx4 v1, s[4:7], s63 offen offset:2048 sc1 lds
    buffer_load_dwordx4 v1, s[4:7], s63 offen offset:3072 sc1 lds
    s_add_u32 s65, s71, 16384
    s_add_u32 s64, s67, 16384
    s_add_u32 m0, s64, 0
    s_add_u32 s63, s65, 0
    buffer_load_dwordx4 v1, s[4:7], s63 offen offset:0 sc1 lds
    buffer_load_dwordx4 v1, s[4:7], s63 offen offset:1024 sc1 lds
    buffer_load_dwordx4 v1, s[4:7], s63 offen offset:2048 sc1 lds
    buffer_load_dwordx4 v1, s[4:7], s63 offen offset:3072 sc1 lds
    s_waitcnt vmcnt(4)
    s_barrier
    ds_read_b128 v[32:35], v2 offset:0
    ds_read_b128 v[36:39], v2 offset:1024
    ds_read_b128 v[40:43], v2 offset:2048
    ds_read_b128 v[44:47], v2 offset:3072
    s_waitcnt lgkmcnt(3)
    v_mfma_f32_32x32x16_bf16 v[16:31], a[0:3], v[32:35], 0
    ds_read_b128 v[32:35], v2 offset:4096
    s_add_u32 s65, s71, 32768
    s_add_u32 s64, s67, 32768
    s_add_u32 m0, s64, 0
    s_add_u32 s63, s65, 0
    buffer_load_dwordx4 v1, s[4:7], s63 offen offset:0 sc1 lds
    s_waitcnt lgkmcnt(3)
    v_mfma_f32_32x32x16_bf16 v[16:31], a[4:7], v[36:39], v[16:31]
    ds_read_b128 v[36:39], v2 offset:5120
    s_waitcnt lgkmcnt(3)
    v_mfma_f32_32x32x16_bf16 v[16:31], a[8:11], v[40:43], v[16:31]
    ds_read_b128 v[40:43], v2 offset:6144
    buffer_load_dwordx4 v1, s[4:7], s63 offen offset:1024 sc1 lds
    s_waitcnt lgkmcnt(3)
    v_mfma_f32_32x32x16_bf16 v[16:31], a[12:15], v[44:47], v[16:31]
    ds_read_b128 v[44:47], v2 offset:7168
    s_waitcnt lgkmcnt(3)
    v_mfma_f32_32x32x16_bf16 v[16:31], a[16:19], v[32:35], v[16:31]
    ds_read_b128 v[32:35], v2 offset:8192
    buffer_load_dwordx4 v1, s[4:7], s63 offen offset:2048 sc1 lds
    s_waitcnt lgkmcnt(3)
    v_mfma_f32_32x32x16_bf16 v[16:31], a[20:23], v[36:39], v[16:31]
    ds_read_b128 v[36:39], v2 offset:9216
    s_waitcnt lgkmcnt(3)
    v_mfma_f32_32x32x16_bf16 v[16:31], a[24:27], v[40:43], v[16:31]
    ds_read_b128 v[40:43], v2 offset:10240
    buffer_load_dwordx4 v1, s[4:7], s63 offen offset:3072 sc1 lds
    s_waitcnt lgkmcnt(3)
    v_mfma_f32_32x32x16_bf16 v[16:31], a[28:31], v[44:47], v[16:31]
    ds_read_b128 v[44:47], v2 offset:11264
    s_waitcnt lgkmcnt(3)
    v_mfma_f32_32x32x16_bf16 v[16:31], a[32:35], v[32:35], v[16:31]
    ds_read_b128 v[32:35], v2 offset:12288
    s_waitcnt lgkmcnt(3)
    v_mfma_f32_32x32x16_bf16 v[16:31], a[36:39], v[36:39], v[16:31]
    ds_read_b128 v[36:39], v2 offset:13312
    s_waitcnt lgkmcnt(3)
    v_mfma_f32_32x32x16_bf16 v[16:31], a[40:43], v[40:43], v[16:31]
    ds_read_b128 v[40:43], v2 offset:14336
    s_waitcnt lgkmcnt(3)
    v_mfma_f32_32x32x16_bf16 v[16:31], a[44:47], v[44:47], v[16:31]
    ds_read_b128 v[44:47], v2 offset:15360
    s_waitcnt lgkmcnt(3)
    v_mfma_f32_32x32x16_bf16 v[16:31], a[48:51], v[32:35], v[16:31]
    s_waitcnt lgkmcnt(2)
    v_mfma_f32_32x32x16_bf16 v[16:31], a[52:55], v[36:39], v[16:31]
    s_waitcnt lgkmcnt(1)
    v_mfma_f32_32x32x16_bf16 v[16:31], a[56:59], v[40:43], v[16:31]
    s_waitcnt lgkmcnt(0)
    v_mfma_f32_32x32x16_bf16 v[16:31], a[60:63], v[44:47], v[16:31]
    s_waitcnt vmcnt(4)
    s_barrier
    ds_read_b128 v[32:35], v2 offset:16384
    ds_read_b128 v[36:39], v2 offset:17408
    ds_read_b128 v[40:43], v2 offset:18432
    ds_read_b128 v[44:47], v2 offset:19456
    s_waitcnt lgkmcnt(3)
    v_mfma_f32_32x32x16_bf16 v[16:31], a[64:67], v[32:35], v[16:31]
    ds_read_b128 v[32:35], v2 offset:20480
    s_add_u32 s65, s71, 49152
    s_add_u32 s64, s67, 49152
    s_add_u32 m0, s64, 0
    s_add_u32 s63, s65, 0
    buffer_load_dwordx4 v1, s[4:7], s63 offen offset:0 sc1 lds
    s_waitcnt lgkmcnt(3)
    v_mfma_f32_32x32x16_bf16 v[16:31], a[68:71], v[36:39], v[16:31]
    ds_read_b128 v[36:39], v2 offset:21504
    s_waitcnt lgkmcnt(3)
    v_mfma_f32_32x32x16_bf16 v[16:31], a[72:75], v[40:43], v[16:31]
    ds_read_b128 v[40:43], v2 offset:22528
    buffer_load_dwordx4 v1, s[4:7], s63 offen offset:1024 sc1 lds
    s_waitcnt lgkmcnt(3)
    v_mfma_f32_32x32x16_bf16 v[16:31], a[76:79], v[44:47], v[16:31]
    ds_read_b128 v[44:47], v2 offset:23552
    s_waitcnt lgkmcnt(3)
    v_mfma_f32_32x32x16_bf16 v[16:31], a[80:83], v[32:35], v[16:31]
    ds_read_b128 v[32:35], v2 offset:24576
    buffer_load_dwordx4 v1, s[4:7], s63 offen offset:2048 sc1 lds
    s_waitcnt lgkmcnt(3)
    v_mfma_f32_32x32x16_bf16 v[16:31], a[84:87], v[36:39], v[16:31]
    ds_read_b128 v[36:39], v2 offset:25600
    s_waitcnt lgkmcnt(3)
    v_mfma_f32_32x32x16_bf16 v[16:31], a[88:91], v[40:43], v[16:31]
    ds_read_b128 v[40:43], v2 offset:26624
    buffer_load_dwordx4 v1, s[4:7], s63 offen offset:3072 sc1 lds
    s_waitcnt lgkmcnt(3)
    v_mfma_f32_32x32x16_bf16 v[16:31], a[92:95], v[44:47], v[16:31]
    ds_read_b128 v[44:47], v2 offset:27648
    s_waitcnt lgkmcnt(3)
    v_mfma_f32_32x32x16_bf16 v[16:31], a[96:99], v[32:35], v[16:31]
    ds_read_b128 v[32:35], v2 offset:28672
    s_waitcnt lgkmcnt(3)
    v_mfma_f32_32x32x16_bf16 v[16:31], a[100:103], v[36:39], v[16:31]
    ds_read_b128 v[36:39], v2 offset:29696
    s_waitcnt lgkmcnt(3)
    v_mfma_f32_32x32x16_bf16 v[16:31], a[104:107], v[40:43], v[16:31]
    ds_read_b128 v[40:43], v2 offset:30720
    s_waitcnt lgkmcnt(3)
    v_mfma_f32_32x32x16_bf16 v[16:31], a[108:111], v[44:47], v[16:31]
    ds_read_b128 v[44:47], v2 offset:31744
    s_waitcnt lgkmcnt(3)
    v_mfma_f32_32x32x16_bf16 v[16:31], a[112:115], v[32:35], v[16:31]
    s_waitcnt lgkmcnt(2)
    v_mfma_f32_32x32x16_bf16 v[16:31], a[116:119], v[36:39], v[16:31]
    s_waitcnt lgkmcnt(1)
    v_mfma_f32_32x32x16_bf16 v[16:31], a[120:123], v[40:43], v[16:31]
    s_waitcnt lgkmcnt(0)
    v_mfma_f32_32x32x16_bf16 v[16:31], a[124:127], v[44:47], v[16:31]
    s_waitcnt vmcnt(4)
    s_barrier
    ds_read_b128 v[32:35], v2 offset:32768
    ds_read_b128 v[36:39], v2 offset:33792
    ds_read_b128 v[40:43], v2 offset:34816
    ds_read_b128 v[44:47], v2 offset:35840
    s_waitcnt lgkmcnt(3)
    v_mfma_f32_32x32x16_bf16 v[16:31], a[128:131], v[32:35], v[16:31]
    ds_read_b128 v[32:35], v2 offset:36864
    s_waitcnt lgkmcnt(3)
    v_mfma_f32_32x32x16_bf16 v[16:31], a[132:135], v[36:39], v[16:31]
    ds_read_b128 v[36:39], v2 offset:37888
    s_waitcnt lgkmcnt(3)
    v_mfma_f32_32x32x16_bf16 v[16:31], a[136:139], v[40:43], v[16:31]
    ds_read_b128 v[40:43], v2 offset:38912
    s_waitcnt lgkmcnt(3)
    v_mfma_f32_32x32x16_bf16 v[16:31], a[140:143], v[44:47], v[16:31]
    ds_read_b128 v[44:47], v2 offset:39936
    s_waitcnt lgkmcnt(3)
    v_mfma_f32_32x32x16_bf16 v[16:31], a[144:147], v[32:35], v[16:31]
    ds_read_b128 v[32:35], v2 offset:40960
    s_waitcnt lgkmcnt(3)
    v_mfma_f32_32x32x16_bf16 v[16:31], a[148:151], v[36:39], v[16:31]
    ds_read_b128 v[36:39], v2 offset:41984
    s_waitcnt lgkmcnt(3)
    v_mfma_f32_32x32x16_bf16 v[16:31], a[152:155], v[40:43], v[16:31]
    ds_read_b128 v[40:43], v2 offset:43008
    s_waitcnt lgkmcnt(3)
    v_mfma_f32_32x32x16_bf16 v[16:31], a[156:159], v[44:47], v[16:31]
    ds_read_b128 v[44:47], v2 offset:44032
    s_waitcnt lgkmcnt(3)
    v_mfma_f32_32x32x16_bf16 v[16:31], a[160:163], v[32:35], v[16:31]
    ds_read_b128 v[32:35], v2 offset:45056
    s_waitcnt lgkmcnt(3)
    v_mfma_f32_32x32x16_bf16 v[16:31], a[164:167], v[36:39], v[16:31]
    ds_read_b128 v[36:39], v2 offset:46080
    s_waitcnt lgkmcnt(3)
    v_mfma_f32_32x32x16_bf16 v[16:31], a[168:171], v[40:43], v[16:31]
    ds_read_b128 v[40:43], v2 offset:47104
    s_waitcnt lgkmcnt(3)
    v_mfma_f32_32x32x16_bf16 v[16:31], a[172:175], v[44:47], v[16:31]
    ds_read_b128 v[44:47], v2 offset:48128
    s_waitcnt lgkmcnt(3)
    v_mfma_f32_32x32x16_bf16 v[16:31], a[176:179], v[32:35], v[16:31]
    s_waitcnt lgkmcnt(2)
    v_mfma_f32_32x32x16_bf16 v[16:31], a[180:183], v[36:39], v[16:31]
    s_waitcnt lgkmcnt(1)
    v_mfma_f32_32x32x16_bf16 v[16:31], a[184:187], v[40:43], v[16:31]
    s_waitcnt lgkmcnt(0)
    v_mfma_f32_32x32x16_bf16 v[16:31], a[188:191], v[44:47], v[16:31]
    s_waitcnt vmcnt(0)
    s_barrier
    ds_read_b128 v[32:35], v2 offset:49152
    ds_read_b128 v[36:39], v2 offset:50176
    ds_read_b128 v[40:43], v2 offset:51200
    ds_read_b128 v[44:47], v2 offset:52224
    s_waitcnt lgkmcnt(3)
    v_mfma_f32_32x32x16_bf16 v[16:31], a[192:195], v[32:35], v[16:31]
    ds_read_b128 v[32:35], v2 offset:53248
    s_waitcnt lgkmcnt(3)
    v_mfma_f32_32x32x16_bf16 v[16:31], a[196:199], v[36:39], v[16:31]
    ds_read_b128 v[36:39], v2 offset:54272
    s_waitcnt lgkmcnt(3)
    v_mfma_f32_32x32x16_bf16 v[16:31], a[200:203], v[40:43], v[16:31]
    ds_read_b128 v[40:43], v2 offset:55296
    s_waitcnt lgkmcnt(3)
    v_mfma_f32_32x32x16_bf16 v[16:31], a[204:207], v[44:47], v[16:31]
    ds_read_b128 v[44:47], v2 offset:56320
    s_waitcnt lgkmcnt(3)
    v_mfma_f32_32x32x16_bf16 v[16:31], a[208:211], v[32:35], v[16:31]
    ds_read_b128 v[32:35], v2 offset:57344
    s_waitcnt lgkmcnt(3)
    v_mfma_f32_32x32x16_bf16 v[16:31], a[212:215], v[36:39], v[16:31]
    ds_read_b128 v[36:39], v2 offset:58368
    s_waitcnt lgkmcnt(3)
    v_mfma_f32_32x32x16_bf16 v[16:31], a[216:219], v[40:43], v[16:31]
    ds_read_b128 v[40:43], v2 offset:59392
    s_waitcnt lgkmcnt(3)
    v_mfma_f32_32x32x16_bf16 v[16:31], a[220:223], v[44:47], v[16:31]
    ds_read_b128 v[44:47], v2 offset:60416
    s_waitcnt lgkmcnt(3)
    v_mfma_f32_32x32x16_bf16 v[16:31], a[224:227], v[32:35], v[16:31]
    ds_read_b128 v[32:35], v2 offset:61440
    s_waitcnt lgkmcnt(3)
    v_mfma_f32_32x32x16_bf16 v[16:31], a[228:231], v[36:39], v[16:31]
    ds_read_b128 v[36:39], v2 offset:62464
    s_waitcnt lgkmcnt(3)
    v_mfma_f32_32x32x16_bf16 v[16:31], a[232:235], v[40:43], v[16:31]
    ds_read_b128 v[40:43], v2 offset:63488
    s_waitcnt lgkmcnt(3)
    v_mfma_f32_32x32x16_bf16 v[16:31], a[236:239], v[44:47], v[16:31]
    ds_read_b128 v[44:47], v2 offset:64512
    s_waitcnt lgkmcnt(3)
    v_mfma_f32_32x32x16_bf16 v[16:31], a[240:243], v[32:35], v[16:31]
    s_waitcnt lgkmcnt(2)
    v_mfma_f32_32x32x16_bf16 v[16:31], a[244:247], v[36:39], v[16:31]
    s_waitcnt lgkmcnt(1)
    v_mfma_f32_32x32x16_bf16 v[16:31], a[248:251], v[40:43], v[16:31]
    s_waitcnt lgkmcnt(0)
    v_mfma_f32_32x32x16_bf16 v[16:31], a[252:255], v[44:47], v[16:31]
    s_nop 11
    buffer_store_dwordx4 v[16:19], v1, s[4:7], s72 offen offset:0 sc1
    buffer_store_dwordx4 v[20:23], v1, s[4:7], s72 offen offset:1024 sc1
    buffer_store_dwordx4 v[24:27], v1, s[4:7], s72 offen offset:2048 sc1
    buffer_store_dwordx4 v[28:31], v1, s[4:7], s72 offen offset:3072 sc1
    s_add_u32 s72, s72, 655360
    s_add_u32 s71, s71, 524288
    s_waitcnt vmcnt(0)
    s_barrier
    s_cmp_lg_u32 s44, 0
    s_cbranch_scc1 L_np_187
    v_mov_b32 v8, 0
    v_mov_b32 v9, s69
    s_mov_b64 exec, 1
    buffer_store_dword v9, v8, s[4:7], s73 offen sc1
    s_mov_b64 exec, -1
L_np_187:
    s_add_u32 s61, s61, 2
    s_cmp_lt_u32 s61, 64
    s_cbranch_scc1 L_OP_LOOP
    s_branch L_END2
L_DP:
    v_bfe_u32 v1, v0, 0, 6
    v_lshlrev_b32 v1, 4, v1
    s_sub_u32 s62, s46, 20
    s_mul_i32 s75, s62, 52
    s_lshr_b32 s75, s75, 8
    s_mul_i32 s76, s75, 5
    s_sub_u32 s76, s62, s76
    s_add_u32 s73, s62, 232
    s_lshl_b32 s73, s73, 6
    s_mov_b32 s8, s36
    s_and_b32 s9, s37, 0xffff
    s_mov_b32 s10, 0x21c000
    s_mov_b32 s11, 0x20000
    s_mul_i32 s66, s75, 1105920
    s_lshl_b32 s62, s76, 8
    s_add_u32 s66, s66, s62
    v_bfe_u32 v4, v0, 0, 4
    v_lshlrev_b32 v4, 4, v4
    v_bfe_u32 v9, v0, 4, 2
    v_lshlrev_b32 v9, 6, v9
    v_xor_b32 v4, v4, v9
    v_bfe_u32 v9, v0, 4, 2
    v_mul_u32_u24 v9, 0x500, v9
    v_bfe_u32 v8, v0, 6, 2
    v_mul_u32_u24 v8, 0x5000, v8
    v_add_u32 v9, v8, v9
    v_add_u32 v4, v4, v9
    v_bfe_u32 v6, v0, 1, 1
    v_lshlrev_b32 v6, 4, v6
    v_bfe_u32 v8, v0, 4, 1
    v_lshl_add_u32 v6, v8, 5, v6
    v_bfe_u32 v8, v0, 6, 2
    v_lshl_add_u32 v6, v8, 6, v6
    v_bfe_u32 v9, v0, 2, 2
    v_lshlrev_b32 v9, 6, v9
    v_xor_b32 v6, v6, v9
    v_bfe_u32 v9, v0, 0, 1
    v_lshlrev_b32 v9, 3, v9
    v_bfe_u32 v8, v0, 2, 2
    v_lshl_add_u32 v9, v8, 8, v9
    v_bfe_u32 v8, v0, 5, 1
    v_lshl_add_u32 v9, v8, 10, v9
    v_add_u32 v6, v6, v9
    v_add_u32 v7, 0x10000, v6
    s_lshl_b32 s67, s44, 12
    s_add_u32 s63, s66, 0x0
    s_add_u32 s64, s67, 0x0
    s_mov_b32 m0, s64
    s_nop 0
    buffer_load_dwordx4 v4, s[8:11], s63 offen lds
    s_add_u32 s63, s66, 0x1400
    s_add_u32 s64, s67, 0x400
    s_mov_b32 m0, s64
    s_nop 0
    buffer_load_dwordx4 v4, s[8:11], s63 offen lds
    s_add_u32 s63, s66, 0x2800
    s_add_u32 s64, s67, 0x800
    s_mov_b32 m0, s64
    s_nop 0
    buffer_load_dwordx4 v4, s[8:11], s63 offen lds
    s_add_u32 s63, s66, 0x3c00
    s_add_u32 s64, s67, 0xc00
    s_mov_b32 m0, s64
    s_nop 0
    buffer_load_dwordx4 v4, s[8:11], s63 offen lds
    s_add_u32 s63, s66, 0x14000
    s_add_u32 s64, s67, 0x4000
    s_mov_b32 m0, s64
    s_nop 0
    buffer_load_dwordx4 v4, s[8:11], s63 offen lds
    s_add_u32 s63, s66, 0x15400
    s_add_u32 s64, s67, 0x4400
    s_mov_b32 m0, s64
    s_nop 0
    buffer_load_dwordx4 v4, s[8:11], s63 offen lds
    s_add_u32 s63, s66, 0x16800
    s_add_u32 s64, s67, 0x4800
    s_mov_b32 m0, s64
    s_nop 0
    buffer_load_dwordx4 v4, s[8:11], s63 offen lds
    s_add_u32 s63, s66, 0x17c00
    s_add_u32 s64, s67, 0x4c00
    s_mov_b32 m0, s64
    s_nop 0
    buffer_load_dwordx4 v4, s[8:11], s63 offen lds
    s_add_u32 s63, s66, 0x28000
    s_add_u32 s64, s67, 0x8000
    s_mov_b32 m0, s64
    s_nop 0
    buffer_load_dwordx4 v4, s[8:11], s63 offen lds
    s_add_u32 s63, s66, 0x29400
    s_add_u32 s64, s67, 0x8400
    s_mov_b32 m0, s64
    s_nop 0
    buffer_load_dwordx4 v4, s[8:11], s63 offen lds
    s_add_u32 s63, s66, 0x2a800
    s_add_u32 s64, s67, 0x8800
    s_mov_b32 m0, s64
    s_nop 0
    buffer_load_dwordx4 v4, s[8:11], s63 offen lds
    s_add_u32 s63, s66, 0x2bc00
    s_add_u32 s64, s67, 0x8c00
    s_mov_b32 m0, s64
    s_nop 0
    buffer_load_dwordx4 v4, s[8:11], s63 offen lds
    s_add_u32 s63, s66, 0x3c000
    s_add_u32 s64, s67, 0xc000
    s_mov_b32 m0, s64
    s_nop 0
    buffer_load_dwordx4 v4, s[8:11], s63 offen lds
    s_add_u32 s63, s66, 0x3d400
    s_add_u32 s64, s67, 0xc400
    s_mov_b32 m0, s64
    s_nop 0
    buffer_load_dwordx4 v4, s[8:11], s63 offen lds
    s_add_u32 s63, s66, 0x3e800
    s_add_u32 s64, s67, 0xc800
    s_mov_b32 m0, s64
    s_nop 0
    buffer_load_dwordx4 v4, s[8:11], s63 offen lds
    s_add_u32 s63, s66, 0x3fc00
    s_add_u32 s64, s67, 0xcc00
    s_mov_b32 m0, s64
    s_nop 0
    buffer_load_dwordx4 v4, s[8:11], s63 offen lds
    s_add_u32 s63, s66, 0x50000
    s_add_u32 s64, s67, 0x10000
    s_mov_b32 m0, s64
    s_nop 0
    buffer_load_dwordx4 v4, s[8:11], s63 offen lds
    s_add_u32 s63, s66, 0x51400
    s_add_u32 s64, s67, 0x10400
    s_mov_b32 m0, s64
    s_nop 0
    buffer_load_dwordx4 v4, s[8:11], s63 offen lds
    s_add_u32 s63, s66, 0x52800
    s_add_u32 s64, s67, 0x10800
    s_mov_b32 m0, s64
    s_nop 0
    buffer_load_dwordx4 v4, s[8:11], s63 offen lds
    s_add_u32 s63, s66, 0x53c00
    s_add_u32 s64, s67, 0x10c00
    s_mov_b32 m0, s64
    s_nop 0
    buffer_load_dwordx4 v4, s[8:11], s63 offen lds
    s_add_u32 s63, s66, 0x64000
    s_add_u32 s64, s67, 0x14000
    s_mov_b32 m0, s64
    s_nop 0
    buffer_load_dwordx4 v4, s[8:11], s63 offen lds
    s_add_u32 s63, s66, 0x65400
    s_add_u32 s64, s67, 0x14400
    s_mov_b32 m0, s64
    s_nop 0
    buffer_load_dwordx4 v4, s[8:11], s63 offen lds
    s_add_u32 s63, s66, 0x66800
    s_add_u32 s64, s67, 0x14800
    s_mov_b32 m0, s64
    s_nop 0
    buffer_load_dwordx4 v4, s[8:11], s63 offen lds
    s_add_u32 s63, s66, 0x67c00
    s_add_u32 s64, s67, 0x14c00
    s_mov_b32 m0, s64
    s_nop 0
    buffer_load_dwordx4 v4, s[8:11], s63 offen lds
    s_add_u32 s63, s66, 0x78000
    s_add_u32 s64, s67, 0x18000
    s_mov_b32 m0, s64
    s_nop 0
    buffer_load_dwordx4 v4, s[8:11], s63 offen lds
    s_add_u32 s63, s66, 0x79400
    s_add_u32 s64, s67, 0x18400
    s_mov_b32 m0, s64
    s_nop 0
    buffer_load_dwordx4 v4, s[8:11], s63 offen lds
    s_add_u32 s63, s66, 0x7a800
    s_add_u32 s64, s67, 0x18800
    s_mov_b32 m0, s64
    s_nop 0
    buffer_load_dwordx4 v4, s[8:11], s63 offen lds
    s_add_u32 s63, s66, 0x7bc00
    s_add_u32 s64, s67, 0x18c00
    s_mov_b32 m0, s64
    s_nop 0
    buffer_load_dwordx4 v4, s[8:11], s63 offen lds
    s_waitcnt vmcnt(24) lgkmcnt(0)
    s_barrier
    s_add_u32 s63, s66, 0x8c000
    s_add_u32 s64, s67, 0x1c000
    s_mov_b32 m0, s64
    s_nop 0
    buffer_load_dwordx4 v4, s[8:11], s63 offen lds
    s_add_u32 s63, s66, 0x8d400
    s_add_u32 s64, s67, 0x1c400
    s_mov_b32 m0, s64
    s_nop 0
    buffer_load_dwordx4 v4, s[8:11], s63 offen lds
    s_add_u32 s63, s66, 0x8e800
    s_add_u32 s64, s67, 0x1c800
    s_mov_b32 m0, s64
    s_nop 0
    buffer_load_dwordx4 v4, s[8:11], s63 offen lds
    s_add_u32 s63, s66, 0x8fc00
    s_add_u32 s64, s67, 0x1cc00
    s_mov_b32 m0, s64
    s_nop 0
    buffer_load_dwordx4 v4, s[8:11], s63 offen lds
    ds_read_b64_tr_b16 a[0:1], v6 offset:0
    ds_read_b64_tr_b16 a[2:3], v6 offset:2048
    ds_read_b64_tr_b16 a[4:5], v6 offset:4096
    ds_read_b64_tr_b16 a[6:7], v6 offset:6144
    ds_read_b64_tr_b16 a[8:9], v6 offset:8192
    ds_read_b64_tr_b16 a[10:11], v6 offset:10240
    ds_read_b64_tr_b16 a[12:13], v6 offset:12288
    ds_read_b64_tr_b16 a[14:15], v6 offset:14336
    s_waitcnt vmcnt(24) lgkmcnt(0)
    s_barrier
    s_add_u32 s63, s66, 0xa0000
    s_add_u32 s64, s67, 0x0
    s_mov_b32 m0, s64
    s_nop 0
    buffer_load_dwordx4 v4, s[8:11], s63 offen lds
    s_add_u32 s63, s66, 0xa1400
    s_add_u32 s64, s67, 0x400
    s_mov_b32 m0, s64
    s_nop 0
    buffer_load_dwordx4 v4, s[8:11], s63 offen lds
    s_add_u32 s63, s66, 0xa2800
    s_add_u32 s64, s67, 0x800
    s_mov_b32 m0, s64
    s_nop 0
    buffer_load_dwordx4 v4, s[8:11], s63 offen lds
    s_add_u32 s63, s66, 0xa3c00
    s_add_u32 s64, s67, 0xc00
    s_mov_b32 m0, s64
    s_nop 0
    buffer_load_dwordx4 v4, s[8:11], s63 offen lds
    ds_read_b64_tr_b16 a[16:17], v6 offset:16384
    ds_read_b64_tr_b16 a[18:19], v6 offset:18432
    ds_read_b64_tr_b16 a[20:21], v6 offset:20480
    ds_read_b64_tr_b16 a[22:23], v6 offset:22528
    ds_read_b64_tr_b16 a[24:25], v6 offset:24576
    ds_read_b64_tr_b16 a[26:27], v6 offset:26624
    ds_read_b64_tr_b16 a[28:29], v6 offset:28672
    ds_read_b64_tr_b16 a[30:31], v6 offset:30720
    s_waitcnt vmcnt(24) lgkmcnt(0)
    s_barrier
    s_add_u32 s63, s66, 0xb4000
    s_add_u32 s64, s67, 0x4000
    s_mov_b32 m0, s64
    s_nop 0
    buffer_load_dwordx4 v4, s[8:11], s63 offen lds
    s_add_u32 s63, s66, 0xb5400
    s_add_u32 s64, s67, 0x4400
    s_mov_b32 m0, s64
    s_nop 0
    buffer_load_dwordx4 v4, s[8:11], s63 offen lds
    s_add_u32 s63, s66, 0xb6800
    s_add_u32 s64, s67, 0x4800
    s_mov_b32 m0, s64
    s_nop 0
    buffer_load_dwordx4 v4, s[8:11], s63 offen lds
    s_add_u32 s63, s66, 0xb7c00
    s_add_u32 s64, s67, 0x4c00
    s_mov_b32 m0, s64
    s_nop 0
    buffer_load_dwordx4 v4, s[8:11], s63 offen lds
    ds_read_b64_tr_b16 a[32:33], v6 offset:32768
    ds_read_b64_tr_b16 a[34:35], v6 offset:34816
    ds_read_b64_tr_b16 a[36:37], v6 offset:36864
    ds_read_b64_tr_b16 a[38:39], v6 offset:38912
    ds_read_b64_tr_b16 a[40:41], v6 offset:40960
    ds_read_b64_tr_b16 a[42:43], v6 offset:43008
    ds_read_b64_tr_b16 a[44:45], v6 offset:45056
    ds_read_b64_tr_b16 a[46:47], v6 offset:47104
    s_waitcnt vmcnt(24) lgkmcnt(0)
    s_barrier
    s_add_u32 s63, s66, 0xc8000
    s_add_u32 s64, s67, 0x8000
    s_mov_b32 m0, s64
    s_nop 0
    buffer_load_dwordx4 v4, s[8:11], s63 offen lds
    s_add_u32 s63, s66, 0xc9400
    s_add_u32 s64, s67, 0x8400
    s_mov_b32 m0, s64
    s_nop 0
    buffer_load_dwordx4 v4, s[8:11], s63 offen lds
    s_add_u32 s63, s66, 0xca800
    s_add_u32 s64, s67, 0x8800
    s_mov_b32 m0, s64
    s_nop 0
    buffer_load_dwordx4 v4, s[8:11], s63 offen lds
    s_add_u32 s63, s66, 0xcbc00
    s_add_u32 s64, s67, 0x8c00
    s_mov_b32 m0, s64
    s_nop 0
    buffer_load_dwordx4 v4, s[8:11], s63 offen lds
    ds_read_b64_tr_b16 a[48:49], v6 offset:49152
    ds_read_b64_tr_b16 a[50:51], v6 offset:51200
    ds_read_b64_tr_b16 a[52:53], v6 offset:53248
    ds_read_b64_tr_b16 a[54:55], v6 offset:55296
    ds_read_b64_tr_b16 a[56:57], v6 offset:57344
    ds_read_b64_tr_b16 a[58:59], v6 offset:59392
    ds_read_b64_tr_b16 a[60:61], v6 offset:61440
    ds_read_b64_tr_b16 a[62:63], v6 offset:63488
    s_waitcnt vmcnt(24) lgkmcnt(0)
    s_barrier
    s_add_u32 s63, s66, 0xdc000
    s_add_u32 s64, s67, 0xc000
    s_mov_b32 m0, s64
    s_nop 0
    buffer_load_dwordx4 v4, s[8:11], s63 offen lds
    s_add_u32 s63, s66, 0xdd400
    s_add_u32 s64, s67, 0xc400
    s_mov_b32 m0, s64
    s_nop 0
    buffer_load_dwordx4 v4, s[8:11], s63 offen lds
    s_add_u32 s63, s66, 0xde800
    s_add_u32 s64, s67, 0xc800
    s_mov_b32 m0, s64
    s_nop 0
    buffer_load_dwordx4 v4, s[8:11], s63 offen lds
    s_add_u32 s63, s66, 0xdfc00
    s_add_u32 s64, s67, 0xcc00
    s_mov_b32 m0, s64
    s_nop 0
    buffer_load_dwordx4 v4, s[8:11], s63 offen lds
    ds_read_b64_tr_b16 a[64:65], v7 offset:0
    ds_read_b64_tr_b16 a[66:67], v7 offset:2048
    ds_read_b64_tr_b16 a[68:69], v7 offset:4096
    ds_read_b64_tr_b16 a[70:71], v7 offset:6144
    ds_read_b64_tr_b16 a[72:73], v7 offset:8192
    ds_read_b64_tr_b16 a[74:75], v7 offset:10240
    ds_read_b64_tr_b16 a[76:77], v7 offset:12288
    ds_read_b64_tr_b16 a[78:79], v7 offset:14336
    s_waitcnt vmcnt(24) lgkmcnt(0)
    s_barrier
    s_add_u32 s63, s66, 0xf0000
    s_add_u32 s64, s67, 0x10000
    s_mov_b32 m0, s64
    s_nop 0
    buffer_load_dwordx4 v4, s[8:11], s63 offen lds
    s_add_u32 s63, s66, 0xf1400
    s_add_u32 s64, s67, 0x10400
    s_mov_b32 m0, s64
    s_nop 0
    buffer_load_dwordx4 v4, s[8:11], s63 offen lds
    s_add_u32 s63, s66, 0xf2800
    s_add_u32 s64, s67, 0x10800
    s_mov_b32 m0, s64
    s_nop 0
    buffer_load_dwordx4 v4, s[8:11], s63 offen lds
    s_add_u32 s63, s66, 0xf3c00
    s_add_u32 s64, s67, 0x10c00
    s_mov_b32 m0, s64
    s_nop 0
    buffer_load_dwordx4 v4, s[8:11], s63 offen lds
    ds_read_b64_tr_b16 a[80:81], v7 offset:16384
    ds_read_b64_tr_b16 a[82:83], v7 offset:18432
    ds_read_b64_tr_b16 a[84:85], v7 offset:20480
    ds_read_b64_tr_b16 a[86:87], v7 offset:22528
    ds_read_b64_tr_b16 a[88:89], v7 offset:24576
    ds_read_b64_tr_b16 a[90:91], v7 offset:26624
    ds_read_b64_tr_b16 a[92:93], v7 offset:28672
    ds_read_b64_tr_b16 a[94:95], v7 offset:30720
    s_waitcnt vmcnt(24) lgkmcnt(0)
    s_barrier
    s_add_u32 s63, s66, 0x104000
    s_add_u32 s64, s67, 0x14000
    s_mov_b32 m0, s64
    s_nop 0
    buffer_load_dwordx4 v4, s[8:11], s63 offen lds
    s_add_u32 s63, s66, 0x105400
    s_add_u32 s64, s67, 0x14400
    s_mov_b32 m0, s64
    s_nop 0
    buffer_load_dwordx4 v4, s[8:11], s63 offen lds
    s_add_u32 s63, s66, 0x106800
    s_add_u32 s64, s67, 0x14800
    s_mov_b32 m0, s64
    s_nop 0
    buffer_load_dwordx4 v4, s[8:11], s63 offen lds
    s_add_u32 s63, s66, 0x107c00
    s_add_u32 s64, s67, 0x14c00
    s_mov_b32 m0, s64
    s_nop 0
    buffer_load_dwordx4 v4, s[8:11], s63 offen lds
    ds_read_b64_tr_b16 a[96:97], v7 offset:32768
    ds_read_b64_tr_b16 a[98:99], v7 offset:34816
    ds_read_b64_tr_b16 a[100:101], v7 offset:36864
    ds_read_b64_tr_b16 a[102:103], v7 offset:38912
    ds_read_b64_tr_b16 a[104:105], v7 offset:40960
    ds_read_b64_tr_b16 a[106:107], v7 offset:43008
    ds_read_b64_tr_b16 a[108:109], v7 offset:45056
    ds_read_b64_tr_b16 a[110:111], v7 offset:47104
    s_waitcnt vmcnt(24) lgkmcnt(0)
    s_barrier
    ds_read_b64_tr_b16 a[112:113], v7 offset:49152
    ds_read_b64_tr_b16 a[114:115], v7 offset:51200
    ds_read_b64_tr_b16 a[116:117], v7 offset:53248
    ds_read_b64_tr_b16 a[118:119], v7 offset:55296
    ds_read_b64_tr_b16 a[120:121], v7 offset:57344
    ds_read_b64_tr_b16 a[122:123], v7 offset:59392
    ds_read_b64_tr_b16 a[124:125], v7 offset:61440
    ds_read_b64_tr_b16 a[126:127], v7 offset:63488
    s_waitcnt vmcnt(20) lgkmcnt(0)
    s_barrier
    ds_read_b64_tr_b16 a[128:129], v6 offset:0
    ds_read_b64_tr_b16 a[130:131], v6 offset:2048
    ds_read_b64_tr_b16 a[132:133], v6 offset:4096
    ds_read_b64_tr_b16 a[134:135], v6 offset:6144
    ds_read_b64_tr_b16 a[136:137], v6 offset:8192
    ds_read_b64_tr_b16 a[138:139], v6 offset:10240
    ds_read_b64_tr_b16 a[140:141], v6 offset:12288
    ds_read_b64_tr_b16 a[142:143], v6 offset:14336
    s_waitcnt vmcnt(16) lgkmcnt(0)
    s_barrier
    ds_read_b64_tr_b16 a[144:145], v6 offset:16384
    ds_read_b64_tr_b16 a[146:147], v6 offset:18432
    ds_read_b64_tr_b16 a[148:149], v6 offset:20480
    ds_read_b64_tr_b16 a[150:151], v6 offset:22528
    ds_read_b64_tr_b16 a[152:153], v6 offset:24576
    ds_read_b64_tr_b16 a[154:155], v6 offset:26624
    ds_read_b64_tr_b16 a[156:157], v6 offset:28672
    ds_read_b64_tr_b16 a[158:159], v6 offset:30720
    s_waitcnt vmcnt(12) lgkmcnt(0)
    s_barrier
    ds_read_b64_tr_b16 a[160:161], v6 offset:32768
    ds_read_b64_tr_b16 a[162:163], v6 offset:34816
    ds_read_b64_tr_b16 a[164:165], v6 offset:36864
    ds_read_b64_tr_b16 a[166:167], v6 offset:38912
    ds_read_b64_tr_b16 a[168:169], v6 offset:40960
    ds_read_b64_tr_b16 a[170:171], v6 offset:43008
    ds_read_b64_tr_b16 a[172:173], v6 offset:45056
    ds_read_b64_tr_b16 a[174:175], v6 offset:47104
    s_waitcnt vmcnt(8) lgkmcnt(0)
    s_barrier
    ds_read_b64_tr_b16 a[176:177], v6 offset:49152
    ds_read_b64_tr_b16 a[178:179], v6 offset:51200
    ds_read_b64_tr_b16 a[180:181], v6 offset:53248
    ds_read_b64_tr_b16 a[182:183], v6 offset:55296
    ds_read_b64_tr_b16 a[184:185], v6 offset:57344
    ds_read_b64_tr_b16 a[186:187], v6 offset:59392
    ds_read_b64_tr_b16 a[188:189], v6 offset:61440
    ds_read_b64_tr_b16 a[190:191], v6 offset:63488
    s_waitcnt vmcnt(4) lgkmcnt(0)
    s_barrier
    ds_read_b64_tr_b16 a[192:193], v7 offset:0
    ds_read_b64_tr_b16 a[194:195], v7 offset:2048
    ds_read_b64_tr_b16 a[196:197], v7 offset:4096
    ds_read_b64_tr_b16 a[198:199], v7 offset:6144
    ds_read_b64_tr_b16 a[200:201], v7 offset:8192
    ds_read_b64_tr_b16 a[202:203], v7 offset:10240
    ds_read_b64_tr_b16 a[204:205], v7 offset:12288
    ds_read_b64_tr_b16 a[206:207], v7 offset:14336
    s_waitcnt vmcnt(0) lgkmcnt(0)
    s_barrier
    ds_read_b64_tr_b16 a[208:209], v7 offset:16384
    ds_read_b64_tr_b16 a[210:211], v7 offset:18432
    ds_read_b64_tr_b16 a[212:213], v7 offset:20480
    ds_read_b64_tr_b16 a[214:215], v7 offset:22528
    s_waitcnt lgkmcnt(0)
    s_barrier
    s_mul_i32 s72, s75, 20
    s_lshl_b32 s62, s76, 2
    s_add_u32 s72, s72, s62
    s_add_u32 s72, s72, s44
    s_lshl_b32 s72, s72, 12
    s_add_u32 s72, s72, 0x5000000
    v_and_b32 v10, 63, v0
    v_min_u32 v10, 13, v10
    s_mul_i32 s62, s75, 13
    s_add_u32 s62, s62, 128
    v_add_u32 v10, s62, v10
    v_lshlrev_b32 v10, 6, v10
    s_mul_i32 s67, s44, 13
    s_min_u32 s62, s44, 1
    s_add_u32 s67, s67, s62
    s_lshl_b32 s67, s67, 10
    s_mul_i32 s71, s75, 55296
    s_add_u32 s71, s71, s67
    s_add_u32 s71, s71, 0x2400000
    s_mov_b32 s70, 0
    s_mov_b32 s74, 0
    s_mov_b32 s68, 0
    s_cmp_ge_u32 s68, 1
    s_cbranch_scc1 L_hv_188
    s_mov_b32 s60, 0
L_pf_189:
    buffer_load_dword v9, v10, s[4:7], 0 offen sc1
    s_waitcnt vmcnt(0)
    v_cmp_gt_u32 vcc, 1, v9
    s_nop 0
    s_cbranch_vccz L_pfd_190
    s_sleep 1
    s_add_u32 s60, s60, 1
    s_cmp_lt_u32 s60, 0x100000
    s_cbranch_scc1 L_pf_189
    s_movk_i32 s62, 5
    s_branch L_ABORT
L_pfd_190:
    v_readlane_b32 s68, v9, 0
    v_readlane_b32 s62, v9, 1
    s_nop 0
    s_min_u32 s68, s68, s62
    v_readlane_b32 s62, v9, 2
    s_nop 0
    s_min_u32 s68, s68, s62
    v_readlane_b32 s62, v9, 3
    s_nop 0
    s_min_u32 s68, s68, s62
    v_readlane_b32 s62, v9, 4
    s_nop 0
    s_min_u32 s68, s68, s62
    v_readlane_b32 s62, v9, 5
    s_nop 0
    s_min_u32 s68, s68, s62
    v_readlane_b32 s62, v9, 6
    s_nop 0
    s_min_u32 s68, s68, s62
    v_readlane_b32 s62, v9, 7
    s_nop 0
    s_min_u32 s68, s68, s62
    v_readlane_b32 s62, v9, 8
    s_nop 0
    s_min_u32 s68, s68, s62
    v_readlane_b32 s62, v9, 9
    s_nop 0
    s_min_u32 s68, s68, s62
    v_readlane_b32 s62, v9, 10
    s_nop 0
    s_min_u32 s68, s68, s62
    v_readlane_b32 s62, v9, 11
    s_nop 0
    s_min_u32 s68, s68, s62
    v_readlane_b32 s62, v9, 12
    s_nop 0
    s_min_u32 s68, s68, s62
    v_readlane_b32 s62, v9, 13
    s_nop 0
    s_min_u32 s68, s68, s62
L_hv_188:
    s_add_u32 s64, s70, s67
    s_add_u32 m0, s64, 0
    s_add_u32 s63, s71, 0
    buffer_load_dwordx4 v1, s[4:7], s63 offen offset:0 sc1 lds
    buffer_load_dwordx4 v1, s[4:7], s63 offen offset:1024 sc1 lds
    buffer_load_dwordx4 v1, s[4:7], s63 offen offset:2048 sc1 lds
    buffer_load_dwordx4 v1, s[4:7], s63 offen offset:3072 sc1 lds
    s_add_u32 m0, s64, 4096
    s_add_u32 s63, s71, 4096
    buffer_load_dwordx4 v1, s[4:7], s63 offen offset:0 sc1 lds
    buffer_load_dwordx4 v1, s[4:7], s63 offen offset:1024 sc1 lds
    buffer_load_dwordx4 v1, s[4:7], s63 offen offset:2048 sc1 lds
    buffer_load_dwordx4 v1, s[4:7], s63 offen offset:3072 sc1 lds
    s_add_u32 m0, s64, 8192
    s_add_u32 s63, s71, 8192
    buffer_load_dwordx4 v1, s[4:7], s63 offen offset:0 sc1 lds
    buffer_load_dwordx4 v1, s[4:7], s63 offen offset:1024 sc1 lds
    buffer_load_dwordx4 v1, s[4:7], s63 offen offset:2048 sc1 lds
    buffer_load_dwordx4 v1, s[4:7], s63 offen offset:3072 sc1 lds
    s_add_u32 m0, s64, 12288
    s_add_u32 s63, s71, 12288
    buffer_load_dwordx4 v1, s[4:7], s63 offen offset:0 sc1 lds
    buffer_load_dwordx4 v1, s[4:7], s63 offen offset:1024 sc1 lds
    s_add_u32 s71, s71, 110592
    s_add_u32 s70, s70, 55296
    s_cmp_ge_u32 s70, 110592
    s_cselect_b32 s70, 0, s70
    s_mov_b32 s61, 0
    s_waitcnt vmcnt(0)
L_DP_LOOP:
    s_barrier
    s_cmp_lg_u32 s44, 0
    s_cbranch_scc1 L_np_191
    s_cmp_lt_u32 s61, 2
    s_cbranch_scc1 L_np_191
    s_sub_u32 s65, s61, 1
    v_mov_b32 v8, 0
    v_mov_b32 v9, s65
    s_mov_b64 exec, 1
    buffer_store_dword v9, v8, s[4:7], s73 offen sc1
    s_mov_b64 exec, -1
L_np_191:
    s_add_u32 s69, s61, 2
    s_min_u32 s69, s69, 64
    s_cmp_ge_u32 s68, s69
    s_cbranch_scc1 L_hv_192
    s_mov_b32 s60, 0
L_pf_193:
    buffer_load_dword v9, v10, s[4:7], 0 offen sc1
    s_waitcnt vmcnt(0)
    v_cmp_gt_u32 vcc, s69, v9
    s_nop 0
    s_cbranch_vccz L_pfd_194
    s_sleep 1
    s_add_u32 s60, s60, 1
    s_cmp_lt_u32 s60, 0x100000
    s_cbranch_scc1 L_pf_193
    s_movk_i32 s62, 6
    s_branch L_ABORT
L_pfd_194:
    v_readlane_b32 s68, v9, 0
    v_readlane_b32 s62, v9, 1
    s_nop 0
    s_min_u32 s68, s68, s62
    v_readlane_b32 s62, v9, 2
    s_nop 0
    s_min_u32 s68, s68, s62
    v_readlane_b32 s62, v9, 3
    s_nop 0
    s_min_u32 s68, s68, s62
    v_readlane_b32 s62, v9, 4
    s_nop 0
    s_min_u32 s68, s68, s62
    v_readlane_b32 s62, v9, 5
    s_nop 0
    s_min_u32 s68, s68, s62
    v_readlane_b32 s62, v9, 6
    s_nop 0
    s_min_u32 s68, s68, s62
    v_readlane_b32 s62, v9, 7
    s_nop 0
    s_min_u32 s68, s68, s62
    v_readlane_b32 s62, v9, 8
    s_nop 0
    s_min_u32 s68, s68, s62
    v_readlane_b32 s62, v9, 9
    s_nop 0
    s_min_u32 s68, s68, s62
    v_readlane_b32 s62, v9, 10
    s_nop 0
    s_min_u32 s68, s68, s62
    v_readlane_b32 s62, v9, 11
    s_nop 0
    s_min_u32 s68, s68, s62
    v_readlane_b32 s62, v9, 12
    s_nop 0
    s_min_u32 s68, s68, s62
    v_readlane_b32 s62, v9, 13
    s_nop 0
    s_min_u32 s68, s68, s62
L_hv_192:
    v_add_u32 v2, s74, v1
    ds_read_b128 v[32:35], v2 offset:0
    ds_read_b128 v[36:39], v2 offset:1024
    ds_read_b128 v[40:43], v2 offset:2048
    ds_read_b128 v[44:47], v2 offset:3072
    s_waitcnt lgkmcnt(3)
    v_mfma_f32_32x32x16_bf16 v[16:31], a[0:3], v[32:35], 0
    ds_read_b128 v[32:35], v2 offset:4096
    s_waitcnt lgkmcnt(3)
    v_mfma_f32_32x32x16_bf16 v[16:31], a[4:7], v[36:39], v[16:31]
    ds_read_b128 v[36:39], v2 offset:5120
    s_add_u32 s64, s70, s67
    s_add_u32 m0, s64, 0
    s_add_u32 s63, s71, 0
    buffer_load_dwordx4 v1, s[4:7], s63 offen offset:0 sc1 lds
    s_waitcnt lgkmcnt(3)
    v_mfma_f32_32x32x16_bf16 v[16:31], a[8:11], v[40:43], v[16:31]
    ds_read_b128 v[40:43], v2 offset:6144
    s_waitcnt lgkmcnt(3)
    v_mfma_f32_32x32x16_bf16 v[16:31], a[12:15], v[44:47], v[16:31]
    ds_read_b128 v[44:47], v2 offset:7168
    s_waitcnt lgkmcnt(3)
    v_mfma_f32_32x32x16_bf16 v[16:31], a[16:19], v[32:35], v[16:31]
    ds_read_b128 v[32:35], v2 offset:8192
    buffer_load_dwordx4 v1, s[4:7], s63 offen offset:1024 sc1 lds
    s_waitcnt lgkmcnt(3)
    v_mfma_f32_32x32x16_bf16 v[16:31], a[20:23], v[36:39], v[16:31]
    ds_read_b128 v[36:39], v2 offset:9216
    s_waitcnt lgkmcnt(3)
    v_mfma_f32_32x32x16_bf16 v[16:31], a[24:27], v[40:43], v[16:31]
    ds_read_b128 v[40:43], v2 offset:10240
    s_waitcnt lgkmcnt(3)
    v_mfma_f32_32x32x16_bf16 v[16:31], a[28:31], v[44:47], v[16:31]
    ds_read_b128 v[44:47], v2 offset:11264
    buffer_load_dwordx4 v1, s[4:7], s63 offen offset:2048 sc1 lds
    s_waitcnt lgkmcnt(3)
    v_mfma_f32_32x32x16_bf16 v[16:31], a[32:35], v[32:35], v[16:31]
    ds_read_b128 v[32:35], v2 offset:12288
    s_waitcnt lgkmcnt(3)
    v_mfma_f32_32x32x16_bf16 v[16:31], a[36:39], v[36:39], v[16:31]
    ds_read_b128 v[36:39], v2 offset:13312
    s_waitcnt lgkmcnt(3)
    v_mfma_f32_32x32x16_bf16 v[16:31], a[40:43], v[40:43], v[16:31]
    ds_read_b128 v[40:43], v2 offset:14336
    buffer_load_dwordx4 v1, s[4:7], s63 offen offset:3072 sc1 lds
    s_waitcnt lgkmcnt(3)
    v_mfma_f32_32x32x16_bf16 v[16:31], a[44:47], v[44:47], v[16:31]
    ds_read_b128 v[44:47], v2 offset:15360
    s_waitcnt lgkmcnt(3)
    v_mfma_f32_32x32x16_bf16 v[16:31], a[48:51], v[32:35], v[16:31]
    ds_read_b128 v[32:35], v2 offset:16384
    s_waitcnt lgkmcnt(3)
    v_mfma_f32_32x32x16_bf16 v[16:31], a[52:55], v[36:39], v[16:31]
    ds_read_b128 v[36:39], v2 offset:17408
    s_add_u32 m0, s64, 4096
    s_add_u32 s63, s71, 4096
    buffer_load_dwordx4 v1, s[4:7], s63 offen offset:0 sc1 lds
    s_waitcnt lgkmcnt(3)
    v_mfma_f32_32x32x16_bf16 v[16:31], a[56:59], v[40:43], v[16:31]
    ds_read_b128 v[40:43], v2 offset:18432
    s_waitcnt lgkmcnt(3)
    v_mfma_f32_32x32x16_bf16 v[16:31], a[60:63], v[44:47], v[16:31]
    ds_read_b128 v[44:47], v2 offset:19456
    s_waitcnt lgkmcnt(3)
    v_mfma_f32_32x32x16_bf16 v[16:31], a[64:67], v[32:35], v[16:31]
    ds_read_b128 v[32:35], v2 offset:20480
    buffer_load_dwordx4 v1, s[4:7], s63 offen offset:1024 sc1 lds
    s_waitcnt lgkmcnt(3)
    v_mfma_f32_32x32x16_bf16 v[16:31], a[68:71], v[36:39], v[16:31]
    ds_read_b128 v[36:39], v2 offset:21504
    s_waitcnt lgkmcnt(3)
    v_mfma_f32_32x32x16_bf16 v[16:31], a[72:75], v[40:43], v[16:31]
    ds_read_b128 v[40:43], v2 offset:22528
    s_waitcnt lgkmcnt(3)
    v_mfma_f32_32x32x16_bf16 v[16:31], a[76:79], v[44:47], v[16:31]
    ds_read_b128 v[44:47], v2 offset:23552
    buffer_load_dwordx4 v1, s[4:7], s63 offen offset:2048 sc1 lds
    s_waitcnt lgkmcnt(3)
    v_mfma_f32_32x32x16_bf16 v[16:31], a[80:83], v[32:35], v[16:31]
    ds_read_b128 v[32:35], v2 offset:24576
    s_waitcnt lgkmcnt(3)
    v_mfma_f32_32x32x16_bf16 v[16:31], a[84:87], v[36:39], v[16:31]
    ds_read_b128 v[36:39], v2 offset:25600
    s_waitcnt lgkmcnt(3)
    v_mfma_f32_32x32x16_bf16 v[16:31], a[88:91], v[40:43], v[16:31]
    ds_read_b128 v[40:43], v2 offset:26624
    buffer_load_dwordx4 v1, s[4:7], s63 offen offset:3072 sc1 lds
    s_waitcnt lgkmcnt(3)
    v_mfma_f32_32x32x16_bf16 v[16:31], a[92:95], v[44:47], v[16:31]
    ds_read_b128 v[44:47], v2 offset:27648
    s_waitcnt lgkmcnt(3)
    v_mfma_f32_32x32x16_bf16 v[16:31], a[96:99], v[32:35], v[16:31]
    ds_read_b128 v[32:35], v2 offset:28672
    s_waitcnt lgkmcnt(3)
    v_mfma_f32_32x32x16_bf16 v[16:31], a[100:103], v[36:39], v[16:31]
    ds_read_b128 v[36:39], v2 offset:29696
    s_add_u32 m0, s64, 8192
    s_add_u32 s63, s71, 8192
    buffer_load_dwordx4 v1, s[4:7], s63 offen offset:0 sc1 lds
    s_waitcnt lgkmcnt(3)
    v_mfma_f32_32x32x16_bf16 v[16:31], a[104:107], v[40:43], v[16:31]
    ds_read_b128 v[40:43], v2 offset:30720
    s_waitcnt lgkmcnt(3)
    v_mfma_f32_32x32x16_bf16 v[16:31], a[108:111], v[44:47], v[16:31]
    ds_read_b128 v[44:47], v2 offset:31744
    s_waitcnt lgkmcnt(3)
    v_mfma_f32_32x32x16_bf16 v[16:31], a[112:115], v[32:35], v[16:31]
    ds_read_b128 v[32:35], v2 offset:32768
    buffer_load_dwordx4 v1, s[4:7], s63 offen offset:1024 sc1 lds
    s_waitcnt lgkmcnt(3)
    v_mfma_f32_32x32x16_bf16 v[16:31], a[116:119], v[36:39], v[16:31]
    ds_read_b128 v[36:39], v2 offset:33792
    s_waitcnt lgkmcnt(3)
    v_mfma_f32_32x32x16_bf16 v[16:31], a[120:123], v[40:43], v[16:31]
    ds_read_b128 v[40:43], v2 offset:34816
    s_waitcnt lgkmcnt(3)
    v_mfma_f32_32x32x16_bf16 v[16:31], a[124:127], v[44:47], v[16:31]
    ds_read_b128 v[44:47], v2 offset:35840
    buffer_load_dwordx4 v1, s[4:7], s63 offen offset:2048 sc1 lds
    s_waitcnt lgkmcnt(3)
    v_mfma_f32_32x32x16_bf16 v[16:31], a[128:131], v[32:35], v[16:31]
    ds_read_b128 v[32:35], v2 offset:36864
    s_waitcnt lgkmcnt(3)
    v_mfma_f32_32x32x16_bf16 v[16:31], a[132:135], v[36:39], v[16:31]
    ds_read_b128 v[36:39], v2 offset:37888
    s_waitcnt lgkmcnt(3)
    v_mfma_f32_32x32x16_bf16 v[16:31], a[136:139], v[40:43], v[16:31]
    ds_read_b128 v[40:43], v2 offset:38912
    buffer_load_dwordx4 v1, s[4:7], s63 offen offset:3072 sc1 lds
    s_waitcnt lgkmcnt(3)
    v_mfma_f32_32x32x16_bf16 v[16:31], a[140:143], v[44:47], v[16:31]
    ds_read_b128 v[44:47], v2 offset:39936
    s_waitcnt lgkmcnt(3)
    v_mfma_f32_32x32x16_bf16 v[16:31], a[144:147], v[32:35], v[16:31]
    ds_read_b128 v[32:35], v2 offset:40960
    s_waitcnt lgkmcnt(3)
    v_mfma_f32_32x32x16_bf16 v[16:31], a[148:151], v[36:39], v[16:31]
    ds_read_b128 v[36:39], v2 offset:41984
    s_add_u32 m0, s64, 12288
    s_add_u32 s63, s71, 12288
    buffer_load_dwordx4 v1, s[4:7], s63 offen offset:0 sc1 lds
    s_waitcnt lgkmcnt(3)
    v_mfma_f32_32x32x16_bf16 v[16:31], a[152:155], v[40:43], v[16:31]
    ds_read_b128 v[40:43], v2 offset:43008
    s_waitcnt lgkmcnt(3)
    v_mfma_f32_32x32x16_bf16 v[16:31], a[156:159], v[44:47], v[16:31]
    ds_read_b128 v[44:47], v2 offset:44032
    s_waitcnt lgkmcnt(3)
    v_mfma_f32_32x32x16_bf16 v[16:31], a[160:163], v[32:35], v[16:31]
    ds_read_b128 v[32:35], v2 offset:45056
    buffer_load_dwordx4 v1, s[4:7], s63 offen offset:1024 sc1 lds
    s_add_u32 s71, s71, 110592
    s_add_u32 s70, s70, 55296
    s_cmp_ge_u32 s70, 110592
    s_cselect_b32 s70, 0, s70
    s_waitcnt lgkmcnt(3)
    v_mfma_f32_32x32x16_bf16 v[16:31], a[164:167], v[36:39], v[16:31]
    ds_read_b128 v[36:39], v2 offset:46080
    s_waitcnt lgkmcnt(3)
    v_mfma_f32_32x32x16_bf16 v[16:31], a[168:171], v[40:43], v[16:31]
    ds_read_b128 v[40:43], v2 offset:47104
    s_waitcnt lgkmcnt(3)
    v_mfma_f32_32x32x16_bf16 v[16:31], a[172:175], v[44:47], v[16:31]
    ds_read_b128 v[44:47], v2 offset:48128
    s_waitcnt lgkmcnt(3)
    v_mfma_f32_32x32x16_bf16 v[16:31], a[176:179], v[32:35], v[16:31]
    ds_read_b128 v[32:35], v2 offset:49152
    s_waitcnt lgkmcnt(3)
    v_mfma_f32_32x32x16_bf16 v[16:31], a[180:183], v[36:39], v[16:31]
    ds_read_b128 v[36:39], v2 offset:50176
    s_waitcnt lgkmcnt(3)
    v_mfma_f32_32x32x16_bf16 v[16:31], a[184:187], v[40:43], v[16:31]
    ds_read_b128 v[40:43], v2 offset:51200
    s_waitcnt lgkmcnt(3)
    v_mfma_f32_32x32x16_bf16 v[16:31], a[188:191], v[44:47], v[16:31]
    ds_read_b128 v[44:47], v2 offset:52224
    s_waitcnt lgkmcnt(3)
    v_mfma_f32_32x32x16_bf16 v[16:31], a[192:195], v[32:35], v[16:31]
    ds_read_b128 v[32:35], v2 offset:53248
    s_waitcnt lgkmcnt(3)
    v_mfma_f32_32x32x16_bf16 v[16:31], a[196:199], v[36:39], v[16:31]
    ds_read_b128 v[36:39], v2 offset:54272
    s_waitcnt lgkmcnt(3)
    v_mfma_f32_32x32x16_bf16 v[16:31], a[200:203], v[40:43], v[16:31]
    s_waitcnt lgkmcnt(2)
    v_mfma_f32_32x32x16_bf16 v[16:31], a[204:207], v[44:47], v[16:31]
    s_waitcnt lgkmcnt(1)
    v_mfma_f32_32x32x16_bf16 v[16:31], a[208:211], v[32:35], v[16:31]
    s_waitcnt lgkmcnt(0)
    v_mfma_f32_32x32x16_bf16 v[16:31], a[212:215], v[36:39], v[16:31]
    s_add_u32 s74, s74, 55296
    s_cmp_ge_u32 s74, 110592
    s_cselect_b32 s74, 0, s74
    s_nop 8
    buffer_store_dwordx4 v[16:19], v1, s[4:7], s72 offen offset:0 sc1
    buffer_store_dwordx4 v[20:23], v1, s[4:7], s72 offen offset:1024 sc1
    buffer_store_dwordx4 v[24:27], v1, s[4:7], s72 offen offset:2048 sc1
    buffer_store_dwordx4 v[28:31], v1, s[4:7], s72 offen offset:3072 sc1
    s_add_u32 s72, s72, 163840
    s_add_u32 s61, s61, 1
    s_waitcnt vmcnt(4)
    s_cmp_lt_u32 s61, 64
    s_cbranch_scc1 L_DP_LOOP
    s_waitcnt vmcnt(0)
    s_barrier
    s_cmp_lg_u32 s44, 0
    s_cbranch_scc1 L_END
    v_mov_b32 v8, 0
    v_mov_b32 v9, 64
    s_mov_b64 exec, 1
    buffer_store_dword v9, v8, s[4:7], s73 offen sc1
    s_mov_b64 exec, -1
    s_branch L_END2
L_CB:
    v_mov_b32 v4, -1
    v_mov_b32 v5, -1
    v_mov_b32 v6, -1
    v_mov_b32 v7, -1
    v_lshlrev_b32 v1, 4, v0
    s_sub_u32 s62, s46, 20
L_hi_195:
    s_lshl_b32 s63, s62, 12
    s_add_u32 s63, s63, 0x6600000
    buffer_store_dwordx4 v[4:7], v1, s[4:7], s63 offen sc1
    s_add_u32 s62, s62, 10
    s_cmp_lt_u32 s62, 160
    s_cbranch_scc1 L_hi_195
    s_sub_u32 s62, s46, 20
L_hi_196:
    s_lshl_b32 s63, s62, 12
    s_add_u32 s63, s63, 0x6700000
    buffer_store_dwordx4 v[4:7], v1, s[4:7], s63 offen sc1
    s_add_u32 s62, s62, 10
    s_cmp_lt_u32 s62, 16
    s_cbranch_scc1 L_hi_196
    s_sub_u32 s62, s46, 20
L_hi_197:
    s_lshl_b32 s63, s62, 12
    s_add_u32 s63, s63, 0x7200000
    buffer_store_dwordx4 v[4:7], v1, s[4:7], s63 offen sc1
    s_add_u32 s62, s62, 10
    s_cmp_lt_u32 s62, 512
    s_cbranch_scc1 L_hi_197
    s_waitcnt vmcnt(0)
    s_barrier
    s_cmp_lg_u32 s44, 0
    s_cbranch_scc1 L_hd_198
    s_add_u32 s63, s46, 236
    s_lshl_b32 s63, s63, 6
    v_mov_b32 v8, 0
    v_mov_b32 v9, 1
    s_mov_b64 exec, 1
    buffer_store_dword v9, v8, s[4:7], s63 offen sc1
    s_mov_b64 exec, -1
L_hd_198:
    v_bfe_u32 v1, v0, 0, 6
    v_lshlrev_b32 v1, 4, v1
    s_sub_u32 s62, s46, 20
    s_lshl_b32 s75, s62, 1
    s_lshr_b32 s63, s44, 1
    s_add_u32 s75, s75, s63
    s_and_b32 s76, s44, 1
    s_mov_b32 s8, s16
    s_and_b32 s9, s17, 0xffff
    s_mov_b32 s10, 0x280000
    s_mov_b32 s11, 0x20000
    s_mov_b32 s12, s38
    s_and_b32 s13, s39, 0xffff
    s_mov_b32 s14, 0x280000
    s_mov_b32 s15, 0x20000
    s_lshl_b32 s77, s75, 12
    s_lshl_b32 s62, s76, 11
    s_add_u32 s77, s77, s62
    s_add_u32 s78, s77, 0x5000000
    s_add_u32 s77, s77, 0x3c00000
    s_lshl_b32 s79, s75, 6
    s_lshl_b32 s62, s76, 5
    s_add_u32 s79, s79, s62
    v_bfe_u32 v3, v0, 0, 5
    v_mul_u32_u24 v3, 0x500, v3
    v_bfe_u32 v8, v0, 5, 1
    v_lshl_add_u32 v3, v8, 4, v3
    s_lshr_b32 s62, s75, 2
    v_and_b32 v8, 3, v0
    v_mul_u32_u24 v10, 5, v8
    v_add_u32 v10, s62, v10
    v_add_u32 v11, 212, v10
    v_add_u32 v10, 192, v10
    v_and_b32 v8, 1, v0
    v_mul_u32_u24 v12, 5, v8
    v_add_u32 v12, s62, v12
    v_add_u32 v12, 232, v12
    v_lshlrev_b32 v10, 6, v10
    v_lshlrev_b32 v11, 6, v11
    v_lshlrev_b32 v12, 6, v12
    s_mov_b32 s61, 0
    s_mov_b32 s68, 0
L_CB_LOOP:
    s_add_u32 s69, s61, 1
    s_cmp_ge_u32 s68, s69
    s_cbranch_scc1 L_hv_199
    s_mov_b32 s60, 0
L_pf_200:
    buffer_load_dword v9, v12, s[4:7], 0 offen sc1
    s_waitcnt vmcnt(0)
    v_cmp_gt_u32 vcc, s69, v9
    s_nop 0
    s_cbranch_vccz L_pfd_201
    s_sleep 1
    s_add_u32 s60, s60, 1
    s_cmp_lt_u32 s60, 0x100000
    s_cbranch_scc1 L_pf_200
    s_movk_i32 s62, 17
    s_branch L_ABORT
L_pfd_201:
    v_readlane_b32 s68, v9, 0
    v_readlane_b32 s62, v9, 1
    s_nop 0
    s_min_u32 s68, s68, s62
L_hv_199:
    s_add_u32 s62, s78, 0
    s_nop 1
    buffer_load_dwordx4 v[48:51], v1, s[4:7], s62 offen offset:0 sc1
    buffer_load_dwordx4 v[52:55], v1, s[4:7], s62 offen offset:1024 sc1
    s_add_u32 s62, s78, 81920
    buffer_load_dwordx4 v[56:59], v1, s[4:7], s62 offen offset:0 sc1
    buffer_load_dwordx4 v[60:63], v1, s[4:7], s62 offen offset:1024 sc1
    buffer_load_dwordx4 v[64:67], v3, s[8:11], s79 offen
    s_mov_b32 s60, 0
L_pf_202:
    buffer_load_dword v9, v10, s[4:7], 0 offen sc1
    s_waitcnt vmcnt(0)
    v_cmp_gt_u32 vcc, s69, v9
    s_nop 0
    s_cbranch_vccz L_pfd_203
    s_sleep 1
    s_add_u32 s60, s60, 1
    s_cmp_lt_u32 s60, 0x100000
    s_cbranch_scc1 L_pf_202
    s_movk_i32 s62, 8
    s_branch L_ABORT
L_pfd_203:
    s_add_u32 s62, s77, 0
    buffer_load_dwordx4 v[16:19], v1, s[4:7], s62 offen offset:0 sc1
    buffer_load_dwordx4 v[20:23], v1, s[4:7], s62 offen offset:1024 sc1
    s_add_u32 s62, s77, 81920
    buffer_load_dwordx4 v[24:27], v1, s[4:7], s62 offen offset:0 sc1
    buffer_load_dwordx4 v[28:31], v1, s[4:7], s62 offen offset:1024 sc1
    s_add_u32 s62, s77, 163840
    buffer_load_dwordx4 v[32:35], v1, s[4:7], s62 offen offset:0 sc1
    buffer_load_dwordx4 v[36:39], v1, s[4:7], s62 offen offset:1024 sc1
    s_add_u32 s62, s77, 245760
    buffer_load_dwordx4 v[40:43], v1, s[4:7], s62 offen offset:0 sc1
    buffer_load_dwordx4 v[44:47], v1, s[4:7], s62 offen offset:1024 sc1
    v_mov_b32 v8, v10
    v_mov_b32 v10, v11
    v_mov_b32 v11, v8
    v_pk_add_f32 v[48:49], v[48:49], v[56:57]
    v_pk_add_f32 v[50:51], v[50:51], v[58:59]
    v_pk_add_f32 v[52:53], v[52:53], v[60:61]
    v_pk_add_f32 v[54:55], v[54:55], v[62:63]
    v_cvt_pk_bf16_f32 v72, v48, v49
    v_cvt_pk_bf16_f32 v73, v50, v51
    v_cvt_pk_bf16_f32 v74, v52, v53
    v_cvt_pk_bf16_f32 v75, v54, v55
    v_lshlrev_b32 v48, 16, v72
    v_and_b32 v49, 0xffff0000, v72
    v_lshlrev_b32 v50, 16, v73
    v_and_b32 v51, 0xffff0000, v73
    v_lshlrev_b32 v52, 16, v74
    v_and_b32 v53, 0xffff0000, v74
    v_lshlrev_b32 v54, 16, v75
    v_and_b32 v55, 0xffff0000, v75
    v_mul_f32 v72, 0xbfb8aa3b, v48
    v_mul_f32 v73, 0xbfb8aa3b, v49
    v_mul_f32 v74, 0xbfb8aa3b, v50
    v_mul_f32 v75, 0xbfb8aa3b, v51
    v_mul_f32 v76, 0xbfb8aa3b, v52
    v_mul_f32 v77, 0xbfb8aa3b, v53
    v_mul_f32 v78, 0xbfb8aa3b, v54
    v_mul_f32 v79, 0xbfb8aa3b, v55
    v_exp_f32 v72, v72
    v_exp_f32 v73, v73
    v_exp_f32 v74, v74
    v_exp_f32 v75, v75
    v_exp_f32 v76, v76
    v_exp_f32 v77, v77
    v_exp_f32 v78, v78
    v_exp_f32 v79, v79
    v_add_f32 v72, 1.0, v72
    v_add_f32 v73, 1.0, v73
    v_add_f32 v74, 1.0, v74
    v_add_f32 v75, 1.0, v75
    v_add_f32 v76, 1.0, v76
    v_add_f32 v77, 1.0, v77
    v_add_f32 v78, 1.0, v78
    v_add_f32 v79, 1.0, v79
    v_rcp_f32 v72, v72
    v_rcp_f32 v73, v73
    v_rcp_f32 v74, v74
    v_rcp_f32 v75, v75
    v_rcp_f32 v76, v76
    v_rcp_f32 v77, v77
    v_rcp_f32 v78, v78
    v_rcp_f32 v79, v79
    v_mul_f32 v48, v48, v72
    v_mul_f32 v49, v49, v73
    v_mul_f32 v50, v50, v74
    v_mul_f32 v51, v51, v75
    v_mul_f32 v52, v52, v76
    v_mul_f32 v53, v53, v77
    v_mul_f32 v54, v54, v78
    v_mul_f32 v55, v55, v79
    v_cvt_pk_bf16_f32 v72, v48, v49
    v_cvt_pk_bf16_f32 v73, v50, v51
    v_cvt_pk_bf16_f32 v74, v52, v53
    v_cvt_pk_bf16_f32 v75, v54, v55
    v_lshlrev_b32 v48, 16, v72
    v_and_b32 v49, 0xffff0000, v72
    v_lshlrev_b32 v50, 16, v73
    v_and_b32 v51, 0xffff0000, v73
    v_lshlrev_b32 v52, 16, v74
    v_and_b32 v53, 0xffff0000, v74
    v_lshlrev_b32 v54, 16, v75
    v_and_b32 v55, 0xffff0000, v75
    s_waitcnt vmcnt(0)
    v_pk_add_f32 v[16:17], v[16:17], v[24:25]
    v_pk_add_f32 v[32:33], v[32:33], v[40:41]
    v_pk_add_f32 v[18:19], v[18:19], v[26:27]
    v_pk_add_f32 v[34:35], v[34:35], v[42:43]
    v_pk_add_f32 v[20:21], v[20:21], v[28:29]
    v_pk_add_f32 v[36:37], v[36:37], v[44:45]
    v_pk_add_f32 v[22:23], v[22:23], v[30:31]
    v_pk_add_f32 v[38:39], v[38:39], v[46:47]
    v_pk_add_f32 v[16:17], v[16:17], v[32:33]
    v_pk_add_f32 v[18:19], v[18:19], v[34:35]
    v_pk_add_f32 v[20:21], v[20:21], v[36:37]
    v_pk_add_f32 v[22:23], v[22:23], v[38:39]
    v_cvt_pk_bf16_f32 v72, v16, v17
    v_cvt_pk_bf16_f32 v73, v18, v19
    v_cvt_pk_bf16_f32 v74, v20, v21
    v_cvt_pk_bf16_f32 v75, v22, v23
    v_lshlrev_b32 v16, 16, v72
    v_and_b32 v17, 0xffff0000, v72
    v_lshlrev_b32 v18, 16, v73
    v_and_b32 v19, 0xffff0000, v73
    v_lshlrev_b32 v20, 16, v74
    v_and_b32 v21, 0xffff0000, v74
    v_lshlrev_b32 v22, 16, v75
    v_and_b32 v23, 0xffff0000, v75
    v_mul_f32 v16, v16, v48
    v_mul_f32 v17, v17, v49
    v_mul_f32 v18, v18, v50
    v_mul_f32 v19, v19, v51
    v_mul_f32 v20, v20, v52
    v_mul_f32 v21, v21, v53
    v_mul_f32 v22, v22, v54
    v_mul_f32 v23, v23, v55
    v_cvt_pk_bf16_f32 v72, v16, v17
    v_cvt_pk_bf16_f32 v73, v18, v19
    v_cvt_pk_bf16_f32 v74, v20, v21
    v_cvt_pk_bf16_f32 v75, v22, v23
    s_nop 0
    v_permlane32_swap_b32 v72, v74
    s_nop 0
    v_permlane32_swap_b32 v73, v75
    v_lshlrev_b32 v16, 16, v72
    v_and_b32 v17, 0xffff0000, v72
    v_lshlrev_b32 v48, 16, v64
    v_and_b32 v49, 0xffff0000, v64
    v_lshlrev_b32 v18, 16, v73
    v_and_b32 v19, 0xffff0000, v73
    v_lshlrev_b32 v50, 16, v65
    v_and_b32 v51, 0xffff0000, v65
    v_lshlrev_b32 v20, 16, v74
    v_and_b32 v21, 0xffff0000, v74
    v_lshlrev_b32 v52, 16, v66
    v_and_b32 v53, 0xffff0000, v66
    v_lshlrev_b32 v22, 16, v75
    v_and_b32 v23, 0xffff0000, v75
    v_lshlrev_b32 v54, 16, v67
    v_and_b32 v55, 0xffff0000, v67
    v_pk_add_f32 v[16:17], v[16:17], v[48:49]
    v_pk_add_f32 v[18:19], v[18:19], v[50:51]
    v_pk_add_f32 v[20:21], v[20:21], v[52:53]
    v_pk_add_f32 v[22:23], v[22:23], v[54:55]
    v_cvt_pk_bf16_f32 v76, v16, v17
    v_cvt_pk_bf16_f32 v77, v18, v19
    v_cvt_pk_bf16_f32 v78, v20, v21
    v_cvt_pk_bf16_f32 v79, v22, v23
    buffer_store_dwordx4 v[76:79], v3, s[12:15], s79 offen
    s_add_u32 s77, s77, 327680
    s_add_u32 s78, s78, 163840
    s_add_u32 s79, s79, 40960
    s_add_u32 s61, s61, 1
    s_cmp_lt_u32 s61, 64
    s_cbranch_scc1 L_CB_LOOP
    s_branch L_END2
L_CODE_END:
.section .rodata,"a"
.p2align 6
.amdhsa_kernel recurrent_scan__memory_aug_recurrent_mem_tr__geglu_ffn__prompt_kernel
  .amdhsa_next_free_vgpr 512
  .amdhsa_next_free_sgpr 102
  .amdhsa_accum_offset 256
  .amdhsa_group_segment_fixed_size 0
  .amdhsa_kernarg_size 112
  .amdhsa_user_sgpr_count 2
  .amdhsa_user_sgpr_kernarg_segment_ptr 1
  .amdhsa_system_sgpr_workgroup_id_x 1
  .amdhsa_float_denorm_mode_32 3
.end_amdhsa_kernel
```
